```python
import torch

def _softmax(x, axis=-1):
    return torch.softmax(x, dim=axis)

def _gelu(x):
    return torch.nn.functional.gelu(x, approximate='tanh')

def _silu(x):
    return torch.nn.functional.silu(x)

def _sigmoid(x):
    return torch.sigmoid(x)

def _layernorm(x, axis=-1, eps=1e-05):
    m = x.mean(dim=axis, keepdim=True)
    v = x.var(dim=axis, keepdim=True, unbiased=False)
    return (x - m) / torch.sqrt(v + eps)

def _scatter_add(tgt, idx, src, axis=0):
    return tgt.clone().index_add_(axis, idx, src)

def _segment_sum(src, seg, n):
    out = torch.zeros((n,) + src.shape[1:], dtype=src.dtype)
    return out.index_add_(0, seg, src)

def _pad(x, pw):
    flat = tuple((v for pair in reversed(pw) for v in pair))
    return torch.nn.functional.pad(x, flat)
kernel_name = 'adaLN_cond__sliding_block_cached__glu_gated_bilinear__prompt'

def setup_inputs():

    _w = lambda a: (lambda t: t.to(torch.bfloat16) if t.is_floating_point() else t)(torch.as_tensor(a))

    def _A_setup():
        B, Sq, D = (1, 2048, 640)
        Hq, Hkv, Sk, Dh = (32, 32, 2048, 128)
        assert Hq % Hkv == 0, (Hq, Hkv)
        return {'x': _w((lambda *s: torch.randn(*s, dtype=torch.bfloat16) * 0.05)(B, Sq, D)), 'k_cache': _w((lambda *s: torch.randn(*s, dtype=torch.bfloat16) * 1.6)(B, Hkv, Sk, Dh)), 'v_cache': _w((lambda *s: torch.randn(*s, dtype=torch.bfloat16) * 0.8)(B, Hkv, Sk, Dh)), 'wq': _w((lambda *s: torch.randn(*s, dtype=torch.bfloat16) * 1.6)(D, Hq * Dh) * D ** (-0.5)), 'wo': _w((lambda *s: torch.randn(*s, dtype=torch.bfloat16) * 0.8)(Hq * Dh, D) * (Hq * Dh) ** (-0.5))}
    _A_in = _A_setup()

    def _B_setup():
        B, S, D, F = (1, 2048, 640, 1728)
        return {'x': _w((lambda *s: torch.randn(*s, dtype=torch.bfloat16) * 0.05)(B, S, D)), 'w_gate': _w((lambda *s: torch.randn(*s, dtype=torch.bfloat16) * 0.4)(D, F) * D ** (-0.5)), 'w_up': _w((lambda *s: torch.randn(*s, dtype=torch.bfloat16) * 0.4)(D, F) * D ** (-0.5)), 'w_down': _w((lambda *s: torch.randn(*s, dtype=torch.bfloat16) * 0.4)(F, D) * F ** (-0.5))}
    _B_in = _B_setup()
    return {'A_x': _A_in['x'], 'A_k_cache': _A_in['k_cache'], 'A_v_cache': _A_in['v_cache'], 'A_wq': _A_in['wq'], 'A_wo': _A_in['wo'], 'B_x': _B_in['x'], 'B_w_gate': _B_in['w_gate'], 'B_w_up': _B_in['w_up'], 'B_w_down': _B_in['w_down'], 'c': _w((lambda *s: torch.randn(*s, dtype=torch.bfloat16) * 0.2)(1, 640) * 8.0), 'w_mod': _w((lambda *s: torch.randn(*s, dtype=torch.bfloat16) * 0.2)(640, 6 * 640) * 640 ** (-0.5) * 8.0)}

def reference(A_x, A_k_cache, A_v_cache, A_wq, A_wo, B_x, B_w_gate, B_w_up, B_w_down, c, w_mod):

    def _A_ref(x, k_cache, v_cache, wq, wo):
        B, Sq, D = x.shape
        Hq, Dh = (32, 128)
        Hkv, Sk = (k_cache.shape[1], k_cache.shape[2])
        W = min(4096, max(256, Sk // 4))
        rep = Hq // Hkv
        q = (lambda x, *d: x.permute(*d))((x @ wq).reshape(B, Sq, Hq, Dh), 0, 2, 1, 3)
        k = (lambda x, n, axis: torch.repeat_interleave(x, n, dim=axis))(k_cache[:, :, Sk - W:, :], rep, axis=1)
        v = (lambda x, n, axis: torch.repeat_interleave(x, n, dim=axis))(v_cache[:, :, Sk - W:, :], rep, axis=1)
        scores = torch.einsum('bhqd,bhkd->bhqk', q, k) * Dh ** (-0.5)
        p = _softmax(scores, axis=-1)
        o = torch.einsum('bhqk,bhkd->bhqd', p, v)
        return (lambda x, *d: x.permute(*d))(o, 0, 2, 1, 3).reshape(B, Sq, Hq * Dh) @ wo

    def _B_ref(x, w_gate, w_up, w_down):
        g = torch.einsum('bsd,df->bsf', x, w_gate)
        u = torch.einsum('bsd,df->bsf', x, w_up)
        h = g * u
        return torch.einsum('bsf,fd->bsd', h, w_down)
    x = A_x
    mod = (_silu(c) @ w_mod).reshape(c.shape[0], 6, 1, -1)
    sa, ca, ga, sb, cb, gb = (mod[:, 0].clone(), mod[:, 1].clone(), mod[:, 2].clone(), mod[:, 3].clone(), mod[:, 4].clone(), mod[:, 5].clone())
    h = _layernorm(x, axis=-1) * (1 + ca) + sa
    x = x + ga * _A_ref(h, A_k_cache, A_v_cache, A_wq, A_wo)
    h = _layernorm(x, axis=-1) * (1 + cb) + sb
    x = x + gb * _B_ref(h, B_w_gate, B_w_up, B_w_down)
    return x
```

```asm
; @launch grid=(256,1,1) block=(256,1,1) lds=163840
.amdgcn_target "amdgcn-amd-amdhsa--gfx950"
.text
.globl adaLN_cond__sliding_block_cached__glu_gated_bilinear__prompt_kernel
.p2align 8
.type adaLN_cond__sliding_block_cached__glu_gated_bilinear__prompt_kernel,@function
adaLN_cond__sliding_block_cached__glu_gated_bilinear__prompt_kernel:
    s_cmp_ge_u32 s2, 256
    s_cbranch_scc1 L_end
    s_load_dwordx2 s[32:33], s[0:1], 72
    s_mov_b32 s34, 1280
    s_mov_b32 s35, 0x20000
    s_load_dwordx2 s[40:41], s[0:1], 0
    s_mov_b32 s42, 2621440
    s_mov_b32 s43, 0x20000
    s_load_dwordx2 s[28:29], s[0:1], 80
    s_mov_b32 s30, 4915200
    s_mov_b32 s31, 0x20000
    s_load_dwordx2 s[8:9], s[0:1], 104
    s_mov_b32 s10, 268435456
    s_mov_b32 s11, 0x20000
    s_load_dwordx2 s[12:13], s[0:1], 24
    s_mov_b32 s14, 5242880
    s_mov_b32 s15, 0x20000
    s_load_dwordx2 s[16:17], s[0:1], 8
    s_mov_b32 s18, 16777216
    s_mov_b32 s19, 0x20000
    s_load_dwordx2 s[20:21], s[0:1], 16
    s_mov_b32 s22, 16777216
    s_mov_b32 s23, 0x20000
    s_load_dwordx2 s[24:25], s[0:1], 32
    s_mov_b32 s26, 5242880
    s_mov_b32 s27, 0x20000
    s_load_dwordx2 s[36:37], s[0:1], 64
    s_mov_b32 s38, 2211840
    s_mov_b32 s39, 0x20000
    s_load_dwordx2 s[44:45], s[0:1], 88
    s_mov_b32 s46, 2621440
    s_mov_b32 s47, 0x20000
    s_getpc_b64 s[94:95]
L_pc:
    s_sub_u32 s94, s94, L_pc - adaLN_cond__sliding_block_cached__glu_gated_bilinear__prompt_kernel
    s_subb_u32 s95, s95, 0
    v_lshlrev_b32 v252, 5, v0
    global_load_dword v251, v252, s[94:95]
    s_and_b32 s4, s2, 7
    s_lshr_b32 s5, s2, 3
    s_lshl_b32 s59, s4, 5
    s_add_u32 s59, s59, s5
    v_lshrrev_b32 v4, 6, v0
    v_and_b32 v1, 63, v0
    v_readfirstlane_b32 s3, v4
    s_mul_i32 s76, s2, 1093
    s_lshr_b32 s76, s76, 16
    s_mul_i32 s77, s76, 60
    s_sub_u32 s77, s2, s77
    v_and_b32 v5, 7, v0
    v_lshrrev_b32 v6, 3, v0
    v_mul_u32_u24 v7, 7680, v6
    v_lshl_add_u32 v7, v5, 4, v7
    v_lshlrev_b32 v8, 1, v6
    v_mul_u32_u24 v10, 1280, v5
    v_lshl_add_u32 v9, v6, 4, v10
    v_lshl_add_u32 v10, v6, 3, v10
    s_mul_i32 s66, s76, 1228800
    s_lshl_b32 s67, s77, 7
    s_add_u32 s66, s66, s67
    s_mul_i32 s67, s76, 320
    s_mul_i32 s68, s59, 10240
    s_waitcnt lgkmcnt(0)
    buffer_load_ushort v76, v8, s[32:35], s67 offen offset:0
    buffer_load_ushort v77, v8, s[32:35], s67 offen offset:64
    buffer_load_ushort v78, v8, s[32:35], s67 offen offset:128
    buffer_load_ushort v79, v8, s[32:35], s67 offen offset:192
    buffer_load_ushort v80, v8, s[32:35], s67 offen offset:256
    buffer_load_dwordx4 v[240:243], v9, s[40:43], s68 offen nt
    buffer_load_dwordx4 v[244:247], v9, s[40:43], s68 offen offset:512 nt
    buffer_load_dwordx2 v[248:249], v10, s[40:43], s68 offen offset:1024 nt
    buffer_load_dwordx4 v[56:59], v7, s[28:31], s66 offen nt
    s_add_u32 s66, s66, 245760
    buffer_load_dwordx4 v[60:63], v7, s[28:31], s66 offen nt
    s_add_u32 s66, s66, 245760
    buffer_load_dwordx4 v[64:67], v7, s[28:31], s66 offen nt
    s_add_u32 s66, s66, 245760
    buffer_load_dwordx4 v[68:71], v7, s[28:31], s66 offen nt
    s_add_u32 s66, s66, 245760
    buffer_load_dwordx4 v[72:75], v7, s[28:31], s66 offen nt
    s_load_dword s97, s[8:9], 49152
    s_load_dwordx2 s[28:29], s[0:1], 48
    s_mov_b32 s30, 2211840
    s_mov_b32 s31, 0x20000
    s_load_dwordx2 s[32:33], s[0:1], 56
    s_mov_b32 s34, 2211840
    s_mov_b32 s35, 0x20000
    v_mul_u32_u24 v144, 272, v6
    v_lshl_add_u32 v144, v5, 5, v144
    v_add_u32 v144, 131072, v144
    s_and_b32 s87, s4, 3
    s_lshl_b32 s87, s87, 3
    s_and_b32 s64, s5, 7
    s_add_u32 s87, s87, s64
    s_and_b32 s86, s4, 4
    s_lshr_b32 s64, s5, 3
    s_add_u32 s86, s86, s64
    s_lshl_b32 s63, s2, 2
    s_add_u32 s63, s63, s3
    s_lshl_b32 s49, s3, 12
    s_lshl_b32 s51, s87, 8
    v_lshrrev_b32 v4, 4, v1
    v_lshlrev_b32 v5, 2, v4
    v_xor_b32 v5, v5, v1
    v_and_b32 v5, 15, v5
    v_lshl_add_u32 v4, s3, 4, v4
    v_mul_u32_u24 v4, 8192, v4
    v_xor_b32 v28, 0, v5
    v_lshl_add_u32 v28, v28, 4, v4
    v_xor_b32 v29, 1, v5
    v_lshl_add_u32 v29, v29, 4, v4
    v_add_u32 v29, 31744, v29
    v_xor_b32 v30, 2, v5
    v_lshl_add_u32 v30, v30, 4, v4
    v_add_u32 v30, 63488, v30
    v_xor_b32 v31, 3, v5
    v_lshl_add_u32 v31, v31, 4, v4
    v_add_u32 v31, 95232, v31
    v_and_b32 v145, 3, v0
    v_mul_u32_u24 v145, 272, v145
    v_and_b32 v146, 0xfc, v0
    v_add_u32 v145, v145, v146
    v_add_u32 v145, 131072, v145
    v_lshrrev_b32 v4, 4, v0
    v_lshlrev_b32 v132, 10, v4
    v_bfe_u32 v4, v0, 3, 1
    v_lshl_add_u32 v132, v4, 9, v132
    v_and_b32 v5, 7, v0
    v_lshl_add_u32 v132, v5, 4, v132
    v_lshrrev_b32 v133, 5, v0
    v_lshlrev_b32 v133, 10, v133
    v_lshl_add_u32 v133, v4, 3, v133
    v_bfe_u32 v4, v0, 4, 1
    v_lshl_add_u32 v133, v4, 9, v133
    v_lshl_add_u32 v133, v5, 4, v133
    v_lshlrev_b32 v134, 5, v5
    v_add_u32 v134, 147008, v134
    v_lshl_add_u32 v135, s3, 3, v134
    s_lshr_b32 s64, s59, 2
    s_mul_i32 s64, s64, 40960
    s_and_b32 s65, s5, 3
    s_lshl_b32 s65, s65, 7
    s_add_u32 s64, s64, s65
    s_add_u32 s73, s64, 1048576
    s_add_u32 s74, s73, 16384
    s_add_u32 s75, s73, 32768
    s_waitcnt vmcnt(12)
    v_lshlrev_b32 v76, 16, v76
    v_mul_f32 v112, 0xbfb8aa3b, v76
    s_waitcnt vmcnt(11)
    v_lshlrev_b32 v77, 16, v77
    v_mul_f32 v113, 0xbfb8aa3b, v77
    s_waitcnt vmcnt(10)
    v_lshlrev_b32 v78, 16, v78
    v_mul_f32 v114, 0xbfb8aa3b, v78
    s_waitcnt vmcnt(9)
    v_lshlrev_b32 v79, 16, v79
    v_mul_f32 v115, 0xbfb8aa3b, v79
    s_waitcnt vmcnt(8)
    v_lshlrev_b32 v80, 16, v80
    v_mul_f32 v116, 0xbfb8aa3b, v80
    v_exp_f32 v112, v112
    v_exp_f32 v113, v113
    v_exp_f32 v114, v114
    v_exp_f32 v115, v115
    v_exp_f32 v116, v116
    v_add_f32 v112, 1.0, v112
    v_add_f32 v113, 1.0, v113
    v_add_f32 v114, 1.0, v114
    v_add_f32 v115, 1.0, v115
    v_add_f32 v116, 1.0, v116
    v_rcp_f32 v112, v112
    v_rcp_f32 v113, v113
    v_rcp_f32 v114, v114
    v_rcp_f32 v115, v115
    v_rcp_f32 v116, v116
    v_mul_f32 v76, v76, v112
    v_mul_f32 v77, v77, v113
    v_mul_f32 v78, v78, v114
    v_mul_f32 v79, v79, v115
    v_mul_f32 v80, v80, v116
    v_cvt_pk_bf16_f32 v76, v76, v76
    v_lshlrev_b32 v76, 16, v76
    v_cvt_pk_bf16_f32 v77, v77, v77
    v_lshlrev_b32 v77, 16, v77
    v_cvt_pk_bf16_f32 v78, v78, v78
    v_lshlrev_b32 v78, 16, v78
    v_cvt_pk_bf16_f32 v79, v79, v79
    v_lshlrev_b32 v79, 16, v79
    v_cvt_pk_bf16_f32 v80, v80, v80
    v_lshlrev_b32 v80, 16, v80
    s_waitcnt vmcnt(7)
    v_lshlrev_b32 v92, 16, v240
    v_and_b32 v93, 0xffff0000, v240
    v_lshlrev_b32 v94, 16, v241
    v_and_b32 v95, 0xffff0000, v241
    v_lshlrev_b32 v96, 16, v242
    v_and_b32 v97, 0xffff0000, v242
    v_lshlrev_b32 v98, 16, v243
    v_and_b32 v99, 0xffff0000, v243
    s_waitcnt vmcnt(6)
    v_lshlrev_b32 v100, 16, v244
    v_and_b32 v101, 0xffff0000, v244
    v_lshlrev_b32 v102, 16, v245
    v_and_b32 v103, 0xffff0000, v245
    v_lshlrev_b32 v104, 16, v246
    v_and_b32 v105, 0xffff0000, v246
    v_lshlrev_b32 v106, 16, v247
    v_and_b32 v107, 0xffff0000, v247
    s_waitcnt vmcnt(5)
    v_lshlrev_b32 v108, 16, v248
    v_and_b32 v109, 0xffff0000, v248
    v_lshlrev_b32 v110, 16, v249
    v_and_b32 v111, 0xffff0000, v249
    v_pk_add_f32 v[4:5], v[92:93], v[94:95]
    v_pk_add_f32 v[4:5], v[4:5], v[96:97]
    v_pk_add_f32 v[4:5], v[4:5], v[98:99]
    v_pk_add_f32 v[4:5], v[4:5], v[100:101]
    v_pk_add_f32 v[4:5], v[4:5], v[102:103]
    v_pk_add_f32 v[4:5], v[4:5], v[104:105]
    v_pk_add_f32 v[4:5], v[4:5], v[106:107]
    v_pk_add_f32 v[4:5], v[4:5], v[108:109]
    v_pk_add_f32 v[4:5], v[4:5], v[110:111]
    v_add_f32 v4, v4, v5
    s_nop 1
    v_add_f32_dpp v4, v4, v4 row_ror:8 row_mask:0xf bank_mask:0xf
    v_mov_b32 v7, v4
    s_nop 1
    v_permlane16_swap_b32 v4, v7
    v_add_f32 v4, v4, v7
    v_mov_b32 v7, v4
    s_nop 1
    v_permlane32_swap_b32 v4, v7
    v_add_f32 v4, v4, v7
    v_mul_f32 v8, 0xbbcccccd, v4
    v_mov_b32 v9, v8
    v_pk_add_f32 v[112:113], v[92:93], v[8:9]
    v_pk_add_f32 v[114:115], v[94:95], v[8:9]
    v_pk_add_f32 v[116:117], v[96:97], v[8:9]
    v_pk_add_f32 v[118:119], v[98:99], v[8:9]
    v_pk_add_f32 v[120:121], v[100:101], v[8:9]
    v_pk_add_f32 v[122:123], v[102:103], v[8:9]
    v_pk_add_f32 v[124:125], v[104:105], v[8:9]
    v_pk_add_f32 v[126:127], v[106:107], v[8:9]
    v_pk_add_f32 v[128:129], v[108:109], v[8:9]
    v_pk_add_f32 v[130:131], v[110:111], v[8:9]
    v_pk_mul_f32 v[4:5], v[112:113], v[112:113]
    v_pk_fma_f32 v[4:5], v[114:115], v[114:115], v[4:5]
    v_pk_fma_f32 v[4:5], v[116:117], v[116:117], v[4:5]
    v_pk_fma_f32 v[4:5], v[118:119], v[118:119], v[4:5]
    v_pk_fma_f32 v[4:5], v[120:121], v[120:121], v[4:5]
    v_pk_fma_f32 v[4:5], v[122:123], v[122:123], v[4:5]
    v_pk_fma_f32 v[4:5], v[124:125], v[124:125], v[4:5]
    v_pk_fma_f32 v[4:5], v[126:127], v[126:127], v[4:5]
    v_pk_fma_f32 v[4:5], v[128:129], v[128:129], v[4:5]
    v_pk_fma_f32 v[4:5], v[130:131], v[130:131], v[4:5]
    v_add_f32 v9, v4, v5
    s_nop 1
    v_add_f32_dpp v9, v9, v9 row_ror:8 row_mask:0xf bank_mask:0xf
    v_mov_b32 v7, v9
    s_nop 1
    v_permlane16_swap_b32 v9, v7
    v_add_f32 v9, v9, v7
    v_mov_b32 v7, v9
    s_nop 1
    v_permlane32_swap_b32 v9, v7
    v_add_f32 v9, v9, v7
    ds_write_b64 v135, v[8:9]
    s_waitcnt vmcnt(4)
    v_lshlrev_b32 v4, 16, v56
    v_and_b32 v5, 0xffff0000, v56
    v_mul_f32 v84, v4, v76
    v_mul_f32 v85, v5, v76
    v_lshlrev_b32 v6, 16, v57
    v_and_b32 v7, 0xffff0000, v57
    v_mul_f32 v86, v6, v76
    v_mul_f32 v87, v7, v76
    v_lshlrev_b32 v4, 16, v58
    v_and_b32 v5, 0xffff0000, v58
    v_mul_f32 v88, v4, v76
    v_mul_f32 v89, v5, v76
    v_lshlrev_b32 v6, 16, v59
    v_and_b32 v7, 0xffff0000, v59
    v_mul_f32 v90, v6, v76
    v_mul_f32 v91, v7, v76
    s_waitcnt vmcnt(3)
    v_lshlrev_b32 v4, 16, v60
    v_and_b32 v5, 0xffff0000, v60
    v_fmac_f32 v84, v4, v77
    v_fmac_f32 v85, v5, v77
    v_lshlrev_b32 v6, 16, v61
    v_and_b32 v7, 0xffff0000, v61
    v_fmac_f32 v86, v6, v77
    v_fmac_f32 v87, v7, v77
    v_lshlrev_b32 v4, 16, v62
    v_and_b32 v5, 0xffff0000, v62
    v_fmac_f32 v88, v4, v77
    v_fmac_f32 v89, v5, v77
    v_lshlrev_b32 v6, 16, v63
    v_and_b32 v7, 0xffff0000, v63
    v_fmac_f32 v90, v6, v77
    v_fmac_f32 v91, v7, v77
    s_waitcnt vmcnt(2)
    v_lshlrev_b32 v4, 16, v64
    v_and_b32 v5, 0xffff0000, v64
    v_fmac_f32 v84, v4, v78
    v_fmac_f32 v85, v5, v78
    v_lshlrev_b32 v6, 16, v65
    v_and_b32 v7, 0xffff0000, v65
    v_fmac_f32 v86, v6, v78
    v_fmac_f32 v87, v7, v78
    v_lshlrev_b32 v4, 16, v66
    v_and_b32 v5, 0xffff0000, v66
    v_fmac_f32 v88, v4, v78
    v_fmac_f32 v89, v5, v78
    v_lshlrev_b32 v6, 16, v67
    v_and_b32 v7, 0xffff0000, v67
    v_fmac_f32 v90, v6, v78
    v_fmac_f32 v91, v7, v78
    s_waitcnt vmcnt(1)
    v_lshlrev_b32 v4, 16, v68
    v_and_b32 v5, 0xffff0000, v68
    v_fmac_f32 v84, v4, v79
    v_fmac_f32 v85, v5, v79
    v_lshlrev_b32 v6, 16, v69
    v_and_b32 v7, 0xffff0000, v69
    v_fmac_f32 v86, v6, v79
    v_fmac_f32 v87, v7, v79
    v_lshlrev_b32 v4, 16, v70
    v_and_b32 v5, 0xffff0000, v70
    v_fmac_f32 v88, v4, v79
    v_fmac_f32 v89, v5, v79
    v_lshlrev_b32 v6, 16, v71
    v_and_b32 v7, 0xffff0000, v71
    v_fmac_f32 v90, v6, v79
    v_fmac_f32 v91, v7, v79
    s_waitcnt vmcnt(0)
    v_lshlrev_b32 v4, 16, v72
    v_and_b32 v5, 0xffff0000, v72
    v_fmac_f32 v84, v4, v80
    v_fmac_f32 v85, v5, v80
    v_lshlrev_b32 v6, 16, v73
    v_and_b32 v7, 0xffff0000, v73
    v_fmac_f32 v86, v6, v80
    v_fmac_f32 v87, v7, v80
    v_lshlrev_b32 v4, 16, v74
    v_and_b32 v5, 0xffff0000, v74
    v_fmac_f32 v88, v4, v80
    v_fmac_f32 v89, v5, v80
    v_lshlrev_b32 v6, 16, v75
    v_and_b32 v7, 0xffff0000, v75
    v_fmac_f32 v90, v6, v80
    v_fmac_f32 v91, v7, v80
    ds_write_b128 v144, v[84:87]
    ds_write_b128 v144, v[88:91] offset:16
    s_waitcnt lgkmcnt(0)
    s_barrier
    ds_read_b32 v56, v145 offset:0
    ds_read_b32 v57, v145 offset:1088
    ds_read_b32 v58, v145 offset:2176
    ds_read_b32 v59, v145 offset:3264
    ds_read_b32 v60, v145 offset:4352
    ds_read_b32 v61, v145 offset:5440
    ds_read_b32 v62, v145 offset:6528
    ds_read_b32 v63, v145 offset:7616
    ds_read_b128 v[136:139], v134
    ds_read_b128 v[140:143], v134 offset:16
    s_waitcnt lgkmcnt(1)
    v_pk_add_f32 v[4:5], v[136:137], v[138:139]
    s_waitcnt lgkmcnt(0)
    v_pk_add_f32 v[8:9], v[140:141], v[142:143]
    v_pk_add_f32 v[4:5], v[4:5], v[8:9]
    v_mul_f32 v4, 0x3e800000, v4
    v_sub_f32 v136, v136, v4
    v_sub_f32 v138, v138, v4
    v_sub_f32 v140, v140, v4
    v_sub_f32 v142, v142, v4
    v_mul_f32 v8, v136, v136
    v_fmac_f32 v8, v138, v138
    v_fmac_f32 v8, v140, v140
    v_fmac_f32 v8, v142, v142
    v_fmac_f32 v5, 0x43200000, v8
    v_mov_b32 v8, 0x3727c5ac
    v_fmac_f32 v8, 0x3acccccd, v5
    v_rsq_f32 v8, v8
    v_mov_b32 v5, v4
    v_pk_add_f32 v[92:93], v[92:93], v[4:5]
    v_pk_add_f32 v[94:95], v[94:95], v[4:5]
    v_pk_add_f32 v[96:97], v[96:97], v[4:5]
    v_pk_add_f32 v[98:99], v[98:99], v[4:5]
    v_pk_add_f32 v[100:101], v[100:101], v[4:5]
    v_pk_add_f32 v[102:103], v[102:103], v[4:5]
    v_pk_add_f32 v[104:105], v[104:105], v[4:5]
    v_pk_add_f32 v[106:107], v[106:107], v[4:5]
    v_pk_add_f32 v[108:109], v[108:109], v[4:5]
    v_pk_add_f32 v[110:111], v[110:111], v[4:5]
    v_mov_b32 v9, v8
    v_pk_mul_f32 v[92:93], v[92:93], v[8:9]
    v_pk_mul_f32 v[94:95], v[94:95], v[8:9]
    v_pk_mul_f32 v[96:97], v[96:97], v[8:9]
    v_pk_mul_f32 v[98:99], v[98:99], v[8:9]
    v_pk_mul_f32 v[100:101], v[100:101], v[8:9]
    v_pk_mul_f32 v[102:103], v[102:103], v[8:9]
    v_pk_mul_f32 v[104:105], v[104:105], v[8:9]
    v_pk_mul_f32 v[106:107], v[106:107], v[8:9]
    v_pk_mul_f32 v[108:109], v[108:109], v[8:9]
    v_pk_mul_f32 v[110:111], v[110:111], v[8:9]
    v_cvt_pk_f16_f32 v112, v92, v93
    v_cvt_pk_f16_f32 v113, v94, v95
    v_cvt_pk_f16_f32 v114, v96, v97
    v_cvt_pk_f16_f32 v115, v98, v99
    v_cvt_pk_f16_f32 v116, v100, v101
    v_cvt_pk_f16_f32 v117, v102, v103
    v_cvt_pk_f16_f32 v118, v104, v105
    v_cvt_pk_f16_f32 v119, v106, v107
    v_cvt_pk_f16_f32 v120, v108, v109
    v_cvt_pk_f16_f32 v121, v110, v111
    buffer_store_dwordx4 v[112:115], v132, s[8:11], s73 offen sc0 sc1
    buffer_store_dwordx4 v[116:119], v132, s[8:11], s74 offen sc0 sc1
    buffer_store_dwordx2 v[120:121], v133, s[8:11], s75 offen sc0 sc1
    v_add_f32 v56, v56, v57
    v_add_f32 v58, v58, v59
    v_add_f32 v60, v60, v61
    v_add_f32 v62, v62, v63
    v_add_f32 v56, v56, v58
    v_add_f32 v60, v60, v62
    v_add_f32 v56, v56, v60
    s_nop 1
    v_add_f32_dpp v57, v56, v56 quad_perm:[1,0,3,2] row_mask:0xf bank_mask:0xf
    s_nop 1
    v_add_f32_dpp v58, v57, v57 quad_perm:[2,3,0,1] row_mask:0xf bank_mask:0xf
    s_mul_i32 s66, s76, 15360
    s_lshl_b32 s67, s77, 8
    s_add_u32 s66, s66, s67
    s_add_u32 s66, s66, 65536
    buffer_store_dword v58, v146, s[8:11], s66 offen sc0 sc1
    s_add_u32 m0, s49, 0
    s_add_u32 s62, s51, 0
    buffer_load_dwordx4 v28, s[12:15], s62 offen offset:0 lds
    buffer_load_dwordx4 v29, s[12:15], s62 offen offset:1024 lds
    buffer_load_dwordx4 v30, s[12:15], s62 offen offset:2048 lds
    buffer_load_dwordx4 v31, s[12:15], s62 offen offset:3072 lds
    s_add_u32 m0, s49, 16384
    s_add_u32 s62, s51, 524288
    buffer_load_dwordx4 v28, s[12:15], s62 offen offset:0 lds
    buffer_load_dwordx4 v29, s[12:15], s62 offen offset:1024 lds
    buffer_load_dwordx4 v30, s[12:15], s62 offen offset:2048 lds
    buffer_load_dwordx4 v31, s[12:15], s62 offen offset:3072 lds
    v_min_u32 v252, 3, v1
    s_lshl_b32 s92, s5, 2
    s_add_u32 s92, s92, s3
    v_lshl_add_u32 v252, s92, 2, v252
    v_lshlrev_b32 v252, 7, v252
    v_add_u32 v252, adaLN_cond__sliding_block_cached__glu_gated_bilinear__prompt_kernel - adaLN_cond__sliding_block_cached__glu_gated_bilinear__prompt_kernel, v252
    v_min_u32 v252, LA_sd - adaLN_cond__sliding_block_cached__glu_gated_bilinear__prompt_kernel - 4, v252
    global_load_dword v251, v252, s[94:95]
    s_mul_i32 s97, s97, 0x2c9277b5
    s_add_u32 s97, s97, 0xac564b05
    s_getreg_b32 s69, hwreg(HW_REG_XCC_ID, 0, 4)
    v_mov_b32 v36, s97
    v_mov_b32 v37, s69
    s_lshl_b32 s65, s2, 5
    s_add_u32 s65, s65, 393216
    s_mov_b32 s70, 393216
    v_lshlrev_b32 v38, 5, v0
    v_lshlrev_b32 v3, 4, v0
    s_mov_b32 s64, 0
    s_cmp_lg_u32 s3, 0
    s_waitcnt vmcnt(9)
    s_cmp_lg_u32 s3, 0
    s_barrier
    s_cbranch_scc1 LS_q
    buffer_store_dwordx2 v[36:37], off, s[8:11], s65 sc0 sc1
LS_q:
    v_lshlrev_b32 v2, 4, v1
    s_mov_b32 s7, 0
    s_lshl_b32 s48, s4, 12
    s_lshl_b32 s50, s87, 19
    s_add_u32 s50, s50, 393216
    s_lshl_b32 s52, s86, 2
    s_add_u32 s52, s52, s3
    s_mul_i32 s52, s52, 81920
    s_add_u32 s52, s52, 1048576
    s_lshl_b32 s90, s4, 22
    s_lshr_b32 s64, s5, 3
    s_lshl_b32 s64, s64, 2
    s_add_u32 s64, s64, s3
    s_lshl_b32 s64, s64, 13
    s_add_u32 s90, s90, s64
    s_and_b32 s64, s5, 7
    s_lshl_b32 s64, s64, 17
    s_add_u32 s90, s90, s64
    s_add_u32 s90, s90, 4194304
    s_lshl_b32 s96, s5, 2
    s_add_u32 s96, s96, s3
    s_mul_i32 s96, s96, 2816
    s_lshl_b32 s64, s4, 22
    s_add_u32 s96, s96, s64
    s_add_u32 s96, s96, 4194304
    s_and_b32 s88, s4, 3
    s_mul_i32 s88, s88, 1310720
    s_and_b32 s64, s5, 3
    s_mul_i32 s64, s64, 320
    s_add_u32 s88, s88, s64
    s_mul_i32 s89, s3, 5120
    s_mul_i32 s55, s5, 6554
    s_lshr_b32 s55, s55, 16
    s_mul_i32 s64, s55, 10
    s_sub_u32 s64, s5, s64
    s_and_b32 s53, s64, 1
    s_lshr_b32 s54, s64, 1
    s_mul_i32 s56, s55, 737280
    s_lshl_b32 s64, s54, 8
    s_add_u32 s56, s56, s64
    s_lshr_b32 s64, s3, 1
    s_mul_i32 s98, s64, 40960
    s_add_u32 s56, s56, s98
    s_mul_i32 s98, s64, 696320
    s_sub_u32 s98, s56, s98
    s_lshl_b32 s99, s5, 2
    s_add_u32 s99, s99, s3
    s_lshl_b32 s99, s99, 2
    s_add_u32 s99, s99, s48
    s_lshl_b32 s57, s5, 7
    s_lshl_b32 s58, s3, 11
    v_lshrrev_b32 v4, 4, v1
    v_lshlrev_b32 v5, 2, v4
    v_xor_b32 v5, v5, v1
    v_and_b32 v5, 15, v5
    v_lshl_add_u32 v4, s3, 4, v4
    v_mul_u32_u24 v4, 256, v4
    v_xor_b32 v32, 0, v5
    v_lshl_add_u32 v32, v32, 4, v4
    v_xor_b32 v33, 1, v5
    v_lshl_add_u32 v33, v33, 4, v4
    v_xor_b32 v34, 2, v5
    v_lshl_add_u32 v34, v34, 4, v4
    v_xor_b32 v35, 3, v5
    v_lshl_add_u32 v35, v35, 4, v4
    v_lshrrev_b32 v4, 5, v1
    v_bfe_u32 v5, v1, 4, 1
    v_bfe_u32 v6, v1, 2, 2
    v_and_b32 v7, 1, v1
    v_lshl_add_u32 v5, v5, 1, v7
    v_lshlrev_b32 v7, 1, v4
    v_xor_b32 v5, v5, v7
    v_lshl_add_u32 v5, v6, 2, v5
    v_lshl_add_u32 v4, v4, 3, v6
    v_lshlrev_b32 v4, 8, v4
    v_bfe_u32 v7, v1, 1, 1
    v_lshl_add_u32 v4, v7, 3, v4
    v_xor_b32 v12, 0, v5
    v_lshl_add_u32 v12, v12, 4, v4
    v_xor_b32 v13, 1, v5
    v_lshl_add_u32 v13, v13, 4, v4
    v_add_u32 v13, 1024, v13
    v_xor_b32 v14, 4, v5
    v_lshl_add_u32 v14, v14, 4, v4
    v_xor_b32 v15, 5, v5
    v_lshl_add_u32 v15, v15, 4, v4
    v_add_u32 v15, 1024, v15
    v_xor_b32 v16, 8, v5
    v_lshl_add_u32 v16, v16, 4, v4
    v_xor_b32 v17, 9, v5
    v_lshl_add_u32 v17, v17, 4, v4
    v_add_u32 v17, 1024, v17
    v_xor_b32 v18, 12, v5
    v_lshl_add_u32 v18, v18, 4, v4
    v_xor_b32 v19, 13, v5
    v_lshl_add_u32 v19, v19, 4, v4
    v_add_u32 v19, 1024, v19
    v_add_u32 v20, 0x10000, v12
    v_add_u32 v21, 0x10000, v13
    v_add_u32 v22, 0x10000, v14
    v_add_u32 v23, 0x10000, v15
    v_add_u32 v24, 0x10000, v16
    v_add_u32 v25, 0x10000, v17
    v_add_u32 v26, 0x10000, v18
    v_add_u32 v27, 0x10000, v19
    v_and_b32 v4, 19, v1
    v_bfe_u32 v5, v1, 2, 1
    v_lshl_add_u32 v4, v5, 3, v4
    v_bfe_u32 v5, v1, 3, 1
    v_lshl_add_u32 v4, v5, 2, v4
    v_and_b32 v5, 3, v4
    v_bfe_u32 v6, v4, 2, 2
    v_lshl_add_u32 v5, v5, 2, v6
    v_lshrrev_b32 v6, 5, v1
    v_xor_b32 v5, v5, v6
    v_lshlrev_b32 v4, 8, v4
    v_xor_b32 v40, 0, v5
    v_lshl_add_u32 v40, v40, 4, v4
    v_xor_b32 v41, 2, v5
    v_lshl_add_u32 v41, v41, 4, v4
    v_xor_b32 v42, 4, v5
    v_lshl_add_u32 v42, v42, 4, v4
    v_xor_b32 v43, 6, v5
    v_lshl_add_u32 v43, v43, 4, v4
    v_xor_b32 v44, 8, v5
    v_lshl_add_u32 v44, v44, 4, v4
    v_xor_b32 v45, 10, v5
    v_lshl_add_u32 v45, v45, 4, v4
    v_xor_b32 v46, 12, v5
    v_lshl_add_u32 v46, v46, 4, v4
    v_xor_b32 v47, 14, v5
    v_lshl_add_u32 v47, v47, 4, v4
    v_add_u32 v48, 0x10000, v40
    v_add_u32 v49, 0x10000, v41
    v_add_u32 v50, 0x10000, v42
    v_add_u32 v51, 0x10000, v43
    v_add_u32 v52, 0x10000, v44
    v_add_u32 v53, 0x10000, v45
    v_add_u32 v54, 0x10000, v46
    v_add_u32 v55, 0x10000, v47
    v_add_u32 v4, 0, v1
    v_mul_u32_u24 v5, 3277, v4
    v_lshrrev_b32 v5, 16, v5
    v_mul_u32_u24 v6, 960, v5
    v_lshl_add_u32 v6, v4, 4, v6
    s_mul_i32 s64, s3, 20480
    s_sub_u32 s64, s64, 0
    v_add_u32 v227, s64, v6
    v_add_u32 v4, 64, v1
    v_mul_u32_u24 v5, 3277, v4
    v_lshrrev_b32 v5, 16, v5
    v_mul_u32_u24 v6, 960, v5
    v_lshl_add_u32 v6, v4, 4, v6
    s_mul_i32 s64, s3, 20480
    s_sub_u32 s64, s64, 1024
    v_add_u32 v228, s64, v6
    v_add_u32 v4, 128, v1
    v_mul_u32_u24 v5, 3277, v4
    v_lshrrev_b32 v5, 16, v5
    v_mul_u32_u24 v6, 960, v5
    v_lshl_add_u32 v6, v4, 4, v6
    s_mul_i32 s64, s3, 20480
    s_sub_u32 s64, s64, 2048
    v_add_u32 v229, s64, v6
    v_add_u32 v4, 192, v1
    v_mul_u32_u24 v5, 3277, v4
    v_lshrrev_b32 v5, 16, v5
    v_mul_u32_u24 v6, 960, v5
    v_lshl_add_u32 v6, v4, 4, v6
    s_mul_i32 s64, s3, 20480
    s_sub_u32 s64, s64, 3072
    v_add_u32 v230, s64, v6
    v_add_u32 v4, 256, v1
    v_mul_u32_u24 v5, 3277, v4
    v_lshrrev_b32 v5, 16, v5
    v_mul_u32_u24 v6, 960, v5
    v_lshl_add_u32 v6, v4, 4, v6
    s_mul_i32 s64, s3, 20480
    s_sub_u32 s64, s64, 0
    v_add_u32 v231, s64, v6
    v_lshrrev_b32 v4, 5, v1
    v_bfe_u32 v5, v1, 2, 2
    v_lshl_add_u32 v4, v4, 3, v5
    v_mul_u32_u24 v4, 320, v4
    v_bfe_u32 v5, v1, 4, 1
    v_lshl_add_u32 v4, v5, 5, v4
    v_and_b32 v5, 1, v1
    v_lshl_add_u32 v4, v5, 4, v4
    v_bfe_u32 v5, v1, 1, 1
    v_lshl_add_u32 v253, v5, 3, v4
    v_add_u32 v254, 0x10000, v253
    v_add_u32 v255, 0x20000, v253
    v_lshlrev_b32 v11, 2, v0
    s_mov_b32 s64, 0
LS_p:
    buffer_load_dwordx2 v[4:5], v38, s[8:11], s70 offen sc1
    s_add_u32 s64, s64, 1
    s_waitcnt vmcnt(0)
    v_cmp_ne_u32 vcc, s97, v4
    s_nop 0
    s_cmp_eq_u64 vcc, 0
    s_cbranch_scc1 LS_pd
    s_cmp_lt_u32 s64, 200000
    s_cbranch_scc1 LS_p
LS_pd:
    s_barrier
    s_mov_b32 s72, 65536
    buffer_load_dwordx4 v[56:59], v3, s[8:11], s72 offen sc1
    s_mov_b32 s73, 80896
    buffer_load_dwordx4 v[60:63], v3, s[8:11], s73 offen sc1
    s_mov_b32 s74, 96256
    buffer_load_dwordx4 v[64:67], v3, s[8:11], s74 offen sc1
    s_mov_b32 s75, 111616
    buffer_load_dwordx4 v[68:71], v3, s[8:11], s75 offen sc1
    s_mov_b32 s72, 69632
    buffer_load_dword v72, v11, s[8:11], s72 offen sc1
    s_mov_b32 s73, 84992
    buffer_load_dword v73, v11, s[8:11], s73 offen sc1
    s_mov_b32 s74, 100352
    buffer_load_dword v74, v11, s[8:11], s74 offen sc1
    s_mov_b32 s75, 115712
    buffer_load_dword v75, v11, s[8:11], s75 offen sc1
    s_add_u32 s60, s52, 0
    s_add_u32 s61, s52, 40960
    buffer_load_dwordx4 v[104:107], v2, s[8:11], s60 offen offset:0 sc1
    buffer_load_dwordx4 v[108:111], v2, s[8:11], s61 offen offset:0 sc1
    buffer_load_dwordx4 v[112:115], v2, s[8:11], s60 offen offset:1024 sc1
    buffer_load_dwordx4 v[116:119], v2, s[8:11], s61 offen offset:1024 sc1
    buffer_load_dwordx4 v[120:123], v2, s[8:11], s60 offen offset:2048 sc1
    buffer_load_dwordx4 v[124:127], v2, s[8:11], s61 offen offset:2048 sc1
    buffer_load_dwordx4 v[128:131], v2, s[8:11], s60 offen offset:3072 sc1
    buffer_load_dwordx4 v[132:135], v2, s[8:11], s61 offen offset:3072 sc1
    s_add_u32 m0, s49, 32768
    s_add_u32 s62, s51, 1048576
    buffer_load_dwordx4 v28, s[12:15], s62 offen offset:0 lds
    buffer_load_dwordx4 v29, s[12:15], s62 offen offset:1024 lds
    buffer_load_dwordx4 v30, s[12:15], s62 offen offset:2048 lds
    buffer_load_dwordx4 v31, s[12:15], s62 offen offset:3072 lds
    s_add_u32 s60, s52, 4096
    s_add_u32 s61, s52, 45056
    buffer_load_dwordx4 v[136:139], v2, s[8:11], s60 offen offset:0 sc1
    buffer_load_dwordx4 v[140:143], v2, s[8:11], s61 offen offset:0 sc1
    buffer_load_dwordx4 v[144:147], v2, s[8:11], s60 offen offset:1024 sc1
    buffer_load_dwordx4 v[148:151], v2, s[8:11], s61 offen offset:1024 sc1
    v_and_b32 v6, 7, v0
    v_cmp_eq_u32 s[66:67], s4, v6
    v_cmp_ne_u32 vcc, s69, v5
    s_nop 0
    s_and_b64 vcc, vcc, s[66:67]
    s_cselect_b32 s64, 1, 0
    v_mov_b32 v9, s64
    s_lshl_b32 s65, s3, 2
    s_add_u32 s65, s65, 146960
    v_mov_b32 v10, s65
    ds_write_b32 v10, v9
    ds_read_b64_tr_b16 a[128:129], v12 offset:0
    ds_read_b64_tr_b16 a[130:131], v13 offset:0
    ds_read_b64_tr_b16 a[132:133], v14 offset:0
    ds_read_b64_tr_b16 a[134:135], v15 offset:0
    ds_read_b64_tr_b16 a[136:137], v16 offset:0
    ds_read_b64_tr_b16 a[138:139], v17 offset:0
    ds_read_b64_tr_b16 a[140:141], v18 offset:0
    ds_read_b64_tr_b16 a[142:143], v19 offset:0
    v_add_u32 v3, 147456, v3
    v_add_u32 v11, 147456, v11
    s_waitcnt vmcnt(22)
    v_add_f32 v56, v56, v60
    s_waitcnt vmcnt(20)
    v_add_f32 v64, v64, v68
    v_add_f32 v57, v57, v61
    v_add_f32 v65, v65, v69
    v_add_f32 v58, v58, v62
    v_add_f32 v66, v66, v70
    v_add_f32 v59, v59, v63
    v_add_f32 v67, v67, v71
    v_mov_b32 v4, 0
    v_subrev_u32 v5, 160, v0
    v_cmp_gt_u32 vcc, 160, v5
    s_nop 1
    v_cndmask_b32 v4, v4, 1.0, vcc
    v_add_f32 v56, v56, v64
    v_add_f32 v57, v57, v65
    v_add_f32 v58, v58, v66
    v_add_f32 v59, v59, v67
    v_cvt_pk_bf16_f32 v56, v56, v56
    v_lshlrev_b32 v56, 16, v56
    v_cvt_pk_bf16_f32 v57, v57, v57
    v_lshlrev_b32 v57, 16, v57
    v_cvt_pk_bf16_f32 v58, v58, v58
    v_lshlrev_b32 v58, 16, v58
    v_cvt_pk_bf16_f32 v59, v59, v59
    v_lshlrev_b32 v59, 16, v59
    v_add_f32 v56, v4, v56
    v_add_f32 v57, v4, v57
    v_add_f32 v58, v4, v58
    v_add_f32 v59, v4, v59
    v_cvt_pk_bf16_f32 v56, v56, v56
    v_lshlrev_b32 v56, 16, v56
    v_cvt_pk_bf16_f32 v57, v57, v57
    v_lshlrev_b32 v57, 16, v57
    v_cvt_pk_bf16_f32 v58, v58, v58
    v_lshlrev_b32 v58, 16, v58
    v_cvt_pk_bf16_f32 v59, v59, v59
    v_lshlrev_b32 v59, 16, v59
    v_mul_f32 v56, 0x3e0293ee, v56
    v_mul_f32 v57, 0x3e0293ee, v57
    v_mul_f32 v58, 0x3e0293ee, v58
    v_mul_f32 v59, 0x3e0293ee, v59
    ds_write_b128 v3, v[56:59] offset:0
    s_waitcnt vmcnt(18)
    v_add_f32 v72, v72, v73
    s_waitcnt vmcnt(16)
    v_add_f32 v74, v74, v75
    v_add_f32 v72, v72, v74
    v_cvt_pk_bf16_f32 v72, v72, v72
    v_lshlrev_b32 v72, 16, v72
    v_add_f32 v72, 1.0, v72
    v_cvt_pk_bf16_f32 v72, v72, v72
    v_lshlrev_b32 v72, 16, v72
    v_mul_f32 v72, 0x3e0293ee, v72
    ds_write_b32 v11, v72 offset:4096
    v_lshrrev_b32 v3, 5, v1
    v_lshlrev_b32 v3, 5, v3
    v_add_u32 v3, 147456, v3
    v_mov_b32 v10, 146960
    s_waitcnt lgkmcnt(0)
    s_barrier
    ds_read_b128 v[36:39], v10
    ds_read_b128 v[72:75], v3 offset:2560
    ds_read_b128 v[80:83], v3 offset:0
    ds_read_b128 v[76:79], v3 offset:2576
    ds_read_b128 v[84:87], v3 offset:16
    ds_read_b128 v[88:91], v3 offset:2624
    ds_read_b128 v[96:99], v3 offset:64
    ds_read_b128 v[92:95], v3 offset:2640
    ds_read_b128 v[100:103], v3 offset:80
    s_waitcnt lgkmcnt(8)
    v_or_b32 v36, v36, v37
    v_or_b32 v38, v38, v39
    v_or_b32 v36, v36, v38
    s_nop 0
    v_readfirstlane_b32 s6, v36
    v_mov_b32 v224, 0xff800000
    v_mov_b32 v225, 0xff800000
    s_waitcnt vmcnt(15) lgkmcnt(6)
    v_fma_mix_f32 v4, v104, v72, v80 op_sel_hi:[1,0,0]
    v_fma_mix_f32 v5, v104, v73, v81 op_sel:[1,0,0] op_sel_hi:[1,0,0]
    v_cvt_pk_bf16_f32 v56, v4, v5
    v_fma_mix_f32 v6, v105, v74, v82 op_sel_hi:[1,0,0]
    v_fma_mix_f32 v7, v105, v75, v83 op_sel:[1,0,0] op_sel_hi:[1,0,0]
    v_cvt_pk_bf16_f32 v57, v6, v7
    s_waitcnt lgkmcnt(4)
    v_fma_mix_f32 v8, v106, v76, v84 op_sel_hi:[1,0,0]
    v_fma_mix_f32 v9, v106, v77, v85 op_sel:[1,0,0] op_sel_hi:[1,0,0]
    v_cvt_pk_bf16_f32 v58, v8, v9
    v_fma_mix_f32 v10, v107, v78, v86 op_sel_hi:[1,0,0]
    v_fma_mix_f32 v11, v107, v79, v87 op_sel:[1,0,0] op_sel_hi:[1,0,0]
    v_cvt_pk_bf16_f32 v59, v10, v11
    s_waitcnt vmcnt(14)
    v_fma_mix_f32 v4, v108, v72, v80 op_sel_hi:[1,0,0]
    v_fma_mix_f32 v5, v108, v73, v81 op_sel:[1,0,0] op_sel_hi:[1,0,0]
    v_cvt_pk_bf16_f32 v60, v4, v5
    v_fma_mix_f32 v6, v109, v74, v82 op_sel_hi:[1,0,0]
    v_fma_mix_f32 v7, v109, v75, v83 op_sel:[1,0,0] op_sel_hi:[1,0,0]
    v_cvt_pk_bf16_f32 v61, v6, v7
    v_fma_mix_f32 v8, v110, v76, v84 op_sel_hi:[1,0,0]
    v_fma_mix_f32 v9, v110, v77, v85 op_sel:[1,0,0] op_sel_hi:[1,0,0]
    v_cvt_pk_bf16_f32 v62, v8, v9
    v_fma_mix_f32 v10, v111, v78, v86 op_sel_hi:[1,0,0]
    v_fma_mix_f32 v11, v111, v79, v87 op_sel:[1,0,0] op_sel_hi:[1,0,0]
    v_cvt_pk_bf16_f32 v63, v10, v11
    v_mfma_f32_32x32x16_bf16 a[0:15], a[128:131], v[56:59], 0
    ds_read_b64_tr_b16 a[144:145], v12 offset:4096
    ds_read_b128 v[72:75], v3 offset:2688
    s_waitcnt vmcnt(13) lgkmcnt(4)
    v_fma_mix_f32 v4, v112, v88, v96 op_sel_hi:[1,0,0]
    v_fma_mix_f32 v5, v112, v89, v97 op_sel:[1,0,0] op_sel_hi:[1,0,0]
    v_cvt_pk_bf16_f32 v64, v4, v5
    v_mfma_f32_32x32x16_bf16 a[16:31], a[128:131], v[60:63], 0
    ds_read_b64_tr_b16 a[146:147], v13 offset:4096
    buffer_load_dwordx4 v[152:155], v2, s[8:11], s60 offen offset:2048 sc1
    v_fma_mix_f32 v6, v113, v90, v98 op_sel_hi:[1,0,0]
    v_fma_mix_f32 v7, v113, v91, v99 op_sel:[1,0,0] op_sel_hi:[1,0,0]
    v_cvt_pk_bf16_f32 v65, v6, v7
    v_mfma_f32_32x32x16_bf16 a[32:47], a[132:135], v[56:59], 0
    ds_read_b64_tr_b16 a[148:149], v14 offset:4096
    ds_read_b128 v[80:83], v3 offset:128
    s_waitcnt lgkmcnt(5)
    v_fma_mix_f32 v8, v114, v92, v100 op_sel_hi:[1,0,0]
    v_fma_mix_f32 v9, v114, v93, v101 op_sel:[1,0,0] op_sel_hi:[1,0,0]
    v_cvt_pk_bf16_f32 v66, v8, v9
    v_mfma_f32_32x32x16_bf16 a[48:63], a[132:135], v[60:63], 0
    ds_read_b64_tr_b16 a[150:151], v15 offset:4096
    buffer_load_dwordx4 v[156:159], v2, s[8:11], s61 offen offset:2048 sc1
    v_fma_mix_f32 v10, v115, v94, v102 op_sel_hi:[1,0,0]
    v_fma_mix_f32 v11, v115, v95, v103 op_sel:[1,0,0] op_sel_hi:[1,0,0]
    v_cvt_pk_bf16_f32 v67, v10, v11
    v_mfma_f32_32x32x16_bf16 a[64:79], a[136:139], v[56:59], 0
    ds_read_b64_tr_b16 a[152:153], v16 offset:4096
    ds_read_b128 v[76:79], v3 offset:2704
    s_waitcnt vmcnt(14)
    v_fma_mix_f32 v4, v116, v88, v96 op_sel_hi:[1,0,0]
    v_fma_mix_f32 v5, v116, v89, v97 op_sel:[1,0,0] op_sel_hi:[1,0,0]
    v_cvt_pk_bf16_f32 v68, v4, v5
    s_add_u32 m0, s49, 49152
    s_add_u32 s62, s51, 1572864
    v_mfma_f32_32x32x16_bf16 a[80:95], a[136:139], v[60:63], 0
    ds_read_b64_tr_b16 a[154:155], v17 offset:4096
    buffer_load_dwordx4 v28, s[12:15], s62 offen offset:0 lds
    v_fma_mix_f32 v6, v117, v90, v98 op_sel_hi:[1,0,0]
    v_fma_mix_f32 v7, v117, v91, v99 op_sel:[1,0,0] op_sel_hi:[1,0,0]
    v_cvt_pk_bf16_f32 v69, v6, v7
    v_mfma_f32_32x32x16_bf16 a[96:111], a[140:143], v[56:59], 0
    ds_read_b64_tr_b16 a[156:157], v18 offset:4096
    ds_read_b128 v[84:87], v3 offset:144
    v_fma_mix_f32 v8, v118, v92, v100 op_sel_hi:[1,0,0]
    v_fma_mix_f32 v9, v118, v93, v101 op_sel:[1,0,0] op_sel_hi:[1,0,0]
    v_cvt_pk_bf16_f32 v70, v8, v9
    v_mfma_f32_32x32x16_bf16 a[112:127], a[140:143], v[60:63], 0
    ds_read_b64_tr_b16 a[158:159], v19 offset:4096
    buffer_load_dwordx4 v29, s[12:15], s62 offen offset:1024 lds
    v_fma_mix_f32 v10, v119, v94, v102 op_sel_hi:[1,0,0]
    v_fma_mix_f32 v11, v119, v95, v103 op_sel:[1,0,0] op_sel_hi:[1,0,0]
    v_cvt_pk_bf16_f32 v71, v10, v11
    s_waitcnt vmcnt(14) lgkmcnt(6)
    v_mfma_f32_32x32x16_bf16 a[0:15], a[144:147], v[64:67], a[0:15]
    ds_read_b64_tr_b16 a[128:129], v12 offset:8192
    ds_read_b128 v[88:91], v3 offset:2752
    v_fma_mix_f32 v4, v120, v72, v80 op_sel_hi:[1,0,0]
    v_fma_mix_f32 v5, v120, v73, v81 op_sel:[1,0,0] op_sel_hi:[1,0,0]
    v_cvt_pk_bf16_f32 v56, v4, v5
    v_mfma_f32_32x32x16_bf16 a[16:31], a[144:147], v[68:71], a[16:31]
    ds_read_b64_tr_b16 a[130:131], v13 offset:8192
    buffer_load_dwordx4 v[160:163], v2, s[8:11], s60 offen offset:3072 sc1
    v_fma_mix_f32 v6, v121, v74, v82 op_sel_hi:[1,0,0]
    v_fma_mix_f32 v7, v121, v75, v83 op_sel:[1,0,0] op_sel_hi:[1,0,0]
    v_cvt_pk_bf16_f32 v57, v6, v7
    s_waitcnt lgkmcnt(3)
    v_mfma_f32_32x32x16_bf16 a[32:47], a[148:151], v[64:67], a[32:47]
    ds_read_b64_tr_b16 a[132:133], v14 offset:8192
    ds_read_b128 v[96:99], v3 offset:192
    buffer_load_dwordx4 v[164:167], v2, s[8:11], s61 offen offset:3072 sc1
    v_fma_mix_f32 v8, v122, v76, v84 op_sel_hi:[1,0,0]
    v_fma_mix_f32 v9, v122, v77, v85 op_sel:[1,0,0] op_sel_hi:[1,0,0]
    v_cvt_pk_bf16_f32 v58, v8, v9
    s_add_u32 s60, s52, 8192
    s_add_u32 s61, s52, 49152
    v_mfma_f32_32x32x16_bf16 a[48:63], a[148:151], v[68:71], a[48:63]
    ds_read_b64_tr_b16 a[134:135], v15 offset:8192
    buffer_load_dwordx4 v[168:171], v2, s[8:11], s60 offen offset:0 sc1
    v_fma_mix_f32 v10, v123, v78, v86 op_sel_hi:[1,0,0]
    v_fma_mix_f32 v11, v123, v79, v87 op_sel:[1,0,0] op_sel_hi:[1,0,0]
    v_cvt_pk_bf16_f32 v59, v10, v11
    v_mfma_f32_32x32x16_bf16 a[64:79], a[152:155], v[64:67], a[64:79]
    ds_read_b64_tr_b16 a[136:137], v16 offset:8192
    ds_read_b128 v[92:95], v3 offset:2768
    buffer_load_dwordx4 v[172:175], v2, s[8:11], s61 offen offset:0 sc1
    v_fma_mix_f32 v4, v124, v72, v80 op_sel_hi:[1,0,0]
    v_fma_mix_f32 v5, v124, v73, v81 op_sel:[1,0,0] op_sel_hi:[1,0,0]
    v_cvt_pk_bf16_f32 v60, v4, v5
    v_mfma_f32_32x32x16_bf16 a[80:95], a[152:155], v[68:71], a[80:95]
    ds_read_b64_tr_b16 a[138:139], v17 offset:8192
    buffer_load_dwordx4 v30, s[12:15], s62 offen offset:2048 lds
    v_fma_mix_f32 v6, v125, v74, v82 op_sel_hi:[1,0,0]
    v_fma_mix_f32 v7, v125, v75, v83 op_sel:[1,0,0] op_sel_hi:[1,0,0]
    v_cvt_pk_bf16_f32 v61, v6, v7
    v_mfma_f32_32x32x16_bf16 a[96:111], a[156:159], v[64:67], a[96:111]
    ds_read_b64_tr_b16 a[140:141], v18 offset:8192
    ds_read_b128 v[100:103], v3 offset:208
    v_fma_mix_f32 v8, v126, v76, v84 op_sel_hi:[1,0,0]
    v_fma_mix_f32 v9, v126, v77, v85 op_sel:[1,0,0] op_sel_hi:[1,0,0]
    v_cvt_pk_bf16_f32 v62, v8, v9
    v_mfma_f32_32x32x16_bf16 a[112:127], a[156:159], v[68:71], a[112:127]
    ds_read_b64_tr_b16 a[142:143], v19 offset:8192
    buffer_load_dwordx4 v31, s[12:15], s62 offen offset:3072 lds
    v_fma_mix_f32 v10, v127, v78, v86 op_sel_hi:[1,0,0]
    v_fma_mix_f32 v11, v127, v79, v87 op_sel:[1,0,0] op_sel_hi:[1,0,0]
    v_cvt_pk_bf16_f32 v63, v10, v11
    s_waitcnt vmcnt(18) lgkmcnt(6)
    v_mfma_f32_32x32x16_bf16 a[0:15], a[128:131], v[56:59], a[0:15]
    ds_read_b64_tr_b16 a[144:145], v12 offset:12288
    ds_read_b128 v[72:75], v3 offset:2816
    v_fma_mix_f32 v4, v128, v88, v96 op_sel_hi:[1,0,0]
    v_fma_mix_f32 v5, v128, v89, v97 op_sel:[1,0,0] op_sel_hi:[1,0,0]
    v_cvt_pk_bf16_f32 v64, v4, v5
    v_mfma_f32_32x32x16_bf16 a[16:31], a[128:131], v[60:63], a[16:31]
    ds_read_b64_tr_b16 a[146:147], v13 offset:12288
    buffer_load_dwordx4 v[176:179], v2, s[8:11], s60 offen offset:1024 sc1
    v_fma_mix_f32 v6, v129, v90, v98 op_sel_hi:[1,0,0]
    v_fma_mix_f32 v7, v129, v91, v99 op_sel:[1,0,0] op_sel_hi:[1,0,0]
    v_cvt_pk_bf16_f32 v65, v6, v7
    s_waitcnt lgkmcnt(3)
    v_mfma_f32_32x32x16_bf16 a[32:47], a[132:135], v[56:59], a[32:47]
    ds_read_b64_tr_b16 a[148:149], v14 offset:12288
    ds_read_b128 v[80:83], v3 offset:256
    v_fma_mix_f32 v8, v130, v92, v100 op_sel_hi:[1,0,0]
    v_fma_mix_f32 v9, v130, v93, v101 op_sel:[1,0,0] op_sel_hi:[1,0,0]
    v_cvt_pk_bf16_f32 v66, v8, v9
    v_mfma_f32_32x32x16_bf16 a[48:63], a[132:135], v[60:63], a[48:63]
    ds_read_b64_tr_b16 a[150:151], v15 offset:12288
    buffer_load_dwordx4 v[180:183], v2, s[8:11], s61 offen offset:1024 sc1
    v_fma_mix_f32 v10, v131, v94, v102 op_sel_hi:[1,0,0]
    v_fma_mix_f32 v11, v131, v95, v103 op_sel:[1,0,0] op_sel_hi:[1,0,0]
    v_cvt_pk_bf16_f32 v67, v10, v11
    v_mfma_f32_32x32x16_bf16 a[64:79], a[136:139], v[56:59], a[64:79]
    ds_read_b64_tr_b16 a[152:153], v16 offset:12288
    ds_read_b128 v[76:79], v3 offset:2832
    v_fma_mix_f32 v4, v132, v88, v96 op_sel_hi:[1,0,0]
    v_fma_mix_f32 v5, v132, v89, v97 op_sel:[1,0,0] op_sel_hi:[1,0,0]
    v_cvt_pk_bf16_f32 v68, v4, v5
    v_mfma_f32_32x32x16_bf16 a[80:95], a[136:139], v[60:63], a[80:95]
    ds_read_b64_tr_b16 a[154:155], v17 offset:12288
    buffer_load_dwordx4 v[184:187], v2, s[8:11], s60 offen offset:2048 sc1
    v_fma_mix_f32 v6, v133, v90, v98 op_sel_hi:[1,0,0]
    v_fma_mix_f32 v7, v133, v91, v99 op_sel:[1,0,0] op_sel_hi:[1,0,0]
    v_cvt_pk_bf16_f32 v69, v6, v7
    v_mfma_f32_32x32x16_bf16 a[96:111], a[140:143], v[56:59], a[96:111]
    ds_read_b64_tr_b16 a[156:157], v18 offset:12288
    ds_read_b128 v[84:87], v3 offset:272
    v_fma_mix_f32 v8, v134, v92, v100 op_sel_hi:[1,0,0]
    v_fma_mix_f32 v9, v134, v93, v101 op_sel:[1,0,0] op_sel_hi:[1,0,0]
    v_cvt_pk_bf16_f32 v70, v8, v9
    v_mfma_f32_32x32x16_bf16 a[112:127], a[140:143], v[60:63], a[112:127]
    ds_read_b64_tr_b16 a[158:159], v19 offset:12288
    buffer_load_dwordx4 v[188:191], v2, s[8:11], s61 offen offset:2048 sc1
    v_fma_mix_f32 v10, v135, v94, v102 op_sel_hi:[1,0,0]
    v_fma_mix_f32 v11, v135, v95, v103 op_sel:[1,0,0] op_sel_hi:[1,0,0]
    v_cvt_pk_bf16_f32 v71, v10, v11
    s_waitcnt vmcnt(16) lgkmcnt(6)
    v_mfma_f32_32x32x16_bf16 a[0:15], a[144:147], v[64:67], a[0:15]
    ds_read_b64_tr_b16 a[128:129], v12 offset:16384
    ds_read_b128 v[88:91], v3 offset:2880
    v_fma_mix_f32 v4, v136, v72, v80 op_sel_hi:[1,0,0]
    v_fma_mix_f32 v5, v136, v73, v81 op_sel:[1,0,0] op_sel_hi:[1,0,0]
    v_cvt_pk_bf16_f32 v56, v4, v5
    v_mfma_f32_32x32x16_bf16 a[16:31], a[144:147], v[68:71], a[16:31]
    ds_read_b64_tr_b16 a[130:131], v13 offset:16384
    v_fma_mix_f32 v6, v137, v74, v82 op_sel_hi:[1,0,0]
    v_fma_mix_f32 v7, v137, v75, v83 op_sel:[1,0,0] op_sel_hi:[1,0,0]
    v_cvt_pk_bf16_f32 v57, v6, v7
    s_waitcnt lgkmcnt(3)
    v_mfma_f32_32x32x16_bf16 a[32:47], a[148:151], v[64:67], a[32:47]
    ds_read_b64_tr_b16 a[132:133], v14 offset:16384
    ds_read_b128 v[96:99], v3 offset:320
    v_fma_mix_f32 v8, v138, v76, v84 op_sel_hi:[1,0,0]
    v_fma_mix_f32 v9, v138, v77, v85 op_sel:[1,0,0] op_sel_hi:[1,0,0]
    v_cvt_pk_bf16_f32 v58, v8, v9
    v_mfma_f32_32x32x16_bf16 a[48:63], a[148:151], v[68:71], a[48:63]
    ds_read_b64_tr_b16 a[134:135], v15 offset:16384
    buffer_load_dwordx4 v[192:195], v2, s[8:11], s60 offen offset:3072 sc1
    v_fma_mix_f32 v10, v139, v78, v86 op_sel_hi:[1,0,0]
    v_fma_mix_f32 v11, v139, v79, v87 op_sel:[1,0,0] op_sel_hi:[1,0,0]
    v_cvt_pk_bf16_f32 v59, v10, v11
    v_mfma_f32_32x32x16_bf16 a[64:79], a[152:155], v[64:67], a[64:79]
    ds_read_b64_tr_b16 a[136:137], v16 offset:16384
    ds_read_b128 v[92:95], v3 offset:2896
    v_fma_mix_f32 v4, v140, v72, v80 op_sel_hi:[1,0,0]
    v_fma_mix_f32 v5, v140, v73, v81 op_sel:[1,0,0] op_sel_hi:[1,0,0]
    v_cvt_pk_bf16_f32 v60, v4, v5
    v_mfma_f32_32x32x16_bf16 a[80:95], a[152:155], v[68:71], a[80:95]
    ds_read_b64_tr_b16 a[138:139], v17 offset:16384
    buffer_load_dwordx4 v[196:199], v2, s[8:11], s61 offen offset:3072 sc1
    v_fma_mix_f32 v6, v141, v74, v82 op_sel_hi:[1,0,0]
    v_fma_mix_f32 v7, v141, v75, v83 op_sel:[1,0,0] op_sel_hi:[1,0,0]
    v_cvt_pk_bf16_f32 v61, v6, v7
    v_mfma_f32_32x32x16_bf16 a[96:111], a[156:159], v[64:67], a[96:111]
    ds_read_b64_tr_b16 a[140:141], v18 offset:16384
    ds_read_b128 v[100:103], v3 offset:336
    v_fma_mix_f32 v8, v142, v76, v84 op_sel_hi:[1,0,0]
    v_fma_mix_f32 v9, v142, v77, v85 op_sel:[1,0,0] op_sel_hi:[1,0,0]
    v_cvt_pk_bf16_f32 v62, v8, v9
    s_add_u32 m0, s49, 65536
    s_add_u32 s62, s51, 2097152
    v_mfma_f32_32x32x16_bf16 a[112:127], a[156:159], v[68:71], a[112:127]
    ds_read_b64_tr_b16 a[142:143], v19 offset:16384
    buffer_load_dwordx4 v28, s[12:15], s62 offen offset:0 lds
    v_fma_mix_f32 v10, v143, v78, v86 op_sel_hi:[1,0,0]
    v_fma_mix_f32 v11, v143, v79, v87 op_sel:[1,0,0] op_sel_hi:[1,0,0]
    v_cvt_pk_bf16_f32 v63, v10, v11
    s_waitcnt vmcnt(17) lgkmcnt(6)
    v_mfma_f32_32x32x16_bf16 a[0:15], a[128:131], v[56:59], a[0:15]
    ds_read_b64_tr_b16 a[144:145], v12 offset:20480
    ds_read_b128 v[72:75], v3 offset:2944
    v_fma_mix_f32 v4, v144, v88, v96 op_sel_hi:[1,0,0]
    v_fma_mix_f32 v5, v144, v89, v97 op_sel:[1,0,0] op_sel_hi:[1,0,0]
    v_cvt_pk_bf16_f32 v64, v4, v5
    v_mfma_f32_32x32x16_bf16 a[16:31], a[128:131], v[60:63], a[16:31]
    ds_read_b64_tr_b16 a[146:147], v13 offset:20480
    v_fma_mix_f32 v6, v145, v90, v98 op_sel_hi:[1,0,0]
    v_fma_mix_f32 v7, v145, v91, v99 op_sel:[1,0,0] op_sel_hi:[1,0,0]
    v_cvt_pk_bf16_f32 v65, v6, v7
    s_waitcnt lgkmcnt(3)
    v_mfma_f32_32x32x16_bf16 a[32:47], a[132:135], v[56:59], a[32:47]
    ds_read_b64_tr_b16 a[148:149], v14 offset:20480
    ds_read_b128 v[80:83], v3 offset:384
    v_fma_mix_f32 v8, v146, v92, v100 op_sel_hi:[1,0,0]
    v_fma_mix_f32 v9, v146, v93, v101 op_sel:[1,0,0] op_sel_hi:[1,0,0]
    v_cvt_pk_bf16_f32 v66, v8, v9
    s_add_u32 s60, s52, 12288
    s_add_u32 s61, s52, 53248
    v_mfma_f32_32x32x16_bf16 a[48:63], a[132:135], v[60:63], a[48:63]
    ds_read_b64_tr_b16 a[150:151], v15 offset:20480
    buffer_load_dwordx4 v[104:107], v2, s[8:11], s60 offen offset:0 sc1
    v_fma_mix_f32 v10, v147, v94, v102 op_sel_hi:[1,0,0]
    v_fma_mix_f32 v11, v147, v95, v103 op_sel:[1,0,0] op_sel_hi:[1,0,0]
    v_cvt_pk_bf16_f32 v67, v10, v11
    v_mfma_f32_32x32x16_bf16 a[64:79], a[136:139], v[56:59], a[64:79]
    ds_read_b64_tr_b16 a[152:153], v16 offset:20480
    ds_read_b128 v[76:79], v3 offset:2960
    v_fma_mix_f32 v4, v148, v88, v96 op_sel_hi:[1,0,0]
    v_fma_mix_f32 v5, v148, v89, v97 op_sel:[1,0,0] op_sel_hi:[1,0,0]
    v_cvt_pk_bf16_f32 v68, v4, v5
    v_mfma_f32_32x32x16_bf16 a[80:95], a[136:139], v[60:63], a[80:95]
    ds_read_b64_tr_b16 a[154:155], v17 offset:20480
    buffer_load_dwordx4 v[108:111], v2, s[8:11], s61 offen offset:0 sc1
    v_fma_mix_f32 v6, v149, v90, v98 op_sel_hi:[1,0,0]
    v_fma_mix_f32 v7, v149, v91, v99 op_sel:[1,0,0] op_sel_hi:[1,0,0]
    v_cvt_pk_bf16_f32 v69, v6, v7
    v_mfma_f32_32x32x16_bf16 a[96:111], a[140:143], v[56:59], a[96:111]
    ds_read_b64_tr_b16 a[156:157], v18 offset:20480
    ds_read_b128 v[84:87], v3 offset:400
    v_fma_mix_f32 v8, v150, v92, v100 op_sel_hi:[1,0,0]
    v_fma_mix_f32 v9, v150, v93, v101 op_sel:[1,0,0] op_sel_hi:[1,0,0]
    v_cvt_pk_bf16_f32 v70, v8, v9
    v_mfma_f32_32x32x16_bf16 a[112:127], a[140:143], v[60:63], a[112:127]
    ds_read_b64_tr_b16 a[158:159], v19 offset:20480
    buffer_load_dwordx4 v29, s[12:15], s62 offen offset:1024 lds
    v_fma_mix_f32 v10, v151, v94, v102 op_sel_hi:[1,0,0]
    v_fma_mix_f32 v11, v151, v95, v103 op_sel:[1,0,0] op_sel_hi:[1,0,0]
    v_cvt_pk_bf16_f32 v71, v10, v11
    s_waitcnt vmcnt(18) lgkmcnt(6)
    v_mfma_f32_32x32x16_bf16 a[0:15], a[144:147], v[64:67], a[0:15]
    ds_read_b64_tr_b16 a[128:129], v12 offset:24576
    ds_read_b128 v[88:91], v3 offset:3008
    v_fma_mix_f32 v4, v152, v72, v80 op_sel_hi:[1,0,0]
    v_fma_mix_f32 v5, v152, v73, v81 op_sel:[1,0,0] op_sel_hi:[1,0,0]
    v_cvt_pk_bf16_f32 v56, v4, v5
    v_mfma_f32_32x32x16_bf16 a[16:31], a[144:147], v[68:71], a[16:31]
    ds_read_b64_tr_b16 a[130:131], v13 offset:24576
    buffer_load_dwordx4 v[112:115], v2, s[8:11], s60 offen offset:1024 sc1
    v_fma_mix_f32 v6, v153, v74, v82 op_sel_hi:[1,0,0]
    v_fma_mix_f32 v7, v153, v75, v83 op_sel:[1,0,0] op_sel_hi:[1,0,0]
    v_cvt_pk_bf16_f32 v57, v6, v7
    s_waitcnt lgkmcnt(3)
    v_mfma_f32_32x32x16_bf16 a[32:47], a[148:151], v[64:67], a[32:47]
    ds_read_b64_tr_b16 a[132:133], v14 offset:24576
    ds_read_b128 v[96:99], v3 offset:448
    v_fma_mix_f32 v8, v154, v76, v84 op_sel_hi:[1,0,0]
    v_fma_mix_f32 v9, v154, v77, v85 op_sel:[1,0,0] op_sel_hi:[1,0,0]
    v_cvt_pk_bf16_f32 v58, v8, v9
    v_mfma_f32_32x32x16_bf16 a[48:63], a[148:151], v[68:71], a[48:63]
    ds_read_b64_tr_b16 a[134:135], v15 offset:24576
    buffer_load_dwordx4 v[116:119], v2, s[8:11], s61 offen offset:1024 sc1
    v_fma_mix_f32 v10, v155, v78, v86 op_sel_hi:[1,0,0]
    v_fma_mix_f32 v11, v155, v79, v87 op_sel:[1,0,0] op_sel_hi:[1,0,0]
    v_cvt_pk_bf16_f32 v59, v10, v11
    v_mfma_f32_32x32x16_bf16 a[64:79], a[152:155], v[64:67], a[64:79]
    ds_read_b64_tr_b16 a[136:137], v16 offset:24576
    ds_read_b128 v[92:95], v3 offset:3024
    buffer_load_dwordx4 v[120:123], v2, s[8:11], s60 offen offset:2048 sc1
    v_fma_mix_f32 v4, v156, v72, v80 op_sel_hi:[1,0,0]
    v_fma_mix_f32 v5, v156, v73, v81 op_sel:[1,0,0] op_sel_hi:[1,0,0]
    v_cvt_pk_bf16_f32 v60, v4, v5
    v_mfma_f32_32x32x16_bf16 a[80:95], a[152:155], v[68:71], a[80:95]
    ds_read_b64_tr_b16 a[138:139], v17 offset:24576
    buffer_load_dwordx4 v[124:127], v2, s[8:11], s61 offen offset:2048 sc1
    v_fma_mix_f32 v6, v157, v74, v82 op_sel_hi:[1,0,0]
    v_fma_mix_f32 v7, v157, v75, v83 op_sel:[1,0,0] op_sel_hi:[1,0,0]
    v_cvt_pk_bf16_f32 v61, v6, v7
    v_mfma_f32_32x32x16_bf16 a[96:111], a[156:159], v[64:67], a[96:111]
    ds_read_b64_tr_b16 a[140:141], v18 offset:24576
    ds_read_b128 v[100:103], v3 offset:464
    v_fma_mix_f32 v8, v158, v76, v84 op_sel_hi:[1,0,0]
    v_fma_mix_f32 v9, v158, v77, v85 op_sel:[1,0,0] op_sel_hi:[1,0,0]
    v_cvt_pk_bf16_f32 v62, v8, v9
    v_mfma_f32_32x32x16_bf16 a[112:127], a[156:159], v[68:71], a[112:127]
    ds_read_b64_tr_b16 a[142:143], v19 offset:24576
    buffer_load_dwordx4 v30, s[12:15], s62 offen offset:2048 lds
    v_fma_mix_f32 v10, v159, v78, v86 op_sel_hi:[1,0,0]
    v_fma_mix_f32 v11, v159, v79, v87 op_sel:[1,0,0] op_sel_hi:[1,0,0]
    v_cvt_pk_bf16_f32 v63, v10, v11
    s_waitcnt vmcnt(19) lgkmcnt(6)
    v_mfma_f32_32x32x16_bf16 a[0:15], a[128:131], v[56:59], a[0:15]
    ds_read_b64_tr_b16 a[144:145], v12 offset:28672
    ds_read_b128 v[72:75], v3 offset:3072
    v_fma_mix_f32 v4, v160, v88, v96 op_sel_hi:[1,0,0]
    v_fma_mix_f32 v5, v160, v89, v97 op_sel:[1,0,0] op_sel_hi:[1,0,0]
    v_cvt_pk_bf16_f32 v64, v4, v5
    v_mfma_f32_32x32x16_bf16 a[16:31], a[128:131], v[60:63], a[16:31]
    ds_read_b64_tr_b16 a[146:147], v13 offset:28672
    v_fma_mix_f32 v6, v161, v90, v98 op_sel_hi:[1,0,0]
    v_fma_mix_f32 v7, v161, v91, v99 op_sel:[1,0,0] op_sel_hi:[1,0,0]
    v_cvt_pk_bf16_f32 v65, v6, v7
    s_waitcnt lgkmcnt(3)
    v_mfma_f32_32x32x16_bf16 a[32:47], a[132:135], v[56:59], a[32:47]
    ds_read_b64_tr_b16 a[148:149], v14 offset:28672
    ds_read_b128 v[80:83], v3 offset:512
    v_fma_mix_f32 v8, v162, v92, v100 op_sel_hi:[1,0,0]
    v_fma_mix_f32 v9, v162, v93, v101 op_sel:[1,0,0] op_sel_hi:[1,0,0]
    v_cvt_pk_bf16_f32 v66, v8, v9
    v_mfma_f32_32x32x16_bf16 a[48:63], a[132:135], v[60:63], a[48:63]
    ds_read_b64_tr_b16 a[150:151], v15 offset:28672
    buffer_load_dwordx4 v[128:131], v2, s[8:11], s60 offen offset:3072 sc1
    v_fma_mix_f32 v10, v163, v94, v102 op_sel_hi:[1,0,0]
    v_fma_mix_f32 v11, v163, v95, v103 op_sel:[1,0,0] op_sel_hi:[1,0,0]
    v_cvt_pk_bf16_f32 v67, v10, v11
    v_mfma_f32_32x32x16_bf16 a[64:79], a[136:139], v[56:59], a[64:79]
    ds_read_b64_tr_b16 a[152:153], v16 offset:28672
    ds_read_b128 v[76:79], v3 offset:3088
    v_fma_mix_f32 v4, v164, v88, v96 op_sel_hi:[1,0,0]
    v_fma_mix_f32 v5, v164, v89, v97 op_sel:[1,0,0] op_sel_hi:[1,0,0]
    v_cvt_pk_bf16_f32 v68, v4, v5
    v_mfma_f32_32x32x16_bf16 a[80:95], a[136:139], v[60:63], a[80:95]
    ds_read_b64_tr_b16 a[154:155], v17 offset:28672
    buffer_load_dwordx4 v[132:135], v2, s[8:11], s61 offen offset:3072 sc1
    v_fma_mix_f32 v6, v165, v90, v98 op_sel_hi:[1,0,0]
    v_fma_mix_f32 v7, v165, v91, v99 op_sel:[1,0,0] op_sel_hi:[1,0,0]
    v_cvt_pk_bf16_f32 v69, v6, v7
    v_mfma_f32_32x32x16_bf16 a[96:111], a[140:143], v[56:59], a[96:111]
    ds_read_b64_tr_b16 a[156:157], v18 offset:28672
    ds_read_b128 v[84:87], v3 offset:528
    v_fma_mix_f32 v8, v166, v92, v100 op_sel_hi:[1,0,0]
    v_fma_mix_f32 v9, v166, v93, v101 op_sel:[1,0,0] op_sel_hi:[1,0,0]
    v_cvt_pk_bf16_f32 v70, v8, v9
    v_mfma_f32_32x32x16_bf16 a[112:127], a[140:143], v[60:63], a[112:127]
    ds_read_b64_tr_b16 a[158:159], v19 offset:28672
    buffer_load_dwordx4 v31, s[12:15], s62 offen offset:3072 lds
    v_fma_mix_f32 v10, v167, v94, v102 op_sel_hi:[1,0,0]
    v_fma_mix_f32 v11, v167, v95, v103 op_sel:[1,0,0] op_sel_hi:[1,0,0]
    v_cvt_pk_bf16_f32 v71, v10, v11
    s_waitcnt vmcnt(18) lgkmcnt(6)
    v_mfma_f32_32x32x16_bf16 a[0:15], a[144:147], v[64:67], a[0:15]
    s_barrier
    v_mfma_f32_32x32x16_bf16 a[16:31], a[144:147], v[68:71], a[16:31]
    ds_read_b64_tr_b16 a[128:129], v12 offset:32768
    ds_read_b64_tr_b16 a[130:131], v13 offset:32768
    v_fma_mix_f32 v4, v168, v72, v80 op_sel_hi:[1,0,0]
    v_fma_mix_f32 v5, v168, v73, v81 op_sel:[1,0,0] op_sel_hi:[1,0,0]
    v_cvt_pk_bf16_f32 v56, v4, v5
    s_waitcnt lgkmcnt(2)
    v_mfma_f32_32x32x16_bf16 a[32:47], a[148:151], v[64:67], a[32:47]
    ds_read_b64_tr_b16 a[132:133], v14 offset:32768
    ds_read_b128 v[88:91], v3 offset:3136
    v_fma_mix_f32 v6, v169, v74, v82 op_sel_hi:[1,0,0]
    v_fma_mix_f32 v7, v169, v75, v83 op_sel:[1,0,0] op_sel_hi:[1,0,0]
    v_cvt_pk_bf16_f32 v57, v6, v7
    v_fma_mix_f32 v8, v170, v76, v84 op_sel_hi:[1,0,0]
    v_mfma_f32_32x32x16_bf16 a[48:63], a[148:151], v[68:71], a[48:63]
    ds_read_b64_tr_b16 a[134:135], v15 offset:32768
    ds_read_b128 v[96:99], v3 offset:576
    v_fma_mix_f32 v9, v170, v77, v85 op_sel:[1,0,0] op_sel_hi:[1,0,0]
    v_cvt_pk_bf16_f32 v58, v8, v9
    v_fma_mix_f32 v10, v171, v78, v86 op_sel_hi:[1,0,0]
    v_fma_mix_f32 v11, v171, v79, v87 op_sel:[1,0,0] op_sel_hi:[1,0,0]
    v_mfma_f32_32x32x16_bf16 a[64:79], a[152:155], v[64:67], a[64:79]
    ds_read_b64_tr_b16 a[136:137], v16 offset:32768
    ds_read_b128 v[92:95], v3 offset:3152
    v_cvt_pk_bf16_f32 v59, v10, v11
    v_fma_mix_f32 v4, v172, v72, v80 op_sel_hi:[1,0,0]
    v_fma_mix_f32 v5, v172, v73, v81 op_sel:[1,0,0] op_sel_hi:[1,0,0]
    v_cvt_pk_bf16_f32 v60, v4, v5
    s_add_u32 s60, s52, 16384
    s_add_u32 s61, s52, 57344
    v_mfma_f32_32x32x16_bf16 a[80:95], a[152:155], v[68:71], a[80:95]
    ds_read_b64_tr_b16 a[138:139], v17 offset:32768
    buffer_load_dwordx4 v[136:139], v2, s[8:11], s60 offen offset:0 sc1
    v_fma_mix_f32 v6, v173, v74, v82 op_sel_hi:[1,0,0]
    v_fma_mix_f32 v7, v173, v75, v83 op_sel:[1,0,0] op_sel_hi:[1,0,0]
    v_cvt_pk_bf16_f32 v61, v6, v7
    v_mfma_f32_32x32x16_bf16 a[96:111], a[156:159], v[64:67], a[96:111]
    ds_read_b64_tr_b16 a[140:141], v18 offset:32768
    ds_read_b128 v[100:103], v3 offset:592
    buffer_load_dwordx4 v[140:143], v2, s[8:11], s61 offen offset:0 sc1
    v_fma_mix_f32 v8, v174, v76, v84 op_sel_hi:[1,0,0]
    v_fma_mix_f32 v9, v174, v77, v85 op_sel:[1,0,0] op_sel_hi:[1,0,0]
    v_cvt_pk_bf16_f32 v62, v8, v9
    s_add_u32 m0, s49, 81920
    s_add_u32 s62, s51, 2621440
    v_mfma_f32_32x32x16_bf16 a[112:127], a[156:159], v[68:71], a[112:127]
    ds_read_b64_tr_b16 a[142:143], v19 offset:32768
    buffer_load_dwordx4 v28, s[12:15], s62 offen offset:0 lds
    v_fma_mix_f32 v10, v175, v78, v86 op_sel_hi:[1,0,0]
    v_fma_mix_f32 v11, v175, v79, v87 op_sel:[1,0,0] op_sel_hi:[1,0,0]
    v_cvt_pk_bf16_f32 v63, v10, v11
    s_waitcnt vmcnt(19) lgkmcnt(6)
    v_mfma_f32_32x32x16_bf16 a[0:15], a[128:131], v[56:59], a[0:15]
    ds_read_b64_tr_b16 a[144:145], v12 offset:36864
    ds_read_b128 v[72:75], v3 offset:3200
    v_fma_mix_f32 v4, v176, v88, v96 op_sel_hi:[1,0,0]
    v_fma_mix_f32 v5, v176, v89, v97 op_sel:[1,0,0] op_sel_hi:[1,0,0]
    v_cvt_pk_bf16_f32 v64, v4, v5
    v_mfma_f32_32x32x16_bf16 a[16:31], a[128:131], v[60:63], a[16:31]
    ds_read_b64_tr_b16 a[146:147], v13 offset:36864
    v_fma_mix_f32 v6, v177, v90, v98 op_sel_hi:[1,0,0]
    v_fma_mix_f32 v7, v177, v91, v99 op_sel:[1,0,0] op_sel_hi:[1,0,0]
    v_cvt_pk_bf16_f32 v65, v6, v7
    s_waitcnt lgkmcnt(3)
    v_mfma_f32_32x32x16_bf16 a[32:47], a[132:135], v[56:59], a[32:47]
    ds_read_b64_tr_b16 a[148:149], v14 offset:36864
    ds_read_b128 v[80:83], v3 offset:640
    v_fma_mix_f32 v8, v178, v92, v100 op_sel_hi:[1,0,0]
    v_fma_mix_f32 v9, v178, v93, v101 op_sel:[1,0,0] op_sel_hi:[1,0,0]
    v_cvt_pk_bf16_f32 v66, v8, v9
    v_mfma_f32_32x32x16_bf16 a[48:63], a[132:135], v[60:63], a[48:63]
    ds_read_b64_tr_b16 a[150:151], v15 offset:36864
    buffer_load_dwordx4 v[144:147], v2, s[8:11], s60 offen offset:1024 sc1
    v_fma_mix_f32 v10, v179, v94, v102 op_sel_hi:[1,0,0]
    v_fma_mix_f32 v11, v179, v95, v103 op_sel:[1,0,0] op_sel_hi:[1,0,0]
    v_cvt_pk_bf16_f32 v67, v10, v11
    v_mfma_f32_32x32x16_bf16 a[64:79], a[136:139], v[56:59], a[64:79]
    ds_read_b64_tr_b16 a[152:153], v16 offset:36864
    ds_read_b128 v[76:79], v3 offset:3216
    v_fma_mix_f32 v4, v180, v88, v96 op_sel_hi:[1,0,0]
    v_fma_mix_f32 v5, v180, v89, v97 op_sel:[1,0,0] op_sel_hi:[1,0,0]
    v_cvt_pk_bf16_f32 v68, v4, v5
    v_mfma_f32_32x32x16_bf16 a[80:95], a[136:139], v[60:63], a[80:95]
    ds_read_b64_tr_b16 a[154:155], v17 offset:36864
    buffer_load_dwordx4 v[148:151], v2, s[8:11], s61 offen offset:1024 sc1
    v_fma_mix_f32 v6, v181, v90, v98 op_sel_hi:[1,0,0]
    v_fma_mix_f32 v7, v181, v91, v99 op_sel:[1,0,0] op_sel_hi:[1,0,0]
    v_cvt_pk_bf16_f32 v69, v6, v7
    v_mfma_f32_32x32x16_bf16 a[96:111], a[140:143], v[56:59], a[96:111]
    ds_read_b64_tr_b16 a[156:157], v18 offset:36864
    ds_read_b128 v[84:87], v3 offset:656
    v_fma_mix_f32 v8, v182, v92, v100 op_sel_hi:[1,0,0]
    v_fma_mix_f32 v9, v182, v93, v101 op_sel:[1,0,0] op_sel_hi:[1,0,0]
    v_cvt_pk_bf16_f32 v70, v8, v9
    v_mfma_f32_32x32x16_bf16 a[112:127], a[140:143], v[60:63], a[112:127]
    ds_read_b64_tr_b16 a[158:159], v19 offset:36864
    buffer_load_dwordx4 v29, s[12:15], s62 offen offset:1024 lds
    v_fma_mix_f32 v10, v183, v94, v102 op_sel_hi:[1,0,0]
    v_fma_mix_f32 v11, v183, v95, v103 op_sel:[1,0,0] op_sel_hi:[1,0,0]
    v_cvt_pk_bf16_f32 v71, v10, v11
    s_waitcnt vmcnt(20) lgkmcnt(6)
    v_mfma_f32_32x32x16_bf16 a[0:15], a[144:147], v[64:67], a[0:15]
    ds_read_b64_tr_b16 a[128:129], v12 offset:40960
    ds_read_b128 v[88:91], v3 offset:3264
    v_fma_mix_f32 v4, v184, v72, v80 op_sel_hi:[1,0,0]
    v_fma_mix_f32 v5, v184, v73, v81 op_sel:[1,0,0] op_sel_hi:[1,0,0]
    v_cvt_pk_bf16_f32 v56, v4, v5
    v_mfma_f32_32x32x16_bf16 a[16:31], a[144:147], v[68:71], a[16:31]
    ds_read_b64_tr_b16 a[130:131], v13 offset:40960
    buffer_load_dwordx4 v[152:155], v2, s[8:11], s60 offen offset:2048 sc1
    v_fma_mix_f32 v6, v185, v74, v82 op_sel_hi:[1,0,0]
    v_fma_mix_f32 v7, v185, v75, v83 op_sel:[1,0,0] op_sel_hi:[1,0,0]
    v_cvt_pk_bf16_f32 v57, v6, v7
    s_waitcnt lgkmcnt(3)
    v_mfma_f32_32x32x16_bf16 a[32:47], a[148:151], v[64:67], a[32:47]
    ds_read_b64_tr_b16 a[132:133], v14 offset:40960
    ds_read_b128 v[96:99], v3 offset:704
    v_fma_mix_f32 v8, v186, v76, v84 op_sel_hi:[1,0,0]
    v_fma_mix_f32 v9, v186, v77, v85 op_sel:[1,0,0] op_sel_hi:[1,0,0]
    v_cvt_pk_bf16_f32 v58, v8, v9
    v_mfma_f32_32x32x16_bf16 a[48:63], a[148:151], v[68:71], a[48:63]
    ds_read_b64_tr_b16 a[134:135], v15 offset:40960
    buffer_load_dwordx4 v[156:159], v2, s[8:11], s61 offen offset:2048 sc1
    v_fma_mix_f32 v10, v187, v78, v86 op_sel_hi:[1,0,0]
    v_fma_mix_f32 v11, v187, v79, v87 op_sel:[1,0,0] op_sel_hi:[1,0,0]
    v_cvt_pk_bf16_f32 v59, v10, v11
    v_mfma_f32_32x32x16_bf16 a[64:79], a[152:155], v[64:67], a[64:79]
    ds_read_b64_tr_b16 a[136:137], v16 offset:40960
    ds_read_b128 v[92:95], v3 offset:3280
    buffer_load_dwordx4 v[160:163], v2, s[8:11], s60 offen offset:3072 sc1
    v_fma_mix_f32 v4, v188, v72, v80 op_sel_hi:[1,0,0]
    v_fma_mix_f32 v5, v188, v73, v81 op_sel:[1,0,0] op_sel_hi:[1,0,0]
    v_cvt_pk_bf16_f32 v60, v4, v5
    v_mfma_f32_32x32x16_bf16 a[80:95], a[152:155], v[68:71], a[80:95]
    ds_read_b64_tr_b16 a[138:139], v17 offset:40960
    buffer_load_dwordx4 v[164:167], v2, s[8:11], s61 offen offset:3072 sc1
    v_fma_mix_f32 v6, v189, v74, v82 op_sel_hi:[1,0,0]
    v_fma_mix_f32 v7, v189, v75, v83 op_sel:[1,0,0] op_sel_hi:[1,0,0]
    v_cvt_pk_bf16_f32 v61, v6, v7
    v_mfma_f32_32x32x16_bf16 a[96:111], a[156:159], v[64:67], a[96:111]
    ds_read_b64_tr_b16 a[140:141], v18 offset:40960
    ds_read_b128 v[100:103], v3 offset:720
    v_fma_mix_f32 v8, v190, v76, v84 op_sel_hi:[1,0,0]
    v_fma_mix_f32 v9, v190, v77, v85 op_sel:[1,0,0] op_sel_hi:[1,0,0]
    v_cvt_pk_bf16_f32 v62, v8, v9
    v_mfma_f32_32x32x16_bf16 a[112:127], a[156:159], v[68:71], a[112:127]
    ds_read_b64_tr_b16 a[142:143], v19 offset:40960
    buffer_load_dwordx4 v30, s[12:15], s62 offen offset:2048 lds
    v_fma_mix_f32 v10, v191, v78, v86 op_sel_hi:[1,0,0]
    v_fma_mix_f32 v11, v191, v79, v87 op_sel:[1,0,0] op_sel_hi:[1,0,0]
    v_cvt_pk_bf16_f32 v63, v10, v11
    s_waitcnt vmcnt(23) lgkmcnt(6)
    v_mfma_f32_32x32x16_bf16 a[0:15], a[128:131], v[56:59], a[0:15]
    ds_read_b64_tr_b16 a[144:145], v12 offset:45056
    ds_read_b128 v[72:75], v3 offset:3328
    v_fma_mix_f32 v4, v192, v88, v96 op_sel_hi:[1,0,0]
    v_fma_mix_f32 v5, v192, v89, v97 op_sel:[1,0,0] op_sel_hi:[1,0,0]
    v_cvt_pk_bf16_f32 v64, v4, v5
    v_mfma_f32_32x32x16_bf16 a[16:31], a[128:131], v[60:63], a[16:31]
    ds_read_b64_tr_b16 a[146:147], v13 offset:45056
    v_fma_mix_f32 v6, v193, v90, v98 op_sel_hi:[1,0,0]
    v_fma_mix_f32 v7, v193, v91, v99 op_sel:[1,0,0] op_sel_hi:[1,0,0]
    v_cvt_pk_bf16_f32 v65, v6, v7
    s_waitcnt lgkmcnt(3)
    v_mfma_f32_32x32x16_bf16 a[32:47], a[132:135], v[56:59], a[32:47]
    ds_read_b64_tr_b16 a[148:149], v14 offset:45056
    ds_read_b128 v[80:83], v3 offset:768
    v_fma_mix_f32 v8, v194, v92, v100 op_sel_hi:[1,0,0]
    v_fma_mix_f32 v9, v194, v93, v101 op_sel:[1,0,0] op_sel_hi:[1,0,0]
    v_cvt_pk_bf16_f32 v66, v8, v9
    s_add_u32 s60, s52, 20480
    s_add_u32 s61, s52, 61440
    v_mfma_f32_32x32x16_bf16 a[48:63], a[132:135], v[60:63], a[48:63]
    ds_read_b64_tr_b16 a[150:151], v15 offset:45056
    buffer_load_dwordx4 v[168:171], v2, s[8:11], s60 offen offset:0 sc1
    v_fma_mix_f32 v10, v195, v94, v102 op_sel_hi:[1,0,0]
    v_fma_mix_f32 v11, v195, v95, v103 op_sel:[1,0,0] op_sel_hi:[1,0,0]
    v_cvt_pk_bf16_f32 v67, v10, v11
    v_mfma_f32_32x32x16_bf16 a[64:79], a[136:139], v[56:59], a[64:79]
    ds_read_b64_tr_b16 a[152:153], v16 offset:45056
    ds_read_b128 v[76:79], v3 offset:3344
    v_fma_mix_f32 v4, v196, v88, v96 op_sel_hi:[1,0,0]
    v_fma_mix_f32 v5, v196, v89, v97 op_sel:[1,0,0] op_sel_hi:[1,0,0]
    v_cvt_pk_bf16_f32 v68, v4, v5
    v_mfma_f32_32x32x16_bf16 a[80:95], a[136:139], v[60:63], a[80:95]
    ds_read_b64_tr_b16 a[154:155], v17 offset:45056
    buffer_load_dwordx4 v[172:175], v2, s[8:11], s61 offen offset:0 sc1
    v_fma_mix_f32 v6, v197, v90, v98 op_sel_hi:[1,0,0]
    v_fma_mix_f32 v7, v197, v91, v99 op_sel:[1,0,0] op_sel_hi:[1,0,0]
    v_cvt_pk_bf16_f32 v69, v6, v7
    v_mfma_f32_32x32x16_bf16 a[96:111], a[140:143], v[56:59], a[96:111]
    ds_read_b64_tr_b16 a[156:157], v18 offset:45056
    ds_read_b128 v[84:87], v3 offset:784
    v_fma_mix_f32 v8, v198, v92, v100 op_sel_hi:[1,0,0]
    v_fma_mix_f32 v9, v198, v93, v101 op_sel:[1,0,0] op_sel_hi:[1,0,0]
    v_cvt_pk_bf16_f32 v70, v8, v9
    v_mfma_f32_32x32x16_bf16 a[112:127], a[140:143], v[60:63], a[112:127]
    ds_read_b64_tr_b16 a[158:159], v19 offset:45056
    buffer_load_dwordx4 v31, s[12:15], s62 offen offset:3072 lds
    v_fma_mix_f32 v10, v199, v94, v102 op_sel_hi:[1,0,0]
    v_fma_mix_f32 v11, v199, v95, v103 op_sel:[1,0,0] op_sel_hi:[1,0,0]
    v_cvt_pk_bf16_f32 v71, v10, v11
    s_waitcnt vmcnt(23) lgkmcnt(6)
    v_mfma_f32_32x32x16_bf16 a[0:15], a[144:147], v[64:67], a[0:15]
    ds_read_b64_tr_b16 a[128:129], v12 offset:49152
    ds_read_b128 v[88:91], v3 offset:3392
    v_fma_mix_f32 v4, v104, v72, v80 op_sel_hi:[1,0,0]
    v_fma_mix_f32 v5, v104, v73, v81 op_sel:[1,0,0] op_sel_hi:[1,0,0]
    v_cvt_pk_bf16_f32 v56, v4, v5
    v_mfma_f32_32x32x16_bf16 a[16:31], a[144:147], v[68:71], a[16:31]
    ds_read_b64_tr_b16 a[130:131], v13 offset:49152
    v_fma_mix_f32 v6, v105, v74, v82 op_sel_hi:[1,0,0]
    v_fma_mix_f32 v7, v105, v75, v83 op_sel:[1,0,0] op_sel_hi:[1,0,0]
    v_cvt_pk_bf16_f32 v57, v6, v7
    s_waitcnt lgkmcnt(3)
    v_mfma_f32_32x32x16_bf16 a[32:47], a[148:151], v[64:67], a[32:47]
    ds_read_b64_tr_b16 a[132:133], v14 offset:49152
    ds_read_b128 v[96:99], v3 offset:832
    v_fma_mix_f32 v8, v106, v76, v84 op_sel_hi:[1,0,0]
    v_fma_mix_f32 v9, v106, v77, v85 op_sel:[1,0,0] op_sel_hi:[1,0,0]
    v_cvt_pk_bf16_f32 v58, v8, v9
    v_mfma_f32_32x32x16_bf16 a[48:63], a[148:151], v[68:71], a[48:63]
    ds_read_b64_tr_b16 a[134:135], v15 offset:49152
    buffer_load_dwordx4 v[176:179], v2, s[8:11], s60 offen offset:1024 sc1
    v_fma_mix_f32 v10, v107, v78, v86 op_sel_hi:[1,0,0]
    v_fma_mix_f32 v11, v107, v79, v87 op_sel:[1,0,0] op_sel_hi:[1,0,0]
    v_cvt_pk_bf16_f32 v59, v10, v11
    v_mfma_f32_32x32x16_bf16 a[64:79], a[152:155], v[64:67], a[64:79]
    ds_read_b64_tr_b16 a[136:137], v16 offset:49152
    ds_read_b128 v[92:95], v3 offset:3408
    v_fma_mix_f32 v4, v108, v72, v80 op_sel_hi:[1,0,0]
    v_fma_mix_f32 v5, v108, v73, v81 op_sel:[1,0,0] op_sel_hi:[1,0,0]
    v_cvt_pk_bf16_f32 v60, v4, v5
    v_mfma_f32_32x32x16_bf16 a[80:95], a[152:155], v[68:71], a[80:95]
    ds_read_b64_tr_b16 a[138:139], v17 offset:49152
    buffer_load_dwordx4 v[180:183], v2, s[8:11], s61 offen offset:1024 sc1
    v_fma_mix_f32 v6, v109, v74, v82 op_sel_hi:[1,0,0]
    v_fma_mix_f32 v7, v109, v75, v83 op_sel:[1,0,0] op_sel_hi:[1,0,0]
    v_cvt_pk_bf16_f32 v61, v6, v7
    v_mfma_f32_32x32x16_bf16 a[96:111], a[156:159], v[64:67], a[96:111]
    ds_read_b64_tr_b16 a[140:141], v18 offset:49152
    ds_read_b128 v[100:103], v3 offset:848
    v_fma_mix_f32 v8, v110, v76, v84 op_sel_hi:[1,0,0]
    v_fma_mix_f32 v9, v110, v77, v85 op_sel:[1,0,0] op_sel_hi:[1,0,0]
    v_cvt_pk_bf16_f32 v62, v8, v9
    s_add_u32 m0, s49, 98304
    s_add_u32 s62, s51, 3145728
    v_mfma_f32_32x32x16_bf16 a[112:127], a[156:159], v[68:71], a[112:127]
    ds_read_b64_tr_b16 a[142:143], v19 offset:49152
    buffer_load_dwordx4 v28, s[12:15], s62 offen offset:0 lds
    v_fma_mix_f32 v10, v111, v78, v86 op_sel_hi:[1,0,0]
    v_fma_mix_f32 v11, v111, v79, v87 op_sel:[1,0,0] op_sel_hi:[1,0,0]
    v_cvt_pk_bf16_f32 v63, v10, v11
    s_waitcnt vmcnt(23) lgkmcnt(6)
    v_mfma_f32_32x32x16_bf16 a[0:15], a[128:131], v[56:59], a[0:15]
    ds_read_b64_tr_b16 a[144:145], v12 offset:53248
    ds_read_b128 v[72:75], v3 offset:3456
    v_fma_mix_f32 v4, v112, v88, v96 op_sel_hi:[1,0,0]
    v_fma_mix_f32 v5, v112, v89, v97 op_sel:[1,0,0] op_sel_hi:[1,0,0]
    v_cvt_pk_bf16_f32 v64, v4, v5
    v_mfma_f32_32x32x16_bf16 a[16:31], a[128:131], v[60:63], a[16:31]
    ds_read_b64_tr_b16 a[146:147], v13 offset:53248
    v_fma_mix_f32 v6, v113, v90, v98 op_sel_hi:[1,0,0]
    v_fma_mix_f32 v7, v113, v91, v99 op_sel:[1,0,0] op_sel_hi:[1,0,0]
    v_cvt_pk_bf16_f32 v65, v6, v7
    s_waitcnt lgkmcnt(3)
    v_mfma_f32_32x32x16_bf16 a[32:47], a[132:135], v[56:59], a[32:47]
    ds_read_b64_tr_b16 a[148:149], v14 offset:53248
    ds_read_b128 v[80:83], v3 offset:896
    v_fma_mix_f32 v8, v114, v92, v100 op_sel_hi:[1,0,0]
    v_fma_mix_f32 v9, v114, v93, v101 op_sel:[1,0,0] op_sel_hi:[1,0,0]
    v_cvt_pk_bf16_f32 v66, v8, v9
    v_mfma_f32_32x32x16_bf16 a[48:63], a[132:135], v[60:63], a[48:63]
    ds_read_b64_tr_b16 a[150:151], v15 offset:53248
    buffer_load_dwordx4 v[184:187], v2, s[8:11], s60 offen offset:2048 sc1
    v_fma_mix_f32 v10, v115, v94, v102 op_sel_hi:[1,0,0]
    v_fma_mix_f32 v11, v115, v95, v103 op_sel:[1,0,0] op_sel_hi:[1,0,0]
    v_cvt_pk_bf16_f32 v67, v10, v11
    v_mfma_f32_32x32x16_bf16 a[64:79], a[136:139], v[56:59], a[64:79]
    ds_read_b64_tr_b16 a[152:153], v16 offset:53248
    ds_read_b128 v[76:79], v3 offset:3472
    v_fma_mix_f32 v4, v116, v88, v96 op_sel_hi:[1,0,0]
    v_fma_mix_f32 v5, v116, v89, v97 op_sel:[1,0,0] op_sel_hi:[1,0,0]
    v_cvt_pk_bf16_f32 v68, v4, v5
    v_mfma_f32_32x32x16_bf16 a[80:95], a[136:139], v[60:63], a[80:95]
    ds_read_b64_tr_b16 a[154:155], v17 offset:53248
    buffer_load_dwordx4 v[188:191], v2, s[8:11], s61 offen offset:2048 sc1
    v_fma_mix_f32 v6, v117, v90, v98 op_sel_hi:[1,0,0]
    v_fma_mix_f32 v7, v117, v91, v99 op_sel:[1,0,0] op_sel_hi:[1,0,0]
    v_cvt_pk_bf16_f32 v69, v6, v7
    v_mfma_f32_32x32x16_bf16 a[96:111], a[140:143], v[56:59], a[96:111]
    ds_read_b64_tr_b16 a[156:157], v18 offset:53248
    ds_read_b128 v[84:87], v3 offset:912
    v_fma_mix_f32 v8, v118, v92, v100 op_sel_hi:[1,0,0]
    v_fma_mix_f32 v9, v118, v93, v101 op_sel:[1,0,0] op_sel_hi:[1,0,0]
    v_cvt_pk_bf16_f32 v70, v8, v9
    v_mfma_f32_32x32x16_bf16 a[112:127], a[140:143], v[60:63], a[112:127]
    ds_read_b64_tr_b16 a[158:159], v19 offset:53248
    buffer_load_dwordx4 v29, s[12:15], s62 offen offset:1024 lds
    v_fma_mix_f32 v10, v119, v94, v102 op_sel_hi:[1,0,0]
    v_fma_mix_f32 v11, v119, v95, v103 op_sel:[1,0,0] op_sel_hi:[1,0,0]
    v_cvt_pk_bf16_f32 v71, v10, v11
    s_waitcnt vmcnt(24) lgkmcnt(6)
    v_mfma_f32_32x32x16_bf16 a[0:15], a[144:147], v[64:67], a[0:15]
    ds_read_b64_tr_b16 a[128:129], v12 offset:57344
    ds_read_b128 v[88:91], v3 offset:3520
    v_fma_mix_f32 v4, v120, v72, v80 op_sel_hi:[1,0,0]
    v_fma_mix_f32 v5, v120, v73, v81 op_sel:[1,0,0] op_sel_hi:[1,0,0]
    v_cvt_pk_bf16_f32 v56, v4, v5
    v_mfma_f32_32x32x16_bf16 a[16:31], a[144:147], v[68:71], a[16:31]
    ds_read_b64_tr_b16 a[130:131], v13 offset:57344
    buffer_load_dwordx4 v[192:195], v2, s[8:11], s60 offen offset:3072 sc1
    v_fma_mix_f32 v6, v121, v74, v82 op_sel_hi:[1,0,0]
    v_fma_mix_f32 v7, v121, v75, v83 op_sel:[1,0,0] op_sel_hi:[1,0,0]
    v_cvt_pk_bf16_f32 v57, v6, v7
    s_waitcnt lgkmcnt(3)
    v_mfma_f32_32x32x16_bf16 a[32:47], a[148:151], v[64:67], a[32:47]
    ds_read_b64_tr_b16 a[132:133], v14 offset:57344
    ds_read_b128 v[96:99], v3 offset:960
    v_fma_mix_f32 v8, v122, v76, v84 op_sel_hi:[1,0,0]
    v_fma_mix_f32 v9, v122, v77, v85 op_sel:[1,0,0] op_sel_hi:[1,0,0]
    v_cvt_pk_bf16_f32 v58, v8, v9
    v_mfma_f32_32x32x16_bf16 a[48:63], a[148:151], v[68:71], a[48:63]
    ds_read_b64_tr_b16 a[134:135], v15 offset:57344
    buffer_load_dwordx4 v[196:199], v2, s[8:11], s61 offen offset:3072 sc1
    v_fma_mix_f32 v10, v123, v78, v86 op_sel_hi:[1,0,0]
    v_fma_mix_f32 v11, v123, v79, v87 op_sel:[1,0,0] op_sel_hi:[1,0,0]
    v_cvt_pk_bf16_f32 v59, v10, v11
    s_add_u32 s60, s52, 24576
    s_add_u32 s61, s52, 65536
    v_mfma_f32_32x32x16_bf16 a[64:79], a[152:155], v[64:67], a[64:79]
    ds_read_b64_tr_b16 a[136:137], v16 offset:57344
    ds_read_b128 v[92:95], v3 offset:3536
    buffer_load_dwordx4 v[104:107], v2, s[8:11], s60 offen offset:0 sc1
    v_fma_mix_f32 v4, v124, v72, v80 op_sel_hi:[1,0,0]
    v_fma_mix_f32 v5, v124, v73, v81 op_sel:[1,0,0] op_sel_hi:[1,0,0]
    v_cvt_pk_bf16_f32 v60, v4, v5
    v_mfma_f32_32x32x16_bf16 a[80:95], a[152:155], v[68:71], a[80:95]
    ds_read_b64_tr_b16 a[138:139], v17 offset:57344
    buffer_load_dwordx4 v[108:111], v2, s[8:11], s61 offen offset:0 sc1
    v_fma_mix_f32 v6, v125, v74, v82 op_sel_hi:[1,0,0]
    v_fma_mix_f32 v7, v125, v75, v83 op_sel:[1,0,0] op_sel_hi:[1,0,0]
    v_cvt_pk_bf16_f32 v61, v6, v7
    v_mfma_f32_32x32x16_bf16 a[96:111], a[156:159], v[64:67], a[96:111]
    ds_read_b64_tr_b16 a[140:141], v18 offset:57344
    ds_read_b128 v[100:103], v3 offset:976
    v_fma_mix_f32 v8, v126, v76, v84 op_sel_hi:[1,0,0]
    v_fma_mix_f32 v9, v126, v77, v85 op_sel:[1,0,0] op_sel_hi:[1,0,0]
    v_cvt_pk_bf16_f32 v62, v8, v9
    v_mfma_f32_32x32x16_bf16 a[112:127], a[156:159], v[68:71], a[112:127]
    ds_read_b64_tr_b16 a[142:143], v19 offset:57344
    buffer_load_dwordx4 v30, s[12:15], s62 offen offset:2048 lds
    v_fma_mix_f32 v10, v127, v78, v86 op_sel_hi:[1,0,0]
    v_fma_mix_f32 v11, v127, v79, v87 op_sel:[1,0,0] op_sel_hi:[1,0,0]
    v_cvt_pk_bf16_f32 v63, v10, v11
    s_waitcnt vmcnt(26) lgkmcnt(6)
    v_mfma_f32_32x32x16_bf16 a[0:15], a[128:131], v[56:59], a[0:15]
    ds_read_b64_tr_b16 a[144:145], v12 offset:61440
    ds_read_b128 v[72:75], v3 offset:3584
    v_fma_mix_f32 v4, v128, v88, v96 op_sel_hi:[1,0,0]
    v_fma_mix_f32 v5, v128, v89, v97 op_sel:[1,0,0] op_sel_hi:[1,0,0]
    v_cvt_pk_bf16_f32 v64, v4, v5
    v_mfma_f32_32x32x16_bf16 a[16:31], a[128:131], v[60:63], a[16:31]
    ds_read_b64_tr_b16 a[146:147], v13 offset:61440
    v_fma_mix_f32 v6, v129, v90, v98 op_sel_hi:[1,0,0]
    v_fma_mix_f32 v7, v129, v91, v99 op_sel:[1,0,0] op_sel_hi:[1,0,0]
    v_cvt_pk_bf16_f32 v65, v6, v7
    s_waitcnt lgkmcnt(3)
    v_mfma_f32_32x32x16_bf16 a[32:47], a[132:135], v[56:59], a[32:47]
    ds_read_b64_tr_b16 a[148:149], v14 offset:61440
    ds_read_b128 v[80:83], v3 offset:1024
    v_fma_mix_f32 v8, v130, v92, v100 op_sel_hi:[1,0,0]
    v_fma_mix_f32 v9, v130, v93, v101 op_sel:[1,0,0] op_sel_hi:[1,0,0]
    v_cvt_pk_bf16_f32 v66, v8, v9
    v_mfma_f32_32x32x16_bf16 a[48:63], a[132:135], v[60:63], a[48:63]
    ds_read_b64_tr_b16 a[150:151], v15 offset:61440
    buffer_load_dwordx4 v[112:115], v2, s[8:11], s60 offen offset:1024 sc1
    v_fma_mix_f32 v10, v131, v94, v102 op_sel_hi:[1,0,0]
    v_fma_mix_f32 v11, v131, v95, v103 op_sel:[1,0,0] op_sel_hi:[1,0,0]
    v_cvt_pk_bf16_f32 v67, v10, v11
    v_mfma_f32_32x32x16_bf16 a[64:79], a[136:139], v[56:59], a[64:79]
    ds_read_b64_tr_b16 a[152:153], v16 offset:61440
    ds_read_b128 v[76:79], v3 offset:3600
    v_fma_mix_f32 v4, v132, v88, v96 op_sel_hi:[1,0,0]
    v_fma_mix_f32 v5, v132, v89, v97 op_sel:[1,0,0] op_sel_hi:[1,0,0]
    v_cvt_pk_bf16_f32 v68, v4, v5
    v_mfma_f32_32x32x16_bf16 a[80:95], a[136:139], v[60:63], a[80:95]
    ds_read_b64_tr_b16 a[154:155], v17 offset:61440
    buffer_load_dwordx4 v[116:119], v2, s[8:11], s61 offen offset:1024 sc1
    v_fma_mix_f32 v6, v133, v90, v98 op_sel_hi:[1,0,0]
    v_fma_mix_f32 v7, v133, v91, v99 op_sel:[1,0,0] op_sel_hi:[1,0,0]
    v_cvt_pk_bf16_f32 v69, v6, v7
    v_mfma_f32_32x32x16_bf16 a[96:111], a[140:143], v[56:59], a[96:111]
    ds_read_b64_tr_b16 a[156:157], v18 offset:61440
    ds_read_b128 v[84:87], v3 offset:1040
    v_fma_mix_f32 v8, v134, v92, v100 op_sel_hi:[1,0,0]
    v_fma_mix_f32 v9, v134, v93, v101 op_sel:[1,0,0] op_sel_hi:[1,0,0]
    v_cvt_pk_bf16_f32 v70, v8, v9
    v_mfma_f32_32x32x16_bf16 a[112:127], a[140:143], v[60:63], a[112:127]
    ds_read_b64_tr_b16 a[158:159], v19 offset:61440
    buffer_load_dwordx4 v31, s[12:15], s62 offen offset:3072 lds
    v_fma_mix_f32 v10, v135, v94, v102 op_sel_hi:[1,0,0]
    v_fma_mix_f32 v11, v135, v95, v103 op_sel:[1,0,0] op_sel_hi:[1,0,0]
    v_cvt_pk_bf16_f32 v71, v10, v11
    s_waitcnt vmcnt(14) lgkmcnt(6)
    v_mfma_f32_32x32x16_bf16 a[0:15], a[144:147], v[64:67], a[0:15]
    s_barrier
    v_mfma_f32_32x32x16_bf16 a[16:31], a[144:147], v[68:71], a[16:31]
    ds_read_b64_tr_b16 a[128:129], v20 offset:0
    ds_read_b64_tr_b16 a[130:131], v21 offset:0
    v_fma_mix_f32 v4, v136, v72, v80 op_sel_hi:[1,0,0]
    v_fma_mix_f32 v5, v136, v73, v81 op_sel:[1,0,0] op_sel_hi:[1,0,0]
    v_cvt_pk_bf16_f32 v56, v4, v5
    s_waitcnt lgkmcnt(2)
    v_mfma_f32_32x32x16_bf16 a[32:47], a[148:151], v[64:67], a[32:47]
    ds_read_b64_tr_b16 a[132:133], v22 offset:0
    ds_read_b128 v[88:91], v3 offset:3648
    v_fma_mix_f32 v6, v137, v74, v82 op_sel_hi:[1,0,0]
    v_fma_mix_f32 v7, v137, v75, v83 op_sel:[1,0,0] op_sel_hi:[1,0,0]
    v_cvt_pk_bf16_f32 v57, v6, v7
    v_fma_mix_f32 v8, v138, v76, v84 op_sel_hi:[1,0,0]
    v_mfma_f32_32x32x16_bf16 a[48:63], a[148:151], v[68:71], a[48:63]
    ds_read_b64_tr_b16 a[134:135], v23 offset:0
    ds_read_b128 v[96:99], v3 offset:1088
    v_fma_mix_f32 v9, v138, v77, v85 op_sel:[1,0,0] op_sel_hi:[1,0,0]
    v_cvt_pk_bf16_f32 v58, v8, v9
    v_fma_mix_f32 v10, v139, v78, v86 op_sel_hi:[1,0,0]
    v_fma_mix_f32 v11, v139, v79, v87 op_sel:[1,0,0] op_sel_hi:[1,0,0]
    v_mfma_f32_32x32x16_bf16 a[64:79], a[152:155], v[64:67], a[64:79]
    ds_read_b64_tr_b16 a[136:137], v24 offset:0
    ds_read_b128 v[92:95], v3 offset:3664
    v_cvt_pk_bf16_f32 v59, v10, v11
    v_fma_mix_f32 v4, v140, v72, v80 op_sel_hi:[1,0,0]
    v_fma_mix_f32 v5, v140, v73, v81 op_sel:[1,0,0] op_sel_hi:[1,0,0]
    v_cvt_pk_bf16_f32 v60, v4, v5
    v_mfma_f32_32x32x16_bf16 a[80:95], a[152:155], v[68:71], a[80:95]
    ds_read_b64_tr_b16 a[138:139], v25 offset:0
    buffer_load_dwordx4 v[120:123], v2, s[8:11], s60 offen offset:2048 sc1
    v_fma_mix_f32 v6, v141, v74, v82 op_sel_hi:[1,0,0]
    v_fma_mix_f32 v7, v141, v75, v83 op_sel:[1,0,0] op_sel_hi:[1,0,0]
    v_cvt_pk_bf16_f32 v61, v6, v7
    v_mfma_f32_32x32x16_bf16 a[96:111], a[156:159], v[64:67], a[96:111]
    ds_read_b64_tr_b16 a[140:141], v26 offset:0
    ds_read_b128 v[100:103], v3 offset:1104
    buffer_load_dwordx4 v[124:127], v2, s[8:11], s61 offen offset:2048 sc1
    v_fma_mix_f32 v8, v142, v76, v84 op_sel_hi:[1,0,0]
    v_fma_mix_f32 v9, v142, v77, v85 op_sel:[1,0,0] op_sel_hi:[1,0,0]
    v_cvt_pk_bf16_f32 v62, v8, v9
    s_add_u32 m0, s49, 114688
    s_add_u32 s62, s51, 3670016
    v_mfma_f32_32x32x16_bf16 a[112:127], a[156:159], v[68:71], a[112:127]
    ds_read_b64_tr_b16 a[142:143], v27 offset:0
    buffer_load_dwordx4 v28, s[12:15], s62 offen offset:0 lds
    v_fma_mix_f32 v10, v143, v78, v86 op_sel_hi:[1,0,0]
    v_fma_mix_f32 v11, v143, v79, v87 op_sel:[1,0,0] op_sel_hi:[1,0,0]
    v_cvt_pk_bf16_f32 v63, v10, v11
    s_waitcnt lgkmcnt(6)
    v_mfma_f32_32x32x16_bf16 a[0:15], a[128:131], v[56:59], a[0:15]
    ds_read_b64_tr_b16 a[144:145], v20 offset:4096
    ds_read_b128 v[72:75], v3 offset:3712
    v_fma_mix_f32 v4, v144, v88, v96 op_sel_hi:[1,0,0]
    v_fma_mix_f32 v5, v144, v89, v97 op_sel:[1,0,0] op_sel_hi:[1,0,0]
    v_cvt_pk_bf16_f32 v64, v4, v5
    v_mfma_f32_32x32x16_bf16 a[16:31], a[128:131], v[60:63], a[16:31]
    ds_read_b64_tr_b16 a[146:147], v21 offset:4096
    v_fma_mix_f32 v6, v145, v90, v98 op_sel_hi:[1,0,0]
    v_fma_mix_f32 v7, v145, v91, v99 op_sel:[1,0,0] op_sel_hi:[1,0,0]
    v_cvt_pk_bf16_f32 v65, v6, v7
    s_waitcnt lgkmcnt(3)
    v_mfma_f32_32x32x16_bf16 a[32:47], a[132:135], v[56:59], a[32:47]
    ds_read_b64_tr_b16 a[148:149], v22 offset:4096
    ds_read_b128 v[80:83], v3 offset:1152
    v_fma_mix_f32 v8, v146, v92, v100 op_sel_hi:[1,0,0]
    v_fma_mix_f32 v9, v146, v93, v101 op_sel:[1,0,0] op_sel_hi:[1,0,0]
    v_cvt_pk_bf16_f32 v66, v8, v9
    v_mfma_f32_32x32x16_bf16 a[48:63], a[132:135], v[60:63], a[48:63]
    ds_read_b64_tr_b16 a[150:151], v23 offset:4096
    buffer_load_dwordx4 v[128:131], v2, s[8:11], s60 offen offset:3072 sc1
    v_fma_mix_f32 v10, v147, v94, v102 op_sel_hi:[1,0,0]
    v_fma_mix_f32 v11, v147, v95, v103 op_sel:[1,0,0] op_sel_hi:[1,0,0]
    v_cvt_pk_bf16_f32 v67, v10, v11
    v_mfma_f32_32x32x16_bf16 a[64:79], a[136:139], v[56:59], a[64:79]
    ds_read_b64_tr_b16 a[152:153], v24 offset:4096
    ds_read_b128 v[76:79], v3 offset:3728
    v_fma_mix_f32 v4, v148, v88, v96 op_sel_hi:[1,0,0]
    v_fma_mix_f32 v5, v148, v89, v97 op_sel:[1,0,0] op_sel_hi:[1,0,0]
    v_cvt_pk_bf16_f32 v68, v4, v5
    v_mfma_f32_32x32x16_bf16 a[80:95], a[136:139], v[60:63], a[80:95]
    ds_read_b64_tr_b16 a[154:155], v25 offset:4096
    buffer_load_dwordx4 v[132:135], v2, s[8:11], s61 offen offset:3072 sc1
    v_fma_mix_f32 v6, v149, v90, v98 op_sel_hi:[1,0,0]
    v_fma_mix_f32 v7, v149, v91, v99 op_sel:[1,0,0] op_sel_hi:[1,0,0]
    v_cvt_pk_bf16_f32 v69, v6, v7
    v_mfma_f32_32x32x16_bf16 a[96:111], a[140:143], v[56:59], a[96:111]
    ds_read_b64_tr_b16 a[156:157], v26 offset:4096
    ds_read_b128 v[84:87], v3 offset:1168
    v_fma_mix_f32 v8, v150, v92, v100 op_sel_hi:[1,0,0]
    v_fma_mix_f32 v9, v150, v93, v101 op_sel:[1,0,0] op_sel_hi:[1,0,0]
    v_cvt_pk_bf16_f32 v70, v8, v9
    v_mfma_f32_32x32x16_bf16 a[112:127], a[140:143], v[60:63], a[112:127]
    ds_read_b64_tr_b16 a[158:159], v27 offset:4096
    buffer_load_dwordx4 v29, s[12:15], s62 offen offset:1024 lds
    v_fma_mix_f32 v10, v151, v94, v102 op_sel_hi:[1,0,0]
    v_fma_mix_f32 v11, v151, v95, v103 op_sel:[1,0,0] op_sel_hi:[1,0,0]
    v_cvt_pk_bf16_f32 v71, v10, v11
    s_waitcnt lgkmcnt(6)
    v_mfma_f32_32x32x16_bf16 a[0:15], a[144:147], v[64:67], a[0:15]
    ds_read_b64_tr_b16 a[128:129], v20 offset:8192
    ds_read_b128 v[88:91], v3 offset:3776
    v_fma_mix_f32 v4, v152, v72, v80 op_sel_hi:[1,0,0]
    v_fma_mix_f32 v5, v152, v73, v81 op_sel:[1,0,0] op_sel_hi:[1,0,0]
    v_cvt_pk_bf16_f32 v56, v4, v5
    v_mfma_f32_32x32x16_bf16 a[16:31], a[144:147], v[68:71], a[16:31]
    ds_read_b64_tr_b16 a[130:131], v21 offset:8192
    v_fma_mix_f32 v6, v153, v74, v82 op_sel_hi:[1,0,0]
    v_fma_mix_f32 v7, v153, v75, v83 op_sel:[1,0,0] op_sel_hi:[1,0,0]
    v_cvt_pk_bf16_f32 v57, v6, v7
    s_waitcnt lgkmcnt(3)
    v_mfma_f32_32x32x16_bf16 a[32:47], a[148:151], v[64:67], a[32:47]
    ds_read_b64_tr_b16 a[132:133], v22 offset:8192
    ds_read_b128 v[96:99], v3 offset:1216
    v_fma_mix_f32 v8, v154, v76, v84 op_sel_hi:[1,0,0]
    v_fma_mix_f32 v9, v154, v77, v85 op_sel:[1,0,0] op_sel_hi:[1,0,0]
    v_cvt_pk_bf16_f32 v58, v8, v9
    s_add_u32 s60, s52, 28672
    s_add_u32 s61, s52, 69632
    v_mfma_f32_32x32x16_bf16 a[48:63], a[148:151], v[68:71], a[48:63]
    ds_read_b64_tr_b16 a[134:135], v23 offset:8192
    buffer_load_dwordx4 v[136:139], v2, s[8:11], s60 offen offset:0 sc1
    v_fma_mix_f32 v10, v155, v78, v86 op_sel_hi:[1,0,0]
    v_fma_mix_f32 v11, v155, v79, v87 op_sel:[1,0,0] op_sel_hi:[1,0,0]
    v_cvt_pk_bf16_f32 v59, v10, v11
    v_mfma_f32_32x32x16_bf16 a[64:79], a[152:155], v[64:67], a[64:79]
    ds_read_b64_tr_b16 a[136:137], v24 offset:8192
    ds_read_b128 v[92:95], v3 offset:3792
    v_fma_mix_f32 v4, v156, v72, v80 op_sel_hi:[1,0,0]
    v_fma_mix_f32 v5, v156, v73, v81 op_sel:[1,0,0] op_sel_hi:[1,0,0]
    v_cvt_pk_bf16_f32 v60, v4, v5
    v_mfma_f32_32x32x16_bf16 a[80:95], a[152:155], v[68:71], a[80:95]
    ds_read_b64_tr_b16 a[138:139], v25 offset:8192
    buffer_load_dwordx4 v[140:143], v2, s[8:11], s61 offen offset:0 sc1
    v_fma_mix_f32 v6, v157, v74, v82 op_sel_hi:[1,0,0]
    v_fma_mix_f32 v7, v157, v75, v83 op_sel:[1,0,0] op_sel_hi:[1,0,0]
    v_cvt_pk_bf16_f32 v61, v6, v7
    v_mfma_f32_32x32x16_bf16 a[96:111], a[156:159], v[64:67], a[96:111]
    ds_read_b64_tr_b16 a[140:141], v26 offset:8192
    ds_read_b128 v[100:103], v3 offset:1232
    v_fma_mix_f32 v8, v158, v76, v84 op_sel_hi:[1,0,0]
    v_fma_mix_f32 v9, v158, v77, v85 op_sel:[1,0,0] op_sel_hi:[1,0,0]
    v_cvt_pk_bf16_f32 v62, v8, v9
    v_mfma_f32_32x32x16_bf16 a[112:127], a[156:159], v[68:71], a[112:127]
    ds_read_b64_tr_b16 a[142:143], v27 offset:8192
    buffer_load_dwordx4 v30, s[12:15], s62 offen offset:2048 lds
    v_fma_mix_f32 v10, v159, v78, v86 op_sel_hi:[1,0,0]
    v_fma_mix_f32 v11, v159, v79, v87 op_sel:[1,0,0] op_sel_hi:[1,0,0]
    v_cvt_pk_bf16_f32 v63, v10, v11
    s_waitcnt lgkmcnt(6)
    v_mfma_f32_32x32x16_bf16 a[0:15], a[128:131], v[56:59], a[0:15]
    ds_read_b64_tr_b16 a[144:145], v20 offset:12288
    ds_read_b128 v[72:75], v3 offset:3840
    v_fma_mix_f32 v4, v160, v88, v96 op_sel_hi:[1,0,0]
    v_fma_mix_f32 v5, v160, v89, v97 op_sel:[1,0,0] op_sel_hi:[1,0,0]
    v_cvt_pk_bf16_f32 v64, v4, v5
    v_mfma_f32_32x32x16_bf16 a[16:31], a[128:131], v[60:63], a[16:31]
    ds_read_b64_tr_b16 a[146:147], v21 offset:12288
    v_fma_mix_f32 v6, v161, v90, v98 op_sel_hi:[1,0,0]
    v_fma_mix_f32 v7, v161, v91, v99 op_sel:[1,0,0] op_sel_hi:[1,0,0]
    v_cvt_pk_bf16_f32 v65, v6, v7
    s_waitcnt lgkmcnt(3)
    v_mfma_f32_32x32x16_bf16 a[32:47], a[132:135], v[56:59], a[32:47]
    ds_read_b64_tr_b16 a[148:149], v22 offset:12288
    ds_read_b128 v[80:83], v3 offset:1280
    v_fma_mix_f32 v8, v162, v92, v100 op_sel_hi:[1,0,0]
    v_fma_mix_f32 v9, v162, v93, v101 op_sel:[1,0,0] op_sel_hi:[1,0,0]
    v_cvt_pk_bf16_f32 v66, v8, v9
    v_mfma_f32_32x32x16_bf16 a[48:63], a[132:135], v[60:63], a[48:63]
    ds_read_b64_tr_b16 a[150:151], v23 offset:12288
    buffer_load_dwordx4 v[144:147], v2, s[8:11], s60 offen offset:1024 sc1
    v_fma_mix_f32 v10, v163, v94, v102 op_sel_hi:[1,0,0]
    v_fma_mix_f32 v11, v163, v95, v103 op_sel:[1,0,0] op_sel_hi:[1,0,0]
    v_cvt_pk_bf16_f32 v67, v10, v11
    v_mfma_f32_32x32x16_bf16 a[64:79], a[136:139], v[56:59], a[64:79]
    ds_read_b64_tr_b16 a[152:153], v24 offset:12288
    ds_read_b128 v[76:79], v3 offset:3856
    v_fma_mix_f32 v4, v164, v88, v96 op_sel_hi:[1,0,0]
    v_fma_mix_f32 v5, v164, v89, v97 op_sel:[1,0,0] op_sel_hi:[1,0,0]
    v_cvt_pk_bf16_f32 v68, v4, v5
    v_mfma_f32_32x32x16_bf16 a[80:95], a[136:139], v[60:63], a[80:95]
    ds_read_b64_tr_b16 a[154:155], v25 offset:12288
    buffer_load_dwordx4 v[148:151], v2, s[8:11], s61 offen offset:1024 sc1
    v_fma_mix_f32 v6, v165, v90, v98 op_sel_hi:[1,0,0]
    v_fma_mix_f32 v7, v165, v91, v99 op_sel:[1,0,0] op_sel_hi:[1,0,0]
    v_cvt_pk_bf16_f32 v69, v6, v7
    v_mfma_f32_32x32x16_bf16 a[96:111], a[140:143], v[56:59], a[96:111]
    ds_read_b64_tr_b16 a[156:157], v26 offset:12288
    ds_read_b128 v[84:87], v3 offset:1296
    v_fma_mix_f32 v8, v166, v92, v100 op_sel_hi:[1,0,0]
    v_fma_mix_f32 v9, v166, v93, v101 op_sel:[1,0,0] op_sel_hi:[1,0,0]
    v_cvt_pk_bf16_f32 v70, v8, v9
    v_mfma_f32_32x32x16_bf16 a[112:127], a[140:143], v[60:63], a[112:127]
    ds_read_b64_tr_b16 a[158:159], v27 offset:12288
    buffer_load_dwordx4 v31, s[12:15], s62 offen offset:3072 lds
    v_fma_mix_f32 v10, v167, v94, v102 op_sel_hi:[1,0,0]
    v_fma_mix_f32 v11, v167, v95, v103 op_sel:[1,0,0] op_sel_hi:[1,0,0]
    v_cvt_pk_bf16_f32 v71, v10, v11
    s_waitcnt lgkmcnt(6)
    v_mfma_f32_32x32x16_bf16 a[0:15], a[144:147], v[64:67], a[0:15]
    ds_read_b64_tr_b16 a[128:129], v20 offset:16384
    ds_read_b128 v[88:91], v3 offset:3904
    v_fma_mix_f32 v4, v168, v72, v80 op_sel_hi:[1,0,0]
    v_fma_mix_f32 v5, v168, v73, v81 op_sel:[1,0,0] op_sel_hi:[1,0,0]
    v_cvt_pk_bf16_f32 v56, v4, v5
    v_mfma_f32_32x32x16_bf16 a[16:31], a[144:147], v[68:71], a[16:31]
    ds_read_b64_tr_b16 a[130:131], v21 offset:16384
    v_fma_mix_f32 v6, v169, v74, v82 op_sel_hi:[1,0,0]
    v_fma_mix_f32 v7, v169, v75, v83 op_sel:[1,0,0] op_sel_hi:[1,0,0]
    v_cvt_pk_bf16_f32 v57, v6, v7
    s_waitcnt lgkmcnt(3)
    v_mfma_f32_32x32x16_bf16 a[32:47], a[148:151], v[64:67], a[32:47]
    ds_read_b64_tr_b16 a[132:133], v22 offset:16384
    ds_read_b128 v[96:99], v3 offset:1344
    v_fma_mix_f32 v8, v170, v76, v84 op_sel_hi:[1,0,0]
    v_fma_mix_f32 v9, v170, v77, v85 op_sel:[1,0,0] op_sel_hi:[1,0,0]
    v_cvt_pk_bf16_f32 v58, v8, v9
    v_mfma_f32_32x32x16_bf16 a[48:63], a[148:151], v[68:71], a[48:63]
    ds_read_b64_tr_b16 a[134:135], v23 offset:16384
    buffer_load_dwordx4 v[152:155], v2, s[8:11], s60 offen offset:2048 sc1
    v_fma_mix_f32 v10, v171, v78, v86 op_sel_hi:[1,0,0]
    v_fma_mix_f32 v11, v171, v79, v87 op_sel:[1,0,0] op_sel_hi:[1,0,0]
    v_cvt_pk_bf16_f32 v59, v10, v11
    v_mfma_f32_32x32x16_bf16 a[64:79], a[152:155], v[64:67], a[64:79]
    ds_read_b64_tr_b16 a[136:137], v24 offset:16384
    ds_read_b128 v[92:95], v3 offset:3920
    v_fma_mix_f32 v4, v172, v72, v80 op_sel_hi:[1,0,0]
    v_fma_mix_f32 v5, v172, v73, v81 op_sel:[1,0,0] op_sel_hi:[1,0,0]
    v_cvt_pk_bf16_f32 v60, v4, v5
    v_mfma_f32_32x32x16_bf16 a[80:95], a[152:155], v[68:71], a[80:95]
    ds_read_b64_tr_b16 a[138:139], v25 offset:16384
    buffer_load_dwordx4 v[156:159], v2, s[8:11], s61 offen offset:2048 sc1
    v_fma_mix_f32 v6, v173, v74, v82 op_sel_hi:[1,0,0]
    v_fma_mix_f32 v7, v173, v75, v83 op_sel:[1,0,0] op_sel_hi:[1,0,0]
    v_cvt_pk_bf16_f32 v61, v6, v7
    v_mfma_f32_32x32x16_bf16 a[96:111], a[156:159], v[64:67], a[96:111]
    ds_read_b64_tr_b16 a[140:141], v26 offset:16384
    ds_read_b128 v[100:103], v3 offset:1360
    v_fma_mix_f32 v8, v174, v76, v84 op_sel_hi:[1,0,0]
    v_fma_mix_f32 v9, v174, v77, v85 op_sel:[1,0,0] op_sel_hi:[1,0,0]
    v_cvt_pk_bf16_f32 v62, v8, v9
    s_add_u32 m0, s49, 0
    s_add_u32 s62, s51, 4194304
    v_mfma_f32_32x32x16_bf16 a[112:127], a[156:159], v[68:71], a[112:127]
    ds_read_b64_tr_b16 a[142:143], v27 offset:16384
    buffer_load_dwordx4 v28, s[12:15], s62 offen offset:0 lds
    v_fma_mix_f32 v10, v175, v78, v86 op_sel_hi:[1,0,0]
    v_fma_mix_f32 v11, v175, v79, v87 op_sel:[1,0,0] op_sel_hi:[1,0,0]
    v_cvt_pk_bf16_f32 v63, v10, v11
    s_waitcnt vmcnt(27) lgkmcnt(6)
    v_mfma_f32_32x32x16_bf16 a[0:15], a[128:131], v[56:59], a[0:15]
    ds_read_b64_tr_b16 a[144:145], v20 offset:20480
    ds_read_b128 v[72:75], v3 offset:3968
    v_fma_mix_f32 v4, v176, v88, v96 op_sel_hi:[1,0,0]
    v_fma_mix_f32 v5, v176, v89, v97 op_sel:[1,0,0] op_sel_hi:[1,0,0]
    v_cvt_pk_bf16_f32 v64, v4, v5
    v_mfma_f32_32x32x16_bf16 a[16:31], a[128:131], v[60:63], a[16:31]
    ds_read_b64_tr_b16 a[146:147], v21 offset:20480
    v_fma_mix_f32 v6, v177, v90, v98 op_sel_hi:[1,0,0]
    v_fma_mix_f32 v7, v177, v91, v99 op_sel:[1,0,0] op_sel_hi:[1,0,0]
    v_cvt_pk_bf16_f32 v65, v6, v7
    s_waitcnt lgkmcnt(3)
    v_mfma_f32_32x32x16_bf16 a[32:47], a[132:135], v[56:59], a[32:47]
    ds_read_b64_tr_b16 a[148:149], v22 offset:20480
    ds_read_b128 v[80:83], v3 offset:1408
    v_fma_mix_f32 v8, v178, v92, v100 op_sel_hi:[1,0,0]
    v_fma_mix_f32 v9, v178, v93, v101 op_sel:[1,0,0] op_sel_hi:[1,0,0]
    v_cvt_pk_bf16_f32 v66, v8, v9
    v_mfma_f32_32x32x16_bf16 a[48:63], a[132:135], v[60:63], a[48:63]
    ds_read_b64_tr_b16 a[150:151], v23 offset:20480
    buffer_load_dwordx4 v[160:163], v2, s[8:11], s60 offen offset:3072 sc1
    v_fma_mix_f32 v10, v179, v94, v102 op_sel_hi:[1,0,0]
    v_fma_mix_f32 v11, v179, v95, v103 op_sel:[1,0,0] op_sel_hi:[1,0,0]
    v_cvt_pk_bf16_f32 v67, v10, v11
    v_mfma_f32_32x32x16_bf16 a[64:79], a[136:139], v[56:59], a[64:79]
    ds_read_b64_tr_b16 a[152:153], v24 offset:20480
    ds_read_b128 v[76:79], v3 offset:3984
    v_fma_mix_f32 v4, v180, v88, v96 op_sel_hi:[1,0,0]
    v_fma_mix_f32 v5, v180, v89, v97 op_sel:[1,0,0] op_sel_hi:[1,0,0]
    v_cvt_pk_bf16_f32 v68, v4, v5
    v_mfma_f32_32x32x16_bf16 a[80:95], a[136:139], v[60:63], a[80:95]
    ds_read_b64_tr_b16 a[154:155], v25 offset:20480
    buffer_load_dwordx4 v[164:167], v2, s[8:11], s61 offen offset:3072 sc1
    v_fma_mix_f32 v6, v181, v90, v98 op_sel_hi:[1,0,0]
    v_fma_mix_f32 v7, v181, v91, v99 op_sel:[1,0,0] op_sel_hi:[1,0,0]
    v_cvt_pk_bf16_f32 v69, v6, v7
    v_mfma_f32_32x32x16_bf16 a[96:111], a[140:143], v[56:59], a[96:111]
    ds_read_b64_tr_b16 a[156:157], v26 offset:20480
    ds_read_b128 v[84:87], v3 offset:1424
    v_fma_mix_f32 v8, v182, v92, v100 op_sel_hi:[1,0,0]
    v_fma_mix_f32 v9, v182, v93, v101 op_sel:[1,0,0] op_sel_hi:[1,0,0]
    v_cvt_pk_bf16_f32 v70, v8, v9
    v_mfma_f32_32x32x16_bf16 a[112:127], a[140:143], v[60:63], a[112:127]
    ds_read_b64_tr_b16 a[158:159], v27 offset:20480
    buffer_load_dwordx4 v29, s[12:15], s62 offen offset:1024 lds
    v_fma_mix_f32 v10, v183, v94, v102 op_sel_hi:[1,0,0]
    v_fma_mix_f32 v11, v183, v95, v103 op_sel:[1,0,0] op_sel_hi:[1,0,0]
    v_cvt_pk_bf16_f32 v71, v10, v11
    s_waitcnt vmcnt(27) lgkmcnt(6)
    v_mfma_f32_32x32x16_bf16 a[0:15], a[144:147], v[64:67], a[0:15]
    ds_read_b64_tr_b16 a[128:129], v20 offset:24576
    ds_read_b128 v[88:91], v3 offset:4032
    v_fma_mix_f32 v4, v184, v72, v80 op_sel_hi:[1,0,0]
    v_fma_mix_f32 v5, v184, v73, v81 op_sel:[1,0,0] op_sel_hi:[1,0,0]
    v_cvt_pk_bf16_f32 v56, v4, v5
    v_mfma_f32_32x32x16_bf16 a[16:31], a[144:147], v[68:71], a[16:31]
    ds_read_b64_tr_b16 a[130:131], v21 offset:24576
    v_fma_mix_f32 v6, v185, v74, v82 op_sel_hi:[1,0,0]
    v_fma_mix_f32 v7, v185, v75, v83 op_sel:[1,0,0] op_sel_hi:[1,0,0]
    v_cvt_pk_bf16_f32 v57, v6, v7
    s_waitcnt lgkmcnt(3)
    v_mfma_f32_32x32x16_bf16 a[32:47], a[148:151], v[64:67], a[32:47]
    ds_read_b64_tr_b16 a[132:133], v22 offset:24576
    ds_read_b128 v[96:99], v3 offset:1472
    v_fma_mix_f32 v8, v186, v76, v84 op_sel_hi:[1,0,0]
    v_fma_mix_f32 v9, v186, v77, v85 op_sel:[1,0,0] op_sel_hi:[1,0,0]
    v_cvt_pk_bf16_f32 v58, v8, v9
    s_add_u32 s60, s52, 32768
    s_add_u32 s61, s52, 73728
    v_mfma_f32_32x32x16_bf16 a[48:63], a[148:151], v[68:71], a[48:63]
    ds_read_b64_tr_b16 a[134:135], v23 offset:24576
    buffer_load_dwordx4 v[168:171], v2, s[8:11], s60 offen offset:0 sc1
    v_fma_mix_f32 v10, v187, v78, v86 op_sel_hi:[1,0,0]
    v_fma_mix_f32 v11, v187, v79, v87 op_sel:[1,0,0] op_sel_hi:[1,0,0]
    v_cvt_pk_bf16_f32 v59, v10, v11
    v_mfma_f32_32x32x16_bf16 a[64:79], a[152:155], v[64:67], a[64:79]
    ds_read_b64_tr_b16 a[136:137], v24 offset:24576
    ds_read_b128 v[92:95], v3 offset:4048
    v_fma_mix_f32 v4, v188, v72, v80 op_sel_hi:[1,0,0]
    v_fma_mix_f32 v5, v188, v73, v81 op_sel:[1,0,0] op_sel_hi:[1,0,0]
    v_cvt_pk_bf16_f32 v60, v4, v5
    v_mfma_f32_32x32x16_bf16 a[80:95], a[152:155], v[68:71], a[80:95]
    ds_read_b64_tr_b16 a[138:139], v25 offset:24576
    buffer_load_dwordx4 v[172:175], v2, s[8:11], s61 offen offset:0 sc1
    v_fma_mix_f32 v6, v189, v74, v82 op_sel_hi:[1,0,0]
    v_fma_mix_f32 v7, v189, v75, v83 op_sel:[1,0,0] op_sel_hi:[1,0,0]
    v_cvt_pk_bf16_f32 v61, v6, v7
    v_mfma_f32_32x32x16_bf16 a[96:111], a[156:159], v[64:67], a[96:111]
    ds_read_b64_tr_b16 a[140:141], v26 offset:24576
    ds_read_b128 v[100:103], v3 offset:1488
    v_fma_mix_f32 v8, v190, v76, v84 op_sel_hi:[1,0,0]
    v_fma_mix_f32 v9, v190, v77, v85 op_sel:[1,0,0] op_sel_hi:[1,0,0]
    v_cvt_pk_bf16_f32 v62, v8, v9
    v_mfma_f32_32x32x16_bf16 a[112:127], a[156:159], v[68:71], a[112:127]
    ds_read_b64_tr_b16 a[142:143], v27 offset:24576
    buffer_load_dwordx4 v30, s[12:15], s62 offen offset:2048 lds
    v_fma_mix_f32 v10, v191, v78, v86 op_sel_hi:[1,0,0]
    v_fma_mix_f32 v11, v191, v79, v87 op_sel:[1,0,0] op_sel_hi:[1,0,0]
    v_cvt_pk_bf16_f32 v63, v10, v11
    s_waitcnt vmcnt(27) lgkmcnt(6)
    v_mfma_f32_32x32x16_bf16 a[0:15], a[128:131], v[56:59], a[0:15]
    ds_read_b64_tr_b16 a[144:145], v20 offset:28672
    ds_read_b128 v[72:75], v3 offset:4096
    v_fma_mix_f32 v4, v192, v88, v96 op_sel_hi:[1,0,0]
    v_fma_mix_f32 v5, v192, v89, v97 op_sel:[1,0,0] op_sel_hi:[1,0,0]
    v_cvt_pk_bf16_f32 v64, v4, v5
    v_mfma_f32_32x32x16_bf16 a[16:31], a[128:131], v[60:63], a[16:31]
    ds_read_b64_tr_b16 a[146:147], v21 offset:28672
    v_fma_mix_f32 v6, v193, v90, v98 op_sel_hi:[1,0,0]
    v_fma_mix_f32 v7, v193, v91, v99 op_sel:[1,0,0] op_sel_hi:[1,0,0]
    v_cvt_pk_bf16_f32 v65, v6, v7
    s_waitcnt lgkmcnt(3)
    v_mfma_f32_32x32x16_bf16 a[32:47], a[132:135], v[56:59], a[32:47]
    ds_read_b64_tr_b16 a[148:149], v22 offset:28672
    ds_read_b128 v[80:83], v3 offset:1536
    v_fma_mix_f32 v8, v194, v92, v100 op_sel_hi:[1,0,0]
    v_fma_mix_f32 v9, v194, v93, v101 op_sel:[1,0,0] op_sel_hi:[1,0,0]
    v_cvt_pk_bf16_f32 v66, v8, v9
    v_mfma_f32_32x32x16_bf16 a[48:63], a[132:135], v[60:63], a[48:63]
    ds_read_b64_tr_b16 a[150:151], v23 offset:28672
    buffer_load_dwordx4 v[176:179], v2, s[8:11], s60 offen offset:1024 sc1
    v_fma_mix_f32 v10, v195, v94, v102 op_sel_hi:[1,0,0]
    v_fma_mix_f32 v11, v195, v95, v103 op_sel:[1,0,0] op_sel_hi:[1,0,0]
    v_cvt_pk_bf16_f32 v67, v10, v11
    v_mfma_f32_32x32x16_bf16 a[64:79], a[136:139], v[56:59], a[64:79]
    ds_read_b64_tr_b16 a[152:153], v24 offset:28672
    ds_read_b128 v[76:79], v3 offset:4112
    v_fma_mix_f32 v4, v196, v88, v96 op_sel_hi:[1,0,0]
    v_fma_mix_f32 v5, v196, v89, v97 op_sel:[1,0,0] op_sel_hi:[1,0,0]
    v_cvt_pk_bf16_f32 v68, v4, v5
    v_mfma_f32_32x32x16_bf16 a[80:95], a[136:139], v[60:63], a[80:95]
    ds_read_b64_tr_b16 a[154:155], v25 offset:28672
    buffer_load_dwordx4 v[180:183], v2, s[8:11], s61 offen offset:1024 sc1
    v_fma_mix_f32 v6, v197, v90, v98 op_sel_hi:[1,0,0]
    v_fma_mix_f32 v7, v197, v91, v99 op_sel:[1,0,0] op_sel_hi:[1,0,0]
    v_cvt_pk_bf16_f32 v69, v6, v7
    v_mfma_f32_32x32x16_bf16 a[96:111], a[140:143], v[56:59], a[96:111]
    ds_read_b64_tr_b16 a[156:157], v26 offset:28672
    ds_read_b128 v[84:87], v3 offset:1552
    v_fma_mix_f32 v8, v198, v92, v100 op_sel_hi:[1,0,0]
    v_fma_mix_f32 v9, v198, v93, v101 op_sel:[1,0,0] op_sel_hi:[1,0,0]
    v_cvt_pk_bf16_f32 v70, v8, v9
    v_mfma_f32_32x32x16_bf16 a[112:127], a[140:143], v[60:63], a[112:127]
    ds_read_b64_tr_b16 a[158:159], v27 offset:28672
    buffer_load_dwordx4 v31, s[12:15], s62 offen offset:3072 lds
    v_fma_mix_f32 v10, v199, v94, v102 op_sel_hi:[1,0,0]
    v_fma_mix_f32 v11, v199, v95, v103 op_sel:[1,0,0] op_sel_hi:[1,0,0]
    v_cvt_pk_bf16_f32 v71, v10, v11
    s_waitcnt vmcnt(12) lgkmcnt(6)
    v_mfma_f32_32x32x16_bf16 a[0:15], a[144:147], v[64:67], a[0:15]
    s_barrier
    v_mfma_f32_32x32x16_bf16 a[16:31], a[144:147], v[68:71], a[16:31]
    ds_read_b64_tr_b16 a[128:129], v20 offset:32768
    ds_read_b64_tr_b16 a[130:131], v21 offset:32768
    v_fma_mix_f32 v4, v104, v72, v80 op_sel_hi:[1,0,0]
    v_fma_mix_f32 v5, v104, v73, v81 op_sel:[1,0,0] op_sel_hi:[1,0,0]
    v_cvt_pk_bf16_f32 v56, v4, v5
    s_waitcnt lgkmcnt(2)
    v_mfma_f32_32x32x16_bf16 a[32:47], a[148:151], v[64:67], a[32:47]
    ds_read_b64_tr_b16 a[132:133], v22 offset:32768
    ds_read_b128 v[88:91], v3 offset:4160
    v_fma_mix_f32 v6, v105, v74, v82 op_sel_hi:[1,0,0]
    v_fma_mix_f32 v7, v105, v75, v83 op_sel:[1,0,0] op_sel_hi:[1,0,0]
    v_cvt_pk_bf16_f32 v57, v6, v7
    v_fma_mix_f32 v8, v106, v76, v84 op_sel_hi:[1,0,0]
    v_mfma_f32_32x32x16_bf16 a[48:63], a[148:151], v[68:71], a[48:63]
    ds_read_b64_tr_b16 a[134:135], v23 offset:32768
    ds_read_b128 v[96:99], v3 offset:1600
    v_fma_mix_f32 v9, v106, v77, v85 op_sel:[1,0,0] op_sel_hi:[1,0,0]
    v_cvt_pk_bf16_f32 v58, v8, v9
    v_fma_mix_f32 v10, v107, v78, v86 op_sel_hi:[1,0,0]
    v_fma_mix_f32 v11, v107, v79, v87 op_sel:[1,0,0] op_sel_hi:[1,0,0]
    v_mfma_f32_32x32x16_bf16 a[64:79], a[152:155], v[64:67], a[64:79]
    ds_read_b64_tr_b16 a[136:137], v24 offset:32768
    ds_read_b128 v[92:95], v3 offset:4176
    v_cvt_pk_bf16_f32 v59, v10, v11
    v_fma_mix_f32 v4, v108, v72, v80 op_sel_hi:[1,0,0]
    v_fma_mix_f32 v5, v108, v73, v81 op_sel:[1,0,0] op_sel_hi:[1,0,0]
    v_cvt_pk_bf16_f32 v60, v4, v5
    v_mfma_f32_32x32x16_bf16 a[80:95], a[152:155], v[68:71], a[80:95]
    ds_read_b64_tr_b16 a[138:139], v25 offset:32768
    buffer_load_dwordx4 v[184:187], v2, s[8:11], s60 offen offset:2048 sc1
    v_fma_mix_f32 v6, v109, v74, v82 op_sel_hi:[1,0,0]
    v_fma_mix_f32 v7, v109, v75, v83 op_sel:[1,0,0] op_sel_hi:[1,0,0]
    v_cvt_pk_bf16_f32 v61, v6, v7
    v_mfma_f32_32x32x16_bf16 a[96:111], a[156:159], v[64:67], a[96:111]
    ds_read_b64_tr_b16 a[140:141], v26 offset:32768
    ds_read_b128 v[100:103], v3 offset:1616
    buffer_load_dwordx4 v[188:191], v2, s[8:11], s61 offen offset:2048 sc1
    v_fma_mix_f32 v8, v110, v76, v84 op_sel_hi:[1,0,0]
    v_fma_mix_f32 v9, v110, v77, v85 op_sel:[1,0,0] op_sel_hi:[1,0,0]
    v_cvt_pk_bf16_f32 v62, v8, v9
    s_add_u32 m0, s49, 16384
    s_add_u32 s62, s51, 4718592
    v_mfma_f32_32x32x16_bf16 a[112:127], a[156:159], v[68:71], a[112:127]
    ds_read_b64_tr_b16 a[142:143], v27 offset:32768
    buffer_load_dwordx4 v28, s[12:15], s62 offen offset:0 lds
    v_fma_mix_f32 v10, v111, v78, v86 op_sel_hi:[1,0,0]
    v_fma_mix_f32 v11, v111, v79, v87 op_sel:[1,0,0] op_sel_hi:[1,0,0]
    v_cvt_pk_bf16_f32 v63, v10, v11
    s_waitcnt lgkmcnt(6)
    v_mfma_f32_32x32x16_bf16 a[0:15], a[128:131], v[56:59], a[0:15]
    ds_read_b64_tr_b16 a[144:145], v20 offset:36864
    ds_read_b128 v[72:75], v3 offset:4224
    v_fma_mix_f32 v4, v112, v88, v96 op_sel_hi:[1,0,0]
    v_fma_mix_f32 v5, v112, v89, v97 op_sel:[1,0,0] op_sel_hi:[1,0,0]
    v_cvt_pk_bf16_f32 v64, v4, v5
    v_mfma_f32_32x32x16_bf16 a[16:31], a[128:131], v[60:63], a[16:31]
    ds_read_b64_tr_b16 a[146:147], v21 offset:36864
    v_fma_mix_f32 v6, v113, v90, v98 op_sel_hi:[1,0,0]
    v_fma_mix_f32 v7, v113, v91, v99 op_sel:[1,0,0] op_sel_hi:[1,0,0]
    v_cvt_pk_bf16_f32 v65, v6, v7
    s_waitcnt lgkmcnt(3)
    v_mfma_f32_32x32x16_bf16 a[32:47], a[132:135], v[56:59], a[32:47]
    ds_read_b64_tr_b16 a[148:149], v22 offset:36864
    ds_read_b128 v[80:83], v3 offset:1664
    v_fma_mix_f32 v8, v114, v92, v100 op_sel_hi:[1,0,0]
    v_fma_mix_f32 v9, v114, v93, v101 op_sel:[1,0,0] op_sel_hi:[1,0,0]
    v_cvt_pk_bf16_f32 v66, v8, v9
    v_mfma_f32_32x32x16_bf16 a[48:63], a[132:135], v[60:63], a[48:63]
    ds_read_b64_tr_b16 a[150:151], v23 offset:36864
    buffer_load_dwordx4 v[192:195], v2, s[8:11], s60 offen offset:3072 sc1
    v_fma_mix_f32 v10, v115, v94, v102 op_sel_hi:[1,0,0]
    v_fma_mix_f32 v11, v115, v95, v103 op_sel:[1,0,0] op_sel_hi:[1,0,0]
    v_cvt_pk_bf16_f32 v67, v10, v11
    v_mfma_f32_32x32x16_bf16 a[64:79], a[136:139], v[56:59], a[64:79]
    ds_read_b64_tr_b16 a[152:153], v24 offset:36864
    ds_read_b128 v[76:79], v3 offset:4240
    v_fma_mix_f32 v4, v116, v88, v96 op_sel_hi:[1,0,0]
    v_fma_mix_f32 v5, v116, v89, v97 op_sel:[1,0,0] op_sel_hi:[1,0,0]
    v_cvt_pk_bf16_f32 v68, v4, v5
    v_mfma_f32_32x32x16_bf16 a[80:95], a[136:139], v[60:63], a[80:95]
    ds_read_b64_tr_b16 a[154:155], v25 offset:36864
    buffer_load_dwordx4 v[196:199], v2, s[8:11], s61 offen offset:3072 sc1
    v_fma_mix_f32 v6, v117, v90, v98 op_sel_hi:[1,0,0]
    v_fma_mix_f32 v7, v117, v91, v99 op_sel:[1,0,0] op_sel_hi:[1,0,0]
    v_cvt_pk_bf16_f32 v69, v6, v7
    v_mfma_f32_32x32x16_bf16 a[96:111], a[140:143], v[56:59], a[96:111]
    ds_read_b64_tr_b16 a[156:157], v26 offset:36864
    ds_read_b128 v[84:87], v3 offset:1680
    v_fma_mix_f32 v8, v118, v92, v100 op_sel_hi:[1,0,0]
    v_fma_mix_f32 v9, v118, v93, v101 op_sel:[1,0,0] op_sel_hi:[1,0,0]
    v_cvt_pk_bf16_f32 v70, v8, v9
    v_mfma_f32_32x32x16_bf16 a[112:127], a[140:143], v[60:63], a[112:127]
    ds_read_b64_tr_b16 a[158:159], v27 offset:36864
    buffer_load_dwordx4 v29, s[12:15], s62 offen offset:1024 lds
    v_fma_mix_f32 v10, v119, v94, v102 op_sel_hi:[1,0,0]
    v_fma_mix_f32 v11, v119, v95, v103 op_sel:[1,0,0] op_sel_hi:[1,0,0]
    v_cvt_pk_bf16_f32 v71, v10, v11
    s_waitcnt lgkmcnt(6)
    v_mfma_f32_32x32x16_bf16 a[0:15], a[144:147], v[64:67], a[0:15]
    ds_read_b64_tr_b16 a[128:129], v20 offset:40960
    ds_read_b128 v[88:91], v3 offset:4288
    v_fma_mix_f32 v4, v120, v72, v80 op_sel_hi:[1,0,0]
    v_fma_mix_f32 v5, v120, v73, v81 op_sel:[1,0,0] op_sel_hi:[1,0,0]
    v_cvt_pk_bf16_f32 v56, v4, v5
    v_mfma_f32_32x32x16_bf16 a[16:31], a[144:147], v[68:71], a[16:31]
    ds_read_b64_tr_b16 a[130:131], v21 offset:40960
    v_fma_mix_f32 v6, v121, v74, v82 op_sel_hi:[1,0,0]
    v_fma_mix_f32 v7, v121, v75, v83 op_sel:[1,0,0] op_sel_hi:[1,0,0]
    v_cvt_pk_bf16_f32 v57, v6, v7
    s_waitcnt lgkmcnt(3)
    v_mfma_f32_32x32x16_bf16 a[32:47], a[148:151], v[64:67], a[32:47]
    ds_read_b64_tr_b16 a[132:133], v22 offset:40960
    ds_read_b128 v[96:99], v3 offset:1728
    v_fma_mix_f32 v8, v122, v76, v84 op_sel_hi:[1,0,0]
    v_fma_mix_f32 v9, v122, v77, v85 op_sel:[1,0,0] op_sel_hi:[1,0,0]
    v_cvt_pk_bf16_f32 v58, v8, v9
    s_add_u32 s60, s52, 36864
    s_add_u32 s61, s52, 77824
    v_mfma_f32_32x32x16_bf16 a[48:63], a[148:151], v[68:71], a[48:63]
    ds_read_b64_tr_b16 a[134:135], v23 offset:40960
    buffer_load_dwordx4 v[104:107], v2, s[8:11], s60 offen offset:0 sc1
    v_fma_mix_f32 v10, v123, v78, v86 op_sel_hi:[1,0,0]
    v_fma_mix_f32 v11, v123, v79, v87 op_sel:[1,0,0] op_sel_hi:[1,0,0]
    v_cvt_pk_bf16_f32 v59, v10, v11
    v_mfma_f32_32x32x16_bf16 a[64:79], a[152:155], v[64:67], a[64:79]
    ds_read_b64_tr_b16 a[136:137], v24 offset:40960
    ds_read_b128 v[92:95], v3 offset:4304
    v_fma_mix_f32 v4, v124, v72, v80 op_sel_hi:[1,0,0]
    v_fma_mix_f32 v5, v124, v73, v81 op_sel:[1,0,0] op_sel_hi:[1,0,0]
    v_cvt_pk_bf16_f32 v60, v4, v5
    v_mfma_f32_32x32x16_bf16 a[80:95], a[152:155], v[68:71], a[80:95]
    ds_read_b64_tr_b16 a[138:139], v25 offset:40960
    buffer_load_dwordx4 v[108:111], v2, s[8:11], s61 offen offset:0 sc1
    v_fma_mix_f32 v6, v125, v74, v82 op_sel_hi:[1,0,0]
    v_fma_mix_f32 v7, v125, v75, v83 op_sel:[1,0,0] op_sel_hi:[1,0,0]
    v_cvt_pk_bf16_f32 v61, v6, v7
    v_mfma_f32_32x32x16_bf16 a[96:111], a[156:159], v[64:67], a[96:111]
    ds_read_b64_tr_b16 a[140:141], v26 offset:40960
    ds_read_b128 v[100:103], v3 offset:1744
    v_fma_mix_f32 v8, v126, v76, v84 op_sel_hi:[1,0,0]
    v_fma_mix_f32 v9, v126, v77, v85 op_sel:[1,0,0] op_sel_hi:[1,0,0]
    v_cvt_pk_bf16_f32 v62, v8, v9
    v_mfma_f32_32x32x16_bf16 a[112:127], a[156:159], v[68:71], a[112:127]
    ds_read_b64_tr_b16 a[142:143], v27 offset:40960
    buffer_load_dwordx4 v30, s[12:15], s62 offen offset:2048 lds
    v_fma_mix_f32 v10, v127, v78, v86 op_sel_hi:[1,0,0]
    v_fma_mix_f32 v11, v127, v79, v87 op_sel:[1,0,0] op_sel_hi:[1,0,0]
    v_cvt_pk_bf16_f32 v63, v10, v11
    s_waitcnt lgkmcnt(6)
    v_mfma_f32_32x32x16_bf16 a[0:15], a[128:131], v[56:59], a[0:15]
    ds_read_b64_tr_b16 a[144:145], v20 offset:45056
    ds_read_b128 v[72:75], v3 offset:4352
    v_fma_mix_f32 v4, v128, v88, v96 op_sel_hi:[1,0,0]
    v_fma_mix_f32 v5, v128, v89, v97 op_sel:[1,0,0] op_sel_hi:[1,0,0]
    v_cvt_pk_bf16_f32 v64, v4, v5
    v_mfma_f32_32x32x16_bf16 a[16:31], a[128:131], v[60:63], a[16:31]
    ds_read_b64_tr_b16 a[146:147], v21 offset:45056
    v_fma_mix_f32 v6, v129, v90, v98 op_sel_hi:[1,0,0]
    v_fma_mix_f32 v7, v129, v91, v99 op_sel:[1,0,0] op_sel_hi:[1,0,0]
    v_cvt_pk_bf16_f32 v65, v6, v7
    s_waitcnt lgkmcnt(3)
    v_mfma_f32_32x32x16_bf16 a[32:47], a[132:135], v[56:59], a[32:47]
    ds_read_b64_tr_b16 a[148:149], v22 offset:45056
    ds_read_b128 v[80:83], v3 offset:1792
    v_fma_mix_f32 v8, v130, v92, v100 op_sel_hi:[1,0,0]
    v_fma_mix_f32 v9, v130, v93, v101 op_sel:[1,0,0] op_sel_hi:[1,0,0]
    v_cvt_pk_bf16_f32 v66, v8, v9
    v_mfma_f32_32x32x16_bf16 a[48:63], a[132:135], v[60:63], a[48:63]
    ds_read_b64_tr_b16 a[150:151], v23 offset:45056
    buffer_load_dwordx4 v[112:115], v2, s[8:11], s60 offen offset:1024 sc1
    v_fma_mix_f32 v10, v131, v94, v102 op_sel_hi:[1,0,0]
    v_fma_mix_f32 v11, v131, v95, v103 op_sel:[1,0,0] op_sel_hi:[1,0,0]
    v_cvt_pk_bf16_f32 v67, v10, v11
    v_mfma_f32_32x32x16_bf16 a[64:79], a[136:139], v[56:59], a[64:79]
    ds_read_b64_tr_b16 a[152:153], v24 offset:45056
    ds_read_b128 v[76:79], v3 offset:4368
    v_fma_mix_f32 v4, v132, v88, v96 op_sel_hi:[1,0,0]
    v_fma_mix_f32 v5, v132, v89, v97 op_sel:[1,0,0] op_sel_hi:[1,0,0]
    v_cvt_pk_bf16_f32 v68, v4, v5
    v_mfma_f32_32x32x16_bf16 a[80:95], a[136:139], v[60:63], a[80:95]
    ds_read_b64_tr_b16 a[154:155], v25 offset:45056
    buffer_load_dwordx4 v[116:119], v2, s[8:11], s61 offen offset:1024 sc1
    v_fma_mix_f32 v6, v133, v90, v98 op_sel_hi:[1,0,0]
    v_fma_mix_f32 v7, v133, v91, v99 op_sel:[1,0,0] op_sel_hi:[1,0,0]
    v_cvt_pk_bf16_f32 v69, v6, v7
    v_mfma_f32_32x32x16_bf16 a[96:111], a[140:143], v[56:59], a[96:111]
    ds_read_b64_tr_b16 a[156:157], v26 offset:45056
    ds_read_b128 v[84:87], v3 offset:1808
    v_fma_mix_f32 v8, v134, v92, v100 op_sel_hi:[1,0,0]
    v_fma_mix_f32 v9, v134, v93, v101 op_sel:[1,0,0] op_sel_hi:[1,0,0]
    v_cvt_pk_bf16_f32 v70, v8, v9
    v_mfma_f32_32x32x16_bf16 a[112:127], a[140:143], v[60:63], a[112:127]
    ds_read_b64_tr_b16 a[158:159], v27 offset:45056
    buffer_load_dwordx4 v31, s[12:15], s62 offen offset:3072 lds
    v_fma_mix_f32 v10, v135, v94, v102 op_sel_hi:[1,0,0]
    v_fma_mix_f32 v11, v135, v95, v103 op_sel:[1,0,0] op_sel_hi:[1,0,0]
    v_cvt_pk_bf16_f32 v71, v10, v11
    s_waitcnt lgkmcnt(6)
    v_mfma_f32_32x32x16_bf16 a[0:15], a[144:147], v[64:67], a[0:15]
    ds_read_b64_tr_b16 a[128:129], v20 offset:49152
    ds_read_b128 v[88:91], v3 offset:4416
    v_fma_mix_f32 v4, v136, v72, v80 op_sel_hi:[1,0,0]
    v_fma_mix_f32 v5, v136, v73, v81 op_sel:[1,0,0] op_sel_hi:[1,0,0]
    v_cvt_pk_bf16_f32 v56, v4, v5
    v_mfma_f32_32x32x16_bf16 a[16:31], a[144:147], v[68:71], a[16:31]
    ds_read_b64_tr_b16 a[130:131], v21 offset:49152
    v_fma_mix_f32 v6, v137, v74, v82 op_sel_hi:[1,0,0]
    v_fma_mix_f32 v7, v137, v75, v83 op_sel:[1,0,0] op_sel_hi:[1,0,0]
    v_cvt_pk_bf16_f32 v57, v6, v7
    s_waitcnt lgkmcnt(3)
    v_mfma_f32_32x32x16_bf16 a[32:47], a[148:151], v[64:67], a[32:47]
    ds_read_b64_tr_b16 a[132:133], v22 offset:49152
    ds_read_b128 v[96:99], v3 offset:1856
    v_fma_mix_f32 v8, v138, v76, v84 op_sel_hi:[1,0,0]
    v_fma_mix_f32 v9, v138, v77, v85 op_sel:[1,0,0] op_sel_hi:[1,0,0]
    v_cvt_pk_bf16_f32 v58, v8, v9
    v_mfma_f32_32x32x16_bf16 a[48:63], a[148:151], v[68:71], a[48:63]
    ds_read_b64_tr_b16 a[134:135], v23 offset:49152
    buffer_load_dwordx4 v[120:123], v2, s[8:11], s60 offen offset:2048 sc1
    v_fma_mix_f32 v10, v139, v78, v86 op_sel_hi:[1,0,0]
    v_fma_mix_f32 v11, v139, v79, v87 op_sel:[1,0,0] op_sel_hi:[1,0,0]
    v_cvt_pk_bf16_f32 v59, v10, v11
    v_mfma_f32_32x32x16_bf16 a[64:79], a[152:155], v[64:67], a[64:79]
    ds_read_b64_tr_b16 a[136:137], v24 offset:49152
    ds_read_b128 v[92:95], v3 offset:4432
    v_fma_mix_f32 v4, v140, v72, v80 op_sel_hi:[1,0,0]
    v_fma_mix_f32 v5, v140, v73, v81 op_sel:[1,0,0] op_sel_hi:[1,0,0]
    v_cvt_pk_bf16_f32 v60, v4, v5
    v_mfma_f32_32x32x16_bf16 a[80:95], a[152:155], v[68:71], a[80:95]
    ds_read_b64_tr_b16 a[138:139], v25 offset:49152
    buffer_load_dwordx4 v[124:127], v2, s[8:11], s61 offen offset:2048 sc1
    v_fma_mix_f32 v6, v141, v74, v82 op_sel_hi:[1,0,0]
    v_fma_mix_f32 v7, v141, v75, v83 op_sel:[1,0,0] op_sel_hi:[1,0,0]
    v_cvt_pk_bf16_f32 v61, v6, v7
    v_mfma_f32_32x32x16_bf16 a[96:111], a[156:159], v[64:67], a[96:111]
    ds_read_b64_tr_b16 a[140:141], v26 offset:49152
    ds_read_b128 v[100:103], v3 offset:1872
    v_fma_mix_f32 v8, v142, v76, v84 op_sel_hi:[1,0,0]
    v_fma_mix_f32 v9, v142, v77, v85 op_sel:[1,0,0] op_sel_hi:[1,0,0]
    v_cvt_pk_bf16_f32 v62, v8, v9
    s_add_u32 m0, s49, 32768
    s_add_u32 s62, s50, 0
    v_mfma_f32_32x32x16_bf16 a[112:127], a[156:159], v[68:71], a[112:127]
    ds_read_b64_tr_b16 a[142:143], v27 offset:49152
    buffer_load_dwordx4 v32, s[16:19], s62 offen offset:0 lds
    v_fma_mix_f32 v10, v143, v78, v86 op_sel_hi:[1,0,0]
    v_fma_mix_f32 v11, v143, v79, v87 op_sel:[1,0,0] op_sel_hi:[1,0,0]
    v_cvt_pk_bf16_f32 v63, v10, v11
    s_waitcnt lgkmcnt(6)
    v_mfma_f32_32x32x16_bf16 a[0:15], a[128:131], v[56:59], a[0:15]
    ds_read_b64_tr_b16 a[144:145], v20 offset:53248
    ds_read_b128 v[72:75], v3 offset:4480
    v_fma_mix_f32 v4, v144, v88, v96 op_sel_hi:[1,0,0]
    v_fma_mix_f32 v5, v144, v89, v97 op_sel:[1,0,0] op_sel_hi:[1,0,0]
    v_cvt_pk_bf16_f32 v64, v4, v5
    v_mfma_f32_32x32x16_bf16 a[16:31], a[128:131], v[60:63], a[16:31]
    ds_read_b64_tr_b16 a[146:147], v21 offset:53248
    v_fma_mix_f32 v6, v145, v90, v98 op_sel_hi:[1,0,0]
    v_fma_mix_f32 v7, v145, v91, v99 op_sel:[1,0,0] op_sel_hi:[1,0,0]
    v_cvt_pk_bf16_f32 v65, v6, v7
    s_waitcnt lgkmcnt(3)
    v_mfma_f32_32x32x16_bf16 a[32:47], a[132:135], v[56:59], a[32:47]
    ds_read_b64_tr_b16 a[148:149], v22 offset:53248
    ds_read_b128 v[80:83], v3 offset:1920
    v_fma_mix_f32 v8, v146, v92, v100 op_sel_hi:[1,0,0]
    v_fma_mix_f32 v9, v146, v93, v101 op_sel:[1,0,0] op_sel_hi:[1,0,0]
    v_cvt_pk_bf16_f32 v66, v8, v9
    v_mfma_f32_32x32x16_bf16 a[48:63], a[132:135], v[60:63], a[48:63]
    ds_read_b64_tr_b16 a[150:151], v23 offset:53248
    buffer_load_dwordx4 v[128:131], v2, s[8:11], s60 offen offset:3072 sc1
    v_fma_mix_f32 v10, v147, v94, v102 op_sel_hi:[1,0,0]
    v_fma_mix_f32 v11, v147, v95, v103 op_sel:[1,0,0] op_sel_hi:[1,0,0]
    v_cvt_pk_bf16_f32 v67, v10, v11
    v_mfma_f32_32x32x16_bf16 a[64:79], a[136:139], v[56:59], a[64:79]
    ds_read_b64_tr_b16 a[152:153], v24 offset:53248
    ds_read_b128 v[76:79], v3 offset:4496
    v_fma_mix_f32 v4, v148, v88, v96 op_sel_hi:[1,0,0]
    v_fma_mix_f32 v5, v148, v89, v97 op_sel:[1,0,0] op_sel_hi:[1,0,0]
    v_cvt_pk_bf16_f32 v68, v4, v5
    v_mfma_f32_32x32x16_bf16 a[80:95], a[136:139], v[60:63], a[80:95]
    ds_read_b64_tr_b16 a[154:155], v25 offset:53248
    buffer_load_dwordx4 v[132:135], v2, s[8:11], s61 offen offset:3072 sc1
    v_fma_mix_f32 v6, v149, v90, v98 op_sel_hi:[1,0,0]
    v_fma_mix_f32 v7, v149, v91, v99 op_sel:[1,0,0] op_sel_hi:[1,0,0]
    v_cvt_pk_bf16_f32 v69, v6, v7
    v_mfma_f32_32x32x16_bf16 a[96:111], a[140:143], v[56:59], a[96:111]
    ds_read_b64_tr_b16 a[156:157], v26 offset:53248
    ds_read_b128 v[84:87], v3 offset:1936
    v_fma_mix_f32 v8, v150, v92, v100 op_sel_hi:[1,0,0]
    v_fma_mix_f32 v9, v150, v93, v101 op_sel:[1,0,0] op_sel_hi:[1,0,0]
    v_cvt_pk_bf16_f32 v70, v8, v9
    v_mfma_f32_32x32x16_bf16 a[112:127], a[140:143], v[60:63], a[112:127]
    ds_read_b64_tr_b16 a[158:159], v27 offset:53248
    buffer_load_dwordx4 v33, s[16:19], s62 offen offset:1024 lds
    v_fma_mix_f32 v10, v151, v94, v102 op_sel_hi:[1,0,0]
    v_fma_mix_f32 v11, v151, v95, v103 op_sel:[1,0,0] op_sel_hi:[1,0,0]
    v_cvt_pk_bf16_f32 v71, v10, v11
    s_waitcnt vmcnt(28) lgkmcnt(6)
    v_mfma_f32_32x32x16_bf16 a[0:15], a[144:147], v[64:67], a[0:15]
    ds_read_b64_tr_b16 a[128:129], v20 offset:57344
    ds_read_b128 v[88:91], v3 offset:4544
    v_fma_mix_f32 v4, v152, v72, v80 op_sel_hi:[1,0,0]
    v_fma_mix_f32 v5, v152, v73, v81 op_sel:[1,0,0] op_sel_hi:[1,0,0]
    v_cvt_pk_bf16_f32 v56, v4, v5
    v_mfma_f32_32x32x16_bf16 a[16:31], a[144:147], v[68:71], a[16:31]
    ds_read_b64_tr_b16 a[130:131], v21 offset:57344
    v_fma_mix_f32 v6, v153, v74, v82 op_sel_hi:[1,0,0]
    v_fma_mix_f32 v7, v153, v75, v83 op_sel:[1,0,0] op_sel_hi:[1,0,0]
    v_cvt_pk_bf16_f32 v57, v6, v7
    s_waitcnt lgkmcnt(3)
    v_mfma_f32_32x32x16_bf16 a[32:47], a[148:151], v[64:67], a[32:47]
    ds_read_b64_tr_b16 a[132:133], v22 offset:57344
    ds_read_b128 v[96:99], v3 offset:1984
    v_fma_mix_f32 v8, v154, v76, v84 op_sel_hi:[1,0,0]
    v_fma_mix_f32 v9, v154, v77, v85 op_sel:[1,0,0] op_sel_hi:[1,0,0]
    v_cvt_pk_bf16_f32 v58, v8, v9
    v_mfma_f32_32x32x16_bf16 a[48:63], a[148:151], v[68:71], a[48:63]
    ds_read_b64_tr_b16 a[134:135], v23 offset:57344
    buffer_load_dwordx4 v34, s[16:19], s62 offen offset:2048 lds
    v_fma_mix_f32 v10, v155, v78, v86 op_sel_hi:[1,0,0]
    v_fma_mix_f32 v11, v155, v79, v87 op_sel:[1,0,0] op_sel_hi:[1,0,0]
    v_cvt_pk_bf16_f32 v59, v10, v11
    v_mfma_f32_32x32x16_bf16 a[64:79], a[152:155], v[64:67], a[64:79]
    ds_read_b64_tr_b16 a[136:137], v24 offset:57344
    ds_read_b128 v[92:95], v3 offset:4560
    v_fma_mix_f32 v4, v156, v72, v80 op_sel_hi:[1,0,0]
    v_fma_mix_f32 v5, v156, v73, v81 op_sel:[1,0,0] op_sel_hi:[1,0,0]
    v_cvt_pk_bf16_f32 v60, v4, v5
    v_mfma_f32_32x32x16_bf16 a[80:95], a[152:155], v[68:71], a[80:95]
    ds_read_b64_tr_b16 a[138:139], v25 offset:57344
    v_fma_mix_f32 v6, v157, v74, v82 op_sel_hi:[1,0,0]
    v_fma_mix_f32 v7, v157, v75, v83 op_sel:[1,0,0] op_sel_hi:[1,0,0]
    v_cvt_pk_bf16_f32 v61, v6, v7
    v_mfma_f32_32x32x16_bf16 a[96:111], a[156:159], v[64:67], a[96:111]
    ds_read_b64_tr_b16 a[140:141], v26 offset:57344
    ds_read_b128 v[100:103], v3 offset:2000
    v_fma_mix_f32 v8, v158, v76, v84 op_sel_hi:[1,0,0]
    v_fma_mix_f32 v9, v158, v77, v85 op_sel:[1,0,0] op_sel_hi:[1,0,0]
    v_cvt_pk_bf16_f32 v62, v8, v9
    v_mfma_f32_32x32x16_bf16 a[112:127], a[156:159], v[68:71], a[112:127]
    ds_read_b64_tr_b16 a[142:143], v27 offset:57344
    buffer_load_dwordx4 v35, s[16:19], s62 offen offset:3072 lds
    v_fma_mix_f32 v10, v159, v78, v86 op_sel_hi:[1,0,0]
    v_fma_mix_f32 v11, v159, v79, v87 op_sel:[1,0,0] op_sel_hi:[1,0,0]
    v_cvt_pk_bf16_f32 v63, v10, v11
    s_waitcnt vmcnt(27) lgkmcnt(6)
    v_mfma_f32_32x32x16_bf16 a[0:15], a[128:131], v[56:59], a[0:15]
    ds_read_b64_tr_b16 a[144:145], v20 offset:61440
    ds_read_b128 v[72:75], v3 offset:4608
    v_fma_mix_f32 v4, v160, v88, v96 op_sel_hi:[1,0,0]
    v_fma_mix_f32 v5, v160, v89, v97 op_sel:[1,0,0] op_sel_hi:[1,0,0]
    v_cvt_pk_bf16_f32 v64, v4, v5
    v_mfma_f32_32x32x16_bf16 a[16:31], a[128:131], v[60:63], a[16:31]
    ds_read_b64_tr_b16 a[146:147], v21 offset:61440
    v_fma_mix_f32 v6, v161, v90, v98 op_sel_hi:[1,0,0]
    v_fma_mix_f32 v7, v161, v91, v99 op_sel:[1,0,0] op_sel_hi:[1,0,0]
    v_cvt_pk_bf16_f32 v65, v6, v7
    s_waitcnt lgkmcnt(3)
    v_mfma_f32_32x32x16_bf16 a[32:47], a[132:135], v[56:59], a[32:47]
    ds_read_b64_tr_b16 a[148:149], v22 offset:61440
    ds_read_b128 v[80:83], v3 offset:2048
    v_fma_mix_f32 v8, v162, v92, v100 op_sel_hi:[1,0,0]
    v_fma_mix_f32 v9, v162, v93, v101 op_sel:[1,0,0] op_sel_hi:[1,0,0]
    v_cvt_pk_bf16_f32 v66, v8, v9
    s_add_u32 m0, s49, 49152
    s_add_u32 s62, s50, 0
    v_mfma_f32_32x32x16_bf16 a[48:63], a[132:135], v[60:63], a[48:63]
    ds_read_b64_tr_b16 a[150:151], v23 offset:61440
    buffer_load_dwordx4 v32, s[20:23], s62 offen offset:0 lds
    v_fma_mix_f32 v10, v163, v94, v102 op_sel_hi:[1,0,0]
    v_fma_mix_f32 v11, v163, v95, v103 op_sel:[1,0,0] op_sel_hi:[1,0,0]
    v_cvt_pk_bf16_f32 v67, v10, v11
    v_mfma_f32_32x32x16_bf16 a[64:79], a[136:139], v[56:59], a[64:79]
    ds_read_b64_tr_b16 a[152:153], v24 offset:61440
    ds_read_b128 v[76:79], v3 offset:4624
    v_fma_mix_f32 v4, v164, v88, v96 op_sel_hi:[1,0,0]
    v_fma_mix_f32 v5, v164, v89, v97 op_sel:[1,0,0] op_sel_hi:[1,0,0]
    v_cvt_pk_bf16_f32 v68, v4, v5
    v_mfma_f32_32x32x16_bf16 a[80:95], a[136:139], v[60:63], a[80:95]
    ds_read_b64_tr_b16 a[154:155], v25 offset:61440
    v_fma_mix_f32 v6, v165, v90, v98 op_sel_hi:[1,0,0]
    v_fma_mix_f32 v7, v165, v91, v99 op_sel:[1,0,0] op_sel_hi:[1,0,0]
    v_cvt_pk_bf16_f32 v69, v6, v7
    v_mfma_f32_32x32x16_bf16 a[96:111], a[140:143], v[56:59], a[96:111]
    ds_read_b64_tr_b16 a[156:157], v26 offset:61440
    ds_read_b128 v[84:87], v3 offset:2064
    v_fma_mix_f32 v8, v166, v92, v100 op_sel_hi:[1,0,0]
    v_fma_mix_f32 v9, v166, v93, v101 op_sel:[1,0,0] op_sel_hi:[1,0,0]
    v_cvt_pk_bf16_f32 v70, v8, v9
    v_mfma_f32_32x32x16_bf16 a[112:127], a[140:143], v[60:63], a[112:127]
    ds_read_b64_tr_b16 a[158:159], v27 offset:61440
    buffer_load_dwordx4 v33, s[20:23], s62 offen offset:1024 lds
    v_fma_mix_f32 v10, v167, v94, v102 op_sel_hi:[1,0,0]
    v_fma_mix_f32 v11, v167, v95, v103 op_sel:[1,0,0] op_sel_hi:[1,0,0]
    v_cvt_pk_bf16_f32 v71, v10, v11
    s_waitcnt vmcnt(10) lgkmcnt(6)
    v_mfma_f32_32x32x16_bf16 a[0:15], a[144:147], v[64:67], a[0:15]
    s_barrier
    v_mfma_f32_32x32x16_bf16 a[16:31], a[144:147], v[68:71], a[16:31]
    ds_read_b64_tr_b16 a[128:129], v12 offset:0
    ds_read_b64_tr_b16 a[130:131], v13 offset:0
    v_fma_mix_f32 v4, v168, v72, v80 op_sel_hi:[1,0,0]
    v_fma_mix_f32 v5, v168, v73, v81 op_sel:[1,0,0] op_sel_hi:[1,0,0]
    v_cvt_pk_bf16_f32 v56, v4, v5
    s_waitcnt lgkmcnt(2)
    v_mfma_f32_32x32x16_bf16 a[32:47], a[148:151], v[64:67], a[32:47]
    ds_read_b64_tr_b16 a[132:133], v14 offset:0
    ds_read_b128 v[88:91], v3 offset:4672
    v_fma_mix_f32 v6, v169, v74, v82 op_sel_hi:[1,0,0]
    v_fma_mix_f32 v7, v169, v75, v83 op_sel:[1,0,0] op_sel_hi:[1,0,0]
    v_cvt_pk_bf16_f32 v57, v6, v7
    v_fma_mix_f32 v8, v170, v76, v84 op_sel_hi:[1,0,0]
    v_mfma_f32_32x32x16_bf16 a[48:63], a[148:151], v[68:71], a[48:63]
    ds_read_b64_tr_b16 a[134:135], v15 offset:0
    ds_read_b128 v[96:99], v3 offset:2112
    v_fma_mix_f32 v9, v170, v77, v85 op_sel:[1,0,0] op_sel_hi:[1,0,0]
    v_cvt_pk_bf16_f32 v58, v8, v9
    v_fma_mix_f32 v10, v171, v78, v86 op_sel_hi:[1,0,0]
    v_fma_mix_f32 v11, v171, v79, v87 op_sel:[1,0,0] op_sel_hi:[1,0,0]
    v_mfma_f32_32x32x16_bf16 a[64:79], a[152:155], v[64:67], a[64:79]
    ds_read_b64_tr_b16 a[136:137], v16 offset:0
    ds_read_b128 v[92:95], v3 offset:4688
    v_cvt_pk_bf16_f32 v59, v10, v11
    v_fma_mix_f32 v4, v172, v72, v80 op_sel_hi:[1,0,0]
    v_fma_mix_f32 v5, v172, v73, v81 op_sel:[1,0,0] op_sel_hi:[1,0,0]
    v_cvt_pk_bf16_f32 v60, v4, v5
    v_mfma_f32_32x32x16_bf16 a[80:95], a[152:155], v[68:71], a[80:95]
    ds_read_b64_tr_b16 a[138:139], v17 offset:0
    buffer_load_dwordx4 v34, s[20:23], s62 offen offset:2048 lds
    v_fma_mix_f32 v6, v173, v74, v82 op_sel_hi:[1,0,0]
    v_fma_mix_f32 v7, v173, v75, v83 op_sel:[1,0,0] op_sel_hi:[1,0,0]
    v_cvt_pk_bf16_f32 v61, v6, v7
    v_mfma_f32_32x32x16_bf16 a[96:111], a[156:159], v[64:67], a[96:111]
    ds_read_b64_tr_b16 a[140:141], v18 offset:0
    ds_read_b128 v[100:103], v3 offset:2128
    v_fma_mix_f32 v8, v174, v76, v84 op_sel_hi:[1,0,0]
    v_fma_mix_f32 v9, v174, v77, v85 op_sel:[1,0,0] op_sel_hi:[1,0,0]
    v_cvt_pk_bf16_f32 v62, v8, v9
    v_mfma_f32_32x32x16_bf16 a[112:127], a[156:159], v[68:71], a[112:127]
    ds_read_b64_tr_b16 a[142:143], v19 offset:0
    buffer_load_dwordx4 v35, s[20:23], s62 offen offset:3072 lds
    v_fma_mix_f32 v10, v175, v78, v86 op_sel_hi:[1,0,0]
    v_fma_mix_f32 v11, v175, v79, v87 op_sel:[1,0,0] op_sel_hi:[1,0,0]
    v_cvt_pk_bf16_f32 v63, v10, v11
    s_waitcnt lgkmcnt(6)
    v_mfma_f32_32x32x16_bf16 a[0:15], a[128:131], v[56:59], a[0:15]
    ds_read_b64_tr_b16 a[144:145], v12 offset:4096
    ds_read_b128 v[72:75], v3 offset:4736
    v_fma_mix_f32 v4, v176, v88, v96 op_sel_hi:[1,0,0]
    v_fma_mix_f32 v5, v176, v89, v97 op_sel:[1,0,0] op_sel_hi:[1,0,0]
    v_cvt_pk_bf16_f32 v64, v4, v5
    v_mfma_f32_32x32x16_bf16 a[16:31], a[128:131], v[60:63], a[16:31]
    ds_read_b64_tr_b16 a[146:147], v13 offset:4096
    v_fma_mix_f32 v6, v177, v90, v98 op_sel_hi:[1,0,0]
    v_fma_mix_f32 v7, v177, v91, v99 op_sel:[1,0,0] op_sel_hi:[1,0,0]
    v_cvt_pk_bf16_f32 v65, v6, v7
    s_waitcnt lgkmcnt(3)
    v_mfma_f32_32x32x16_bf16 a[32:47], a[132:135], v[56:59], a[32:47]
    ds_read_b64_tr_b16 a[148:149], v14 offset:4096
    ds_read_b128 v[80:83], v3 offset:2176
    v_fma_mix_f32 v8, v178, v92, v100 op_sel_hi:[1,0,0]
    v_fma_mix_f32 v9, v178, v93, v101 op_sel:[1,0,0] op_sel_hi:[1,0,0]
    v_cvt_pk_bf16_f32 v66, v8, v9
    s_add_u32 m0, s49, 65536
    s_add_u32 s62, s50, 16384
    v_mfma_f32_32x32x16_bf16 a[48:63], a[132:135], v[60:63], a[48:63]
    ds_read_b64_tr_b16 a[150:151], v15 offset:4096
    buffer_load_dwordx4 v32, s[16:19], s62 offen offset:0 lds
    v_fma_mix_f32 v10, v179, v94, v102 op_sel_hi:[1,0,0]
    v_fma_mix_f32 v11, v179, v95, v103 op_sel:[1,0,0] op_sel_hi:[1,0,0]
    v_cvt_pk_bf16_f32 v67, v10, v11
    v_mfma_f32_32x32x16_bf16 a[64:79], a[136:139], v[56:59], a[64:79]
    ds_read_b64_tr_b16 a[152:153], v16 offset:4096
    ds_read_b128 v[76:79], v3 offset:4752
    v_fma_mix_f32 v4, v180, v88, v96 op_sel_hi:[1,0,0]
    v_fma_mix_f32 v5, v180, v89, v97 op_sel:[1,0,0] op_sel_hi:[1,0,0]
    v_cvt_pk_bf16_f32 v68, v4, v5
    v_mfma_f32_32x32x16_bf16 a[80:95], a[136:139], v[60:63], a[80:95]
    ds_read_b64_tr_b16 a[154:155], v17 offset:4096
    v_fma_mix_f32 v6, v181, v90, v98 op_sel_hi:[1,0,0]
    v_fma_mix_f32 v7, v181, v91, v99 op_sel:[1,0,0] op_sel_hi:[1,0,0]
    v_cvt_pk_bf16_f32 v69, v6, v7
    v_mfma_f32_32x32x16_bf16 a[96:111], a[140:143], v[56:59], a[96:111]
    ds_read_b64_tr_b16 a[156:157], v18 offset:4096
    ds_read_b128 v[84:87], v3 offset:2192
    v_fma_mix_f32 v8, v182, v92, v100 op_sel_hi:[1,0,0]
    v_fma_mix_f32 v9, v182, v93, v101 op_sel:[1,0,0] op_sel_hi:[1,0,0]
    v_cvt_pk_bf16_f32 v70, v8, v9
    v_mfma_f32_32x32x16_bf16 a[112:127], a[140:143], v[60:63], a[112:127]
    ds_read_b64_tr_b16 a[158:159], v19 offset:4096
    buffer_load_dwordx4 v33, s[16:19], s62 offen offset:1024 lds
    v_fma_mix_f32 v10, v183, v94, v102 op_sel_hi:[1,0,0]
    v_fma_mix_f32 v11, v183, v95, v103 op_sel:[1,0,0] op_sel_hi:[1,0,0]
    v_cvt_pk_bf16_f32 v71, v10, v11
    s_waitcnt lgkmcnt(6)
    v_mfma_f32_32x32x16_bf16 a[0:15], a[144:147], v[64:67], a[0:15]
    ds_read_b64_tr_b16 a[128:129], v12 offset:8192
    ds_read_b128 v[88:91], v3 offset:4800
    v_fma_mix_f32 v4, v184, v72, v80 op_sel_hi:[1,0,0]
    v_fma_mix_f32 v5, v184, v73, v81 op_sel:[1,0,0] op_sel_hi:[1,0,0]
    v_cvt_pk_bf16_f32 v56, v4, v5
    v_mfma_f32_32x32x16_bf16 a[16:31], a[144:147], v[68:71], a[16:31]
    ds_read_b64_tr_b16 a[130:131], v13 offset:8192
    v_fma_mix_f32 v6, v185, v74, v82 op_sel_hi:[1,0,0]
    v_fma_mix_f32 v7, v185, v75, v83 op_sel:[1,0,0] op_sel_hi:[1,0,0]
    v_cvt_pk_bf16_f32 v57, v6, v7
    s_waitcnt lgkmcnt(3)
    v_mfma_f32_32x32x16_bf16 a[32:47], a[148:151], v[64:67], a[32:47]
    ds_read_b64_tr_b16 a[132:133], v14 offset:8192
    ds_read_b128 v[96:99], v3 offset:2240
    v_fma_mix_f32 v8, v186, v76, v84 op_sel_hi:[1,0,0]
    v_fma_mix_f32 v9, v186, v77, v85 op_sel:[1,0,0] op_sel_hi:[1,0,0]
    v_cvt_pk_bf16_f32 v58, v8, v9
    v_mfma_f32_32x32x16_bf16 a[48:63], a[148:151], v[68:71], a[48:63]
    ds_read_b64_tr_b16 a[134:135], v15 offset:8192
    buffer_load_dwordx4 v34, s[16:19], s62 offen offset:2048 lds
    v_fma_mix_f32 v10, v187, v78, v86 op_sel_hi:[1,0,0]
    v_fma_mix_f32 v11, v187, v79, v87 op_sel:[1,0,0] op_sel_hi:[1,0,0]
    v_cvt_pk_bf16_f32 v59, v10, v11
    v_mfma_f32_32x32x16_bf16 a[64:79], a[152:155], v[64:67], a[64:79]
    ds_read_b64_tr_b16 a[136:137], v16 offset:8192
    ds_read_b128 v[92:95], v3 offset:4816
    v_fma_mix_f32 v4, v188, v72, v80 op_sel_hi:[1,0,0]
    v_fma_mix_f32 v5, v188, v73, v81 op_sel:[1,0,0] op_sel_hi:[1,0,0]
    v_cvt_pk_bf16_f32 v60, v4, v5
    v_mfma_f32_32x32x16_bf16 a[80:95], a[152:155], v[68:71], a[80:95]
    ds_read_b64_tr_b16 a[138:139], v17 offset:8192
    v_fma_mix_f32 v6, v189, v74, v82 op_sel_hi:[1,0,0]
    v_fma_mix_f32 v7, v189, v75, v83 op_sel:[1,0,0] op_sel_hi:[1,0,0]
    v_cvt_pk_bf16_f32 v61, v6, v7
    v_mfma_f32_32x32x16_bf16 a[96:111], a[156:159], v[64:67], a[96:111]
    ds_read_b64_tr_b16 a[140:141], v18 offset:8192
    ds_read_b128 v[100:103], v3 offset:2256
    v_fma_mix_f32 v8, v190, v76, v84 op_sel_hi:[1,0,0]
    v_fma_mix_f32 v9, v190, v77, v85 op_sel:[1,0,0] op_sel_hi:[1,0,0]
    v_cvt_pk_bf16_f32 v62, v8, v9
    v_mfma_f32_32x32x16_bf16 a[112:127], a[156:159], v[68:71], a[112:127]
    ds_read_b64_tr_b16 a[142:143], v19 offset:8192
    buffer_load_dwordx4 v35, s[16:19], s62 offen offset:3072 lds
    v_fma_mix_f32 v10, v191, v78, v86 op_sel_hi:[1,0,0]
    v_fma_mix_f32 v11, v191, v79, v87 op_sel:[1,0,0] op_sel_hi:[1,0,0]
    v_cvt_pk_bf16_f32 v63, v10, v11
    s_waitcnt lgkmcnt(6)
    v_mfma_f32_32x32x16_bf16 a[0:15], a[128:131], v[56:59], a[0:15]
    ds_read_b64_tr_b16 a[144:145], v12 offset:12288
    ds_read_b128 v[72:75], v3 offset:4864
    v_fma_mix_f32 v4, v192, v88, v96 op_sel_hi:[1,0,0]
    v_fma_mix_f32 v5, v192, v89, v97 op_sel:[1,0,0] op_sel_hi:[1,0,0]
    v_cvt_pk_bf16_f32 v64, v4, v5
    v_mfma_f32_32x32x16_bf16 a[16:31], a[128:131], v[60:63], a[16:31]
    ds_read_b64_tr_b16 a[146:147], v13 offset:12288
    v_fma_mix_f32 v6, v193, v90, v98 op_sel_hi:[1,0,0]
    v_fma_mix_f32 v7, v193, v91, v99 op_sel:[1,0,0] op_sel_hi:[1,0,0]
    v_cvt_pk_bf16_f32 v65, v6, v7
    s_waitcnt lgkmcnt(3)
    v_mfma_f32_32x32x16_bf16 a[32:47], a[132:135], v[56:59], a[32:47]
    ds_read_b64_tr_b16 a[148:149], v14 offset:12288
    ds_read_b128 v[80:83], v3 offset:2304
    v_fma_mix_f32 v8, v194, v92, v100 op_sel_hi:[1,0,0]
    v_fma_mix_f32 v9, v194, v93, v101 op_sel:[1,0,0] op_sel_hi:[1,0,0]
    v_cvt_pk_bf16_f32 v66, v8, v9
    s_add_u32 m0, s49, 81920
    s_add_u32 s62, s50, 16384
    v_mfma_f32_32x32x16_bf16 a[48:63], a[132:135], v[60:63], a[48:63]
    ds_read_b64_tr_b16 a[150:151], v15 offset:12288
    buffer_load_dwordx4 v32, s[20:23], s62 offen offset:0 lds
    v_fma_mix_f32 v10, v195, v94, v102 op_sel_hi:[1,0,0]
    v_fma_mix_f32 v11, v195, v95, v103 op_sel:[1,0,0] op_sel_hi:[1,0,0]
    v_cvt_pk_bf16_f32 v67, v10, v11
    v_mfma_f32_32x32x16_bf16 a[64:79], a[136:139], v[56:59], a[64:79]
    ds_read_b64_tr_b16 a[152:153], v16 offset:12288
    ds_read_b128 v[76:79], v3 offset:4880
    v_fma_mix_f32 v4, v196, v88, v96 op_sel_hi:[1,0,0]
    v_fma_mix_f32 v5, v196, v89, v97 op_sel:[1,0,0] op_sel_hi:[1,0,0]
    v_cvt_pk_bf16_f32 v68, v4, v5
    v_mfma_f32_32x32x16_bf16 a[80:95], a[136:139], v[60:63], a[80:95]
    ds_read_b64_tr_b16 a[154:155], v17 offset:12288
    v_fma_mix_f32 v6, v197, v90, v98 op_sel_hi:[1,0,0]
    v_fma_mix_f32 v7, v197, v91, v99 op_sel:[1,0,0] op_sel_hi:[1,0,0]
    v_cvt_pk_bf16_f32 v69, v6, v7
    v_mfma_f32_32x32x16_bf16 a[96:111], a[140:143], v[56:59], a[96:111]
    ds_read_b64_tr_b16 a[156:157], v18 offset:12288
    ds_read_b128 v[84:87], v3 offset:2320
    v_fma_mix_f32 v8, v198, v92, v100 op_sel_hi:[1,0,0]
    v_fma_mix_f32 v9, v198, v93, v101 op_sel:[1,0,0] op_sel_hi:[1,0,0]
    v_cvt_pk_bf16_f32 v70, v8, v9
    v_mfma_f32_32x32x16_bf16 a[112:127], a[140:143], v[60:63], a[112:127]
    ds_read_b64_tr_b16 a[158:159], v19 offset:12288
    buffer_load_dwordx4 v33, s[20:23], s62 offen offset:1024 lds
    v_fma_mix_f32 v10, v199, v94, v102 op_sel_hi:[1,0,0]
    v_fma_mix_f32 v11, v199, v95, v103 op_sel:[1,0,0] op_sel_hi:[1,0,0]
    v_cvt_pk_bf16_f32 v71, v10, v11
    s_waitcnt lgkmcnt(6)
    v_mfma_f32_32x32x16_bf16 a[0:15], a[144:147], v[64:67], a[0:15]
    ds_read_b64_tr_b16 a[128:129], v12 offset:16384
    ds_read_b128 v[88:91], v3 offset:4928
    v_fma_mix_f32 v4, v104, v72, v80 op_sel_hi:[1,0,0]
    v_fma_mix_f32 v5, v104, v73, v81 op_sel:[1,0,0] op_sel_hi:[1,0,0]
    v_cvt_pk_bf16_f32 v56, v4, v5
    v_mfma_f32_32x32x16_bf16 a[16:31], a[144:147], v[68:71], a[16:31]
    ds_read_b64_tr_b16 a[130:131], v13 offset:16384
    v_fma_mix_f32 v6, v105, v74, v82 op_sel_hi:[1,0,0]
    v_fma_mix_f32 v7, v105, v75, v83 op_sel:[1,0,0] op_sel_hi:[1,0,0]
    v_cvt_pk_bf16_f32 v57, v6, v7
    s_waitcnt lgkmcnt(3)
    v_mfma_f32_32x32x16_bf16 a[32:47], a[148:151], v[64:67], a[32:47]
    ds_read_b64_tr_b16 a[132:133], v14 offset:16384
    ds_read_b128 v[96:99], v3 offset:2368
    v_fma_mix_f32 v8, v106, v76, v84 op_sel_hi:[1,0,0]
    v_fma_mix_f32 v9, v106, v77, v85 op_sel:[1,0,0] op_sel_hi:[1,0,0]
    v_cvt_pk_bf16_f32 v58, v8, v9
    v_mfma_f32_32x32x16_bf16 a[48:63], a[148:151], v[68:71], a[48:63]
    ds_read_b64_tr_b16 a[134:135], v15 offset:16384
    buffer_load_dwordx4 v34, s[20:23], s62 offen offset:2048 lds
    v_fma_mix_f32 v10, v107, v78, v86 op_sel_hi:[1,0,0]
    v_fma_mix_f32 v11, v107, v79, v87 op_sel:[1,0,0] op_sel_hi:[1,0,0]
    v_cvt_pk_bf16_f32 v59, v10, v11
    v_mfma_f32_32x32x16_bf16 a[64:79], a[152:155], v[64:67], a[64:79]
    ds_read_b64_tr_b16 a[136:137], v16 offset:16384
    ds_read_b128 v[92:95], v3 offset:4944
    v_fma_mix_f32 v4, v108, v72, v80 op_sel_hi:[1,0,0]
    v_fma_mix_f32 v5, v108, v73, v81 op_sel:[1,0,0] op_sel_hi:[1,0,0]
    v_cvt_pk_bf16_f32 v60, v4, v5
    v_mfma_f32_32x32x16_bf16 a[80:95], a[152:155], v[68:71], a[80:95]
    ds_read_b64_tr_b16 a[138:139], v17 offset:16384
    v_fma_mix_f32 v6, v109, v74, v82 op_sel_hi:[1,0,0]
    v_fma_mix_f32 v7, v109, v75, v83 op_sel:[1,0,0] op_sel_hi:[1,0,0]
    v_cvt_pk_bf16_f32 v61, v6, v7
    v_mfma_f32_32x32x16_bf16 a[96:111], a[156:159], v[64:67], a[96:111]
    ds_read_b64_tr_b16 a[140:141], v18 offset:16384
    ds_read_b128 v[100:103], v3 offset:2384
    v_fma_mix_f32 v8, v110, v76, v84 op_sel_hi:[1,0,0]
    v_fma_mix_f32 v9, v110, v77, v85 op_sel:[1,0,0] op_sel_hi:[1,0,0]
    v_cvt_pk_bf16_f32 v62, v8, v9
    v_mfma_f32_32x32x16_bf16 a[112:127], a[156:159], v[68:71], a[112:127]
    ds_read_b64_tr_b16 a[142:143], v19 offset:16384
    buffer_load_dwordx4 v35, s[20:23], s62 offen offset:3072 lds
    v_fma_mix_f32 v10, v111, v78, v86 op_sel_hi:[1,0,0]
    v_fma_mix_f32 v11, v111, v79, v87 op_sel:[1,0,0] op_sel_hi:[1,0,0]
    v_cvt_pk_bf16_f32 v63, v10, v11
    s_waitcnt lgkmcnt(6)
    v_mfma_f32_32x32x16_bf16 a[0:15], a[128:131], v[56:59], a[0:15]
    ds_read_b64_tr_b16 a[144:145], v12 offset:20480
    ds_read_b128 v[72:75], v3 offset:4992
    v_fma_mix_f32 v4, v112, v88, v96 op_sel_hi:[1,0,0]
    v_fma_mix_f32 v5, v112, v89, v97 op_sel:[1,0,0] op_sel_hi:[1,0,0]
    v_cvt_pk_bf16_f32 v64, v4, v5
    v_min_u32 v252, 23, v1
    v_lshlrev_b32 v252, 7, v252
    v_mfma_f32_32x32x16_bf16 a[16:31], a[128:131], v[60:63], a[16:31]
    ds_read_b64_tr_b16 a[146:147], v13 offset:20480
    v_fma_mix_f32 v6, v113, v90, v98 op_sel_hi:[1,0,0]
    v_fma_mix_f32 v7, v113, v91, v99 op_sel:[1,0,0] op_sel_hi:[1,0,0]
    v_cvt_pk_bf16_f32 v65, v6, v7
    s_waitcnt lgkmcnt(3)
    v_mfma_f32_32x32x16_bf16 a[32:47], a[132:135], v[56:59], a[32:47]
    ds_read_b64_tr_b16 a[148:149], v14 offset:20480
    ds_read_b128 v[80:83], v3 offset:2432
    v_fma_mix_f32 v8, v114, v92, v100 op_sel_hi:[1,0,0]
    v_fma_mix_f32 v9, v114, v93, v101 op_sel:[1,0,0] op_sel_hi:[1,0,0]
    v_cvt_pk_bf16_f32 v66, v8, v9
    s_lshl_b32 s92, s86, 2
    s_add_u32 s92, s92, s3
    s_mul_i32 s92, s92, 3072
    s_add_u32 s92, s92, s50
    s_add_u32 s92, s92, 32768
    v_mfma_f32_32x32x16_bf16 a[48:63], a[132:135], v[60:63], a[48:63]
    ds_read_b64_tr_b16 a[150:151], v15 offset:20480
    buffer_load_dword v251, v252, s[16:19], s92 offen
    v_fma_mix_f32 v10, v115, v94, v102 op_sel_hi:[1,0,0]
    v_fma_mix_f32 v11, v115, v95, v103 op_sel:[1,0,0] op_sel_hi:[1,0,0]
    v_cvt_pk_bf16_f32 v67, v10, v11
    v_mfma_f32_32x32x16_bf16 a[64:79], a[136:139], v[56:59], a[64:79]
    ds_read_b64_tr_b16 a[152:153], v16 offset:20480
    ds_read_b128 v[76:79], v3 offset:5008
    v_fma_mix_f32 v4, v116, v88, v96 op_sel_hi:[1,0,0]
    v_fma_mix_f32 v5, v116, v89, v97 op_sel:[1,0,0] op_sel_hi:[1,0,0]
    v_cvt_pk_bf16_f32 v68, v4, v5
    v_mfma_f32_32x32x16_bf16 a[80:95], a[136:139], v[60:63], a[80:95]
    ds_read_b64_tr_b16 a[154:155], v17 offset:20480
    v_fma_mix_f32 v6, v117, v90, v98 op_sel_hi:[1,0,0]
    v_fma_mix_f32 v7, v117, v91, v99 op_sel:[1,0,0] op_sel_hi:[1,0,0]
    v_cvt_pk_bf16_f32 v69, v6, v7
    v_mfma_f32_32x32x16_bf16 a[96:111], a[140:143], v[56:59], a[96:111]
    ds_read_b64_tr_b16 a[156:157], v18 offset:20480
    ds_read_b128 v[84:87], v3 offset:2448
    v_fma_mix_f32 v8, v118, v92, v100 op_sel_hi:[1,0,0]
    v_fma_mix_f32 v9, v118, v93, v101 op_sel:[1,0,0] op_sel_hi:[1,0,0]
    v_cvt_pk_bf16_f32 v70, v8, v9
    v_mfma_f32_32x32x16_bf16 a[112:127], a[140:143], v[60:63], a[112:127]
    ds_read_b64_tr_b16 a[158:159], v19 offset:20480
    buffer_load_dword v251, v252, s[20:23], s92 offen
    v_fma_mix_f32 v10, v119, v94, v102 op_sel_hi:[1,0,0]
    v_fma_mix_f32 v11, v119, v95, v103 op_sel:[1,0,0] op_sel_hi:[1,0,0]
    v_cvt_pk_bf16_f32 v71, v10, v11
    s_waitcnt vmcnt(20) lgkmcnt(6)
    v_mfma_f32_32x32x16_bf16 a[0:15], a[144:147], v[64:67], a[0:15]
    ds_read_b64_tr_b16 a[128:129], v12 offset:24576
    ds_read_b128 v[88:91], v3 offset:5056
    v_fma_mix_f32 v4, v120, v72, v80 op_sel_hi:[1,0,0]
    v_fma_mix_f32 v5, v120, v73, v81 op_sel:[1,0,0] op_sel_hi:[1,0,0]
    v_cvt_pk_bf16_f32 v56, v4, v5
    v_mfma_f32_32x32x16_bf16 a[16:31], a[144:147], v[68:71], a[16:31]
    ds_read_b64_tr_b16 a[130:131], v13 offset:24576
    v_fma_mix_f32 v6, v121, v74, v82 op_sel_hi:[1,0,0]
    v_fma_mix_f32 v7, v121, v75, v83 op_sel:[1,0,0] op_sel_hi:[1,0,0]
    v_cvt_pk_bf16_f32 v57, v6, v7
    s_waitcnt lgkmcnt(3)
    v_mfma_f32_32x32x16_bf16 a[32:47], a[148:151], v[64:67], a[32:47]
    ds_read_b64_tr_b16 a[132:133], v14 offset:24576
    ds_read_b128 v[96:99], v3 offset:2496
    v_fma_mix_f32 v8, v122, v76, v84 op_sel_hi:[1,0,0]
    v_fma_mix_f32 v9, v122, v77, v85 op_sel:[1,0,0] op_sel_hi:[1,0,0]
    v_cvt_pk_bf16_f32 v58, v8, v9
    v_mfma_f32_32x32x16_bf16 a[48:63], a[148:151], v[68:71], a[48:63]
    ds_read_b64_tr_b16 a[134:135], v15 offset:24576
    v_fma_mix_f32 v10, v123, v78, v86 op_sel_hi:[1,0,0]
    v_fma_mix_f32 v11, v123, v79, v87 op_sel:[1,0,0] op_sel_hi:[1,0,0]
    v_cvt_pk_bf16_f32 v59, v10, v11
    v_mfma_f32_32x32x16_bf16 a[64:79], a[152:155], v[64:67], a[64:79]
    ds_read_b64_tr_b16 a[136:137], v16 offset:24576
    ds_read_b128 v[92:95], v3 offset:5072
    v_fma_mix_f32 v4, v124, v72, v80 op_sel_hi:[1,0,0]
    v_fma_mix_f32 v5, v124, v73, v81 op_sel:[1,0,0] op_sel_hi:[1,0,0]
    v_cvt_pk_bf16_f32 v60, v4, v5
    v_mfma_f32_32x32x16_bf16 a[80:95], a[152:155], v[68:71], a[80:95]
    ds_read_b64_tr_b16 a[138:139], v17 offset:24576
    v_fma_mix_f32 v6, v125, v74, v82 op_sel_hi:[1,0,0]
    v_fma_mix_f32 v7, v125, v75, v83 op_sel:[1,0,0] op_sel_hi:[1,0,0]
    v_cvt_pk_bf16_f32 v61, v6, v7
    v_mfma_f32_32x32x16_bf16 a[96:111], a[156:159], v[64:67], a[96:111]
    ds_read_b64_tr_b16 a[140:141], v18 offset:24576
    ds_read_b128 v[100:103], v3 offset:2512
    v_fma_mix_f32 v8, v126, v76, v84 op_sel_hi:[1,0,0]
    v_fma_mix_f32 v9, v126, v77, v85 op_sel:[1,0,0] op_sel_hi:[1,0,0]
    v_cvt_pk_bf16_f32 v62, v8, v9
    v_mfma_f32_32x32x16_bf16 a[112:127], a[156:159], v[68:71], a[112:127]
    ds_read_b64_tr_b16 a[142:143], v19 offset:24576
    v_fma_mix_f32 v10, v127, v78, v86 op_sel_hi:[1,0,0]
    v_fma_mix_f32 v11, v127, v79, v87 op_sel:[1,0,0] op_sel_hi:[1,0,0]
    v_cvt_pk_bf16_f32 v63, v10, v11
    s_waitcnt vmcnt(10) lgkmcnt(6)
    v_mfma_f32_32x32x16_bf16 a[0:15], a[128:131], v[56:59], a[0:15]
    s_barrier
    v_mfma_f32_32x32x16_bf16 a[16:31], a[128:131], v[60:63], a[16:31]
    ds_read_b64_tr_b16 a[144:145], v12 offset:28672
    ds_read_b64_tr_b16 a[146:147], v13 offset:28672
    v_fma_mix_f32 v4, v128, v88, v96 op_sel_hi:[1,0,0]
    v_fma_mix_f32 v5, v128, v89, v97 op_sel:[1,0,0] op_sel_hi:[1,0,0]
    v_cvt_pk_bf16_f32 v64, v4, v5
    s_waitcnt lgkmcnt(2)
    v_mfma_f32_32x32x16_bf16 a[32:47], a[132:135], v[56:59], a[32:47]
    ds_read_b64_tr_b16 a[148:149], v14 offset:28672
    ds_read_b128 a[160:163], v40 offset:32768
    v_fma_mix_f32 v6, v129, v90, v98 op_sel_hi:[1,0,0]
    v_fma_mix_f32 v7, v129, v91, v99 op_sel:[1,0,0] op_sel_hi:[1,0,0]
    v_cvt_pk_bf16_f32 v65, v6, v7
    v_fma_mix_f32 v8, v130, v92, v100 op_sel_hi:[1,0,0]
    v_mfma_f32_32x32x16_bf16 a[48:63], a[132:135], v[60:63], a[48:63]
    ds_read_b64_tr_b16 a[150:151], v15 offset:28672
    ds_read_b128 a[164:167], v41 offset:32768
    v_fma_mix_f32 v9, v130, v93, v101 op_sel:[1,0,0] op_sel_hi:[1,0,0]
    v_cvt_pk_bf16_f32 v66, v8, v9
    v_fma_mix_f32 v10, v131, v94, v102 op_sel_hi:[1,0,0]
    v_fma_mix_f32 v11, v131, v95, v103 op_sel:[1,0,0] op_sel_hi:[1,0,0]
    v_mfma_f32_32x32x16_bf16 a[64:79], a[136:139], v[56:59], a[64:79]
    ds_read_b64_tr_b16 a[152:153], v16 offset:28672
    ds_read_b128 a[168:171], v42 offset:32768
    v_cvt_pk_bf16_f32 v67, v10, v11
    v_fma_mix_f32 v4, v132, v88, v96 op_sel_hi:[1,0,0]
    v_fma_mix_f32 v5, v132, v89, v97 op_sel:[1,0,0] op_sel_hi:[1,0,0]
    v_cvt_pk_bf16_f32 v68, v4, v5
    v_mfma_f32_32x32x16_bf16 a[80:95], a[136:139], v[60:63], a[80:95]
    ds_read_b64_tr_b16 a[154:155], v17 offset:28672
    ds_read_b128 a[172:175], v43 offset:32768
    v_fma_mix_f32 v6, v133, v90, v98 op_sel_hi:[1,0,0]
    v_fma_mix_f32 v7, v133, v91, v99 op_sel:[1,0,0] op_sel_hi:[1,0,0]
    v_cvt_pk_bf16_f32 v69, v6, v7
    v_mfma_f32_32x32x16_bf16 a[96:111], a[140:143], v[56:59], a[96:111]
    ds_read_b64_tr_b16 a[156:157], v18 offset:28672
    ds_read_b128 a[176:179], v44 offset:32768
    v_fma_mix_f32 v8, v134, v92, v100 op_sel_hi:[1,0,0]
    v_fma_mix_f32 v9, v134, v93, v101 op_sel:[1,0,0] op_sel_hi:[1,0,0]
    v_cvt_pk_bf16_f32 v70, v8, v9
    v_mfma_f32_32x32x16_bf16 a[112:127], a[140:143], v[60:63], a[112:127]
    ds_read_b64_tr_b16 a[158:159], v19 offset:28672
    ds_read_b128 a[180:183], v45 offset:32768
    v_fma_mix_f32 v10, v135, v94, v102 op_sel_hi:[1,0,0]
    v_fma_mix_f32 v11, v135, v95, v103 op_sel:[1,0,0] op_sel_hi:[1,0,0]
    v_cvt_pk_bf16_f32 v71, v10, v11
    s_waitcnt lgkmcnt(1)
    v_mfma_f32_32x32x16_bf16 a[0:15], a[144:147], v[64:67], a[0:15]
    ds_read_b128 a[184:187], v46 offset:32768
    ds_read_b128 a[188:191], v47 offset:32768
    ds_read_b64_tr_b16 a[192:193], v12 offset:49152
    v_lshrrev_b32 v4, 4, v1
    v_lshlrev_b32 v5, 2, v4
    v_xor_b32 v5, v5, v1
    v_and_b32 v5, 15, v5
    v_lshl_add_u32 v4, s3, 4, v4
    v_mfma_f32_32x32x16_bf16 a[32:47], a[148:151], v[64:67], a[32:47]
    ds_read_b64_tr_b16 a[194:195], v13 offset:49152
    ds_read_b64_tr_b16 a[196:197], v14 offset:49152
    ds_read_b64_tr_b16 a[198:199], v15 offset:49152
    v_mul_u32_u24 v4, 1280, v4
    v_xor_b32 v28, 0, v5
    v_lshl_add_u32 v28, v28, 4, v4
    v_xor_b32 v29, 1, v5
    v_lshl_add_u32 v29, v29, 4, v4
    v_mfma_f32_32x32x16_bf16 a[64:79], a[152:155], v[64:67], a[64:79]
    ds_read_b64_tr_b16 a[200:201], v16 offset:49152
    ds_read_b64_tr_b16 a[202:203], v17 offset:49152
    ds_read_b64_tr_b16 a[204:205], v18 offset:49152
    v_add_u32 v29, 4096, v29
    v_xor_b32 v30, 2, v5
    v_lshl_add_u32 v30, v30, 4, v4
    v_add_u32 v30, 8192, v30
    v_xor_b32 v31, 3, v5
    v_mfma_f32_32x32x16_bf16 a[96:111], a[156:159], v[64:67], a[96:111]
    ds_read_b64_tr_b16 a[206:207], v19 offset:49152
    ds_read_b64_tr_b16 a[208:209], v12 offset:53248
    ds_read_b64_tr_b16 a[210:211], v13 offset:53248
    v_lshl_add_u32 v31, v31, 4, v4
    v_add_u32 v31, 12288, v31
    v_mfma_f32_32x32x16_bf16 a[16:31], a[144:147], v[68:71], a[16:31]
    ds_read_b64_tr_b16 a[212:213], v14 offset:53248
    ds_read_b64_tr_b16 a[214:215], v15 offset:53248
    ds_read_b64_tr_b16 a[216:217], v16 offset:53248
    v_accvgpr_read_b32 v4, a0
    v_accvgpr_read_b32 v5, a1
    v_cvt_pk_bf16_f32 v92, v4, v5
    v_accvgpr_read_b32 v6, a2
    v_accvgpr_read_b32 v7, a3
    v_cvt_pk_bf16_f32 v93, v6, v7
    v_mfma_f32_32x32x16_bf16 a[48:63], a[148:151], v[68:71], a[48:63]
    ds_read_b64_tr_b16 a[218:219], v17 offset:53248
    ds_read_b64_tr_b16 a[220:221], v18 offset:53248
    ds_read_b64_tr_b16 a[222:223], v19 offset:53248
    v_accvgpr_read_b32 v8, a4
    v_accvgpr_read_b32 v9, a5
    v_cvt_pk_bf16_f32 v94, v8, v9
    v_accvgpr_read_b32 v10, a6
    v_accvgpr_read_b32 v11, a7
    v_cvt_pk_bf16_f32 v95, v10, v11
    v_mfma_f32_32x32x16_bf16 a[80:95], a[152:155], v[68:71], a[80:95]
    v_accvgpr_read_b32 v4, a8
    v_accvgpr_read_b32 v5, a9
    v_cvt_pk_bf16_f32 v96, v4, v5
    v_accvgpr_read_b32 v6, a10
    v_accvgpr_read_b32 v7, a11
    v_cvt_pk_bf16_f32 v97, v6, v7
    v_mfma_f32_32x32x16_bf16 a[112:127], a[156:159], v[68:71], a[112:127]
    v_accvgpr_read_b32 v8, a12
    v_accvgpr_read_b32 v9, a13
    v_cvt_pk_bf16_f32 v98, v8, v9
    v_accvgpr_read_b32 v10, a14
    v_accvgpr_read_b32 v11, a15
    v_cvt_pk_bf16_f32 v99, v10, v11
    v_mfma_f32_32x32x16_bf16 v[124:139], a[160:163], v[92:95], 0
    v_accvgpr_read_b32 v4, a32
    v_accvgpr_read_b32 v5, a33
    v_cvt_pk_bf16_f32 v100, v4, v5
    v_accvgpr_read_b32 v6, a34
    v_accvgpr_read_b32 v7, a35
    v_cvt_pk_bf16_f32 v101, v6, v7
    v_accvgpr_read_b32 v8, a36
    v_accvgpr_read_b32 v9, a37
    v_cvt_pk_bf16_f32 v102, v8, v9
    v_accvgpr_read_b32 v10, a38
    v_accvgpr_read_b32 v11, a39
    v_cvt_pk_bf16_f32 v103, v10, v11
    v_mfma_f32_32x32x16_bf16 v[124:139], a[164:167], v[96:99], v[124:139]
    v_accvgpr_read_b32 v4, a40
    v_accvgpr_read_b32 v5, a41
    v_cvt_pk_bf16_f32 v104, v4, v5
    v_accvgpr_read_b32 v6, a42
    v_accvgpr_read_b32 v7, a43
    v_cvt_pk_bf16_f32 v105, v6, v7
    v_accvgpr_read_b32 v8, a44
    v_accvgpr_read_b32 v9, a45
    v_cvt_pk_bf16_f32 v106, v8, v9
    v_accvgpr_read_b32 v10, a46
    v_accvgpr_read_b32 v11, a47
    v_cvt_pk_bf16_f32 v107, v10, v11
    v_mfma_f32_32x32x16_bf16 v[124:139], a[168:171], v[100:103], v[124:139]
    v_accvgpr_read_b32 v4, a64
    v_accvgpr_read_b32 v5, a65
    v_cvt_pk_bf16_f32 v108, v4, v5
    v_accvgpr_read_b32 v6, a66
    v_accvgpr_read_b32 v7, a67
    v_cvt_pk_bf16_f32 v109, v6, v7
    v_accvgpr_read_b32 v8, a68
    v_accvgpr_read_b32 v9, a69
    v_cvt_pk_bf16_f32 v110, v8, v9
    v_accvgpr_read_b32 v10, a70
    v_accvgpr_read_b32 v11, a71
    v_cvt_pk_bf16_f32 v111, v10, v11
    v_mfma_f32_32x32x16_bf16 v[124:139], a[172:175], v[104:107], v[124:139]
    v_accvgpr_read_b32 v4, a72
    v_accvgpr_read_b32 v5, a73
    v_cvt_pk_bf16_f32 v112, v4, v5
    v_accvgpr_read_b32 v6, a74
    v_accvgpr_read_b32 v7, a75
    v_cvt_pk_bf16_f32 v113, v6, v7
    v_accvgpr_read_b32 v8, a76
    v_accvgpr_read_b32 v9, a77
    v_cvt_pk_bf16_f32 v114, v8, v9
    v_accvgpr_read_b32 v10, a78
    v_accvgpr_read_b32 v11, a79
    v_cvt_pk_bf16_f32 v115, v10, v11
    v_mfma_f32_32x32x16_bf16 v[124:139], a[176:179], v[108:111], v[124:139]
    v_accvgpr_read_b32 v4, a96
    v_accvgpr_read_b32 v5, a97
    v_cvt_pk_bf16_f32 v116, v4, v5
    v_accvgpr_read_b32 v6, a98
    v_accvgpr_read_b32 v7, a99
    v_cvt_pk_bf16_f32 v117, v6, v7
    v_accvgpr_read_b32 v8, a100
    v_accvgpr_read_b32 v9, a101
    v_cvt_pk_bf16_f32 v118, v8, v9
    v_accvgpr_read_b32 v10, a102
    v_accvgpr_read_b32 v11, a103
    v_cvt_pk_bf16_f32 v119, v10, v11
    s_waitcnt lgkmcnt(15)
    v_mfma_f32_32x32x16_bf16 v[124:139], a[180:183], v[112:115], v[124:139]
    v_accvgpr_read_b32 v4, a104
    v_accvgpr_read_b32 v5, a105
    v_cvt_pk_bf16_f32 v120, v4, v5
    v_accvgpr_read_b32 v6, a106
    v_accvgpr_read_b32 v7, a107
    v_cvt_pk_bf16_f32 v121, v6, v7
    v_accvgpr_read_b32 v8, a108
    v_accvgpr_read_b32 v9, a109
    v_cvt_pk_bf16_f32 v122, v8, v9
    v_accvgpr_read_b32 v10, a110
    v_accvgpr_read_b32 v11, a111
    v_cvt_pk_bf16_f32 v123, v10, v11
    v_mfma_f32_32x32x16_bf16 v[124:139], a[184:187], v[116:119], v[124:139]
    v_accvgpr_read_b32 v4, a16
    v_accvgpr_read_b32 v5, a17
    v_cvt_pk_bf16_f32 v60, v4, v5
    v_accvgpr_read_b32 v6, a18
    v_accvgpr_read_b32 v7, a19
    v_cvt_pk_bf16_f32 v61, v6, v7
    v_accvgpr_read_b32 v8, a20
    v_accvgpr_read_b32 v9, a21
    v_cvt_pk_bf16_f32 v62, v8, v9
    v_accvgpr_read_b32 v10, a22
    v_accvgpr_read_b32 v11, a23
    v_cvt_pk_bf16_f32 v63, v10, v11
    v_mfma_f32_32x32x16_bf16 v[124:139], a[188:191], v[120:123], v[124:139]
    v_accvgpr_read_b32 v4, a24
    v_accvgpr_read_b32 v5, a25
    v_cvt_pk_bf16_f32 v64, v4, v5
    v_accvgpr_read_b32 v6, a26
    v_accvgpr_read_b32 v7, a27
    v_cvt_pk_bf16_f32 v65, v6, v7
    v_accvgpr_read_b32 v8, a28
    v_accvgpr_read_b32 v9, a29
    v_cvt_pk_bf16_f32 v66, v8, v9
    v_accvgpr_read_b32 v10, a30
    v_accvgpr_read_b32 v11, a31
    v_cvt_pk_bf16_f32 v67, v10, v11
    v_accvgpr_read_b32 v4, a48
    v_accvgpr_read_b32 v5, a49
    v_cvt_pk_bf16_f32 v68, v4, v5
    v_accvgpr_read_b32 v6, a50
    v_accvgpr_read_b32 v7, a51
    v_cvt_pk_bf16_f32 v69, v6, v7
    v_accvgpr_read_b32 v8, a52
    v_accvgpr_read_b32 v9, a53
    v_cvt_pk_bf16_f32 v70, v8, v9
    v_accvgpr_read_b32 v10, a54
    v_accvgpr_read_b32 v11, a55
    v_cvt_pk_bf16_f32 v71, v10, v11
    v_accvgpr_read_b32 v4, a56
    v_accvgpr_read_b32 v5, a57
    v_cvt_pk_bf16_f32 v72, v4, v5
    v_accvgpr_read_b32 v6, a58
    v_accvgpr_read_b32 v7, a59
    v_cvt_pk_bf16_f32 v73, v6, v7
    v_accvgpr_read_b32 v8, a60
    v_accvgpr_read_b32 v9, a61
    v_cvt_pk_bf16_f32 v74, v8, v9
    v_accvgpr_read_b32 v10, a62
    v_accvgpr_read_b32 v11, a63
    v_cvt_pk_bf16_f32 v75, v10, v11
    v_accvgpr_read_b32 v4, a80
    v_accvgpr_read_b32 v5, a81
    v_cvt_pk_bf16_f32 v76, v4, v5
    v_accvgpr_read_b32 v6, a82
    v_accvgpr_read_b32 v7, a83
    v_cvt_pk_bf16_f32 v77, v6, v7
    v_accvgpr_read_b32 v8, a84
    v_accvgpr_read_b32 v9, a85
    v_cvt_pk_bf16_f32 v78, v8, v9
    v_accvgpr_read_b32 v10, a86
    v_accvgpr_read_b32 v11, a87
    v_cvt_pk_bf16_f32 v79, v10, v11
    v_accvgpr_read_b32 v4, a88
    v_accvgpr_read_b32 v5, a89
    v_cvt_pk_bf16_f32 v80, v4, v5
    v_accvgpr_read_b32 v6, a90
    v_accvgpr_read_b32 v7, a91
    v_cvt_pk_bf16_f32 v81, v6, v7
    v_accvgpr_read_b32 v8, a92
    v_accvgpr_read_b32 v9, a93
    v_cvt_pk_bf16_f32 v82, v8, v9
    v_accvgpr_read_b32 v10, a94
    v_accvgpr_read_b32 v11, a95
    v_cvt_pk_bf16_f32 v83, v10, v11
    v_accvgpr_read_b32 v4, a112
    v_accvgpr_read_b32 v5, a113
    v_cvt_pk_bf16_f32 v84, v4, v5
    v_accvgpr_read_b32 v6, a114
    v_accvgpr_read_b32 v7, a115
    v_cvt_pk_bf16_f32 v85, v6, v7
    v_accvgpr_read_b32 v8, a116
    v_accvgpr_read_b32 v9, a117
    v_cvt_pk_bf16_f32 v86, v8, v9
    v_accvgpr_read_b32 v10, a118
    v_accvgpr_read_b32 v11, a119
    v_cvt_pk_bf16_f32 v87, v10, v11
    v_accvgpr_read_b32 v4, a120
    v_accvgpr_read_b32 v5, a121
    v_cvt_pk_bf16_f32 v88, v4, v5
    v_accvgpr_read_b32 v6, a122
    v_accvgpr_read_b32 v7, a123
    v_cvt_pk_bf16_f32 v89, v6, v7
    v_accvgpr_read_b32 v8, a124
    v_accvgpr_read_b32 v9, a125
    v_cvt_pk_bf16_f32 v90, v8, v9
    v_accvgpr_read_b32 v10, a126
    v_accvgpr_read_b32 v11, a127
    v_cvt_pk_bf16_f32 v91, v10, v11
LA_att:
    v_mfma_f32_32x32x16_bf16 v[140:155], a[160:163], v[60:63], 0
    v_max3_f32 v4, v224, v124, v125
    v_max3_f32 v4, v4, v126, v127
    v_max3_f32 v4, v4, v128, v129
    v_max3_f32 v4, v4, v130, v131
    v_max3_f32 v4, v4, v132, v133
    v_max3_f32 v4, v4, v134, v135
    v_mfma_f32_32x32x16_bf16 v[140:155], a[164:167], v[64:67], v[140:155]
    ds_read_b128 a[128:131], v40 offset:40960
    v_max3_f32 v4, v4, v136, v137
    v_max3_f32 v4, v4, v138, v139
    v_mov_b32 v5, v4
    v_mov_b32 v56, 0
    v_mov_b32 v57, 0
    v_permlane32_swap_b32 v4, v5
    v_mfma_f32_32x32x16_bf16 v[140:155], a[168:171], v[68:71], v[140:155]
    ds_read_b128 a[132:135], v41 offset:40960
    v_max_f32 v4, v4, v5
    v_sub_f32 v124, v124, v4
    v_sub_f32 v125, v125, v4
    v_sub_f32 v126, v126, v4
    v_sub_f32 v127, v127, v4
    v_sub_f32 v128, v128, v4
    v_mfma_f32_32x32x16_bf16 v[140:155], a[172:175], v[72:75], v[140:155]
    ds_read_b128 a[136:139], v42 offset:40960
    v_min_u32 v252, 16, v1
    v_sub_f32 v129, v129, v4
    v_sub_f32 v130, v130, v4
    v_sub_f32 v131, v131, v4
    v_sub_f32 v132, v132, v4
    v_sub_f32 v133, v133, v4
    v_sub_f32 v134, v134, v4
    v_mfma_f32_32x32x16_bf16 v[140:155], a[176:179], v[76:79], v[140:155]
    ds_read_b128 a[140:143], v43 offset:40960
    v_sub_f32 v135, v135, v4
    v_sub_f32 v136, v136, v4
    v_sub_f32 v137, v137, v4
    v_sub_f32 v138, v138, v4
    v_sub_f32 v139, v139, v4
    v_sub_f32 v172, 0, v4
    s_add_u32 m0, s49, 98304
    s_add_u32 s62, s50, 32768
    v_mfma_f32_32x32x16_bf16 v[140:155], a[180:183], v[80:83], v[140:155]
    ds_read_b128 a[144:147], v44 offset:40960
    buffer_load_dwordx4 v32, s[16:19], s62 offen offset:0 lds
    v_lshlrev_b32 v252, 7, v252
    v_sub_f32 v173, 0, v4
    v_sub_f32 v174, 0, v4
    v_sub_f32 v175, 0, v4
    v_sub_f32 v176, 0, v4
    v_sub_f32 v177, 0, v4
    v_sub_f32 v178, 0, v4
    v_mfma_f32_32x32x16_bf16 v[140:155], a[184:187], v[84:87], v[140:155]
    ds_read_b128 a[148:151], v45 offset:40960
    v_sub_f32 v179, 0, v4
    v_sub_f32 v180, 0, v4
    v_sub_f32 v181, 0, v4
    v_sub_f32 v182, 0, v4
    v_sub_f32 v183, 0, v4
    v_sub_f32 v184, 0, v4
    v_mfma_f32_32x32x16_bf16 v[140:155], a[188:191], v[88:91], v[140:155]
    ds_read_b128 a[152:155], v46 offset:40960
    v_sub_f32 v185, 0, v4
    v_sub_f32 v186, 0, v4
    v_sub_f32 v187, 0, v4
    ds_read_b128 a[156:159], v47 offset:40960
    v_exp_f32 v124, v124
    v_exp_f32 v125, v125
    v_add_f32 v56, v56, v124
    ds_read_b64_tr_b16 a[224:225], v12 offset:57344
    buffer_load_dwordx4 v33, s[16:19], s62 offen offset:1024 lds
    v_exp_f32 v126, v126
    v_add_f32 v57, v57, v125
    v_cvt_pk_bf16_f32 v156, v124, v125
    v_exp_f32 v127, v127
    v_add_f32 v56, v56, v126
    ds_read_b64_tr_b16 a[226:227], v13 offset:57344
    v_exp_f32 v128, v128
    v_add_f32 v57, v57, v127
    v_cvt_pk_bf16_f32 v157, v126, v127
    v_exp_f32 v129, v129
    v_add_f32 v56, v56, v128
    ds_read_b64_tr_b16 a[228:229], v14 offset:57344
    v_exp_f32 v130, v130
    v_add_f32 v57, v57, v129
    v_cvt_pk_bf16_f32 v158, v128, v129
    v_exp_f32 v131, v131
    v_add_f32 v56, v56, v130
    ds_read_b64_tr_b16 a[230:231], v15 offset:57344
    v_exp_f32 v132, v132
    v_add_f32 v57, v57, v131
    v_cvt_pk_bf16_f32 v159, v130, v131
    v_exp_f32 v133, v133
    v_add_f32 v56, v56, v132
    buffer_load_dwordx4 v34, s[16:19], s62 offen offset:2048 lds
    v_exp_f32 v134, v134
    v_add_f32 v57, v57, v133
    v_cvt_pk_bf16_f32 v160, v132, v133
    v_exp_f32 v135, v135
    v_add_f32 v56, v56, v134
    v_exp_f32 v136, v136
    v_add_f32 v57, v57, v135
    v_cvt_pk_bf16_f32 v161, v134, v135
    v_exp_f32 v137, v137
    v_add_f32 v56, v56, v136
    buffer_load_dwordx4 v35, s[16:19], s62 offen offset:3072 lds
    v_exp_f32 v138, v138
    v_add_f32 v57, v57, v137
    v_cvt_pk_bf16_f32 v162, v136, v137
    v_exp_f32 v139, v139
    v_add_f32 v56, v56, v138
    v_add_f32 v57, v57, v139
    v_cvt_pk_bf16_f32 v163, v138, v139
    s_waitcnt lgkmcnt(4)
    v_mfma_f32_32x32x16_bf16 v[124:139], a[128:131], v[92:95], v[172:187]
    ds_read_b64_tr_b16 a[232:233], v16 offset:57344
    v_max3_f32 v6, v225, v140, v141
    v_max3_f32 v6, v6, v142, v143
    v_max3_f32 v6, v6, v144, v145
    v_max3_f32 v6, v6, v146, v147
    v_max3_f32 v6, v6, v148, v149
    v_max3_f32 v6, v6, v150, v151
    v_mfma_f32_32x32x16_bf16 v[124:139], a[132:135], v[96:99], v[124:139]
    ds_read_b64_tr_b16 a[234:235], v17 offset:57344
    v_max3_f32 v6, v6, v152, v153
    v_max3_f32 v6, v6, v154, v155
    v_mov_b32 v7, v6
    v_mov_b32 v58, 0
    v_mov_b32 v59, 0
    v_permlane32_swap_b32 v6, v7
    s_mul_i32 s92, s63, 2176
    v_mfma_f32_32x32x16_bf16 v[124:139], a[136:139], v[100:103], v[124:139]
    ds_read_b64_tr_b16 a[236:237], v18 offset:57344
    v_max_f32 v6, v6, v7
    v_sub_f32 v140, v140, v6
    v_sub_f32 v141, v141, v6
    v_sub_f32 v142, v142, v6
    v_sub_f32 v143, v143, v6
    v_sub_f32 v144, v144, v6
    v_mfma_f32_32x32x16_bf16 v[124:139], a[140:143], v[104:107], v[124:139]
    ds_read_b64_tr_b16 a[238:239], v19 offset:57344
    v_sub_f32 v145, v145, v6
    v_sub_f32 v146, v146, v6
    v_sub_f32 v147, v147, v6
    v_sub_f32 v148, v148, v6
    v_sub_f32 v149, v149, v6
    v_sub_f32 v150, v150, v6
    v_mfma_f32_32x32x16_bf16 v[124:139], a[144:147], v[108:111], v[124:139]
    ds_read_b64_tr_b16 a[240:241], v12 offset:61440
    v_sub_f32 v151, v151, v6
    v_sub_f32 v152, v152, v6
    v_sub_f32 v153, v153, v6
    v_sub_f32 v154, v154, v6
    v_sub_f32 v155, v155, v6
    v_sub_f32 v188, 0, v6
    s_add_u32 m0, s49, 114688
    s_add_u32 s62, s50, 32768
    v_mfma_f32_32x32x16_bf16 v[124:139], a[148:151], v[112:115], v[124:139]
    ds_read_b64_tr_b16 a[242:243], v13 offset:61440
    buffer_load_dwordx4 v32, s[20:23], s62 offen offset:0 lds
    v_sub_f32 v189, 0, v6
    v_sub_f32 v190, 0, v6
    v_sub_f32 v191, 0, v6
    v_sub_f32 v192, 0, v6
    v_sub_f32 v193, 0, v6
    v_sub_f32 v194, 0, v6
    v_mfma_f32_32x32x16_bf16 v[124:139], a[152:155], v[116:119], v[124:139]
    ds_read_b64_tr_b16 a[244:245], v14 offset:61440
    v_sub_f32 v195, 0, v6
    v_sub_f32 v196, 0, v6
    v_sub_f32 v197, 0, v6
    v_sub_f32 v198, 0, v6
    v_sub_f32 v199, 0, v6
    v_sub_f32 v200, 0, v6
    v_mfma_f32_32x32x16_bf16 v[124:139], a[156:159], v[120:123], v[124:139]
    ds_read_b64_tr_b16 a[246:247], v15 offset:61440
    v_sub_f32 v201, 0, v6
    v_sub_f32 v202, 0, v6
    v_sub_f32 v203, 0, v6
    v_mfma_f32_32x32x16_bf16 a[0:15], a[192:195], v[156:159], 0
    ds_read_b64_tr_b16 a[248:249], v16 offset:61440
    v_exp_f32 v140, v140
    v_exp_f32 v141, v141
    v_add_f32 v58, v58, v140
    v_mfma_f32_32x32x16_bf16 a[32:47], a[196:199], v[156:159], 0
    ds_read_b64_tr_b16 a[250:251], v17 offset:61440
    buffer_load_dwordx4 v33, s[20:23], s62 offen offset:1024 lds
    v_exp_f32 v142, v142
    v_add_f32 v59, v59, v141
    v_cvt_pk_bf16_f32 v164, v140, v141
    v_exp_f32 v143, v143
    v_add_f32 v58, v58, v142
    v_mfma_f32_32x32x16_bf16 a[64:79], a[200:203], v[156:159], 0
    ds_read_b64_tr_b16 a[252:253], v18 offset:61440
    v_exp_f32 v144, v144
    v_add_f32 v59, v59, v143
    v_cvt_pk_bf16_f32 v165, v142, v143
    v_exp_f32 v145, v145
    v_add_f32 v58, v58, v144
    v_mfma_f32_32x32x16_bf16 a[96:111], a[204:207], v[156:159], 0
    ds_read_b64_tr_b16 a[254:255], v19 offset:61440
    v_exp_f32 v146, v146
    v_add_f32 v59, v59, v145
    v_cvt_pk_bf16_f32 v166, v144, v145
    v_exp_f32 v147, v147
    v_add_f32 v58, v58, v146
    v_mfma_f32_32x32x16_bf16 a[0:15], a[208:211], v[160:163], a[0:15]
    buffer_load_dwordx4 v34, s[20:23], s62 offen offset:2048 lds
    v_exp_f32 v148, v148
    v_add_f32 v59, v59, v147
    v_cvt_pk_bf16_f32 v167, v146, v147
    v_exp_f32 v149, v149
    v_add_f32 v58, v58, v148
    v_mfma_f32_32x32x16_bf16 a[32:47], a[212:215], v[160:163], a[32:47]
    v_exp_f32 v150, v150
    v_add_f32 v59, v59, v149
    v_cvt_pk_bf16_f32 v168, v148, v149
    v_exp_f32 v151, v151
    v_add_f32 v58, v58, v150
    v_mfma_f32_32x32x16_bf16 a[64:79], a[216:219], v[160:163], a[64:79]
    buffer_load_dwordx4 v35, s[20:23], s62 offen offset:3072 lds
    v_exp_f32 v152, v152
    v_add_f32 v59, v59, v151
    v_cvt_pk_bf16_f32 v169, v150, v151
    v_exp_f32 v153, v153
    v_add_f32 v58, v58, v152
    v_mfma_f32_32x32x16_bf16 a[96:111], a[220:223], v[160:163], a[96:111]
    buffer_load_dword v251, v252, s[28:31], s92 offen
    v_exp_f32 v154, v154
    v_add_f32 v59, v59, v153
    v_cvt_pk_bf16_f32 v170, v152, v153
    v_exp_f32 v155, v155
    v_add_f32 v58, v58, v154
    v_add_f32 v59, v59, v155
    v_cvt_pk_bf16_f32 v171, v154, v155
    s_waitcnt vmcnt(9) lgkmcnt(0)
    v_mfma_f32_32x32x16_bf16 v[140:155], a[128:131], v[60:63], v[188:203]
    s_barrier
    v_mfma_f32_32x32x16_bf16 v[140:155], a[132:135], v[64:67], v[140:155]
    ds_read_b128 a[160:163], v48 offset:0
    v_exp_f32 v124, v124
    v_exp_f32 v125, v125
    v_add_f32 v56, v56, v124
    v_mfma_f32_32x32x16_bf16 v[140:155], a[136:139], v[68:71], v[140:155]
    ds_read_b128 a[164:167], v49 offset:0
    v_exp_f32 v126, v126
    v_add_f32 v57, v57, v125
    v_cvt_pk_bf16_f32 v156, v124, v125
    v_mfma_f32_32x32x16_bf16 v[140:155], a[140:143], v[72:75], v[140:155]
    ds_read_b128 a[168:171], v50 offset:0
    v_lshlrev_b32 v223, 4, v0
    v_exp_f32 v127, v127
    v_add_f32 v56, v56, v126
    v_mfma_f32_32x32x16_bf16 v[140:155], a[144:147], v[76:79], v[140:155]
    ds_read_b128 a[172:175], v51 offset:0
    v_exp_f32 v128, v128
    v_add_f32 v57, v57, v127
    v_cvt_pk_bf16_f32 v157, v126, v127
    s_add_u32 m0, s49, 0
    s_add_u32 s62, s50, 49152
    v_mfma_f32_32x32x16_bf16 v[140:155], a[148:151], v[80:83], v[140:155]
    ds_read_b128 a[176:179], v52 offset:0
    buffer_load_dwordx4 v32, s[16:19], s62 offen offset:0 lds
    v_exp_f32 v129, v129
    v_add_f32 v56, v56, v128
    v_mfma_f32_32x32x16_bf16 v[140:155], a[152:155], v[84:87], v[140:155]
    ds_read_b128 a[180:183], v53 offset:0
    v_exp_f32 v130, v130
    v_add_f32 v57, v57, v129
    v_cvt_pk_bf16_f32 v158, v128, v129
    v_mfma_f32_32x32x16_bf16 v[140:155], a[156:159], v[88:91], v[140:155]
    ds_read_b128 a[184:187], v54 offset:0
    v_exp_f32 v131, v131
    v_add_f32 v56, v56, v130
    v_mfma_f32_32x32x16_bf16 a[16:31], a[192:195], v[164:167], 0
    ds_read_b128 a[188:191], v55 offset:0
    v_exp_f32 v132, v132
    v_add_f32 v57, v57, v131
    v_cvt_pk_bf16_f32 v159, v130, v131
    v_mfma_f32_32x32x16_bf16 a[48:63], a[196:199], v[164:167], 0
    ds_read_b64_tr_b16 a[192:193], v20 offset:16384
    buffer_load_dwordx4 v33, s[16:19], s62 offen offset:1024 lds
    v_exp_f32 v133, v133
    v_add_f32 v56, v56, v132
    v_mfma_f32_32x32x16_bf16 a[80:95], a[200:203], v[164:167], 0
    ds_read_b64_tr_b16 a[194:195], v21 offset:16384
    v_exp_f32 v134, v134
    v_add_f32 v57, v57, v133
    v_cvt_pk_bf16_f32 v160, v132, v133
    v_mfma_f32_32x32x16_bf16 a[112:127], a[204:207], v[164:167], 0
    ds_read_b64_tr_b16 a[196:197], v22 offset:16384
    v_exp_f32 v135, v135
    v_add_f32 v56, v56, v134
    v_mfma_f32_32x32x16_bf16 a[16:31], a[208:211], v[168:171], a[16:31]
    ds_read_b64_tr_b16 a[198:199], v23 offset:16384
    v_exp_f32 v136, v136
    v_add_f32 v57, v57, v135
    v_cvt_pk_bf16_f32 v161, v134, v135
    v_mfma_f32_32x32x16_bf16 a[48:63], a[212:215], v[168:171], a[48:63]
    buffer_load_dwordx4 v34, s[16:19], s62 offen offset:2048 lds
    v_exp_f32 v137, v137
    v_add_f32 v56, v56, v136
    v_mfma_f32_32x32x16_bf16 a[80:95], a[216:219], v[168:171], a[80:95]
    v_exp_f32 v138, v138
    v_add_f32 v57, v57, v137
    v_cvt_pk_bf16_f32 v162, v136, v137
    v_mfma_f32_32x32x16_bf16 a[112:127], a[220:223], v[168:171], a[112:127]
    buffer_load_dwordx4 v35, s[16:19], s62 offen offset:3072 lds
    v_exp_f32 v139, v139
    v_add_f32 v56, v56, v138
    v_add_f32 v57, v57, v139
    v_cvt_pk_bf16_f32 v163, v138, v139
    s_waitcnt lgkmcnt(4)
    v_mfma_f32_32x32x16_bf16 v[124:139], a[160:163], v[92:95], v[172:187]
    ds_read_b64_tr_b16 a[200:201], v24 offset:16384
    v_exp_f32 v140, v140
    v_mfma_f32_32x32x16_bf16 v[124:139], a[164:167], v[96:99], v[124:139]
    ds_read_b64_tr_b16 a[202:203], v25 offset:16384
    v_exp_f32 v141, v141
    v_add_f32 v58, v58, v140
    v_mfma_f32_32x32x16_bf16 v[124:139], a[168:171], v[100:103], v[124:139]
    ds_read_b64_tr_b16 a[204:205], v26 offset:16384
    v_exp_f32 v142, v142
    v_add_f32 v59, v59, v141
    v_cvt_pk_bf16_f32 v164, v140, v141
    v_mfma_f32_32x32x16_bf16 v[124:139], a[172:175], v[104:107], v[124:139]
    ds_read_b64_tr_b16 a[206:207], v27 offset:16384
    v_exp_f32 v143, v143
    v_add_f32 v58, v58, v142
    v_mfma_f32_32x32x16_bf16 v[124:139], a[176:179], v[108:111], v[124:139]
    ds_read_b64_tr_b16 a[208:209], v20 offset:20480
    v_exp_f32 v144, v144
    v_add_f32 v59, v59, v143
    v_cvt_pk_bf16_f32 v165, v142, v143
    s_mov_b32 s68, 70656
    v_mfma_f32_32x32x16_bf16 v[124:139], a[180:183], v[112:115], v[124:139]
    ds_read_b64_tr_b16 a[210:211], v21 offset:20480
    buffer_load_dwordx4 v[204:207], v223, s[8:11], s68 offen sc1
    v_exp_f32 v145, v145
    v_add_f32 v58, v58, v144
    v_mfma_f32_32x32x16_bf16 v[124:139], a[184:187], v[116:119], v[124:139]
    ds_read_b64_tr_b16 a[212:213], v22 offset:20480
    v_exp_f32 v146, v146
    v_add_f32 v59, v59, v145
    v_cvt_pk_bf16_f32 v166, v144, v145
    v_mfma_f32_32x32x16_bf16 v[124:139], a[188:191], v[120:123], v[124:139]
    ds_read_b64_tr_b16 a[214:215], v23 offset:20480
    v_exp_f32 v147, v147
    v_add_f32 v58, v58, v146
    v_mfma_f32_32x32x16_bf16 a[0:15], a[224:227], v[156:159], a[0:15]
    ds_read_b64_tr_b16 a[216:217], v24 offset:20480
    v_exp_f32 v148, v148
    v_add_f32 v59, v59, v147
    v_cvt_pk_bf16_f32 v167, v146, v147
    s_mov_b32 s69, 86016
    v_mfma_f32_32x32x16_bf16 a[32:47], a[228:231], v[156:159], a[32:47]
    ds_read_b64_tr_b16 a[218:219], v25 offset:20480
    buffer_load_dwordx4 v[208:211], v223, s[8:11], s69 offen sc1
    v_exp_f32 v149, v149
    v_add_f32 v58, v58, v148
    v_mfma_f32_32x32x16_bf16 a[64:79], a[232:235], v[156:159], a[64:79]
    ds_read_b64_tr_b16 a[220:221], v26 offset:20480
    v_exp_f32 v150, v150
    v_add_f32 v59, v59, v149
    v_cvt_pk_bf16_f32 v168, v148, v149
    v_mfma_f32_32x32x16_bf16 a[96:111], a[236:239], v[156:159], a[96:111]
    ds_read_b64_tr_b16 a[222:223], v27 offset:20480
    v_exp_f32 v151, v151
    v_add_f32 v58, v58, v150
    s_mov_b32 s70, 101376
    v_mfma_f32_32x32x16_bf16 a[0:15], a[240:243], v[160:163], a[0:15]
    buffer_load_dwordx4 v[212:215], v223, s[8:11], s70 offen sc1
    v_exp_f32 v152, v152
    v_add_f32 v59, v59, v151
    v_cvt_pk_bf16_f32 v169, v150, v151
    v_mfma_f32_32x32x16_bf16 a[32:47], a[244:247], v[160:163], a[32:47]
    v_exp_f32 v153, v153
    v_add_f32 v58, v58, v152
    s_mov_b32 s71, 116736
    v_mfma_f32_32x32x16_bf16 a[64:79], a[248:251], v[160:163], a[64:79]
    buffer_load_dwordx4 v[216:219], v223, s[8:11], s71 offen sc1
    v_exp_f32 v154, v154
    v_add_f32 v59, v59, v153
    v_cvt_pk_bf16_f32 v170, v152, v153
    v_mfma_f32_32x32x16_bf16 a[96:111], a[252:255], v[160:163], a[96:111]
    buffer_load_dword v251, v252, s[32:35], s92 offen
    v_exp_f32 v155, v155
    v_add_f32 v58, v58, v154
    v_add_f32 v59, v59, v155
    v_cvt_pk_bf16_f32 v171, v154, v155
    v_mfma_f32_32x32x16_bf16 v[140:155], a[160:163], v[60:63], v[188:203]
    v_exp_f32 v124, v124
    v_mfma_f32_32x32x16_bf16 v[140:155], a[164:167], v[64:67], v[140:155]
    ds_read_b128 a[128:131], v48 offset:8192
    v_exp_f32 v125, v125
    v_add_f32 v56, v56, v124
    v_mfma_f32_32x32x16_bf16 v[140:155], a[168:171], v[68:71], v[140:155]
    ds_read_b128 a[132:135], v49 offset:8192
    v_exp_f32 v126, v126
    v_add_f32 v57, v57, v125
    v_cvt_pk_bf16_f32 v156, v124, v125
    v_mfma_f32_32x32x16_bf16 v[140:155], a[172:175], v[72:75], v[140:155]
    ds_read_b128 a[136:139], v50 offset:8192
    v_exp_f32 v127, v127
    v_add_f32 v56, v56, v126
    v_mfma_f32_32x32x16_bf16 v[140:155], a[176:179], v[76:79], v[140:155]
    ds_read_b128 a[140:143], v51 offset:8192
    v_exp_f32 v128, v128
    v_add_f32 v57, v57, v127
    v_cvt_pk_bf16_f32 v157, v126, v127
    v_mfma_f32_32x32x16_bf16 v[140:155], a[180:183], v[80:83], v[140:155]
    ds_read_b128 a[144:147], v52 offset:8192
    v_exp_f32 v129, v129
    v_add_f32 v56, v56, v128
    v_mfma_f32_32x32x16_bf16 v[140:155], a[184:187], v[84:87], v[140:155]
    ds_read_b128 a[148:151], v53 offset:8192
    v_exp_f32 v130, v130
    v_add_f32 v57, v57, v129
    v_cvt_pk_bf16_f32 v158, v128, v129
    v_mfma_f32_32x32x16_bf16 v[140:155], a[188:191], v[88:91], v[140:155]
    ds_read_b128 a[152:155], v54 offset:8192
    v_exp_f32 v131, v131
    v_add_f32 v56, v56, v130
    v_mfma_f32_32x32x16_bf16 a[16:31], a[224:227], v[164:167], a[16:31]
    ds_read_b128 a[156:159], v55 offset:8192
    v_exp_f32 v132, v132
    v_add_f32 v57, v57, v131
    v_cvt_pk_bf16_f32 v159, v130, v131
    v_mfma_f32_32x32x16_bf16 a[48:63], a[228:231], v[164:167], a[48:63]
    ds_read_b64_tr_b16 a[224:225], v20 offset:24576
    v_exp_f32 v133, v133
    v_add_f32 v56, v56, v132
    v_mfma_f32_32x32x16_bf16 a[80:95], a[232:235], v[164:167], a[80:95]
    ds_read_b64_tr_b16 a[226:227], v21 offset:24576
    v_exp_f32 v134, v134
    v_add_f32 v57, v57, v133
    v_cvt_pk_bf16_f32 v160, v132, v133
    v_mfma_f32_32x32x16_bf16 a[112:127], a[236:239], v[164:167], a[112:127]
    ds_read_b64_tr_b16 a[228:229], v22 offset:24576
    v_exp_f32 v135, v135
    v_add_f32 v56, v56, v134
    v_mfma_f32_32x32x16_bf16 a[16:31], a[240:243], v[168:171], a[16:31]
    ds_read_b64_tr_b16 a[230:231], v23 offset:24576
    v_exp_f32 v136, v136
    v_add_f32 v57, v57, v135
    v_cvt_pk_bf16_f32 v161, v134, v135
    s_add_u32 m0, s49, 16384
    s_add_u32 s62, s50, 49152
    v_mfma_f32_32x32x16_bf16 a[48:63], a[244:247], v[168:171], a[48:63]
    buffer_load_dwordx4 v32, s[20:23], s62 offen offset:0 lds
    v_exp_f32 v137, v137
    v_add_f32 v56, v56, v136
    v_mfma_f32_32x32x16_bf16 a[80:95], a[248:251], v[168:171], a[80:95]
    v_exp_f32 v138, v138
    v_add_f32 v57, v57, v137
    v_cvt_pk_bf16_f32 v162, v136, v137
    v_mfma_f32_32x32x16_bf16 a[112:127], a[252:255], v[168:171], a[112:127]
    buffer_load_dwordx4 v33, s[20:23], s62 offen offset:1024 lds
    v_exp_f32 v139, v139
    v_add_f32 v56, v56, v138
    v_add_f32 v57, v57, v139
    v_cvt_pk_bf16_f32 v163, v138, v139
    s_waitcnt lgkmcnt(4)
    v_mfma_f32_32x32x16_bf16 v[124:139], a[128:131], v[92:95], v[172:187]
    ds_read_b64_tr_b16 a[232:233], v24 offset:24576
    v_exp_f32 v140, v140
    v_mfma_f32_32x32x16_bf16 v[124:139], a[132:135], v[96:99], v[124:139]
    ds_read_b64_tr_b16 a[234:235], v25 offset:24576
    v_exp_f32 v141, v141
    v_add_f32 v58, v58, v140
    v_mfma_f32_32x32x16_bf16 v[124:139], a[136:139], v[100:103], v[124:139]
    ds_read_b64_tr_b16 a[236:237], v26 offset:24576
    v_exp_f32 v142, v142
    v_add_f32 v59, v59, v141
    v_cvt_pk_bf16_f32 v164, v140, v141
    v_mfma_f32_32x32x16_bf16 v[124:139], a[140:143], v[104:107], v[124:139]
    ds_read_b64_tr_b16 a[238:239], v27 offset:24576
    v_exp_f32 v143, v143
    v_add_f32 v58, v58, v142
    v_mfma_f32_32x32x16_bf16 v[124:139], a[144:147], v[108:111], v[124:139]
    ds_read_b64_tr_b16 a[240:241], v20 offset:28672
    v_exp_f32 v144, v144
    v_add_f32 v59, v59, v143
    v_cvt_pk_bf16_f32 v165, v142, v143
    v_mfma_f32_32x32x16_bf16 v[124:139], a[148:151], v[112:115], v[124:139]
    ds_read_b64_tr_b16 a[242:243], v21 offset:28672
    v_exp_f32 v145, v145
    v_add_f32 v58, v58, v144
    v_mfma_f32_32x32x16_bf16 v[124:139], a[152:155], v[116:119], v[124:139]
    ds_read_b64_tr_b16 a[244:245], v22 offset:28672
    v_exp_f32 v146, v146
    v_add_f32 v59, v59, v145
    v_cvt_pk_bf16_f32 v166, v144, v145
    v_mfma_f32_32x32x16_bf16 v[124:139], a[156:159], v[120:123], v[124:139]
    ds_read_b64_tr_b16 a[246:247], v23 offset:28672
    v_exp_f32 v147, v147
    v_add_f32 v58, v58, v146
    v_mfma_f32_32x32x16_bf16 a[0:15], a[192:195], v[156:159], a[0:15]
    ds_read_b64_tr_b16 a[248:249], v24 offset:28672
    v_exp_f32 v148, v148
    v_add_f32 v59, v59, v147
    v_cvt_pk_bf16_f32 v167, v146, v147
    v_mfma_f32_32x32x16_bf16 a[32:47], a[196:199], v[156:159], a[32:47]
    ds_read_b64_tr_b16 a[250:251], v25 offset:28672
    v_exp_f32 v149, v149
    v_add_f32 v58, v58, v148
    v_mfma_f32_32x32x16_bf16 a[64:79], a[200:203], v[156:159], a[64:79]
    ds_read_b64_tr_b16 a[252:253], v26 offset:28672
    v_exp_f32 v150, v150
    v_add_f32 v59, v59, v149
    v_cvt_pk_bf16_f32 v168, v148, v149
    v_mfma_f32_32x32x16_bf16 a[96:111], a[204:207], v[156:159], a[96:111]
    ds_read_b64_tr_b16 a[254:255], v27 offset:28672
    v_exp_f32 v151, v151
    v_add_f32 v58, v58, v150
    v_mfma_f32_32x32x16_bf16 a[0:15], a[208:211], v[160:163], a[0:15]
    buffer_load_dwordx4 v34, s[20:23], s62 offen offset:2048 lds
    v_exp_f32 v152, v152
    v_add_f32 v59, v59, v151
    v_cvt_pk_bf16_f32 v169, v150, v151
    v_mfma_f32_32x32x16_bf16 a[32:47], a[212:215], v[160:163], a[32:47]
    v_exp_f32 v153, v153
    v_add_f32 v58, v58, v152
    v_mfma_f32_32x32x16_bf16 a[64:79], a[216:219], v[160:163], a[64:79]
    buffer_load_dwordx4 v35, s[20:23], s62 offen offset:3072 lds
    v_exp_f32 v154, v154
    v_add_f32 v59, v59, v153
    v_cvt_pk_bf16_f32 v170, v152, v153
    v_mfma_f32_32x32x16_bf16 a[96:111], a[220:223], v[160:163], a[96:111]
    buffer_load_dword v251, v252, s[36:39], s92 offen
    v_exp_f32 v155, v155
    v_add_f32 v58, v58, v154
    v_add_f32 v59, v59, v155
    v_cvt_pk_bf16_f32 v171, v154, v155
    s_waitcnt vmcnt(15) lgkmcnt(0)
    v_mfma_f32_32x32x16_bf16 v[140:155], a[128:131], v[60:63], v[188:203]
    s_barrier
    v_mfma_f32_32x32x16_bf16 v[140:155], a[132:135], v[64:67], v[140:155]
    ds_read_b128 a[160:163], v48 offset:32768
    v_exp_f32 v124, v124
    v_add_u32 v3, 147456, v223
    v_exp_f32 v125, v125
    v_add_f32 v56, v56, v124
    v_mfma_f32_32x32x16_bf16 v[140:155], a[136:139], v[68:71], v[140:155]
    ds_read_b128 a[164:167], v49 offset:32768
    v_exp_f32 v126, v126
    s_waitcnt vmcnt(8)
    v_add_f32 v204, v204, v208
    v_add_f32 v57, v57, v125
    v_cvt_pk_bf16_f32 v156, v124, v125
    v_mfma_f32_32x32x16_bf16 v[140:155], a[140:143], v[72:75], v[140:155]
    ds_read_b128 a[168:171], v50 offset:32768
    v_min_u32 v252, 19, v1
    s_waitcnt vmcnt(6)
    v_add_f32 v212, v212, v216
    v_add_f32 v205, v205, v209
    v_exp_f32 v127, v127
    v_add_f32 v56, v56, v126
    v_mfma_f32_32x32x16_bf16 v[140:155], a[144:147], v[76:79], v[140:155]
    ds_read_b128 a[172:175], v51 offset:32768
    v_exp_f32 v128, v128
    v_add_f32 v213, v213, v217
    v_add_f32 v57, v57, v127
    v_cvt_pk_bf16_f32 v157, v126, v127
    v_mfma_f32_32x32x16_bf16 v[140:155], a[148:151], v[80:83], v[140:155]
    ds_read_b128 a[176:179], v52 offset:32768
    v_lshlrev_b32 v252, 7, v252
    v_add_f32 v206, v206, v210
    v_add_f32 v214, v214, v218
    v_exp_f32 v129, v129
    v_add_f32 v56, v56, v128
    v_mfma_f32_32x32x16_bf16 v[140:155], a[152:155], v[84:87], v[140:155]
    ds_read_b128 a[180:183], v53 offset:32768
    v_exp_f32 v130, v130
    v_add_f32 v207, v207, v211
    v_add_f32 v57, v57, v129
    v_cvt_pk_bf16_f32 v158, v128, v129
    v_mfma_f32_32x32x16_bf16 v[140:155], a[156:159], v[88:91], v[140:155]
    ds_read_b128 a[184:187], v54 offset:32768
    v_exp_f32 v131, v131
    v_add_f32 v215, v215, v219
    v_add_f32 v204, v204, v212
    v_add_f32 v56, v56, v130
    v_mfma_f32_32x32x16_bf16 a[16:31], a[192:195], v[164:167], a[16:31]
    ds_read_b128 a[188:191], v55 offset:32768
    v_exp_f32 v132, v132
    v_add_f32 v205, v205, v213
    v_add_f32 v57, v57, v131
    v_cvt_pk_bf16_f32 v159, v130, v131
    v_mfma_f32_32x32x16_bf16 a[48:63], a[196:199], v[164:167], a[48:63]
    ds_read_b64_tr_b16 a[192:193], v20 offset:49152
    v_exp_f32 v133, v133
    v_add_f32 v206, v206, v214
    v_add_f32 v207, v207, v215
    v_add_f32 v56, v56, v132
    v_mfma_f32_32x32x16_bf16 a[80:95], a[200:203], v[164:167], a[80:95]
    ds_read_b64_tr_b16 a[194:195], v21 offset:49152
    v_exp_f32 v134, v134
    v_cvt_pk_bf16_f32 v204, v204, v204
    v_add_f32 v57, v57, v133
    v_cvt_pk_bf16_f32 v160, v132, v133
    v_mfma_f32_32x32x16_bf16 a[112:127], a[204:207], v[164:167], a[112:127]
    ds_read_b64_tr_b16 a[196:197], v22 offset:49152
    v_exp_f32 v135, v135
    v_lshlrev_b32 v204, 16, v204
    v_cvt_pk_bf16_f32 v205, v205, v205
    v_add_f32 v56, v56, v134
    v_mfma_f32_32x32x16_bf16 a[16:31], a[208:211], v[168:171], a[16:31]
    ds_read_b64_tr_b16 a[198:199], v23 offset:49152
    v_exp_f32 v136, v136
    v_lshlrev_b32 v205, 16, v205
    v_add_f32 v57, v57, v135
    v_cvt_pk_bf16_f32 v161, v134, v135
    s_add_u32 m0, s49, 32768
    s_add_u32 s62, s50, 65536
    v_mfma_f32_32x32x16_bf16 a[48:63], a[212:215], v[168:171], a[48:63]
    buffer_load_dwordx4 v32, s[16:19], s62 offen offset:0 lds
    v_exp_f32 v137, v137
    v_cvt_pk_bf16_f32 v206, v206, v206
    v_lshlrev_b32 v206, 16, v206
    v_add_f32 v56, v56, v136
    v_mfma_f32_32x32x16_bf16 a[80:95], a[216:219], v[168:171], a[80:95]
    v_exp_f32 v138, v138
    v_cvt_pk_bf16_f32 v207, v207, v207
    v_add_f32 v57, v57, v137
    v_cvt_pk_bf16_f32 v162, v136, v137
    v_mfma_f32_32x32x16_bf16 a[112:127], a[220:223], v[168:171], a[112:127]
    buffer_load_dwordx4 v33, s[16:19], s62 offen offset:1024 lds
    v_exp_f32 v139, v139
    v_lshlrev_b32 v207, 16, v207
    v_add_f32 v56, v56, v138
    v_add_f32 v57, v57, v139
    v_cvt_pk_bf16_f32 v163, v138, v139
    s_waitcnt lgkmcnt(4)
    v_mfma_f32_32x32x16_bf16 v[124:139], a[160:163], v[92:95], v[172:187]
    ds_read_b64_tr_b16 a[200:201], v24 offset:49152
    ds_write_b128 v3, v[204:207] offset:5120
    v_exp_f32 v140, v140
    v_mfma_f32_32x32x16_bf16 v[124:139], a[164:167], v[96:99], v[124:139]
    ds_read_b64_tr_b16 a[202:203], v25 offset:49152
    v_exp_f32 v141, v141
    v_add_f32 v58, v58, v140
    s_and_b32 s92, s4, 3
    v_mfma_f32_32x32x16_bf16 v[124:139], a[168:171], v[100:103], v[124:139]
    ds_read_b64_tr_b16 a[204:205], v26 offset:49152
    v_exp_f32 v142, v142
    v_add_f32 v59, v59, v141
    v_cvt_pk_bf16_f32 v164, v140, v141
    s_lshl_b32 s92, s92, 7
    v_mfma_f32_32x32x16_bf16 v[124:139], a[172:175], v[104:107], v[124:139]
    ds_read_b64_tr_b16 a[206:207], v27 offset:49152
    v_exp_f32 v143, v143
    v_add_f32 v58, v58, v142
    s_add_u32 s92, s92, s5
    v_mfma_f32_32x32x16_bf16 v[124:139], a[176:179], v[108:111], v[124:139]
    ds_read_b64_tr_b16 a[208:209], v20 offset:53248
    v_exp_f32 v144, v144
    v_add_f32 v59, v59, v143
    v_cvt_pk_bf16_f32 v165, v142, v143
    s_lshl_b32 s92, s92, 2
    v_mfma_f32_32x32x16_bf16 v[124:139], a[180:183], v[112:115], v[124:139]
    ds_read_b64_tr_b16 a[210:211], v21 offset:53248
    v_exp_f32 v145, v145
    v_add_f32 v58, v58, v144
    s_add_u32 s92, s92, s3
    v_mfma_f32_32x32x16_bf16 v[124:139], a[184:187], v[116:119], v[124:139]
    ds_read_b64_tr_b16 a[212:213], v22 offset:53248
    v_exp_f32 v146, v146
    v_add_f32 v59, v59, v145
    v_cvt_pk_bf16_f32 v166, v144, v145
    s_mul_i32 s92, s92, 2560
    v_mfma_f32_32x32x16_bf16 v[124:139], a[188:191], v[120:123], v[124:139]
    ds_read_b64_tr_b16 a[214:215], v23 offset:53248
    v_exp_f32 v147, v147
    v_add_f32 v58, v58, v146
    v_mfma_f32_32x32x16_bf16 a[0:15], a[224:227], v[156:159], a[0:15]
    ds_read_b64_tr_b16 a[216:217], v24 offset:53248
    v_exp_f32 v148, v148
    v_add_f32 v59, v59, v147
    v_cvt_pk_bf16_f32 v167, v146, v147
    v_mfma_f32_32x32x16_bf16 a[32:47], a[228:231], v[156:159], a[32:47]
    ds_read_b64_tr_b16 a[218:219], v25 offset:53248
    v_exp_f32 v149, v149
    v_add_f32 v58, v58, v148
    v_mfma_f32_32x32x16_bf16 a[64:79], a[232:235], v[156:159], a[64:79]
    ds_read_b64_tr_b16 a[220:221], v26 offset:53248
    v_exp_f32 v150, v150
    v_add_f32 v59, v59, v149
    v_cvt_pk_bf16_f32 v168, v148, v149
    v_mfma_f32_32x32x16_bf16 a[96:111], a[236:239], v[156:159], a[96:111]
    ds_read_b64_tr_b16 a[222:223], v27 offset:53248
    v_exp_f32 v151, v151
    v_add_f32 v58, v58, v150
    v_mfma_f32_32x32x16_bf16 a[0:15], a[240:243], v[160:163], a[0:15]
    buffer_load_dwordx4 v34, s[16:19], s62 offen offset:2048 lds
    v_exp_f32 v152, v152
    v_add_f32 v59, v59, v151
    v_cvt_pk_bf16_f32 v169, v150, v151
    v_mfma_f32_32x32x16_bf16 a[32:47], a[244:247], v[160:163], a[32:47]
    v_exp_f32 v153, v153
    v_add_f32 v58, v58, v152
    v_mfma_f32_32x32x16_bf16 a[64:79], a[248:251], v[160:163], a[64:79]
    buffer_load_dwordx4 v35, s[16:19], s62 offen offset:3072 lds
    v_exp_f32 v154, v154
    v_add_f32 v59, v59, v153
    v_cvt_pk_bf16_f32 v170, v152, v153
    v_mfma_f32_32x32x16_bf16 a[96:111], a[252:255], v[160:163], a[96:111]
    buffer_load_dword v251, v252, s[24:27], s92 offen
    v_exp_f32 v155, v155
    v_add_f32 v58, v58, v154
    v_add_f32 v59, v59, v155
    v_cvt_pk_bf16_f32 v171, v154, v155
    v_mfma_f32_32x32x16_bf16 v[140:155], a[160:163], v[60:63], v[188:203]
    v_exp_f32 v124, v124
    v_mfma_f32_32x32x16_bf16 v[140:155], a[164:167], v[64:67], v[140:155]
    ds_read_b128 a[128:131], v48 offset:40960
    v_exp_f32 v125, v125
    v_add_f32 v56, v56, v124
    v_mfma_f32_32x32x16_bf16 v[140:155], a[168:171], v[68:71], v[140:155]
    ds_read_b128 a[132:135], v49 offset:40960
    v_exp_f32 v126, v126
    v_add_f32 v57, v57, v125
    v_cvt_pk_bf16_f32 v156, v124, v125
    v_mfma_f32_32x32x16_bf16 v[140:155], a[172:175], v[72:75], v[140:155]
    ds_read_b128 a[136:139], v50 offset:40960
    v_lshlrev_b32 v223, 4, v0
    v_exp_f32 v127, v127
    v_add_f32 v56, v56, v126
    v_mfma_f32_32x32x16_bf16 v[140:155], a[176:179], v[76:79], v[140:155]
    ds_read_b128 a[140:143], v51 offset:40960
    v_exp_f32 v128, v128
    v_add_f32 v57, v57, v127
    v_cvt_pk_bf16_f32 v157, v126, v127
    s_add_u32 m0, s49, 49152
    s_add_u32 s62, s50, 65536
    v_mfma_f32_32x32x16_bf16 v[140:155], a[180:183], v[80:83], v[140:155]
    ds_read_b128 a[144:147], v52 offset:40960
    buffer_load_dwordx4 v32, s[20:23], s62 offen offset:0 lds
    v_exp_f32 v129, v129
    v_add_f32 v56, v56, v128
    v_mfma_f32_32x32x16_bf16 v[140:155], a[184:187], v[84:87], v[140:155]
    ds_read_b128 a[148:151], v53 offset:40960
    v_exp_f32 v130, v130
    v_add_f32 v57, v57, v129
    v_cvt_pk_bf16_f32 v158, v128, v129
    v_mfma_f32_32x32x16_bf16 v[140:155], a[188:191], v[88:91], v[140:155]
    ds_read_b128 a[152:155], v54 offset:40960
    v_exp_f32 v131, v131
    v_add_f32 v56, v56, v130
    v_mfma_f32_32x32x16_bf16 a[16:31], a[224:227], v[164:167], a[16:31]
    ds_read_b128 a[156:159], v55 offset:40960
    v_exp_f32 v132, v132
    v_add_f32 v57, v57, v131
    v_cvt_pk_bf16_f32 v159, v130, v131
    v_mfma_f32_32x32x16_bf16 a[48:63], a[228:231], v[164:167], a[48:63]
    ds_read_b64_tr_b16 a[224:225], v20 offset:57344
    buffer_load_dwordx4 v33, s[20:23], s62 offen offset:1024 lds
    v_exp_f32 v133, v133
    v_add_f32 v56, v56, v132
    v_mfma_f32_32x32x16_bf16 a[80:95], a[232:235], v[164:167], a[80:95]
    ds_read_b64_tr_b16 a[226:227], v21 offset:57344
    v_exp_f32 v134, v134
    v_add_f32 v57, v57, v133
    v_cvt_pk_bf16_f32 v160, v132, v133
    v_mfma_f32_32x32x16_bf16 a[112:127], a[236:239], v[164:167], a[112:127]
    ds_read_b64_tr_b16 a[228:229], v22 offset:57344
    v_exp_f32 v135, v135
    v_add_f32 v56, v56, v134
    v_mfma_f32_32x32x16_bf16 a[16:31], a[240:243], v[168:171], a[16:31]
    ds_read_b64_tr_b16 a[230:231], v23 offset:57344
    v_exp_f32 v136, v136
    v_add_f32 v57, v57, v135
    v_cvt_pk_bf16_f32 v161, v134, v135
    v_mfma_f32_32x32x16_bf16 a[48:63], a[244:247], v[168:171], a[48:63]
    buffer_load_dwordx4 v34, s[20:23], s62 offen offset:2048 lds
    v_exp_f32 v137, v137
    v_add_f32 v56, v56, v136
    v_mfma_f32_32x32x16_bf16 a[80:95], a[248:251], v[168:171], a[80:95]
    v_exp_f32 v138, v138
    v_add_f32 v57, v57, v137
    v_cvt_pk_bf16_f32 v162, v136, v137
    v_mfma_f32_32x32x16_bf16 a[112:127], a[252:255], v[168:171], a[112:127]
    buffer_load_dwordx4 v35, s[20:23], s62 offen offset:3072 lds
    v_exp_f32 v139, v139
    v_add_f32 v56, v56, v138
    v_add_f32 v57, v57, v139
    v_cvt_pk_bf16_f32 v163, v138, v139
    s_waitcnt lgkmcnt(4)
    v_mfma_f32_32x32x16_bf16 v[124:139], a[128:131], v[92:95], v[172:187]
    ds_read_b64_tr_b16 a[232:233], v24 offset:57344
    v_exp_f32 v140, v140
    v_mfma_f32_32x32x16_bf16 v[124:139], a[132:135], v[96:99], v[124:139]
    ds_read_b64_tr_b16 a[234:235], v25 offset:57344
    v_exp_f32 v141, v141
    v_add_f32 v58, v58, v140
    s_add_u32 s92, s92, 327680
    v_mfma_f32_32x32x16_bf16 v[124:139], a[136:139], v[100:103], v[124:139]
    ds_read_b64_tr_b16 a[236:237], v26 offset:57344
    v_exp_f32 v142, v142
    v_add_f32 v59, v59, v141
    v_cvt_pk_bf16_f32 v164, v140, v141
    v_mfma_f32_32x32x16_bf16 v[124:139], a[140:143], v[104:107], v[124:139]
    ds_read_b64_tr_b16 a[238:239], v27 offset:57344
    v_exp_f32 v143, v143
    v_add_f32 v58, v58, v142
    v_mfma_f32_32x32x16_bf16 v[124:139], a[144:147], v[108:111], v[124:139]
    ds_read_b64_tr_b16 a[240:241], v20 offset:61440
    v_exp_f32 v144, v144
    v_add_f32 v59, v59, v143
    v_cvt_pk_bf16_f32 v165, v142, v143
    s_mov_b32 s68, 74752
    v_mfma_f32_32x32x16_bf16 v[124:139], a[148:151], v[112:115], v[124:139]
    ds_read_b64_tr_b16 a[242:243], v21 offset:61440
    buffer_load_dwordx4 v[204:207], v223, s[8:11], s68 offen sc1
    v_exp_f32 v145, v145
    v_add_f32 v58, v58, v144
    v_mfma_f32_32x32x16_bf16 v[124:139], a[152:155], v[116:119], v[124:139]
    ds_read_b64_tr_b16 a[244:245], v22 offset:61440
    v_exp_f32 v146, v146
    v_add_f32 v59, v59, v145
    v_cvt_pk_bf16_f32 v166, v144, v145
    v_mfma_f32_32x32x16_bf16 v[124:139], a[156:159], v[120:123], v[124:139]
    ds_read_b64_tr_b16 a[246:247], v23 offset:61440
    v_exp_f32 v147, v147
    v_add_f32 v58, v58, v146
    v_mfma_f32_32x32x16_bf16 a[0:15], a[192:195], v[156:159], a[0:15]
    ds_read_b64_tr_b16 a[248:249], v24 offset:61440
    v_exp_f32 v148, v148
    v_add_f32 v59, v59, v147
    v_cvt_pk_bf16_f32 v167, v146, v147
    s_mov_b32 s69, 90112
    v_mfma_f32_32x32x16_bf16 a[32:47], a[196:199], v[156:159], a[32:47]
    ds_read_b64_tr_b16 a[250:251], v25 offset:61440
    buffer_load_dwordx4 v[208:211], v223, s[8:11], s69 offen sc1
    v_exp_f32 v149, v149
    v_add_f32 v58, v58, v148
    v_mfma_f32_32x32x16_bf16 a[64:79], a[200:203], v[156:159], a[64:79]
    ds_read_b64_tr_b16 a[252:253], v26 offset:61440
    v_exp_f32 v150, v150
    v_add_f32 v59, v59, v149
    v_cvt_pk_bf16_f32 v168, v148, v149
    v_mfma_f32_32x32x16_bf16 a[96:111], a[204:207], v[156:159], a[96:111]
    ds_read_b64_tr_b16 a[254:255], v27 offset:61440
    v_exp_f32 v151, v151
    v_add_f32 v58, v58, v150
    s_mov_b32 s70, 105472
    v_mfma_f32_32x32x16_bf16 a[0:15], a[208:211], v[160:163], a[0:15]
    buffer_load_dwordx4 v[212:215], v223, s[8:11], s70 offen sc1
    v_exp_f32 v152, v152
    v_add_f32 v59, v59, v151
    v_cvt_pk_bf16_f32 v169, v150, v151
    v_mfma_f32_32x32x16_bf16 a[32:47], a[212:215], v[160:163], a[32:47]
    v_exp_f32 v153, v153
    v_add_f32 v58, v58, v152
    s_mov_b32 s71, 120832
    v_mfma_f32_32x32x16_bf16 a[64:79], a[216:219], v[160:163], a[64:79]
    buffer_load_dwordx4 v[216:219], v223, s[8:11], s71 offen sc1
    v_exp_f32 v154, v154
    v_add_f32 v59, v59, v153
    v_cvt_pk_bf16_f32 v170, v152, v153
    v_mfma_f32_32x32x16_bf16 a[96:111], a[220:223], v[160:163], a[96:111]
    buffer_load_dword v251, v252, s[24:27], s92 offen
    v_exp_f32 v155, v155
    v_add_f32 v58, v58, v154
    v_add_f32 v59, v59, v155
    v_cvt_pk_bf16_f32 v171, v154, v155
    s_waitcnt vmcnt(15) lgkmcnt(0)
    v_mfma_f32_32x32x16_bf16 v[140:155], a[128:131], v[60:63], v[188:203]
    s_barrier
    v_mfma_f32_32x32x16_bf16 v[140:155], a[132:135], v[64:67], v[140:155]
    ds_read_b128 a[160:163], v40 offset:0
    v_exp_f32 v124, v124
    v_exp_f32 v125, v125
    v_add_f32 v56, v56, v124
    v_mfma_f32_32x32x16_bf16 v[140:155], a[136:139], v[68:71], v[140:155]
    ds_read_b128 a[164:167], v41 offset:0
    v_exp_f32 v126, v126
    v_add_f32 v57, v57, v125
    v_cvt_pk_bf16_f32 v156, v124, v125
    v_mfma_f32_32x32x16_bf16 v[140:155], a[140:143], v[72:75], v[140:155]
    ds_read_b128 a[168:171], v42 offset:0
    v_exp_f32 v127, v127
    v_add_f32 v56, v56, v126
    v_mfma_f32_32x32x16_bf16 v[140:155], a[144:147], v[76:79], v[140:155]
    ds_read_b128 a[172:175], v43 offset:0
    v_exp_f32 v128, v128
    v_add_f32 v57, v57, v127
    v_cvt_pk_bf16_f32 v157, v126, v127
    v_mfma_f32_32x32x16_bf16 v[140:155], a[148:151], v[80:83], v[140:155]
    ds_read_b128 a[176:179], v44 offset:0
    v_exp_f32 v129, v129
    v_add_f32 v56, v56, v128
    v_mfma_f32_32x32x16_bf16 v[140:155], a[152:155], v[84:87], v[140:155]
    ds_read_b128 a[180:183], v45 offset:0
    v_exp_f32 v130, v130
    v_add_f32 v57, v57, v129
    v_cvt_pk_bf16_f32 v158, v128, v129
    v_mfma_f32_32x32x16_bf16 v[140:155], a[156:159], v[88:91], v[140:155]
    ds_read_b128 a[184:187], v46 offset:0
    v_exp_f32 v131, v131
    v_add_f32 v56, v56, v130
    v_mfma_f32_32x32x16_bf16 a[16:31], a[192:195], v[164:167], a[16:31]
    ds_read_b128 a[188:191], v47 offset:0
    v_exp_f32 v132, v132
    v_add_f32 v57, v57, v131
    v_cvt_pk_bf16_f32 v159, v130, v131
    v_mfma_f32_32x32x16_bf16 a[48:63], a[196:199], v[164:167], a[48:63]
    ds_read_b64_tr_b16 a[192:193], v12 offset:16384
    v_exp_f32 v133, v133
    v_add_f32 v56, v56, v132
    v_mfma_f32_32x32x16_bf16 a[80:95], a[200:203], v[164:167], a[80:95]
    ds_read_b64_tr_b16 a[194:195], v13 offset:16384
    v_exp_f32 v134, v134
    v_add_f32 v57, v57, v133
    v_cvt_pk_bf16_f32 v160, v132, v133
    v_mfma_f32_32x32x16_bf16 a[112:127], a[204:207], v[164:167], a[112:127]
    ds_read_b64_tr_b16 a[196:197], v14 offset:16384
    v_exp_f32 v135, v135
    v_add_f32 v56, v56, v134
    v_mfma_f32_32x32x16_bf16 a[16:31], a[208:211], v[168:171], a[16:31]
    ds_read_b64_tr_b16 a[198:199], v15 offset:16384
    v_exp_f32 v136, v136
    v_add_f32 v57, v57, v135
    v_cvt_pk_bf16_f32 v161, v134, v135
    s_add_u32 m0, s49, 65536
    s_add_u32 s62, s50, 81920
    v_mfma_f32_32x32x16_bf16 a[48:63], a[212:215], v[168:171], a[48:63]
    buffer_load_dwordx4 v32, s[16:19], s62 offen offset:0 lds
    v_exp_f32 v137, v137
    v_add_f32 v56, v56, v136
    v_mfma_f32_32x32x16_bf16 a[80:95], a[216:219], v[168:171], a[80:95]
    v_exp_f32 v138, v138
    v_add_f32 v57, v57, v137
    v_cvt_pk_bf16_f32 v162, v136, v137
    v_mfma_f32_32x32x16_bf16 a[112:127], a[220:223], v[168:171], a[112:127]
    buffer_load_dwordx4 v33, s[16:19], s62 offen offset:1024 lds
    v_exp_f32 v139, v139
    v_add_f32 v56, v56, v138
    v_add_f32 v57, v57, v139
    v_cvt_pk_bf16_f32 v163, v138, v139
    s_waitcnt lgkmcnt(4)
    v_mfma_f32_32x32x16_bf16 v[124:139], a[160:163], v[92:95], v[172:187]
    ds_read_b64_tr_b16 a[200:201], v16 offset:16384
    v_exp_f32 v140, v140
    v_mfma_f32_32x32x16_bf16 v[124:139], a[164:167], v[96:99], v[124:139]
    ds_read_b64_tr_b16 a[202:203], v17 offset:16384
    v_exp_f32 v141, v141
    v_add_f32 v58, v58, v140
    s_add_u32 s92, s92, 327680
    v_mfma_f32_32x32x16_bf16 v[124:139], a[168:171], v[100:103], v[124:139]
    ds_read_b64_tr_b16 a[204:205], v18 offset:16384
    v_exp_f32 v142, v142
    v_add_f32 v59, v59, v141
    v_cvt_pk_bf16_f32 v164, v140, v141
    v_mfma_f32_32x32x16_bf16 v[124:139], a[172:175], v[104:107], v[124:139]
    ds_read_b64_tr_b16 a[206:207], v19 offset:16384
    v_exp_f32 v143, v143
    v_add_f32 v58, v58, v142
    v_mfma_f32_32x32x16_bf16 v[124:139], a[176:179], v[108:111], v[124:139]
    ds_read_b64_tr_b16 a[208:209], v12 offset:20480
    v_exp_f32 v144, v144
    v_add_f32 v59, v59, v143
    v_cvt_pk_bf16_f32 v165, v142, v143
    v_mfma_f32_32x32x16_bf16 v[124:139], a[180:183], v[112:115], v[124:139]
    ds_read_b64_tr_b16 a[210:211], v13 offset:20480
    v_exp_f32 v145, v145
    v_add_f32 v58, v58, v144
    v_mfma_f32_32x32x16_bf16 v[124:139], a[184:187], v[116:119], v[124:139]
    ds_read_b64_tr_b16 a[212:213], v14 offset:20480
    v_exp_f32 v146, v146
    v_add_f32 v59, v59, v145
    v_cvt_pk_bf16_f32 v166, v144, v145
    v_mfma_f32_32x32x16_bf16 v[124:139], a[188:191], v[120:123], v[124:139]
    ds_read_b64_tr_b16 a[214:215], v15 offset:20480
    v_exp_f32 v147, v147
    v_add_f32 v58, v58, v146
    v_mfma_f32_32x32x16_bf16 a[0:15], a[224:227], v[156:159], a[0:15]
    ds_read_b64_tr_b16 a[216:217], v16 offset:20480
    v_exp_f32 v148, v148
    v_add_f32 v59, v59, v147
    v_cvt_pk_bf16_f32 v167, v146, v147
    v_mfma_f32_32x32x16_bf16 a[32:47], a[228:231], v[156:159], a[32:47]
    ds_read_b64_tr_b16 a[218:219], v17 offset:20480
    v_exp_f32 v149, v149
    v_add_f32 v58, v58, v148
    v_mfma_f32_32x32x16_bf16 a[64:79], a[232:235], v[156:159], a[64:79]
    ds_read_b64_tr_b16 a[220:221], v18 offset:20480
    v_exp_f32 v150, v150
    v_add_f32 v59, v59, v149
    v_cvt_pk_bf16_f32 v168, v148, v149
    v_mfma_f32_32x32x16_bf16 a[96:111], a[236:239], v[156:159], a[96:111]
    ds_read_b64_tr_b16 a[222:223], v19 offset:20480
    v_exp_f32 v151, v151
    v_add_f32 v58, v58, v150
    v_mfma_f32_32x32x16_bf16 a[0:15], a[240:243], v[160:163], a[0:15]
    buffer_load_dwordx4 v34, s[16:19], s62 offen offset:2048 lds
    v_exp_f32 v152, v152
    v_add_f32 v59, v59, v151
    v_cvt_pk_bf16_f32 v169, v150, v151
    v_mfma_f32_32x32x16_bf16 a[32:47], a[244:247], v[160:163], a[32:47]
    v_exp_f32 v153, v153
    v_add_f32 v58, v58, v152
    v_mfma_f32_32x32x16_bf16 a[64:79], a[248:251], v[160:163], a[64:79]
    buffer_load_dwordx4 v35, s[16:19], s62 offen offset:3072 lds
    v_exp_f32 v154, v154
    v_add_f32 v59, v59, v153
    v_cvt_pk_bf16_f32 v170, v152, v153
    v_mfma_f32_32x32x16_bf16 a[96:111], a[252:255], v[160:163], a[96:111]
    buffer_load_dword v251, v252, s[24:27], s92 offen
    v_exp_f32 v155, v155
    v_add_f32 v58, v58, v154
    v_add_f32 v59, v59, v155
    v_cvt_pk_bf16_f32 v171, v154, v155
    v_mfma_f32_32x32x16_bf16 v[140:155], a[160:163], v[60:63], v[188:203]
    v_exp_f32 v124, v124
    v_mfma_f32_32x32x16_bf16 v[140:155], a[164:167], v[64:67], v[140:155]
    ds_read_b128 a[128:131], v40 offset:8192
    v_exp_f32 v125, v125
    v_add_u32 v3, 147456, v223
    v_add_f32 v56, v56, v124
    v_mfma_f32_32x32x16_bf16 v[140:155], a[168:171], v[68:71], v[140:155]
    ds_read_b128 a[132:135], v41 offset:8192
    v_exp_f32 v126, v126
    s_waitcnt vmcnt(8)
    v_add_f32 v204, v204, v208
    v_add_f32 v57, v57, v125
    v_cvt_pk_bf16_f32 v156, v124, v125
    v_mfma_f32_32x32x16_bf16 v[140:155], a[172:175], v[72:75], v[140:155]
    ds_read_b128 a[136:139], v42 offset:8192
    v_exp_f32 v127, v127
    s_waitcnt vmcnt(6)
    v_add_f32 v212, v212, v216
    v_add_f32 v205, v205, v209
    v_add_f32 v56, v56, v126
    v_mfma_f32_32x32x16_bf16 v[140:155], a[176:179], v[76:79], v[140:155]
    ds_read_b128 a[140:143], v43 offset:8192
    v_exp_f32 v128, v128
    v_add_f32 v213, v213, v217
    v_add_f32 v57, v57, v127
    v_cvt_pk_bf16_f32 v157, v126, v127
    v_mfma_f32_32x32x16_bf16 v[140:155], a[180:183], v[80:83], v[140:155]
    ds_read_b128 a[144:147], v44 offset:8192
    v_exp_f32 v129, v129
    v_add_f32 v206, v206, v210
    v_add_f32 v214, v214, v218
    v_add_f32 v56, v56, v128
    v_mfma_f32_32x32x16_bf16 v[140:155], a[184:187], v[84:87], v[140:155]
    ds_read_b128 a[148:151], v45 offset:8192
    v_exp_f32 v130, v130
    v_add_f32 v207, v207, v211
    v_add_f32 v57, v57, v129
    v_cvt_pk_bf16_f32 v158, v128, v129
    v_mfma_f32_32x32x16_bf16 v[140:155], a[188:191], v[88:91], v[140:155]
    ds_read_b128 a[152:155], v46 offset:8192
    v_exp_f32 v131, v131
    v_add_f32 v215, v215, v219
    v_mov_b32 v220, 0
    v_add_f32 v56, v56, v130
    v_mfma_f32_32x32x16_bf16 a[16:31], a[224:227], v[164:167], a[16:31]
    ds_read_b128 a[156:159], v47 offset:8192
    v_exp_f32 v132, v132
    v_subrev_u32 v221, 64, v0
    v_add_f32 v57, v57, v131
    v_cvt_pk_bf16_f32 v159, v130, v131
    v_mfma_f32_32x32x16_bf16 a[48:63], a[228:231], v[164:167], a[48:63]
    ds_read_b64_tr_b16 a[224:225], v12 offset:24576
    v_exp_f32 v133, v133
    v_cmp_gt_u32 vcc, 160, v221
    s_nop 1
    v_cndmask_b32 v220, v220, 1.0, vcc
    v_add_f32 v56, v56, v132
    v_mfma_f32_32x32x16_bf16 a[80:95], a[232:235], v[164:167], a[80:95]
    ds_read_b64_tr_b16 a[226:227], v13 offset:24576
    v_exp_f32 v134, v134
    v_add_f32 v204, v204, v212
    v_add_f32 v57, v57, v133
    v_cvt_pk_bf16_f32 v160, v132, v133
    v_mfma_f32_32x32x16_bf16 a[112:127], a[236:239], v[164:167], a[112:127]
    ds_read_b64_tr_b16 a[228:229], v14 offset:24576
    v_exp_f32 v135, v135
    v_add_f32 v205, v205, v213
    v_add_f32 v206, v206, v214
    v_add_f32 v56, v56, v134
    v_mfma_f32_32x32x16_bf16 a[16:31], a[240:243], v[168:171], a[16:31]
    ds_read_b64_tr_b16 a[230:231], v15 offset:24576
    v_exp_f32 v136, v136
    v_add_f32 v207, v207, v215
    v_add_f32 v57, v57, v135
    v_cvt_pk_bf16_f32 v161, v134, v135
    s_add_u32 m0, s49, 81920
    s_add_u32 s62, s50, 81920
    v_mfma_f32_32x32x16_bf16 a[48:63], a[244:247], v[168:171], a[48:63]
    buffer_load_dwordx4 v32, s[20:23], s62 offen offset:0 lds
    v_exp_f32 v137, v137
    v_cvt_pk_bf16_f32 v204, v204, v204
    v_lshlrev_b32 v204, 16, v204
    v_add_f32 v56, v56, v136
    v_mfma_f32_32x32x16_bf16 a[80:95], a[248:251], v[168:171], a[80:95]
    v_exp_f32 v138, v138
    v_cvt_pk_bf16_f32 v205, v205, v205
    v_add_f32 v57, v57, v137
    v_cvt_pk_bf16_f32 v162, v136, v137
    v_mfma_f32_32x32x16_bf16 a[112:127], a[252:255], v[168:171], a[112:127]
    buffer_load_dwordx4 v33, s[20:23], s62 offen offset:1024 lds
    v_exp_f32 v139, v139
    v_lshlrev_b32 v205, 16, v205
    v_cvt_pk_bf16_f32 v206, v206, v206
    v_add_f32 v56, v56, v138
    v_add_f32 v57, v57, v139
    v_cvt_pk_bf16_f32 v163, v138, v139
    s_waitcnt lgkmcnt(4)
    v_mfma_f32_32x32x16_bf16 v[124:139], a[128:131], v[92:95], v[172:187]
    ds_read_b64_tr_b16 a[232:233], v16 offset:24576
    v_exp_f32 v140, v140
    v_lshlrev_b32 v206, 16, v206
    v_mfma_f32_32x32x16_bf16 v[124:139], a[132:135], v[96:99], v[124:139]
    ds_read_b64_tr_b16 a[234:235], v17 offset:24576
    v_exp_f32 v141, v141
    v_cvt_pk_bf16_f32 v207, v207, v207
    v_lshlrev_b32 v207, 16, v207
    v_add_f32 v58, v58, v140
    s_add_u32 s92, s92, 327680
    v_mfma_f32_32x32x16_bf16 v[124:139], a[136:139], v[100:103], v[124:139]
    ds_read_b64_tr_b16 a[236:237], v18 offset:24576
    v_exp_f32 v142, v142
    v_add_f32 v204, v220, v204
    v_add_f32 v59, v59, v141
    v_cvt_pk_bf16_f32 v164, v140, v141
    v_mfma_f32_32x32x16_bf16 v[124:139], a[140:143], v[104:107], v[124:139]
    ds_read_b64_tr_b16 a[238:239], v19 offset:24576
    v_exp_f32 v143, v143
    v_add_f32 v205, v220, v205
    v_add_f32 v206, v220, v206
    v_add_f32 v58, v58, v142
    v_mfma_f32_32x32x16_bf16 v[124:139], a[144:147], v[108:111], v[124:139]
    ds_read_b64_tr_b16 a[240:241], v12 offset:28672
    v_exp_f32 v144, v144
    v_add_f32 v207, v220, v207
    v_add_f32 v59, v59, v143
    v_cvt_pk_bf16_f32 v165, v142, v143
    v_mfma_f32_32x32x16_bf16 v[124:139], a[148:151], v[112:115], v[124:139]
    ds_read_b64_tr_b16 a[242:243], v13 offset:28672
    v_exp_f32 v145, v145
    v_cvt_pk_bf16_f32 v204, v204, v204
    v_lshlrev_b32 v204, 16, v204
    v_add_f32 v58, v58, v144
    v_mfma_f32_32x32x16_bf16 v[124:139], a[152:155], v[116:119], v[124:139]
    ds_read_b64_tr_b16 a[244:245], v14 offset:28672
    v_exp_f32 v146, v146
    v_cvt_pk_bf16_f32 v205, v205, v205
    v_add_f32 v59, v59, v145
    v_cvt_pk_bf16_f32 v166, v144, v145
    v_mfma_f32_32x32x16_bf16 v[124:139], a[156:159], v[120:123], v[124:139]
    ds_read_b64_tr_b16 a[246:247], v15 offset:28672
    v_exp_f32 v147, v147
    v_lshlrev_b32 v205, 16, v205
    v_cvt_pk_bf16_f32 v206, v206, v206
    v_add_f32 v58, v58, v146
    v_mfma_f32_32x32x16_bf16 a[0:15], a[192:195], v[156:159], a[0:15]
    ds_read_b64_tr_b16 a[248:249], v16 offset:28672
    v_exp_f32 v148, v148
    v_lshlrev_b32 v206, 16, v206
    v_add_f32 v59, v59, v147
    v_cvt_pk_bf16_f32 v167, v146, v147
    v_mfma_f32_32x32x16_bf16 a[32:47], a[196:199], v[156:159], a[32:47]
    ds_read_b64_tr_b16 a[250:251], v17 offset:28672
    v_exp_f32 v149, v149
    v_cvt_pk_bf16_f32 v207, v207, v207
    v_lshlrev_b32 v207, 16, v207
    v_add_f32 v58, v58, v148
    v_mfma_f32_32x32x16_bf16 a[64:79], a[200:203], v[156:159], a[64:79]
    ds_read_b64_tr_b16 a[252:253], v18 offset:28672
    v_exp_f32 v150, v150
    v_add_f32 v59, v59, v149
    v_cvt_pk_bf16_f32 v168, v148, v149
    v_mfma_f32_32x32x16_bf16 a[96:111], a[204:207], v[156:159], a[96:111]
    ds_read_b64_tr_b16 a[254:255], v19 offset:28672
    ds_write_b128 v3, v[204:207] offset:9216
    v_exp_f32 v151, v151
    v_add_f32 v58, v58, v150
    v_mfma_f32_32x32x16_bf16 a[0:15], a[208:211], v[160:163], a[0:15]
    buffer_load_dwordx4 v34, s[20:23], s62 offen offset:2048 lds
    v_exp_f32 v152, v152
    v_add_f32 v59, v59, v151
    v_cvt_pk_bf16_f32 v169, v150, v151
    v_mfma_f32_32x32x16_bf16 a[32:47], a[212:215], v[160:163], a[32:47]
    v_exp_f32 v153, v153
    v_add_f32 v58, v58, v152
    v_mfma_f32_32x32x16_bf16 a[64:79], a[216:219], v[160:163], a[64:79]
    buffer_load_dwordx4 v35, s[20:23], s62 offen offset:3072 lds
    v_exp_f32 v154, v154
    v_add_f32 v59, v59, v153
    v_cvt_pk_bf16_f32 v170, v152, v153
    v_mfma_f32_32x32x16_bf16 a[96:111], a[220:223], v[160:163], a[96:111]
    buffer_load_dword v251, v252, s[24:27], s92 offen
    v_exp_f32 v155, v155
    v_add_f32 v58, v58, v154
    v_add_f32 v59, v59, v155
    v_cvt_pk_bf16_f32 v171, v154, v155
    s_waitcnt lgkmcnt(0)
    v_mfma_f32_32x32x16_bf16 v[140:155], a[128:131], v[60:63], v[188:203]
    s_barrier
    v_mfma_f32_32x32x16_bf16 v[140:155], a[132:135], v[64:67], v[140:155]
    ds_read_b128 a[160:163], v40 offset:32768
    v_exp_f32 v124, v124
    v_exp_f32 v125, v125
    v_add_f32 v56, v56, v124
    v_mfma_f32_32x32x16_bf16 v[140:155], a[136:139], v[68:71], v[140:155]
    ds_read_b128 a[164:167], v41 offset:32768
    v_exp_f32 v126, v126
    v_add_f32 v57, v57, v125
    v_cvt_pk_bf16_f32 v156, v124, v125
    v_mfma_f32_32x32x16_bf16 v[140:155], a[140:143], v[72:75], v[140:155]
    ds_read_b128 a[168:171], v42 offset:32768
    v_lshlrev_b32 v223, 3, v0
    v_min_u32 v252, 21, v1
    v_exp_f32 v127, v127
    v_add_f32 v56, v56, v126
    v_mfma_f32_32x32x16_bf16 v[140:155], a[144:147], v[76:79], v[140:155]
    ds_read_b128 a[172:175], v43 offset:32768
    v_exp_f32 v128, v128
    v_add_f32 v57, v57, v127
    v_cvt_pk_bf16_f32 v157, v126, v127
    s_add_u32 m0, s49, 98304
    s_add_u32 s62, s50, 98304
    v_mfma_f32_32x32x16_bf16 v[140:155], a[148:151], v[80:83], v[140:155]
    ds_read_b128 a[176:179], v44 offset:32768
    buffer_load_dwordx4 v32, s[16:19], s62 offen offset:0 lds
    v_lshlrev_b32 v252, 7, v252
    v_exp_f32 v129, v129
    v_add_f32 v56, v56, v128
    v_mfma_f32_32x32x16_bf16 v[140:155], a[152:155], v[84:87], v[140:155]
    ds_read_b128 a[180:183], v45 offset:32768
    v_exp_f32 v130, v130
    v_add_f32 v57, v57, v129
    v_cvt_pk_bf16_f32 v158, v128, v129
    v_mfma_f32_32x32x16_bf16 v[140:155], a[156:159], v[88:91], v[140:155]
    ds_read_b128 a[184:187], v46 offset:32768
    v_exp_f32 v131, v131
    v_add_f32 v56, v56, v130
    v_mfma_f32_32x32x16_bf16 a[16:31], a[192:195], v[164:167], a[16:31]
    ds_read_b128 a[188:191], v47 offset:32768
    v_exp_f32 v132, v132
    v_add_f32 v57, v57, v131
    v_cvt_pk_bf16_f32 v159, v130, v131
    v_mfma_f32_32x32x16_bf16 a[48:63], a[196:199], v[164:167], a[48:63]
    ds_read_b64_tr_b16 a[192:193], v12 offset:49152
    buffer_load_dwordx4 v33, s[16:19], s62 offen offset:1024 lds
    v_exp_f32 v133, v133
    v_add_f32 v56, v56, v132
    v_mfma_f32_32x32x16_bf16 a[80:95], a[200:203], v[164:167], a[80:95]
    ds_read_b64_tr_b16 a[194:195], v13 offset:49152
    v_exp_f32 v134, v134
    v_add_f32 v57, v57, v133
    v_cvt_pk_bf16_f32 v160, v132, v133
    v_mfma_f32_32x32x16_bf16 a[112:127], a[204:207], v[164:167], a[112:127]
    ds_read_b64_tr_b16 a[196:197], v14 offset:49152
    v_exp_f32 v135, v135
    v_add_f32 v56, v56, v134
    v_mfma_f32_32x32x16_bf16 a[16:31], a[208:211], v[168:171], a[16:31]
    ds_read_b64_tr_b16 a[198:199], v15 offset:49152
    v_exp_f32 v136, v136
    v_add_f32 v57, v57, v135
    v_cvt_pk_bf16_f32 v161, v134, v135
    v_mfma_f32_32x32x16_bf16 a[48:63], a[212:215], v[168:171], a[48:63]
    buffer_load_dwordx4 v34, s[16:19], s62 offen offset:2048 lds
    v_exp_f32 v137, v137
    v_add_f32 v56, v56, v136
    v_mfma_f32_32x32x16_bf16 a[80:95], a[216:219], v[168:171], a[80:95]
    v_exp_f32 v138, v138
    v_add_f32 v57, v57, v137
    v_cvt_pk_bf16_f32 v162, v136, v137
    v_mfma_f32_32x32x16_bf16 a[112:127], a[220:223], v[168:171], a[112:127]
    buffer_load_dwordx4 v35, s[16:19], s62 offen offset:3072 lds
    v_exp_f32 v139, v139
    v_add_f32 v56, v56, v138
    v_add_f32 v57, v57, v139
    v_cvt_pk_bf16_f32 v163, v138, v139
    s_waitcnt lgkmcnt(4)
    v_mfma_f32_32x32x16_bf16 v[124:139], a[160:163], v[92:95], v[172:187]
    ds_read_b64_tr_b16 a[200:201], v16 offset:49152
    v_exp_f32 v140, v140
    v_mfma_f32_32x32x16_bf16 v[124:139], a[164:167], v[96:99], v[124:139]
    ds_read_b64_tr_b16 a[202:203], v17 offset:49152
    v_exp_f32 v141, v141
    v_add_f32 v58, v58, v140
    s_add_u32 s92, s4, 0
    v_mfma_f32_32x32x16_bf16 v[124:139], a[168:171], v[100:103], v[124:139]
    ds_read_b64_tr_b16 a[204:205], v18 offset:49152
    v_exp_f32 v142, v142
    v_add_f32 v59, v59, v141
    v_cvt_pk_bf16_f32 v164, v140, v141
    s_sub_u32 s65, s92, 6
    v_mfma_f32_32x32x16_bf16 v[124:139], a[172:175], v[104:107], v[124:139]
    ds_read_b64_tr_b16 a[206:207], v19 offset:49152
    v_exp_f32 v143, v143
    v_add_f32 v58, v58, v142
    s_min_u32 s92, s92, s65
    v_mfma_f32_32x32x16_bf16 v[124:139], a[176:179], v[108:111], v[124:139]
    ds_read_b64_tr_b16 a[208:209], v12 offset:53248
    v_exp_f32 v144, v144
    v_add_f32 v59, v59, v143
    v_cvt_pk_bf16_f32 v165, v142, v143
    s_sub_u32 s65, s92, 6
    s_mov_b32 s68, 78848
    v_mfma_f32_32x32x16_bf16 v[124:139], a[180:183], v[112:115], v[124:139]
    ds_read_b64_tr_b16 a[210:211], v13 offset:53248
    buffer_load_dwordx2 v[204:205], v223, s[8:11], s68 offen sc1
    v_exp_f32 v145, v145
    v_add_f32 v58, v58, v144
    s_min_u32 s92, s92, s65
    v_mfma_f32_32x32x16_bf16 v[124:139], a[184:187], v[116:119], v[124:139]
    ds_read_b64_tr_b16 a[212:213], v14 offset:53248
    v_exp_f32 v146, v146
    v_add_f32 v59, v59, v145
    v_cvt_pk_bf16_f32 v166, v144, v145
    s_mul_i32 s92, s92, 360448
    v_mfma_f32_32x32x16_bf16 v[124:139], a[188:191], v[120:123], v[124:139]
    ds_read_b64_tr_b16 a[214:215], v15 offset:53248
    v_exp_f32 v147, v147
    v_add_f32 v58, v58, v146
    s_add_u32 s92, s92, s96
    v_mfma_f32_32x32x16_bf16 a[0:15], a[224:227], v[156:159], a[0:15]
    ds_read_b64_tr_b16 a[216:217], v16 offset:53248
    v_exp_f32 v148, v148
    v_add_f32 v59, v59, v147
    v_cvt_pk_bf16_f32 v167, v146, v147
    s_mov_b32 s69, 94208
    v_mfma_f32_32x32x16_bf16 a[32:47], a[228:231], v[156:159], a[32:47]
    ds_read_b64_tr_b16 a[218:219], v17 offset:53248
    buffer_load_dwordx2 v[206:207], v223, s[8:11], s69 offen sc1
    v_exp_f32 v149, v149
    v_add_f32 v58, v58, v148
    v_mfma_f32_32x32x16_bf16 a[64:79], a[232:235], v[156:159], a[64:79]
    ds_read_b64_tr_b16 a[220:221], v18 offset:53248
    v_exp_f32 v150, v150
    v_add_f32 v59, v59, v149
    v_cvt_pk_bf16_f32 v168, v148, v149
    v_mfma_f32_32x32x16_bf16 a[96:111], a[236:239], v[156:159], a[96:111]
    ds_read_b64_tr_b16 a[222:223], v19 offset:53248
    v_exp_f32 v151, v151
    v_add_f32 v58, v58, v150
    s_mov_b32 s70, 109568
    v_mfma_f32_32x32x16_bf16 a[0:15], a[240:243], v[160:163], a[0:15]
    buffer_load_dwordx2 v[208:209], v223, s[8:11], s70 offen sc1
    v_exp_f32 v152, v152
    v_add_f32 v59, v59, v151
    v_cvt_pk_bf16_f32 v169, v150, v151
    v_mfma_f32_32x32x16_bf16 a[32:47], a[244:247], v[160:163], a[32:47]
    v_exp_f32 v153, v153
    v_add_f32 v58, v58, v152
    s_mov_b32 s71, 124928
    v_mfma_f32_32x32x16_bf16 a[64:79], a[248:251], v[160:163], a[64:79]
    buffer_load_dwordx2 v[210:211], v223, s[8:11], s71 offen sc1
    v_exp_f32 v154, v154
    v_add_f32 v59, v59, v153
    v_cvt_pk_bf16_f32 v170, v152, v153
    v_mfma_f32_32x32x16_bf16 a[96:111], a[252:255], v[160:163], a[96:111]
    buffer_load_dword v251, v252, s[8:11], s92 offen
    v_exp_f32 v155, v155
    v_add_f32 v58, v58, v154
    v_add_f32 v59, v59, v155
    v_cvt_pk_bf16_f32 v171, v154, v155
    v_mfma_f32_32x32x16_bf16 v[140:155], a[160:163], v[60:63], v[188:203]
    v_exp_f32 v124, v124
    v_mfma_f32_32x32x16_bf16 v[140:155], a[164:167], v[64:67], v[140:155]
    ds_read_b128 a[128:131], v40 offset:40960
    v_exp_f32 v125, v125
    v_add_f32 v56, v56, v124
    v_mfma_f32_32x32x16_bf16 v[140:155], a[168:171], v[68:71], v[140:155]
    ds_read_b128 a[132:135], v41 offset:40960
    v_exp_f32 v126, v126
    v_add_f32 v57, v57, v125
    v_cvt_pk_bf16_f32 v156, v124, v125
    v_mfma_f32_32x32x16_bf16 v[140:155], a[172:175], v[72:75], v[140:155]
    ds_read_b128 a[136:139], v42 offset:40960
    v_exp_f32 v127, v127
    v_add_f32 v56, v56, v126
    v_mfma_f32_32x32x16_bf16 v[140:155], a[176:179], v[76:79], v[140:155]
    ds_read_b128 a[140:143], v43 offset:40960
    v_exp_f32 v128, v128
    v_add_f32 v57, v57, v127
    v_cvt_pk_bf16_f32 v157, v126, v127
    v_mfma_f32_32x32x16_bf16 v[140:155], a[180:183], v[80:83], v[140:155]
    ds_read_b128 a[144:147], v44 offset:40960
    v_exp_f32 v129, v129
    v_add_f32 v56, v56, v128
    v_mfma_f32_32x32x16_bf16 v[140:155], a[184:187], v[84:87], v[140:155]
    ds_read_b128 a[148:151], v45 offset:40960
    v_exp_f32 v130, v130
    v_add_f32 v57, v57, v129
    v_cvt_pk_bf16_f32 v158, v128, v129
    v_mfma_f32_32x32x16_bf16 v[140:155], a[188:191], v[88:91], v[140:155]
    ds_read_b128 a[152:155], v46 offset:40960
    v_exp_f32 v131, v131
    v_add_f32 v56, v56, v130
    v_mfma_f32_32x32x16_bf16 a[16:31], a[224:227], v[164:167], a[16:31]
    ds_read_b128 a[156:159], v47 offset:40960
    v_exp_f32 v132, v132
    v_add_f32 v57, v57, v131
    v_cvt_pk_bf16_f32 v159, v130, v131
    v_mfma_f32_32x32x16_bf16 a[48:63], a[228:231], v[164:167], a[48:63]
    ds_read_b64_tr_b16 a[224:225], v12 offset:57344
    v_exp_f32 v133, v133
    v_add_f32 v56, v56, v132
    v_mfma_f32_32x32x16_bf16 a[80:95], a[232:235], v[164:167], a[80:95]
    ds_read_b64_tr_b16 a[226:227], v13 offset:57344
    v_exp_f32 v134, v134
    v_add_f32 v57, v57, v133
    v_cvt_pk_bf16_f32 v160, v132, v133
    v_mfma_f32_32x32x16_bf16 a[112:127], a[236:239], v[164:167], a[112:127]
    ds_read_b64_tr_b16 a[228:229], v14 offset:57344
    v_exp_f32 v135, v135
    v_add_f32 v56, v56, v134
    v_mfma_f32_32x32x16_bf16 a[16:31], a[240:243], v[168:171], a[16:31]
    ds_read_b64_tr_b16 a[230:231], v15 offset:57344
    v_exp_f32 v136, v136
    v_add_f32 v57, v57, v135
    v_cvt_pk_bf16_f32 v161, v134, v135
    s_add_u32 m0, s49, 114688
    s_add_u32 s62, s50, 98304
    v_mfma_f32_32x32x16_bf16 a[48:63], a[244:247], v[168:171], a[48:63]
    buffer_load_dwordx4 v32, s[20:23], s62 offen offset:0 lds
    v_exp_f32 v137, v137
    v_add_f32 v56, v56, v136
    v_mfma_f32_32x32x16_bf16 a[80:95], a[248:251], v[168:171], a[80:95]
    v_exp_f32 v138, v138
    v_add_f32 v57, v57, v137
    v_cvt_pk_bf16_f32 v162, v136, v137
    v_mfma_f32_32x32x16_bf16 a[112:127], a[252:255], v[168:171], a[112:127]
    buffer_load_dwordx4 v33, s[20:23], s62 offen offset:1024 lds
    v_exp_f32 v139, v139
    v_add_f32 v56, v56, v138
    v_add_f32 v57, v57, v139
    v_cvt_pk_bf16_f32 v163, v138, v139
    s_waitcnt lgkmcnt(4)
    v_mfma_f32_32x32x16_bf16 v[124:139], a[128:131], v[92:95], v[172:187]
    ds_read_b64_tr_b16 a[232:233], v16 offset:57344
    v_exp_f32 v140, v140
    v_mfma_f32_32x32x16_bf16 v[124:139], a[132:135], v[96:99], v[124:139]
    ds_read_b64_tr_b16 a[234:235], v17 offset:57344
    v_exp_f32 v141, v141
    v_add_f32 v58, v58, v140
    s_add_u32 s92, s4, 1
    v_mfma_f32_32x32x16_bf16 v[124:139], a[136:139], v[100:103], v[124:139]
    ds_read_b64_tr_b16 a[236:237], v18 offset:57344
    v_exp_f32 v142, v142
    v_add_f32 v59, v59, v141
    v_cvt_pk_bf16_f32 v164, v140, v141
    s_sub_u32 s65, s92, 6
    v_mfma_f32_32x32x16_bf16 v[124:139], a[140:143], v[104:107], v[124:139]
    ds_read_b64_tr_b16 a[238:239], v19 offset:57344
    v_exp_f32 v143, v143
    v_add_f32 v58, v58, v142
    s_min_u32 s92, s92, s65
    v_mfma_f32_32x32x16_bf16 v[124:139], a[144:147], v[108:111], v[124:139]
    ds_read_b64_tr_b16 a[240:241], v12 offset:61440
    v_exp_f32 v144, v144
    v_add_f32 v59, v59, v143
    v_cvt_pk_bf16_f32 v165, v142, v143
    s_sub_u32 s65, s92, 6
    v_mfma_f32_32x32x16_bf16 v[124:139], a[148:151], v[112:115], v[124:139]
    ds_read_b64_tr_b16 a[242:243], v13 offset:61440
    v_exp_f32 v145, v145
    v_add_f32 v58, v58, v144
    s_min_u32 s92, s92, s65
    v_mfma_f32_32x32x16_bf16 v[124:139], a[152:155], v[116:119], v[124:139]
    ds_read_b64_tr_b16 a[244:245], v14 offset:61440
    v_exp_f32 v146, v146
    v_add_f32 v59, v59, v145
    v_cvt_pk_bf16_f32 v166, v144, v145
    s_mul_i32 s92, s92, 360448
    v_mfma_f32_32x32x16_bf16 v[124:139], a[156:159], v[120:123], v[124:139]
    ds_read_b64_tr_b16 a[246:247], v15 offset:61440
    v_exp_f32 v147, v147
    v_add_f32 v58, v58, v146
    s_add_u32 s92, s92, s96
    v_mfma_f32_32x32x16_bf16 a[0:15], a[192:195], v[156:159], a[0:15]
    ds_read_b64_tr_b16 a[248:249], v16 offset:61440
    v_exp_f32 v148, v148
    v_add_f32 v59, v59, v147
    v_cvt_pk_bf16_f32 v167, v146, v147
    v_mfma_f32_32x32x16_bf16 a[32:47], a[196:199], v[156:159], a[32:47]
    ds_read_b64_tr_b16 a[250:251], v17 offset:61440
    v_exp_f32 v149, v149
    v_add_f32 v58, v58, v148
    v_mfma_f32_32x32x16_bf16 a[64:79], a[200:203], v[156:159], a[64:79]
    ds_read_b64_tr_b16 a[252:253], v18 offset:61440
    v_exp_f32 v150, v150
    v_add_f32 v59, v59, v149
    v_cvt_pk_bf16_f32 v168, v148, v149
    v_mfma_f32_32x32x16_bf16 a[96:111], a[204:207], v[156:159], a[96:111]
    ds_read_b64_tr_b16 a[254:255], v19 offset:61440
    v_exp_f32 v151, v151
    v_add_f32 v58, v58, v150
    v_mfma_f32_32x32x16_bf16 a[0:15], a[208:211], v[160:163], a[0:15]
    buffer_load_dwordx4 v34, s[20:23], s62 offen offset:2048 lds
    v_exp_f32 v152, v152
    v_add_f32 v59, v59, v151
    v_cvt_pk_bf16_f32 v169, v150, v151
    v_mfma_f32_32x32x16_bf16 a[32:47], a[212:215], v[160:163], a[32:47]
    v_exp_f32 v153, v153
    v_add_f32 v58, v58, v152
    v_mfma_f32_32x32x16_bf16 a[64:79], a[216:219], v[160:163], a[64:79]
    buffer_load_dwordx4 v35, s[20:23], s62 offen offset:3072 lds
    v_exp_f32 v154, v154
    v_add_f32 v59, v59, v153
    v_cvt_pk_bf16_f32 v170, v152, v153
    v_mfma_f32_32x32x16_bf16 a[96:111], a[220:223], v[160:163], a[96:111]
    buffer_load_dword v251, v252, s[8:11], s92 offen
    v_exp_f32 v155, v155
    v_add_f32 v58, v58, v154
    v_add_f32 v59, v59, v155
    v_cvt_pk_bf16_f32 v171, v154, v155
    s_waitcnt vmcnt(15) lgkmcnt(0)
    v_mfma_f32_32x32x16_bf16 v[140:155], a[128:131], v[60:63], v[188:203]
    s_barrier
    v_mfma_f32_32x32x16_bf16 v[140:155], a[132:135], v[64:67], v[140:155]
    ds_read_b128 a[160:163], v48 offset:0
    v_exp_f32 v124, v124
    v_add_u32 v3, 147456, v223
    v_exp_f32 v125, v125
    v_add_f32 v56, v56, v124
    v_mfma_f32_32x32x16_bf16 v[140:155], a[136:139], v[68:71], v[140:155]
    ds_read_b128 a[164:167], v49 offset:0
    v_exp_f32 v126, v126
    s_waitcnt vmcnt(8)
    v_add_f32 v204, v204, v206
    v_add_f32 v57, v57, v125
    v_cvt_pk_bf16_f32 v156, v124, v125
    v_mfma_f32_32x32x16_bf16 v[140:155], a[140:143], v[72:75], v[140:155]
    ds_read_b128 a[168:171], v50 offset:0
    v_exp_f32 v127, v127
    s_waitcnt vmcnt(6)
    v_add_f32 v208, v208, v210
    v_add_f32 v205, v205, v207
    v_add_f32 v56, v56, v126
    v_mfma_f32_32x32x16_bf16 v[140:155], a[144:147], v[76:79], v[140:155]
    ds_read_b128 a[172:175], v51 offset:0
    v_exp_f32 v128, v128
    v_add_f32 v209, v209, v211
    v_add_f32 v57, v57, v127
    v_cvt_pk_bf16_f32 v157, v126, v127
    v_mfma_f32_32x32x16_bf16 v[140:155], a[148:151], v[80:83], v[140:155]
    ds_read_b128 a[176:179], v52 offset:0
    v_exp_f32 v129, v129
    v_add_f32 v204, v204, v208
    v_add_f32 v205, v205, v209
    v_add_f32 v56, v56, v128
    v_mfma_f32_32x32x16_bf16 v[140:155], a[152:155], v[84:87], v[140:155]
    ds_read_b128 a[180:183], v53 offset:0
    v_exp_f32 v130, v130
    v_cvt_pk_bf16_f32 v204, v204, v204
    v_add_f32 v57, v57, v129
    v_cvt_pk_bf16_f32 v158, v128, v129
    v_mfma_f32_32x32x16_bf16 v[140:155], a[156:159], v[88:91], v[140:155]
    ds_read_b128 a[184:187], v54 offset:0
    v_exp_f32 v131, v131
    v_lshlrev_b32 v204, 16, v204
    v_cvt_pk_bf16_f32 v205, v205, v205
    v_add_f32 v56, v56, v130
    v_mfma_f32_32x32x16_bf16 a[16:31], a[192:195], v[164:167], a[16:31]
    ds_read_b128 a[188:191], v55 offset:0
    v_exp_f32 v132, v132
    v_lshlrev_b32 v205, 16, v205
    v_add_f32 v57, v57, v131
    v_cvt_pk_bf16_f32 v159, v130, v131
    v_mfma_f32_32x32x16_bf16 a[48:63], a[196:199], v[164:167], a[48:63]
    ds_read_b64_tr_b16 a[192:193], v20 offset:16384
    v_exp_f32 v133, v133
    v_add_f32 v56, v56, v132
    v_mfma_f32_32x32x16_bf16 a[80:95], a[200:203], v[164:167], a[80:95]
    ds_read_b64_tr_b16 a[194:195], v21 offset:16384
    ds_write_b64 v3, v[204:205] offset:13312
    v_exp_f32 v134, v134
    v_add_f32 v57, v57, v133
    v_cvt_pk_bf16_f32 v160, v132, v133
    v_mfma_f32_32x32x16_bf16 a[112:127], a[204:207], v[164:167], a[112:127]
    ds_read_b64_tr_b16 a[196:197], v22 offset:16384
    v_exp_f32 v135, v135
    v_add_f32 v56, v56, v134
    v_mfma_f32_32x32x16_bf16 a[16:31], a[208:211], v[168:171], a[16:31]
    ds_read_b64_tr_b16 a[198:199], v23 offset:16384
    v_exp_f32 v136, v136
    v_add_f32 v57, v57, v135
    v_cvt_pk_bf16_f32 v161, v134, v135
    s_add_u32 m0, s49, 0
    s_add_u32 s62, s50, 114688
    v_mfma_f32_32x32x16_bf16 a[48:63], a[212:215], v[168:171], a[48:63]
    buffer_load_dwordx4 v32, s[16:19], s62 offen offset:0 lds
    v_exp_f32 v137, v137
    v_add_f32 v56, v56, v136
    v_mfma_f32_32x32x16_bf16 a[80:95], a[216:219], v[168:171], a[80:95]
    v_exp_f32 v138, v138
    v_add_f32 v57, v57, v137
    v_cvt_pk_bf16_f32 v162, v136, v137
    v_mfma_f32_32x32x16_bf16 a[112:127], a[220:223], v[168:171], a[112:127]
    buffer_load_dwordx4 v33, s[16:19], s62 offen offset:1024 lds
    v_exp_f32 v139, v139
    v_add_f32 v56, v56, v138
    v_add_f32 v57, v57, v139
    v_cvt_pk_bf16_f32 v163, v138, v139
    s_waitcnt lgkmcnt(4)
    v_mfma_f32_32x32x16_bf16 v[124:139], a[160:163], v[92:95], v[172:187]
    ds_read_b64_tr_b16 a[200:201], v24 offset:16384
    v_exp_f32 v140, v140
    v_mfma_f32_32x32x16_bf16 v[124:139], a[164:167], v[96:99], v[124:139]
    ds_read_b64_tr_b16 a[202:203], v25 offset:16384
    v_exp_f32 v141, v141
    v_add_f32 v58, v58, v140
    s_add_u32 s92, s4, 2
    v_mfma_f32_32x32x16_bf16 v[124:139], a[168:171], v[100:103], v[124:139]
    ds_read_b64_tr_b16 a[204:205], v26 offset:16384
    v_exp_f32 v142, v142
    v_add_f32 v59, v59, v141
    v_cvt_pk_bf16_f32 v164, v140, v141
    s_sub_u32 s65, s92, 6
    v_mfma_f32_32x32x16_bf16 v[124:139], a[172:175], v[104:107], v[124:139]
    ds_read_b64_tr_b16 a[206:207], v27 offset:16384
    v_exp_f32 v143, v143
    v_add_f32 v58, v58, v142
    s_min_u32 s92, s92, s65
    v_mfma_f32_32x32x16_bf16 v[124:139], a[176:179], v[108:111], v[124:139]
    ds_read_b64_tr_b16 a[208:209], v20 offset:20480
    v_exp_f32 v144, v144
    v_add_f32 v59, v59, v143
    v_cvt_pk_bf16_f32 v165, v142, v143
    s_sub_u32 s65, s92, 6
    v_mfma_f32_32x32x16_bf16 v[124:139], a[180:183], v[112:115], v[124:139]
    ds_read_b64_tr_b16 a[210:211], v21 offset:20480
    v_exp_f32 v145, v145
    v_add_f32 v58, v58, v144
    s_min_u32 s92, s92, s65
    v_mfma_f32_32x32x16_bf16 v[124:139], a[184:187], v[116:119], v[124:139]
    ds_read_b64_tr_b16 a[212:213], v22 offset:20480
    v_exp_f32 v146, v146
    v_add_f32 v59, v59, v145
    v_cvt_pk_bf16_f32 v166, v144, v145
    s_mul_i32 s92, s92, 360448
    v_mfma_f32_32x32x16_bf16 v[124:139], a[188:191], v[120:123], v[124:139]
    ds_read_b64_tr_b16 a[214:215], v23 offset:20480
    v_exp_f32 v147, v147
    v_add_f32 v58, v58, v146
    s_add_u32 s92, s92, s96
    v_mfma_f32_32x32x16_bf16 a[0:15], a[224:227], v[156:159], a[0:15]
    ds_read_b64_tr_b16 a[216:217], v24 offset:20480
    v_exp_f32 v148, v148
    v_add_f32 v59, v59, v147
    v_cvt_pk_bf16_f32 v167, v146, v147
    v_mfma_f32_32x32x16_bf16 a[32:47], a[228:231], v[156:159], a[32:47]
    ds_read_b64_tr_b16 a[218:219], v25 offset:20480
    v_exp_f32 v149, v149
    v_add_f32 v58, v58, v148
    v_mfma_f32_32x32x16_bf16 a[64:79], a[232:235], v[156:159], a[64:79]
    ds_read_b64_tr_b16 a[220:221], v26 offset:20480
    v_exp_f32 v150, v150
    v_add_f32 v59, v59, v149
    v_cvt_pk_bf16_f32 v168, v148, v149
    v_mfma_f32_32x32x16_bf16 a[96:111], a[236:239], v[156:159], a[96:111]
    ds_read_b64_tr_b16 a[222:223], v27 offset:20480
    v_exp_f32 v151, v151
    v_add_f32 v58, v58, v150
    v_mfma_f32_32x32x16_bf16 a[0:15], a[240:243], v[160:163], a[0:15]
    buffer_load_dwordx4 v34, s[16:19], s62 offen offset:2048 lds
    v_exp_f32 v152, v152
    v_add_f32 v59, v59, v151
    v_cvt_pk_bf16_f32 v169, v150, v151
    v_mfma_f32_32x32x16_bf16 a[32:47], a[244:247], v[160:163], a[32:47]
    v_exp_f32 v153, v153
    v_add_f32 v58, v58, v152
    v_mfma_f32_32x32x16_bf16 a[64:79], a[248:251], v[160:163], a[64:79]
    buffer_load_dwordx4 v35, s[16:19], s62 offen offset:3072 lds
    v_exp_f32 v154, v154
    v_add_f32 v59, v59, v153
    v_cvt_pk_bf16_f32 v170, v152, v153
    v_mfma_f32_32x32x16_bf16 a[96:111], a[252:255], v[160:163], a[96:111]
    buffer_load_dword v251, v252, s[8:11], s92 offen
    v_exp_f32 v155, v155
    v_add_f32 v58, v58, v154
    v_add_f32 v59, v59, v155
    v_cvt_pk_bf16_f32 v171, v154, v155
    v_mfma_f32_32x32x16_bf16 v[140:155], a[160:163], v[60:63], v[188:203]
    v_exp_f32 v124, v124
    v_mfma_f32_32x32x16_bf16 v[140:155], a[164:167], v[64:67], v[140:155]
    ds_read_b128 a[128:131], v48 offset:8192
    v_exp_f32 v125, v125
    v_add_f32 v56, v56, v124
    v_mfma_f32_32x32x16_bf16 v[140:155], a[168:171], v[68:71], v[140:155]
    ds_read_b128 a[132:135], v49 offset:8192
    v_exp_f32 v126, v126
    v_add_f32 v57, v57, v125
    v_cvt_pk_bf16_f32 v156, v124, v125
    v_mfma_f32_32x32x16_bf16 v[140:155], a[172:175], v[72:75], v[140:155]
    ds_read_b128 a[136:139], v50 offset:8192
    v_exp_f32 v127, v127
    v_add_f32 v56, v56, v126
    v_mfma_f32_32x32x16_bf16 v[140:155], a[176:179], v[76:79], v[140:155]
    ds_read_b128 a[140:143], v51 offset:8192
    v_exp_f32 v128, v128
    v_add_f32 v57, v57, v127
    v_cvt_pk_bf16_f32 v157, v126, v127
    v_mfma_f32_32x32x16_bf16 v[140:155], a[180:183], v[80:83], v[140:155]
    ds_read_b128 a[144:147], v52 offset:8192
    v_exp_f32 v129, v129
    v_add_f32 v56, v56, v128
    v_mfma_f32_32x32x16_bf16 v[140:155], a[184:187], v[84:87], v[140:155]
    ds_read_b128 a[148:151], v53 offset:8192
    v_exp_f32 v130, v130
    v_add_f32 v57, v57, v129
    v_cvt_pk_bf16_f32 v158, v128, v129
    v_mfma_f32_32x32x16_bf16 v[140:155], a[188:191], v[88:91], v[140:155]
    ds_read_b128 a[152:155], v54 offset:8192
    v_exp_f32 v131, v131
    v_add_f32 v56, v56, v130
    v_mfma_f32_32x32x16_bf16 a[16:31], a[224:227], v[164:167], a[16:31]
    ds_read_b128 a[156:159], v55 offset:8192
    v_exp_f32 v132, v132
    v_add_f32 v57, v57, v131
    v_cvt_pk_bf16_f32 v159, v130, v131
    v_mfma_f32_32x32x16_bf16 a[48:63], a[228:231], v[164:167], a[48:63]
    ds_read_b64_tr_b16 a[224:225], v20 offset:24576
    v_exp_f32 v133, v133
    v_add_f32 v56, v56, v132
    v_mfma_f32_32x32x16_bf16 a[80:95], a[232:235], v[164:167], a[80:95]
    ds_read_b64_tr_b16 a[226:227], v21 offset:24576
    v_exp_f32 v134, v134
    v_add_f32 v57, v57, v133
    v_cvt_pk_bf16_f32 v160, v132, v133
    v_mfma_f32_32x32x16_bf16 a[112:127], a[236:239], v[164:167], a[112:127]
    ds_read_b64_tr_b16 a[228:229], v22 offset:24576
    v_exp_f32 v135, v135
    v_add_f32 v56, v56, v134
    v_mfma_f32_32x32x16_bf16 a[16:31], a[240:243], v[168:171], a[16:31]
    ds_read_b64_tr_b16 a[230:231], v23 offset:24576
    v_exp_f32 v136, v136
    v_add_f32 v57, v57, v135
    v_cvt_pk_bf16_f32 v161, v134, v135
    s_add_u32 m0, s49, 16384
    s_add_u32 s62, s50, 114688
    v_mfma_f32_32x32x16_bf16 a[48:63], a[244:247], v[168:171], a[48:63]
    buffer_load_dwordx4 v32, s[20:23], s62 offen offset:0 lds
    v_exp_f32 v137, v137
    v_add_f32 v56, v56, v136
    v_mfma_f32_32x32x16_bf16 a[80:95], a[248:251], v[168:171], a[80:95]
    v_exp_f32 v138, v138
    v_add_f32 v57, v57, v137
    v_cvt_pk_bf16_f32 v162, v136, v137
    v_mfma_f32_32x32x16_bf16 a[112:127], a[252:255], v[168:171], a[112:127]
    buffer_load_dwordx4 v33, s[20:23], s62 offen offset:1024 lds
    v_exp_f32 v139, v139
    v_add_f32 v56, v56, v138
    v_add_f32 v57, v57, v139
    v_cvt_pk_bf16_f32 v163, v138, v139
    s_waitcnt lgkmcnt(4)
    v_mfma_f32_32x32x16_bf16 v[124:139], a[128:131], v[92:95], v[172:187]
    ds_read_b64_tr_b16 a[232:233], v24 offset:24576
    v_exp_f32 v140, v140
    v_mfma_f32_32x32x16_bf16 v[124:139], a[132:135], v[96:99], v[124:139]
    ds_read_b64_tr_b16 a[234:235], v25 offset:24576
    v_exp_f32 v141, v141
    v_add_f32 v58, v58, v140
    s_add_u32 s92, s4, 3
    v_mfma_f32_32x32x16_bf16 v[124:139], a[136:139], v[100:103], v[124:139]
    ds_read_b64_tr_b16 a[236:237], v26 offset:24576
    v_exp_f32 v142, v142
    v_add_f32 v59, v59, v141
    v_cvt_pk_bf16_f32 v164, v140, v141
    s_sub_u32 s65, s92, 6
    v_mfma_f32_32x32x16_bf16 v[124:139], a[140:143], v[104:107], v[124:139]
    ds_read_b64_tr_b16 a[238:239], v27 offset:24576
    v_exp_f32 v143, v143
    v_add_f32 v58, v58, v142
    s_min_u32 s92, s92, s65
    v_mfma_f32_32x32x16_bf16 v[124:139], a[144:147], v[108:111], v[124:139]
    ds_read_b64_tr_b16 a[240:241], v20 offset:28672
    v_exp_f32 v144, v144
    v_add_f32 v59, v59, v143
    v_cvt_pk_bf16_f32 v165, v142, v143
    s_sub_u32 s65, s92, 6
    v_mfma_f32_32x32x16_bf16 v[124:139], a[148:151], v[112:115], v[124:139]
    ds_read_b64_tr_b16 a[242:243], v21 offset:28672
    v_exp_f32 v145, v145
    v_add_f32 v58, v58, v144
    s_min_u32 s92, s92, s65
    v_mfma_f32_32x32x16_bf16 v[124:139], a[152:155], v[116:119], v[124:139]
    ds_read_b64_tr_b16 a[244:245], v22 offset:28672
    v_exp_f32 v146, v146
    v_add_f32 v59, v59, v145
    v_cvt_pk_bf16_f32 v166, v144, v145
    s_mul_i32 s92, s92, 360448
    v_mfma_f32_32x32x16_bf16 v[124:139], a[156:159], v[120:123], v[124:139]
    ds_read_b64_tr_b16 a[246:247], v23 offset:28672
    v_exp_f32 v147, v147
    v_add_f32 v58, v58, v146
    s_add_u32 s92, s92, s96
    v_mfma_f32_32x32x16_bf16 a[0:15], a[192:195], v[156:159], a[0:15]
    ds_read_b64_tr_b16 a[248:249], v24 offset:28672
    v_exp_f32 v148, v148
    v_add_f32 v59, v59, v147
    v_cvt_pk_bf16_f32 v167, v146, v147
    v_mfma_f32_32x32x16_bf16 a[32:47], a[196:199], v[156:159], a[32:47]
    ds_read_b64_tr_b16 a[250:251], v25 offset:28672
    v_exp_f32 v149, v149
    v_add_f32 v58, v58, v148
    v_mfma_f32_32x32x16_bf16 a[64:79], a[200:203], v[156:159], a[64:79]
    ds_read_b64_tr_b16 a[252:253], v26 offset:28672
    v_exp_f32 v150, v150
    v_add_f32 v59, v59, v149
    v_cvt_pk_bf16_f32 v168, v148, v149
    v_mfma_f32_32x32x16_bf16 a[96:111], a[204:207], v[156:159], a[96:111]
    ds_read_b64_tr_b16 a[254:255], v27 offset:28672
    v_exp_f32 v151, v151
    v_add_f32 v58, v58, v150
    v_mfma_f32_32x32x16_bf16 a[0:15], a[208:211], v[160:163], a[0:15]
    buffer_load_dwordx4 v34, s[20:23], s62 offen offset:2048 lds
    v_exp_f32 v152, v152
    v_add_f32 v59, v59, v151
    v_cvt_pk_bf16_f32 v169, v150, v151
    v_mfma_f32_32x32x16_bf16 a[32:47], a[212:215], v[160:163], a[32:47]
    v_exp_f32 v153, v153
    v_add_f32 v58, v58, v152
    v_mfma_f32_32x32x16_bf16 a[64:79], a[216:219], v[160:163], a[64:79]
    buffer_load_dwordx4 v35, s[20:23], s62 offen offset:3072 lds
    v_exp_f32 v154, v154
    v_add_f32 v59, v59, v153
    v_cvt_pk_bf16_f32 v170, v152, v153
    v_mfma_f32_32x32x16_bf16 a[96:111], a[220:223], v[160:163], a[96:111]
    buffer_load_dword v251, v252, s[8:11], s92 offen
    v_exp_f32 v155, v155
    v_add_f32 v58, v58, v154
    v_add_f32 v59, v59, v155
    v_cvt_pk_bf16_f32 v171, v154, v155
    s_waitcnt vmcnt(11) lgkmcnt(0)
    v_mfma_f32_32x32x16_bf16 v[140:155], a[128:131], v[60:63], v[188:203]
    s_barrier
    v_mfma_f32_32x32x16_bf16 v[140:155], a[132:135], v[64:67], v[140:155]
    ds_read_b128 a[160:163], v48 offset:32768
    v_exp_f32 v124, v124
    v_exp_f32 v125, v125
    v_add_f32 v56, v56, v124
    v_mfma_f32_32x32x16_bf16 v[140:155], a[136:139], v[68:71], v[140:155]
    ds_read_b128 a[164:167], v49 offset:32768
    v_exp_f32 v126, v126
    v_add_f32 v57, v57, v125
    v_cvt_pk_bf16_f32 v156, v124, v125
    v_mfma_f32_32x32x16_bf16 v[140:155], a[140:143], v[72:75], v[140:155]
    ds_read_b128 a[168:171], v50 offset:32768
    v_exp_f32 v127, v127
    v_add_f32 v56, v56, v126
    v_mfma_f32_32x32x16_bf16 v[140:155], a[144:147], v[76:79], v[140:155]
    ds_read_b128 a[172:175], v51 offset:32768
    v_exp_f32 v128, v128
    v_add_f32 v57, v57, v127
    v_cvt_pk_bf16_f32 v157, v126, v127
    s_add_u32 m0, s89, 40960
    s_add_u32 s62, s88, 0
    v_mfma_f32_32x32x16_bf16 v[140:155], a[148:151], v[80:83], v[140:155]
    ds_read_b128 a[176:179], v52 offset:32768
    buffer_load_dwordx4 v227, s[24:27], s62 offen offset:0 lds
    v_exp_f32 v129, v129
    v_add_f32 v56, v56, v128
    v_mfma_f32_32x32x16_bf16 v[140:155], a[152:155], v[84:87], v[140:155]
    ds_read_b128 a[180:183], v53 offset:32768
    v_exp_f32 v130, v130
    v_add_f32 v57, v57, v129
    v_cvt_pk_bf16_f32 v158, v128, v129
    v_mfma_f32_32x32x16_bf16 v[140:155], a[156:159], v[88:91], v[140:155]
    ds_read_b128 a[184:187], v54 offset:32768
    v_exp_f32 v131, v131
    v_add_f32 v56, v56, v130
    v_mfma_f32_32x32x16_bf16 a[16:31], a[192:195], v[164:167], a[16:31]
    ds_read_b128 a[188:191], v55 offset:32768
    v_exp_f32 v132, v132
    v_add_f32 v57, v57, v131
    v_cvt_pk_bf16_f32 v159, v130, v131
    v_mfma_f32_32x32x16_bf16 a[48:63], a[196:199], v[164:167], a[48:63]
    ds_read_b64_tr_b16 a[192:193], v20 offset:49152
    v_exp_f32 v133, v133
    v_add_f32 v56, v56, v132
    v_mfma_f32_32x32x16_bf16 a[80:95], a[200:203], v[164:167], a[80:95]
    ds_read_b64_tr_b16 a[194:195], v21 offset:49152
    v_exp_f32 v134, v134
    v_add_f32 v57, v57, v133
    v_cvt_pk_bf16_f32 v160, v132, v133
    v_mfma_f32_32x32x16_bf16 a[112:127], a[204:207], v[164:167], a[112:127]
    ds_read_b64_tr_b16 a[196:197], v22 offset:49152
    v_exp_f32 v135, v135
    v_add_f32 v56, v56, v134
    v_mfma_f32_32x32x16_bf16 a[16:31], a[208:211], v[168:171], a[16:31]
    ds_read_b64_tr_b16 a[198:199], v23 offset:49152
    v_exp_f32 v136, v136
    v_add_f32 v57, v57, v135
    v_cvt_pk_bf16_f32 v161, v134, v135
    v_mfma_f32_32x32x16_bf16 a[48:63], a[212:215], v[168:171], a[48:63]
    buffer_load_dwordx4 v228, s[24:27], s62 offen offset:1024 lds
    v_exp_f32 v137, v137
    v_add_f32 v56, v56, v136
    v_mfma_f32_32x32x16_bf16 a[80:95], a[216:219], v[168:171], a[80:95]
    v_exp_f32 v138, v138
    v_add_f32 v57, v57, v137
    v_cvt_pk_bf16_f32 v162, v136, v137
    v_mfma_f32_32x32x16_bf16 a[112:127], a[220:223], v[168:171], a[112:127]
    buffer_load_dwordx4 v229, s[24:27], s62 offen offset:2048 lds
    v_exp_f32 v139, v139
    v_add_f32 v56, v56, v138
    v_add_f32 v57, v57, v139
    v_cvt_pk_bf16_f32 v163, v138, v139
    s_waitcnt lgkmcnt(4)
    v_mfma_f32_32x32x16_bf16 v[124:139], a[160:163], v[92:95], v[172:187]
    ds_read_b64_tr_b16 a[200:201], v24 offset:49152
    v_exp_f32 v140, v140
    v_mfma_f32_32x32x16_bf16 v[124:139], a[164:167], v[96:99], v[124:139]
    ds_read_b64_tr_b16 a[202:203], v25 offset:49152
    v_exp_f32 v141, v141
    v_add_f32 v58, v58, v140
    s_add_u32 s92, s4, 4
    v_mfma_f32_32x32x16_bf16 v[124:139], a[168:171], v[100:103], v[124:139]
    ds_read_b64_tr_b16 a[204:205], v26 offset:49152
    v_exp_f32 v142, v142
    v_add_f32 v59, v59, v141
    v_cvt_pk_bf16_f32 v164, v140, v141
    s_sub_u32 s65, s92, 6
    v_mfma_f32_32x32x16_bf16 v[124:139], a[172:175], v[104:107], v[124:139]
    ds_read_b64_tr_b16 a[206:207], v27 offset:49152
    v_exp_f32 v143, v143
    v_add_f32 v58, v58, v142
    s_min_u32 s92, s92, s65
    v_mfma_f32_32x32x16_bf16 v[124:139], a[176:179], v[108:111], v[124:139]
    ds_read_b64_tr_b16 a[208:209], v20 offset:53248
    v_exp_f32 v144, v144
    v_add_f32 v59, v59, v143
    v_cvt_pk_bf16_f32 v165, v142, v143
    s_sub_u32 s65, s92, 6
    v_mfma_f32_32x32x16_bf16 v[124:139], a[180:183], v[112:115], v[124:139]
    ds_read_b64_tr_b16 a[210:211], v21 offset:53248
    buffer_load_dwordx4 v230, s[24:27], s62 offen offset:3072 lds
    v_exp_f32 v145, v145
    v_add_f32 v58, v58, v144
    s_min_u32 s92, s92, s65
    v_mfma_f32_32x32x16_bf16 v[124:139], a[184:187], v[116:119], v[124:139]
    ds_read_b64_tr_b16 a[212:213], v22 offset:53248
    v_exp_f32 v146, v146
    v_add_f32 v59, v59, v145
    v_cvt_pk_bf16_f32 v166, v144, v145
    s_mul_i32 s92, s92, 360448
    v_mfma_f32_32x32x16_bf16 v[124:139], a[188:191], v[120:123], v[124:139]
    ds_read_b64_tr_b16 a[214:215], v23 offset:53248
    v_exp_f32 v147, v147
    v_add_f32 v58, v58, v146
    s_add_u32 s92, s92, s96
    v_mfma_f32_32x32x16_bf16 a[0:15], a[224:227], v[156:159], a[0:15]
    ds_read_b64_tr_b16 a[216:217], v24 offset:53248
    v_exp_f32 v148, v148
    v_add_f32 v59, v59, v147
    v_cvt_pk_bf16_f32 v167, v146, v147
    v_mfma_f32_32x32x16_bf16 a[32:47], a[228:231], v[156:159], a[32:47]
    ds_read_b64_tr_b16 a[218:219], v25 offset:53248
    v_exp_f32 v149, v149
    v_add_f32 v58, v58, v148
    v_mfma_f32_32x32x16_bf16 a[64:79], a[232:235], v[156:159], a[64:79]
    ds_read_b64_tr_b16 a[220:221], v26 offset:53248
    v_exp_f32 v150, v150
    v_add_f32 v59, v59, v149
    v_cvt_pk_bf16_f32 v168, v148, v149
    v_mfma_f32_32x32x16_bf16 a[96:111], a[236:239], v[156:159], a[96:111]
    ds_read_b64_tr_b16 a[222:223], v27 offset:53248
    v_exp_f32 v151, v151
    v_add_f32 v58, v58, v150
    s_add_u32 m0, s89, 45056
    v_mfma_f32_32x32x16_bf16 a[0:15], a[240:243], v[160:163], a[0:15]
    buffer_load_dwordx4 v231, s[24:27], s62 offen offset:0 lds
    v_exp_f32 v152, v152
    v_add_f32 v59, v59, v151
    v_cvt_pk_bf16_f32 v169, v150, v151
    v_mfma_f32_32x32x16_bf16 a[32:47], a[244:247], v[160:163], a[32:47]
    v_exp_f32 v153, v153
    v_add_f32 v58, v58, v152
    v_mfma_f32_32x32x16_bf16 a[64:79], a[248:251], v[160:163], a[64:79]
    v_exp_f32 v154, v154
    v_add_f32 v59, v59, v153
    v_cvt_pk_bf16_f32 v170, v152, v153
    v_mfma_f32_32x32x16_bf16 a[96:111], a[252:255], v[160:163], a[96:111]
    buffer_load_dword v251, v252, s[8:11], s92 offen
    v_exp_f32 v155, v155
    v_add_f32 v58, v58, v154
    v_add_f32 v59, v59, v155
    v_cvt_pk_bf16_f32 v171, v154, v155
    v_mfma_f32_32x32x16_bf16 v[140:155], a[160:163], v[60:63], v[188:203]
    v_exp_f32 v124, v124
    v_mfma_f32_32x32x16_bf16 v[140:155], a[164:167], v[64:67], v[140:155]
    ds_read_b128 a[128:131], v48 offset:40960
    v_exp_f32 v125, v125
    v_add_f32 v56, v56, v124
    v_mfma_f32_32x32x16_bf16 v[140:155], a[168:171], v[68:71], v[140:155]
    ds_read_b128 a[132:135], v49 offset:40960
    v_exp_f32 v126, v126
    v_add_f32 v57, v57, v125
    v_cvt_pk_bf16_f32 v156, v124, v125
    v_mfma_f32_32x32x16_bf16 v[140:155], a[172:175], v[72:75], v[140:155]
    ds_read_b128 a[136:139], v50 offset:40960
    v_min_u32 v252, 15, v1
    v_exp_f32 v127, v127
    v_add_f32 v56, v56, v126
    s_lshr_b32 s92, s59, 2
    v_mfma_f32_32x32x16_bf16 v[140:155], a[176:179], v[76:79], v[140:155]
    ds_read_b128 a[140:143], v51 offset:40960
    v_exp_f32 v128, v128
    v_add_f32 v57, v57, v127
    v_cvt_pk_bf16_f32 v157, v126, v127
    s_lshl_b32 s92, s92, 11
    s_add_u32 m0, s89, 61440
    s_add_u32 s62, s88, 163840
    v_mfma_f32_32x32x16_bf16 v[140:155], a[180:183], v[80:83], v[140:155]
    ds_read_b128 a[144:147], v52 offset:40960
    buffer_load_dwordx4 v227, s[24:27], s62 offen offset:0 lds
    v_lshlrev_b32 v252, 7, v252
    v_exp_f32 v129, v129
    v_add_f32 v56, v56, v128
    s_add_u32 s92, s92, 262144
    v_mfma_f32_32x32x16_bf16 v[140:155], a[184:187], v[84:87], v[140:155]
    ds_read_b128 a[148:151], v53 offset:40960
    v_exp_f32 v130, v130
    v_add_f32 v57, v57, v129
    v_cvt_pk_bf16_f32 v158, v128, v129
    v_mfma_f32_32x32x16_bf16 v[140:155], a[188:191], v[88:91], v[140:155]
    ds_read_b128 a[152:155], v54 offset:40960
    v_exp_f32 v131, v131
    v_add_f32 v56, v56, v130
    v_mfma_f32_32x32x16_bf16 a[16:31], a[224:227], v[164:167], a[16:31]
    ds_read_b128 a[156:159], v55 offset:40960
    v_exp_f32 v132, v132
    v_add_f32 v57, v57, v131
    v_cvt_pk_bf16_f32 v159, v130, v131
    v_mfma_f32_32x32x16_bf16 a[48:63], a[228:231], v[164:167], a[48:63]
    ds_read_b64_tr_b16 a[224:225], v20 offset:57344
    v_exp_f32 v133, v133
    v_add_f32 v56, v56, v132
    v_mfma_f32_32x32x16_bf16 a[80:95], a[232:235], v[164:167], a[80:95]
    ds_read_b64_tr_b16 a[226:227], v21 offset:57344
    v_exp_f32 v134, v134
    v_add_f32 v57, v57, v133
    v_cvt_pk_bf16_f32 v160, v132, v133
    v_mfma_f32_32x32x16_bf16 a[112:127], a[236:239], v[164:167], a[112:127]
    ds_read_b64_tr_b16 a[228:229], v22 offset:57344
    v_exp_f32 v135, v135
    v_add_f32 v56, v56, v134
    v_mfma_f32_32x32x16_bf16 a[16:31], a[240:243], v[168:171], a[16:31]
    ds_read_b64_tr_b16 a[230:231], v23 offset:57344
    v_exp_f32 v136, v136
    v_add_f32 v57, v57, v135
    v_cvt_pk_bf16_f32 v161, v134, v135
    v_mfma_f32_32x32x16_bf16 a[48:63], a[244:247], v[168:171], a[48:63]
    buffer_load_dwordx4 v228, s[24:27], s62 offen offset:1024 lds
    v_exp_f32 v137, v137
    v_add_f32 v56, v56, v136
    v_mfma_f32_32x32x16_bf16 a[80:95], a[248:251], v[168:171], a[80:95]
    buffer_load_dword v251, v252, s[8:11], s92 offen
    v_exp_f32 v138, v138
    v_add_f32 v57, v57, v137
    v_cvt_pk_bf16_f32 v162, v136, v137
    v_mfma_f32_32x32x16_bf16 a[112:127], a[252:255], v[168:171], a[112:127]
    buffer_load_dwordx4 v229, s[24:27], s62 offen offset:2048 lds
    v_exp_f32 v139, v139
    v_add_f32 v56, v56, v138
    v_add_f32 v57, v57, v139
    v_cvt_pk_bf16_f32 v163, v138, v139
    s_waitcnt lgkmcnt(4)
    v_mfma_f32_32x32x16_bf16 v[124:139], a[128:131], v[92:95], v[172:187]
    ds_read_b64_tr_b16 a[232:233], v24 offset:57344
    v_exp_f32 v140, v140
    v_mfma_f32_32x32x16_bf16 v[124:139], a[132:135], v[96:99], v[124:139]
    ds_read_b64_tr_b16 a[234:235], v25 offset:57344
    v_min_u32 v252, 21, v1
    v_exp_f32 v141, v141
    v_add_f32 v58, v58, v140
    s_add_u32 s92, s4, 5
    v_mfma_f32_32x32x16_bf16 v[124:139], a[136:139], v[100:103], v[124:139]
    ds_read_b64_tr_b16 a[236:237], v26 offset:57344
    v_exp_f32 v142, v142
    v_add_f32 v59, v59, v141
    v_cvt_pk_bf16_f32 v164, v140, v141
    s_sub_u32 s65, s92, 6
    v_mfma_f32_32x32x16_bf16 v[124:139], a[140:143], v[104:107], v[124:139]
    ds_read_b64_tr_b16 a[238:239], v27 offset:57344
    v_lshlrev_b32 v252, 7, v252
    v_exp_f32 v143, v143
    v_add_f32 v58, v58, v142
    s_min_u32 s92, s92, s65
    v_mfma_f32_32x32x16_bf16 v[124:139], a[144:147], v[108:111], v[124:139]
    ds_read_b64_tr_b16 a[240:241], v20 offset:61440
    v_exp_f32 v144, v144
    v_add_f32 v59, v59, v143
    v_cvt_pk_bf16_f32 v165, v142, v143
    s_sub_u32 s65, s92, 6
    v_mfma_f32_32x32x16_bf16 v[124:139], a[148:151], v[112:115], v[124:139]
    ds_read_b64_tr_b16 a[242:243], v21 offset:61440
    buffer_load_dwordx4 v230, s[24:27], s62 offen offset:3072 lds
    v_exp_f32 v145, v145
    v_add_f32 v58, v58, v144
    s_min_u32 s92, s92, s65
    v_mfma_f32_32x32x16_bf16 v[124:139], a[152:155], v[116:119], v[124:139]
    ds_read_b64_tr_b16 a[244:245], v22 offset:61440
    v_exp_f32 v146, v146
    v_add_f32 v59, v59, v145
    v_cvt_pk_bf16_f32 v166, v144, v145
    s_mul_i32 s92, s92, 360448
    v_mfma_f32_32x32x16_bf16 v[124:139], a[156:159], v[120:123], v[124:139]
    ds_read_b64_tr_b16 a[246:247], v23 offset:61440
    v_exp_f32 v147, v147
    v_add_f32 v58, v58, v146
    s_add_u32 s92, s92, s96
    v_mfma_f32_32x32x16_bf16 a[0:15], a[192:195], v[156:159], a[0:15]
    ds_read_b64_tr_b16 a[248:249], v24 offset:61440
    v_exp_f32 v148, v148
    v_add_f32 v59, v59, v147
    v_cvt_pk_bf16_f32 v167, v146, v147
    v_mfma_f32_32x32x16_bf16 a[32:47], a[196:199], v[156:159], a[32:47]
    ds_read_b64_tr_b16 a[250:251], v25 offset:61440
    v_exp_f32 v149, v149
    v_add_f32 v58, v58, v148
    v_mfma_f32_32x32x16_bf16 a[64:79], a[200:203], v[156:159], a[64:79]
    ds_read_b64_tr_b16 a[252:253], v26 offset:61440
    v_exp_f32 v150, v150
    v_add_f32 v59, v59, v149
    v_cvt_pk_bf16_f32 v168, v148, v149
    v_mfma_f32_32x32x16_bf16 a[96:111], a[204:207], v[156:159], a[96:111]
    ds_read_b64_tr_b16 a[254:255], v27 offset:61440
    v_exp_f32 v151, v151
    v_add_f32 v58, v58, v150
    s_add_u32 m0, s89, 65536
    v_mfma_f32_32x32x16_bf16 a[0:15], a[208:211], v[160:163], a[0:15]
    buffer_load_dwordx4 v231, s[24:27], s62 offen offset:0 lds
    v_exp_f32 v152, v152
    v_add_f32 v59, v59, v151
    v_cvt_pk_bf16_f32 v169, v150, v151
    v_mfma_f32_32x32x16_bf16 a[32:47], a[212:215], v[160:163], a[32:47]
    v_exp_f32 v153, v153
    v_add_f32 v58, v58, v152
    v_mfma_f32_32x32x16_bf16 a[64:79], a[216:219], v[160:163], a[64:79]
    v_exp_f32 v154, v154
    v_add_f32 v59, v59, v153
    v_cvt_pk_bf16_f32 v170, v152, v153
    v_mfma_f32_32x32x16_bf16 a[96:111], a[220:223], v[160:163], a[96:111]
    buffer_load_dword v251, v252, s[8:11], s92 offen
    v_exp_f32 v155, v155
    v_add_f32 v58, v58, v154
    v_add_f32 v59, v59, v155
    v_cvt_pk_bf16_f32 v171, v154, v155
    s_waitcnt vmcnt(14) lgkmcnt(0)
    v_mfma_f32_32x32x16_bf16 v[140:155], a[128:131], v[60:63], v[188:203]
    s_barrier
    v_mfma_f32_32x32x16_bf16 v[140:155], a[132:135], v[64:67], v[140:155]
    ds_read_b128 a[160:163], v40 offset:0
    v_exp_f32 v124, v124
    v_exp_f32 v125, v125
    v_add_f32 v56, v56, v124
    v_mfma_f32_32x32x16_bf16 v[140:155], a[136:139], v[68:71], v[140:155]
    ds_read_b128 a[164:167], v41 offset:0
    v_exp_f32 v126, v126
    v_add_f32 v57, v57, v125
    v_cvt_pk_bf16_f32 v156, v124, v125
    v_mfma_f32_32x32x16_bf16 v[140:155], a[140:143], v[72:75], v[140:155]
    ds_read_b128 a[168:171], v42 offset:0
    v_min_u32 v252, 26, v1
    v_exp_f32 v127, v127
    v_add_f32 v56, v56, v126
    s_lshl_b32 s92, s5, 2
    v_mfma_f32_32x32x16_bf16 v[140:155], a[144:147], v[76:79], v[140:155]
    ds_read_b128 a[172:175], v43 offset:0
    v_exp_f32 v128, v128
    v_add_f32 v57, v57, v127
    v_cvt_pk_bf16_f32 v157, v126, v127
    s_add_u32 s92, s92, s3
    s_add_u32 m0, s89, 81920
    s_add_u32 s62, s88, 327680
    v_mfma_f32_32x32x16_bf16 v[140:155], a[148:151], v[80:83], v[140:155]
    ds_read_b128 a[176:179], v44 offset:0
    buffer_load_dwordx4 v227, s[24:27], s62 offen offset:0 lds
    v_lshlrev_b32 v252, 7, v252
    v_exp_f32 v129, v129
    v_add_f32 v56, v56, v128
    s_mul_i32 s92, s92, 3456
    v_mfma_f32_32x32x16_bf16 v[140:155], a[152:155], v[84:87], v[140:155]
    ds_read_b128 a[180:183], v45 offset:0
    v_exp_f32 v130, v130
    v_add_f32 v57, v57, v129
    v_cvt_pk_bf16_f32 v158, v128, v129
    s_add_u32 s92, s92, 442368
    v_mfma_f32_32x32x16_bf16 v[140:155], a[156:159], v[88:91], v[140:155]
    ds_read_b128 a[184:187], v46 offset:0
    v_exp_f32 v131, v131
    v_add_f32 v56, v56, v130
    v_mfma_f32_32x32x16_bf16 a[16:31], a[192:195], v[164:167], a[16:31]
    ds_read_b128 a[188:191], v47 offset:0
    v_exp_f32 v132, v132
    v_add_f32 v57, v57, v131
    v_cvt_pk_bf16_f32 v159, v130, v131
    v_mfma_f32_32x32x16_bf16 a[48:63], a[196:199], v[164:167], a[48:63]
    ds_read_b64_tr_b16 a[192:193], v12 offset:16384
    v_exp_f32 v133, v133
    v_add_f32 v56, v56, v132
    v_mfma_f32_32x32x16_bf16 a[80:95], a[200:203], v[164:167], a[80:95]
    ds_read_b64_tr_b16 a[194:195], v13 offset:16384
    v_exp_f32 v134, v134
    v_add_f32 v57, v57, v133
    v_cvt_pk_bf16_f32 v160, v132, v133
    v_mfma_f32_32x32x16_bf16 a[112:127], a[204:207], v[164:167], a[112:127]
    ds_read_b64_tr_b16 a[196:197], v14 offset:16384
    v_exp_f32 v135, v135
    v_add_f32 v56, v56, v134
    v_mfma_f32_32x32x16_bf16 a[16:31], a[208:211], v[168:171], a[16:31]
    ds_read_b64_tr_b16 a[198:199], v15 offset:16384
    v_exp_f32 v136, v136
    v_add_f32 v57, v57, v135
    v_cvt_pk_bf16_f32 v161, v134, v135
    v_mfma_f32_32x32x16_bf16 a[48:63], a[212:215], v[168:171], a[48:63]
    buffer_load_dwordx4 v228, s[24:27], s62 offen offset:1024 lds
    v_exp_f32 v137, v137
    v_add_f32 v56, v56, v136
    v_mfma_f32_32x32x16_bf16 a[80:95], a[216:219], v[168:171], a[80:95]
    buffer_load_dword v251, v252, s[28:31], s92 offen
    v_exp_f32 v138, v138
    v_add_f32 v57, v57, v137
    v_cvt_pk_bf16_f32 v162, v136, v137
    v_mfma_f32_32x32x16_bf16 a[112:127], a[220:223], v[168:171], a[112:127]
    buffer_load_dwordx4 v229, s[24:27], s62 offen offset:2048 lds
    v_exp_f32 v139, v139
    v_add_f32 v56, v56, v138
    v_add_f32 v57, v57, v139
    v_cvt_pk_bf16_f32 v163, v138, v139
    s_waitcnt lgkmcnt(4)
    v_mfma_f32_32x32x16_bf16 v[124:139], a[160:163], v[92:95], v[172:187]
    ds_read_b64_tr_b16 a[200:201], v16 offset:16384
    v_exp_f32 v140, v140
    v_mfma_f32_32x32x16_bf16 v[124:139], a[164:167], v[96:99], v[124:139]
    ds_read_b64_tr_b16 a[202:203], v17 offset:16384
    v_min_u32 v252, 19, v1
    v_exp_f32 v141, v141
    v_add_f32 v58, v58, v140
    s_lshr_b32 s92, s59, 2
    v_mfma_f32_32x32x16_bf16 v[124:139], a[168:171], v[100:103], v[124:139]
    ds_read_b64_tr_b16 a[204:205], v18 offset:16384
    v_exp_f32 v142, v142
    v_add_f32 v59, v59, v141
    v_cvt_pk_bf16_f32 v164, v140, v141
    s_lshl_b32 s92, s92, 2
    v_mfma_f32_32x32x16_bf16 v[124:139], a[172:175], v[104:107], v[124:139]
    ds_read_b64_tr_b16 a[206:207], v19 offset:16384
    v_lshlrev_b32 v252, 9, v252
    v_exp_f32 v143, v143
    v_add_f32 v58, v58, v142
    s_add_u32 s92, s92, s3
    v_mfma_f32_32x32x16_bf16 v[124:139], a[176:179], v[108:111], v[124:139]
    ds_read_b64_tr_b16 a[208:209], v12 offset:20480
    v_exp_f32 v144, v144
    v_add_f32 v59, v59, v143
    v_cvt_pk_bf16_f32 v165, v142, v143
    s_mul_i32 s92, s92, 10240
    v_mfma_f32_32x32x16_bf16 v[124:139], a[180:183], v[112:115], v[124:139]
    ds_read_b64_tr_b16 a[210:211], v13 offset:20480
    buffer_load_dwordx4 v230, s[24:27], s62 offen offset:3072 lds
    v_exp_f32 v145, v145
    v_add_f32 v58, v58, v144
    s_and_b32 s65, s5, 3
    v_mfma_f32_32x32x16_bf16 v[124:139], a[184:187], v[116:119], v[124:139]
    ds_read_b64_tr_b16 a[212:213], v14 offset:20480
    v_exp_f32 v146, v146
    v_add_f32 v59, v59, v145
    v_cvt_pk_bf16_f32 v166, v144, v145
    s_lshl_b32 s65, s65, 7
    v_mfma_f32_32x32x16_bf16 v[124:139], a[188:191], v[120:123], v[124:139]
    ds_read_b64_tr_b16 a[214:215], v15 offset:20480
    v_exp_f32 v147, v147
    v_add_f32 v58, v58, v146
    s_add_u32 s92, s92, s65
    v_mfma_f32_32x32x16_bf16 a[0:15], a[224:227], v[156:159], a[0:15]
    ds_read_b64_tr_b16 a[216:217], v16 offset:20480
    v_exp_f32 v148, v148
    v_add_f32 v59, v59, v147
    v_cvt_pk_bf16_f32 v167, v146, v147
    s_add_u32 s92, s92, 1048576
    v_mfma_f32_32x32x16_bf16 a[32:47], a[228:231], v[156:159], a[32:47]
    ds_read_b64_tr_b16 a[218:219], v17 offset:20480
    v_exp_f32 v149, v149
    v_add_f32 v58, v58, v148
    v_mfma_f32_32x32x16_bf16 a[64:79], a[232:235], v[156:159], a[64:79]
    ds_read_b64_tr_b16 a[220:221], v18 offset:20480
    v_exp_f32 v150, v150
    v_add_f32 v59, v59, v149
    v_cvt_pk_bf16_f32 v168, v148, v149
    v_mfma_f32_32x32x16_bf16 a[96:111], a[236:239], v[156:159], a[96:111]
    ds_read_b64_tr_b16 a[222:223], v19 offset:20480
    v_exp_f32 v151, v151
    v_add_f32 v58, v58, v150
    s_add_u32 m0, s89, 86016
    v_mfma_f32_32x32x16_bf16 a[0:15], a[240:243], v[160:163], a[0:15]
    buffer_load_dwordx4 v231, s[24:27], s62 offen offset:0 lds
    v_exp_f32 v152, v152
    v_add_f32 v59, v59, v151
    v_cvt_pk_bf16_f32 v169, v150, v151
    v_mfma_f32_32x32x16_bf16 a[32:47], a[244:247], v[160:163], a[32:47]
    v_exp_f32 v153, v153
    v_add_f32 v58, v58, v152
    v_mfma_f32_32x32x16_bf16 a[64:79], a[248:251], v[160:163], a[64:79]
    v_exp_f32 v154, v154
    v_add_f32 v59, v59, v153
    v_cvt_pk_bf16_f32 v170, v152, v153
    v_mfma_f32_32x32x16_bf16 a[96:111], a[252:255], v[160:163], a[96:111]
    buffer_load_dword v251, v252, s[8:11], s92 offen
    v_exp_f32 v155, v155
    v_add_f32 v58, v58, v154
    v_add_f32 v59, v59, v155
    v_cvt_pk_bf16_f32 v171, v154, v155
    v_mfma_f32_32x32x16_bf16 v[140:155], a[160:163], v[60:63], v[188:203]
    v_exp_f32 v124, v124
    v_mfma_f32_32x32x16_bf16 v[140:155], a[164:167], v[64:67], v[140:155]
    ds_read_b128 a[128:131], v40 offset:8192
    v_exp_f32 v125, v125
    v_add_f32 v56, v56, v124
    v_mfma_f32_32x32x16_bf16 v[140:155], a[168:171], v[68:71], v[140:155]
    ds_read_b128 a[132:135], v41 offset:8192
    v_exp_f32 v126, v126
    v_add_f32 v57, v57, v125
    v_cvt_pk_bf16_f32 v156, v124, v125
    v_mfma_f32_32x32x16_bf16 v[140:155], a[172:175], v[72:75], v[140:155]
    ds_read_b128 a[136:139], v42 offset:8192
    v_min_u32 v252, 26, v1
    v_exp_f32 v127, v127
    v_add_f32 v56, v56, v126
    s_lshl_b32 s92, s5, 2
    v_mfma_f32_32x32x16_bf16 v[140:155], a[176:179], v[76:79], v[140:155]
    ds_read_b128 a[140:143], v43 offset:8192
    v_exp_f32 v128, v128
    v_add_f32 v57, v57, v127
    v_cvt_pk_bf16_f32 v157, v126, v127
    s_add_u32 s92, s92, s3
    s_add_u32 m0, s89, 102400
    s_add_u32 s62, s88, 491520
    v_mfma_f32_32x32x16_bf16 v[140:155], a[180:183], v[80:83], v[140:155]
    ds_read_b128 a[144:147], v44 offset:8192
    buffer_load_dwordx4 v227, s[24:27], s62 offen offset:0 lds
    v_lshlrev_b32 v252, 7, v252
    v_exp_f32 v129, v129
    v_add_f32 v56, v56, v128
    s_mul_i32 s92, s92, 3456
    v_mfma_f32_32x32x16_bf16 v[140:155], a[184:187], v[84:87], v[140:155]
    ds_read_b128 a[148:151], v45 offset:8192
    v_exp_f32 v130, v130
    v_add_f32 v57, v57, v129
    v_cvt_pk_bf16_f32 v158, v128, v129
    s_add_u32 s92, s92, 442368
    v_mfma_f32_32x32x16_bf16 v[140:155], a[188:191], v[88:91], v[140:155]
    ds_read_b128 a[152:155], v46 offset:8192
    v_exp_f32 v131, v131
    v_add_f32 v56, v56, v130
    v_mfma_f32_32x32x16_bf16 a[16:31], a[224:227], v[164:167], a[16:31]
    ds_read_b128 a[156:159], v47 offset:8192
    v_exp_f32 v132, v132
    v_add_f32 v57, v57, v131
    v_cvt_pk_bf16_f32 v159, v130, v131
    v_mfma_f32_32x32x16_bf16 a[48:63], a[228:231], v[164:167], a[48:63]
    ds_read_b64_tr_b16 a[224:225], v12 offset:24576
    v_exp_f32 v133, v133
    v_add_f32 v56, v56, v132
    v_mfma_f32_32x32x16_bf16 a[80:95], a[232:235], v[164:167], a[80:95]
    ds_read_b64_tr_b16 a[226:227], v13 offset:24576
    v_exp_f32 v134, v134
    v_add_f32 v57, v57, v133
    v_cvt_pk_bf16_f32 v160, v132, v133
    v_mfma_f32_32x32x16_bf16 a[112:127], a[236:239], v[164:167], a[112:127]
    ds_read_b64_tr_b16 a[228:229], v14 offset:24576
    v_exp_f32 v135, v135
    v_add_f32 v56, v56, v134
    v_mfma_f32_32x32x16_bf16 a[16:31], a[240:243], v[168:171], a[16:31]
    ds_read_b64_tr_b16 a[230:231], v15 offset:24576
    v_exp_f32 v136, v136
    v_add_f32 v57, v57, v135
    v_cvt_pk_bf16_f32 v161, v134, v135
    v_mfma_f32_32x32x16_bf16 a[48:63], a[244:247], v[168:171], a[48:63]
    buffer_load_dwordx4 v228, s[24:27], s62 offen offset:1024 lds
    v_exp_f32 v137, v137
    v_add_f32 v56, v56, v136
    v_mfma_f32_32x32x16_bf16 a[80:95], a[248:251], v[168:171], a[80:95]
    buffer_load_dword v251, v252, s[32:35], s92 offen
    v_exp_f32 v138, v138
    v_add_f32 v57, v57, v137
    v_cvt_pk_bf16_f32 v162, v136, v137
    v_mfma_f32_32x32x16_bf16 a[112:127], a[252:255], v[168:171], a[112:127]
    buffer_load_dwordx4 v229, s[24:27], s62 offen offset:2048 lds
    v_exp_f32 v139, v139
    v_add_f32 v56, v56, v138
    v_add_f32 v57, v57, v139
    v_cvt_pk_bf16_f32 v163, v138, v139
    s_waitcnt lgkmcnt(4)
    v_mfma_f32_32x32x16_bf16 v[124:139], a[128:131], v[92:95], v[172:187]
    ds_read_b64_tr_b16 a[232:233], v16 offset:24576
    v_exp_f32 v140, v140
    v_mfma_f32_32x32x16_bf16 v[124:139], a[132:135], v[96:99], v[124:139]
    ds_read_b64_tr_b16 a[234:235], v17 offset:24576
    v_min_u32 v252, 31, v1
    v_exp_f32 v141, v141
    v_add_f32 v58, v58, v140
    v_mfma_f32_32x32x16_bf16 v[124:139], a[136:139], v[100:103], v[124:139]
    ds_read_b64_tr_b16 a[236:237], v18 offset:24576
    v_exp_f32 v142, v142
    v_add_f32 v59, v59, v141
    v_cvt_pk_bf16_f32 v164, v140, v141
    v_mfma_f32_32x32x16_bf16 v[124:139], a[140:143], v[104:107], v[124:139]
    ds_read_b64_tr_b16 a[238:239], v19 offset:24576
    v_lshlrev_b32 v252, 7, v252
    v_exp_f32 v143, v143
    v_add_f32 v58, v58, v142
    v_mfma_f32_32x32x16_bf16 v[124:139], a[144:147], v[108:111], v[124:139]
    ds_read_b64_tr_b16 a[240:241], v12 offset:28672
    v_exp_f32 v144, v144
    v_add_f32 v59, v59, v143
    v_cvt_pk_bf16_f32 v165, v142, v143
    v_mfma_f32_32x32x16_bf16 v[124:139], a[148:151], v[112:115], v[124:139]
    ds_read_b64_tr_b16 a[242:243], v13 offset:28672
    buffer_load_dwordx4 v230, s[24:27], s62 offen offset:3072 lds
    v_exp_f32 v145, v145
    v_add_f32 v58, v58, v144
    v_mfma_f32_32x32x16_bf16 v[124:139], a[152:155], v[116:119], v[124:139]
    ds_read_b64_tr_b16 a[244:245], v14 offset:28672
    v_exp_f32 v146, v146
    v_add_f32 v59, v59, v145
    v_cvt_pk_bf16_f32 v166, v144, v145
    v_mfma_f32_32x32x16_bf16 v[124:139], a[156:159], v[120:123], v[124:139]
    ds_read_b64_tr_b16 a[246:247], v15 offset:28672
    v_exp_f32 v147, v147
    v_add_f32 v58, v58, v146
    v_mfma_f32_32x32x16_bf16 a[0:15], a[192:195], v[156:159], a[0:15]
    ds_read_b64_tr_b16 a[248:249], v16 offset:28672
    v_exp_f32 v148, v148
    v_add_f32 v59, v59, v147
    v_cvt_pk_bf16_f32 v167, v146, v147
    v_mfma_f32_32x32x16_bf16 a[32:47], a[196:199], v[156:159], a[32:47]
    ds_read_b64_tr_b16 a[250:251], v17 offset:28672
    v_exp_f32 v149, v149
    v_add_f32 v58, v58, v148
    v_mfma_f32_32x32x16_bf16 a[64:79], a[200:203], v[156:159], a[64:79]
    ds_read_b64_tr_b16 a[252:253], v18 offset:28672
    v_exp_f32 v150, v150
    v_add_f32 v59, v59, v149
    v_cvt_pk_bf16_f32 v168, v148, v149
    v_mfma_f32_32x32x16_bf16 a[96:111], a[204:207], v[156:159], a[96:111]
    ds_read_b64_tr_b16 a[254:255], v19 offset:28672
    v_exp_f32 v151, v151
    v_add_f32 v58, v58, v150
    s_add_u32 m0, s89, 106496
    v_mfma_f32_32x32x16_bf16 a[0:15], a[208:211], v[160:163], a[0:15]
    buffer_load_dwordx4 v231, s[24:27], s62 offen offset:0 lds
    v_exp_f32 v152, v152
    v_add_f32 v59, v59, v151
    v_cvt_pk_bf16_f32 v169, v150, v151
    v_mfma_f32_32x32x16_bf16 a[32:47], a[212:215], v[160:163], a[32:47]
    v_exp_f32 v153, v153
    v_add_f32 v58, v58, v152
    v_mfma_f32_32x32x16_bf16 a[64:79], a[216:219], v[160:163], a[64:79]
    v_exp_f32 v154, v154
    v_add_f32 v59, v59, v153
    v_cvt_pk_bf16_f32 v170, v152, v153
    v_mfma_f32_32x32x16_bf16 a[96:111], a[220:223], v[160:163], a[96:111]
    buffer_load_dword v251, v252, s[8:11], s48 offen
    v_exp_f32 v155, v155
    v_add_f32 v58, v58, v154
    v_add_f32 v59, v59, v155
    v_cvt_pk_bf16_f32 v171, v154, v155
    v_mfma_f32_32x32x16_bf16 v[140:155], a[128:131], v[60:63], v[188:203]
    v_exp_f32 v124, v124
    v_mfma_f32_32x32x16_bf16 v[140:155], a[132:135], v[64:67], v[140:155]
    v_exp_f32 v125, v125
    v_add_f32 v56, v56, v124
    s_add_u32 m0, s89, 122880
    s_add_u32 s62, s88, 655360
    v_mfma_f32_32x32x16_bf16 v[140:155], a[136:139], v[68:71], v[140:155]
    buffer_load_dwordx4 v227, s[24:27], s62 offen offset:0 lds
    v_exp_f32 v126, v126
    v_add_f32 v57, v57, v125
    v_cvt_pk_bf16_f32 v156, v124, v125
    v_mfma_f32_32x32x16_bf16 v[140:155], a[140:143], v[72:75], v[140:155]
    v_min_u32 v252, 3, v1
    v_exp_f32 v127, v127
    v_add_f32 v56, v56, v126
    v_mfma_f32_32x32x16_bf16 v[140:155], a[144:147], v[76:79], v[140:155]
    buffer_load_dwordx4 v228, s[24:27], s62 offen offset:1024 lds
    v_exp_f32 v128, v128
    v_add_f32 v57, v57, v127
    v_cvt_pk_bf16_f32 v157, v126, v127
    v_mfma_f32_32x32x16_bf16 v[140:155], a[148:151], v[80:83], v[140:155]
    s_lshl_b32 s92, s5, 2
    v_exp_f32 v129, v129
    v_add_f32 v56, v56, v128
    v_mfma_f32_32x32x16_bf16 v[140:155], a[152:155], v[84:87], v[140:155]
    buffer_load_dwordx4 v229, s[24:27], s62 offen offset:2048 lds
    v_exp_f32 v130, v130
    v_add_f32 v57, v57, v129
    v_cvt_pk_bf16_f32 v158, v128, v129
    v_mfma_f32_32x32x16_bf16 v[140:155], a[156:159], v[88:91], v[140:155]
    s_add_u32 s92, s92, s3
    v_exp_f32 v131, v131
    v_add_f32 v56, v56, v130
    v_mfma_f32_32x32x16_bf16 a[16:31], a[192:195], v[164:167], a[16:31]
    buffer_load_dwordx4 v230, s[24:27], s62 offen offset:3072 lds
    v_exp_f32 v132, v132
    v_add_f32 v57, v57, v131
    v_cvt_pk_bf16_f32 v159, v130, v131
    v_mfma_f32_32x32x16_bf16 a[48:63], a[196:199], v[164:167], a[48:63]
    v_lshl_add_u32 v252, s92, 2, v252
    v_exp_f32 v133, v133
    v_add_f32 v56, v56, v132
    s_add_u32 m0, s89, 126976
    v_mfma_f32_32x32x16_bf16 a[80:95], a[200:203], v[164:167], a[80:95]
    buffer_load_dwordx4 v231, s[24:27], s62 offen offset:0 lds
    v_exp_f32 v134, v134
    v_add_f32 v57, v57, v133
    v_cvt_pk_bf16_f32 v160, v132, v133
    v_mfma_f32_32x32x16_bf16 a[112:127], a[204:207], v[164:167], a[112:127]
    v_lshlrev_b32 v252, 7, v252
    v_exp_f32 v135, v135
    v_add_f32 v56, v56, v134
    v_mfma_f32_32x32x16_bf16 a[16:31], a[208:211], v[168:171], a[16:31]
    v_exp_f32 v136, v136
    v_add_f32 v57, v57, v135
    v_cvt_pk_bf16_f32 v161, v134, v135
    v_mfma_f32_32x32x16_bf16 a[48:63], a[212:215], v[168:171], a[48:63]
    v_add_u32 v252, LA_sd - adaLN_cond__sliding_block_cached__glu_gated_bilinear__prompt_kernel, v252
    v_exp_f32 v137, v137
    v_add_f32 v56, v56, v136
    v_mfma_f32_32x32x16_bf16 a[80:95], a[216:219], v[168:171], a[80:95]
    v_exp_f32 v138, v138
    v_add_f32 v57, v57, v137
    v_cvt_pk_bf16_f32 v162, v136, v137
    v_mfma_f32_32x32x16_bf16 a[112:127], a[220:223], v[168:171], a[112:127]
    v_min_u32 v252, L_end - adaLN_cond__sliding_block_cached__glu_gated_bilinear__prompt_kernel - 4, v252
    v_exp_f32 v139, v139
    v_add_f32 v56, v56, v138
    v_add_f32 v57, v57, v139
    v_cvt_pk_bf16_f32 v163, v138, v139
    s_waitcnt lgkmcnt(14)
    v_mfma_f32_32x32x16_bf16 a[0:15], a[224:227], v[156:159], a[0:15]
    global_load_dword v251, v252, s[94:95]
    v_exp_f32 v140, v140
    v_exp_f32 v141, v141
    v_add_f32 v58, v58, v140
    s_waitcnt lgkmcnt(6)
    v_mfma_f32_32x32x16_bf16 a[0:15], a[240:243], v[160:163], a[0:15]
    v_exp_f32 v142, v142
    v_add_f32 v59, v59, v141
    v_cvt_pk_bf16_f32 v164, v140, v141
    v_exp_f32 v143, v143
    v_add_f32 v58, v58, v142
    v_mfma_f32_32x32x16_bf16 a[32:47], a[228:231], v[156:159], a[32:47]
    v_exp_f32 v144, v144
    v_add_f32 v59, v59, v143
    v_cvt_pk_bf16_f32 v165, v142, v143
    v_exp_f32 v145, v145
    v_add_f32 v58, v58, v144
    s_waitcnt lgkmcnt(4)
    v_mfma_f32_32x32x16_bf16 a[32:47], a[244:247], v[160:163], a[32:47]
    v_exp_f32 v146, v146
    v_add_f32 v59, v59, v145
    v_cvt_pk_bf16_f32 v166, v144, v145
    v_exp_f32 v147, v147
    v_add_f32 v58, v58, v146
    v_mfma_f32_32x32x16_bf16 a[64:79], a[232:235], v[156:159], a[64:79]
    v_exp_f32 v148, v148
    v_add_f32 v59, v59, v147
    v_cvt_pk_bf16_f32 v167, v146, v147
    v_exp_f32 v149, v149
    v_add_f32 v58, v58, v148
    s_waitcnt lgkmcnt(2)
    v_mfma_f32_32x32x16_bf16 a[64:79], a[248:251], v[160:163], a[64:79]
    v_exp_f32 v150, v150
    v_add_f32 v59, v59, v149
    v_cvt_pk_bf16_f32 v168, v148, v149
    v_exp_f32 v151, v151
    v_add_f32 v58, v58, v150
    v_mfma_f32_32x32x16_bf16 a[96:111], a[236:239], v[156:159], a[96:111]
    v_exp_f32 v152, v152
    v_add_f32 v59, v59, v151
    v_cvt_pk_bf16_f32 v169, v150, v151
    v_exp_f32 v153, v153
    v_add_f32 v58, v58, v152
    s_waitcnt lgkmcnt(0)
    v_mfma_f32_32x32x16_bf16 a[96:111], a[252:255], v[160:163], a[96:111]
    v_exp_f32 v154, v154
    v_add_f32 v59, v59, v153
    v_cvt_pk_bf16_f32 v170, v152, v153
    v_exp_f32 v155, v155
    v_add_f32 v58, v58, v154
    v_add_f32 v59, v59, v155
    v_cvt_pk_bf16_f32 v171, v154, v155
    v_mfma_f32_32x32x16_bf16 a[16:31], a[224:227], v[164:167], a[16:31]
    v_add_f32 v4, v56, v57
    v_add_f32 v5, v58, v59
    v_mov_b32 v6, v4
    v_mov_b32 v7, v5
    v_mov_b32 v8, 0x5d800000
    v_mfma_f32_32x32x16_bf16 a[16:31], a[240:243], v[168:171], a[16:31]
    v_permlane32_swap_b32 v4, v6
    v_permlane32_swap_b32 v5, v7
    v_add_f32 v4, v4, v6
    v_add_f32 v5, v5, v7
    v_add_f32 v7, v4, v5
    v_mfma_f32_32x32x16_bf16 a[48:63], a[228:231], v[164:167], a[48:63]
    v_rcp_f32 v156, v4
    v_cmp_nle_f32 vcc, v7, v8
    v_rcp_f32 v158, v5
    s_cmp_lg_u64 vcc, 0
    s_cselect_b32 s64, 1, 0
    s_lshl_b32 s65, s3, 2
    s_add_u32 s65, s65, 146944
    v_mfma_f32_32x32x16_bf16 a[48:63], a[244:247], v[168:171], a[48:63]
    v_mov_b32 v9, s64
    v_mov_b32 v10, s65
    v_mov_b32 v157, v156
    v_mov_b32 v159, v158
    v_mov_b32 v11, 146944
    v_mfma_f32_32x32x16_bf16 a[80:95], a[232:235], v[164:167], a[80:95]
    ds_write_b32 v10, v9
    v_accvgpr_read_b32 v124, a0
    v_accvgpr_read_b32 v125, a1
    v_accvgpr_read_b32 v126, a2
    v_accvgpr_read_b32 v127, a3
    v_accvgpr_read_b32 v128, a4
    v_accvgpr_read_b32 v129, a5
    v_mfma_f32_32x32x16_bf16 a[80:95], a[248:251], v[168:171], a[80:95]
    v_accvgpr_read_b32 v130, a6
    v_accvgpr_read_b32 v131, a7
    v_accvgpr_read_b32 v132, a8
    v_accvgpr_read_b32 v133, a9
    v_accvgpr_read_b32 v134, a10
    v_accvgpr_read_b32 v135, a11
    v_mfma_f32_32x32x16_bf16 a[112:127], a[236:239], v[164:167], a[112:127]
    v_accvgpr_read_b32 v136, a12
    v_accvgpr_read_b32 v137, a13
    v_accvgpr_read_b32 v138, a14
    v_accvgpr_read_b32 v139, a15
    s_waitcnt lgkmcnt(0)
    v_mfma_f32_32x32x16_bf16 a[112:127], a[252:255], v[168:171], a[112:127]
    s_barrier
    ds_read_b128 v[36:39], v11
    v_pk_mul_f32 v[124:125], v[124:125], v[156:157]
    v_pk_mul_f32 v[126:127], v[126:127], v[156:157]
    v_pk_mul_f32 v[128:129], v[128:129], v[156:157]
    v_pk_mul_f32 v[130:131], v[130:131], v[156:157]
    v_cvt_pk_bf16_f32 v204, v124, v125
    v_cvt_pk_bf16_f32 v205, v126, v127
    v_cvt_pk_bf16_f32 v206, v128, v129
    v_cvt_pk_bf16_f32 v207, v130, v131
    s_add_u32 s73, s90, 0
    buffer_store_dwordx4 v[204:207], v2, s[8:11], s73 offen offset:0
    v_pk_mul_f32 v[132:133], v[132:133], v[156:157]
    v_pk_mul_f32 v[134:135], v[134:135], v[156:157]
    v_pk_mul_f32 v[136:137], v[136:137], v[156:157]
    v_pk_mul_f32 v[138:139], v[138:139], v[156:157]
    v_cvt_pk_bf16_f32 v208, v132, v133
    v_cvt_pk_bf16_f32 v209, v134, v135
    v_cvt_pk_bf16_f32 v210, v136, v137
    v_cvt_pk_bf16_f32 v211, v138, v139
    buffer_store_dwordx4 v[208:211], v2, s[8:11], s73 offen offset:1024
    v_accvgpr_read_b32 v140, a32
    v_accvgpr_read_b32 v141, a33
    v_accvgpr_read_b32 v142, a34
    v_accvgpr_read_b32 v143, a35
    v_accvgpr_read_b32 v144, a36
    v_accvgpr_read_b32 v145, a37
    v_accvgpr_read_b32 v146, a38
    v_accvgpr_read_b32 v147, a39
    v_pk_mul_f32 v[140:141], v[140:141], v[156:157]
    v_pk_mul_f32 v[142:143], v[142:143], v[156:157]
    v_pk_mul_f32 v[144:145], v[144:145], v[156:157]
    v_pk_mul_f32 v[146:147], v[146:147], v[156:157]
    v_cvt_pk_bf16_f32 v212, v140, v141
    v_cvt_pk_bf16_f32 v213, v142, v143
    v_cvt_pk_bf16_f32 v214, v144, v145
    v_cvt_pk_bf16_f32 v215, v146, v147
    buffer_store_dwordx4 v[212:215], v2, s[8:11], s73 offen offset:2048
    v_accvgpr_read_b32 v148, a40
    v_accvgpr_read_b32 v149, a41
    v_accvgpr_read_b32 v150, a42
    v_accvgpr_read_b32 v151, a43
    v_accvgpr_read_b32 v152, a44
    v_accvgpr_read_b32 v153, a45
    v_accvgpr_read_b32 v154, a46
    v_accvgpr_read_b32 v155, a47
    v_pk_mul_f32 v[148:149], v[148:149], v[156:157]
    v_pk_mul_f32 v[150:151], v[150:151], v[156:157]
    v_pk_mul_f32 v[152:153], v[152:153], v[156:157]
    v_pk_mul_f32 v[154:155], v[154:155], v[156:157]
    v_cvt_pk_bf16_f32 v216, v148, v149
    v_cvt_pk_bf16_f32 v217, v150, v151
    v_cvt_pk_bf16_f32 v218, v152, v153
    v_cvt_pk_bf16_f32 v219, v154, v155
    buffer_store_dwordx4 v[216:219], v2, s[8:11], s73 offen offset:3072
    v_accvgpr_read_b32 v124, a16
    v_accvgpr_read_b32 v125, a17
    v_accvgpr_read_b32 v126, a18
    v_accvgpr_read_b32 v127, a19
    v_accvgpr_read_b32 v128, a20
    v_accvgpr_read_b32 v129, a21
    v_accvgpr_read_b32 v130, a22
    v_accvgpr_read_b32 v131, a23
    v_pk_mul_f32 v[124:125], v[124:125], v[158:159]
    v_pk_mul_f32 v[126:127], v[126:127], v[158:159]
    v_pk_mul_f32 v[128:129], v[128:129], v[158:159]
    v_pk_mul_f32 v[130:131], v[130:131], v[158:159]
    v_cvt_pk_bf16_f32 v204, v124, v125
    v_cvt_pk_bf16_f32 v205, v126, v127
    v_cvt_pk_bf16_f32 v206, v128, v129
    v_cvt_pk_bf16_f32 v207, v130, v131
    s_add_u32 s73, s90, 4096
    buffer_store_dwordx4 v[204:207], v2, s[8:11], s73 offen offset:0
    v_accvgpr_read_b32 v132, a24
    v_accvgpr_read_b32 v133, a25
    v_accvgpr_read_b32 v134, a26
    v_accvgpr_read_b32 v135, a27
    v_accvgpr_read_b32 v136, a28
    v_accvgpr_read_b32 v137, a29
    v_accvgpr_read_b32 v138, a30
    v_accvgpr_read_b32 v139, a31
    v_pk_mul_f32 v[132:133], v[132:133], v[158:159]
    v_pk_mul_f32 v[134:135], v[134:135], v[158:159]
    v_pk_mul_f32 v[136:137], v[136:137], v[158:159]
    v_pk_mul_f32 v[138:139], v[138:139], v[158:159]
    v_cvt_pk_bf16_f32 v208, v132, v133
    v_cvt_pk_bf16_f32 v209, v134, v135
    v_cvt_pk_bf16_f32 v210, v136, v137
    v_cvt_pk_bf16_f32 v211, v138, v139
    buffer_store_dwordx4 v[208:211], v2, s[8:11], s73 offen offset:1024
    v_accvgpr_read_b32 v140, a48
    v_accvgpr_read_b32 v141, a49
    v_accvgpr_read_b32 v142, a50
    v_accvgpr_read_b32 v143, a51
    v_accvgpr_read_b32 v144, a52
    v_accvgpr_read_b32 v145, a53
    v_accvgpr_read_b32 v146, a54
    v_accvgpr_read_b32 v147, a55
    v_pk_mul_f32 v[140:141], v[140:141], v[158:159]
    v_pk_mul_f32 v[142:143], v[142:143], v[158:159]
    v_pk_mul_f32 v[144:145], v[144:145], v[158:159]
    v_pk_mul_f32 v[146:147], v[146:147], v[158:159]
    v_cvt_pk_bf16_f32 v212, v140, v141
    v_cvt_pk_bf16_f32 v213, v142, v143
    v_cvt_pk_bf16_f32 v214, v144, v145
    v_cvt_pk_bf16_f32 v215, v146, v147
    buffer_store_dwordx4 v[212:215], v2, s[8:11], s73 offen offset:2048
    v_accvgpr_read_b32 v148, a56
    v_accvgpr_read_b32 v149, a57
    v_accvgpr_read_b32 v150, a58
    v_accvgpr_read_b32 v151, a59
    v_accvgpr_read_b32 v152, a60
    v_accvgpr_read_b32 v153, a61
    v_accvgpr_read_b32 v154, a62
    v_accvgpr_read_b32 v155, a63
    v_pk_mul_f32 v[148:149], v[148:149], v[158:159]
    v_pk_mul_f32 v[150:151], v[150:151], v[158:159]
    v_pk_mul_f32 v[152:153], v[152:153], v[158:159]
    v_pk_mul_f32 v[154:155], v[154:155], v[158:159]
    v_cvt_pk_bf16_f32 v216, v148, v149
    v_cvt_pk_bf16_f32 v217, v150, v151
    v_cvt_pk_bf16_f32 v218, v152, v153
    v_cvt_pk_bf16_f32 v219, v154, v155
    buffer_store_dwordx4 v[216:219], v2, s[8:11], s73 offen offset:3072
    s_waitcnt lgkmcnt(0)
    v_or_b32 v36, v36, v37
    v_or_b32 v38, v38, v39
    v_or_b32 v36, v36, v38
    s_nop 0
    v_readfirstlane_b32 s64, v36
    s_nop 0
    s_andn2_b32 s64, s64, s7
    s_cbranch_scc1 LA_fallback
    v_accvgpr_read_b32 v124, a64
    v_accvgpr_read_b32 v125, a65
    v_accvgpr_read_b32 v126, a66
    v_accvgpr_read_b32 v127, a67
    v_accvgpr_read_b32 v128, a68
    v_accvgpr_read_b32 v129, a69
    v_accvgpr_read_b32 v130, a70
    v_accvgpr_read_b32 v131, a71
    v_pk_mul_f32 v[124:125], v[124:125], v[156:157]
    v_pk_mul_f32 v[126:127], v[126:127], v[156:157]
    v_pk_mul_f32 v[128:129], v[128:129], v[156:157]
    v_pk_mul_f32 v[130:131], v[130:131], v[156:157]
    v_cvt_pk_bf16_f32 v204, v124, v125
    v_cvt_pk_bf16_f32 v205, v126, v127
    v_cvt_pk_bf16_f32 v206, v128, v129
    v_cvt_pk_bf16_f32 v207, v130, v131
    s_add_u32 s73, s90, 1048576
    buffer_store_dwordx4 v[204:207], v2, s[8:11], s73 offen offset:0
    v_accvgpr_read_b32 v132, a72
    v_accvgpr_read_b32 v133, a73
    v_accvgpr_read_b32 v134, a74
    v_accvgpr_read_b32 v135, a75
    v_accvgpr_read_b32 v136, a76
    v_accvgpr_read_b32 v137, a77
    v_accvgpr_read_b32 v138, a78
    v_accvgpr_read_b32 v139, a79
    v_pk_mul_f32 v[132:133], v[132:133], v[156:157]
    v_pk_mul_f32 v[134:135], v[134:135], v[156:157]
    v_pk_mul_f32 v[136:137], v[136:137], v[156:157]
    v_pk_mul_f32 v[138:139], v[138:139], v[156:157]
    v_cvt_pk_bf16_f32 v208, v132, v133
    v_cvt_pk_bf16_f32 v209, v134, v135
    v_cvt_pk_bf16_f32 v210, v136, v137
    v_cvt_pk_bf16_f32 v211, v138, v139
    buffer_store_dwordx4 v[208:211], v2, s[8:11], s73 offen offset:1024
    v_accvgpr_read_b32 v140, a96
    v_accvgpr_read_b32 v141, a97
    v_accvgpr_read_b32 v142, a98
    v_accvgpr_read_b32 v143, a99
    v_accvgpr_read_b32 v144, a100
    v_accvgpr_read_b32 v145, a101
    v_accvgpr_read_b32 v146, a102
    v_accvgpr_read_b32 v147, a103
    v_pk_mul_f32 v[140:141], v[140:141], v[156:157]
    v_pk_mul_f32 v[142:143], v[142:143], v[156:157]
    v_pk_mul_f32 v[144:145], v[144:145], v[156:157]
    v_pk_mul_f32 v[146:147], v[146:147], v[156:157]
    v_cvt_pk_bf16_f32 v212, v140, v141
    v_cvt_pk_bf16_f32 v213, v142, v143
    v_cvt_pk_bf16_f32 v214, v144, v145
    v_cvt_pk_bf16_f32 v215, v146, v147
    buffer_store_dwordx4 v[212:215], v2, s[8:11], s73 offen offset:2048
    v_accvgpr_read_b32 v148, a104
    v_accvgpr_read_b32 v149, a105
    v_accvgpr_read_b32 v150, a106
    v_accvgpr_read_b32 v151, a107
    v_accvgpr_read_b32 v152, a108
    v_accvgpr_read_b32 v153, a109
    v_accvgpr_read_b32 v154, a110
    v_accvgpr_read_b32 v155, a111
    v_pk_mul_f32 v[148:149], v[148:149], v[156:157]
    v_pk_mul_f32 v[150:151], v[150:151], v[156:157]
    v_pk_mul_f32 v[152:153], v[152:153], v[156:157]
    v_pk_mul_f32 v[154:155], v[154:155], v[156:157]
    v_cvt_pk_bf16_f32 v216, v148, v149
    v_cvt_pk_bf16_f32 v217, v150, v151
    v_cvt_pk_bf16_f32 v218, v152, v153
    v_cvt_pk_bf16_f32 v219, v154, v155
    buffer_store_dwordx4 v[216:219], v2, s[8:11], s73 offen offset:3072
    s_mov_b32 s64, s99
    v_mov_b32 v39, s97
    s_cmp_eq_u32 s6, 0
    s_waitcnt vmcnt(4)
    s_cbranch_scc1 LA_sf
    buffer_wbl2 sc1
    s_waitcnt vmcnt(0)
    buffer_store_dword v39, off, s[8:11], s64 offset:0 sc0 sc1
    s_branch LA_sd
LA_sf:
    buffer_store_dword v39, off, s[8:11], s64 offset:0
LA_sd:
    v_accvgpr_read_b32 v124, a80
    v_accvgpr_read_b32 v125, a81
    v_accvgpr_read_b32 v126, a82
    v_accvgpr_read_b32 v127, a83
    v_accvgpr_read_b32 v128, a84
    v_accvgpr_read_b32 v129, a85
    v_accvgpr_read_b32 v130, a86
    v_accvgpr_read_b32 v131, a87
    v_pk_mul_f32 v[124:125], v[124:125], v[158:159]
    v_pk_mul_f32 v[126:127], v[126:127], v[158:159]
    v_pk_mul_f32 v[128:129], v[128:129], v[158:159]
    v_pk_mul_f32 v[130:131], v[130:131], v[158:159]
    v_cvt_pk_bf16_f32 v204, v124, v125
    v_cvt_pk_bf16_f32 v205, v126, v127
    v_cvt_pk_bf16_f32 v206, v128, v129
    v_cvt_pk_bf16_f32 v207, v130, v131
    s_add_u32 s73, s90, 1052672
    buffer_store_dwordx4 v[204:207], v2, s[8:11], s73 offen offset:0
    v_accvgpr_read_b32 v132, a88
    v_accvgpr_read_b32 v133, a89
    v_accvgpr_read_b32 v134, a90
    v_accvgpr_read_b32 v135, a91
    v_accvgpr_read_b32 v136, a92
    v_accvgpr_read_b32 v137, a93
    v_accvgpr_read_b32 v138, a94
    v_accvgpr_read_b32 v139, a95
    v_pk_mul_f32 v[132:133], v[132:133], v[158:159]
    v_pk_mul_f32 v[134:135], v[134:135], v[158:159]
    v_pk_mul_f32 v[136:137], v[136:137], v[158:159]
    v_pk_mul_f32 v[138:139], v[138:139], v[158:159]
    v_cvt_pk_bf16_f32 v208, v132, v133
    v_cvt_pk_bf16_f32 v209, v134, v135
    v_cvt_pk_bf16_f32 v210, v136, v137
    v_cvt_pk_bf16_f32 v211, v138, v139
    buffer_store_dwordx4 v[208:211], v2, s[8:11], s73 offen offset:1024
    v_accvgpr_read_b32 v140, a112
    v_accvgpr_read_b32 v141, a113
    v_accvgpr_read_b32 v142, a114
    v_accvgpr_read_b32 v143, a115
    v_accvgpr_read_b32 v144, a116
    v_accvgpr_read_b32 v145, a117
    v_accvgpr_read_b32 v146, a118
    v_accvgpr_read_b32 v147, a119
    v_pk_mul_f32 v[140:141], v[140:141], v[158:159]
    v_pk_mul_f32 v[142:143], v[142:143], v[158:159]
    v_pk_mul_f32 v[144:145], v[144:145], v[158:159]
    v_pk_mul_f32 v[146:147], v[146:147], v[158:159]
    v_cvt_pk_bf16_f32 v212, v140, v141
    v_cvt_pk_bf16_f32 v213, v142, v143
    v_cvt_pk_bf16_f32 v214, v144, v145
    v_cvt_pk_bf16_f32 v215, v146, v147
    buffer_store_dwordx4 v[212:215], v2, s[8:11], s73 offen offset:2048
    v_accvgpr_read_b32 v148, a120
    v_accvgpr_read_b32 v149, a121
    v_accvgpr_read_b32 v150, a122
    v_accvgpr_read_b32 v151, a123
    v_accvgpr_read_b32 v152, a124
    v_accvgpr_read_b32 v153, a125
    v_accvgpr_read_b32 v154, a126
    v_accvgpr_read_b32 v155, a127
    v_pk_mul_f32 v[148:149], v[148:149], v[158:159]
    v_pk_mul_f32 v[150:151], v[150:151], v[158:159]
    v_pk_mul_f32 v[152:153], v[152:153], v[158:159]
    v_pk_mul_f32 v[154:155], v[154:155], v[158:159]
    v_cvt_pk_bf16_f32 v216, v148, v149
    v_cvt_pk_bf16_f32 v217, v150, v151
    v_cvt_pk_bf16_f32 v218, v152, v153
    v_cvt_pk_bf16_f32 v219, v154, v155
    buffer_store_dwordx4 v[216:219], v2, s[8:11], s73 offen offset:3072
    s_add_u32 m0, s89, 0
    s_add_u32 s62, s88, 819200
    buffer_load_dwordx4 v227, s[24:27], s62 offen offset:0 lds
    buffer_load_dwordx4 v228, s[24:27], s62 offen offset:1024 lds
    buffer_load_dwordx4 v229, s[24:27], s62 offen offset:2048 lds
    buffer_load_dwordx4 v230, s[24:27], s62 offen offset:3072 lds
    s_add_u32 m0, s89, 4096
    s_nop 0
    buffer_load_dwordx4 v231, s[24:27], s62 offen offset:0 lds
    s_add_u32 m0, s89, 20480
    s_add_u32 s62, s88, 983040
    buffer_load_dwordx4 v227, s[24:27], s62 offen offset:0 lds
    buffer_load_dwordx4 v228, s[24:27], s62 offen offset:1024 lds
    buffer_load_dwordx4 v229, s[24:27], s62 offen offset:2048 lds
    buffer_load_dwordx4 v230, s[24:27], s62 offen offset:3072 lds
    s_add_u32 m0, s89, 24576
    s_nop 0
    buffer_load_dwordx4 v231, s[24:27], s62 offen offset:0 lds
    s_cmp_eq_u32 s6, 0
    s_cbranch_scc1 LA2_skip
    s_waitcnt vmcnt(0)
    buffer_wbl2 sc1
    s_waitcnt vmcnt(0)
    buffer_store_dword v39, off, s[8:11], s64 offset:2560 sc0 sc1
LA2_skip:
    s_barrier
    ds_read_b64_tr_b16 a[0:1], v253 offset:40960
    ds_read_b64_tr_b16 a[2:3], v253 offset:42240
    ds_read_b64_tr_b16 a[4:5], v253 offset:41024
    ds_read_b64_tr_b16 a[6:7], v253 offset:42304
    ds_read_b64_tr_b16 a[8:9], v253 offset:41088
    ds_read_b64_tr_b16 a[10:11], v253 offset:42368
    ds_read_b64_tr_b16 a[12:13], v253 offset:41152
    ds_read_b64_tr_b16 a[14:15], v253 offset:42432
    ds_read_b64_tr_b16 a[16:17], v253 offset:41216
    ds_read_b64_tr_b16 a[18:19], v253 offset:42496
    ds_read_b64_tr_b16 a[20:21], v253 offset:46080
    ds_read_b64_tr_b16 a[22:23], v253 offset:47360
    ds_read_b64_tr_b16 a[24:25], v253 offset:46144
    ds_read_b64_tr_b16 a[26:27], v253 offset:47424
    ds_read_b64_tr_b16 a[28:29], v253 offset:46208
    ds_read_b64_tr_b16 a[30:31], v253 offset:47488
    ds_read_b64_tr_b16 a[32:33], v253 offset:46272
    ds_read_b64_tr_b16 a[34:35], v253 offset:47552
    ds_read_b64_tr_b16 a[36:37], v253 offset:46336
    ds_read_b64_tr_b16 a[38:39], v253 offset:47616
    s_lshr_b32 s64, s5, 3
    s_lshl_b32 s64, s64, 7
    s_and_b32 s65, s5, 4
    s_lshl_b32 s65, s65, 1
    s_add_u32 s64, s64, s65
    s_and_b32 s65, s3, 2
    s_lshl_b32 s65, s65, 1
    s_add_u32 s64, s64, s65
    v_and_b32 v4, 7, v1
    v_lshl_add_u32 v38, v4, 4, s64
    s_and_b32 s64, s5, 28
    s_add_u32 s64, s64, s3
    s_lshl_b32 s52, s64, 12
    s_lshl_b32 s65, s4, 22
    s_add_u32 s52, s52, s65
    s_add_u32 s52, s52, 4194304
    s_and_b32 s64, s64, 7
    s_and_b32 s65, s4, 3
    s_and_b32 s66, s5, 3
    s_lshl_b32 s67, s65, 3
    s_add_u32 s67, s67, s64
    s_mul_i32 s67, s67, 40960
    s_mul_i32 s51, s66, 2560
    s_add_u32 s51, s51, s67
    s_lshl_b32 s67, s86, 22
    s_add_u32 s51, s51, s67
    s_add_u32 s51, s51, 6291456
    s_lshl_b32 s91, s64, 2
    s_add_u32 s91, s91, s65
    s_lshl_b32 s91, s91, 2
    s_add_u32 s91, s91, s66
    s_lshl_b32 s91, s91, 7
    s_lshl_b32 s67, s86, 14
    s_add_u32 s91, s91, s67
    s_add_u32 s91, s91, 261632
    v_bfe_u32 v4, v1, 3, 2
    v_mul_u32_u24 v4, 10240, v4
    v_and_b32 v5, 7, v1
    v_lshl_add_u32 v4, v5, 4, v4
    v_lshrrev_b32 v5, 5, v1
    v_lshl_add_u32 v136, v5, 7, v4
    v_lshrrev_b32 v4, 3, v1
    v_bfe_u32 v5, v1, 4, 1
    v_lshlrev_b32 v5, 1, v5
    v_xor_b32 v5, v5, v1
    v_and_b32 v5, 7, v5
    v_lshl_add_u32 v4, s3, 4, v4
    v_mul_u32_u24 v4, 3456, v4
    v_xor_b32 v32, 0, v5
    v_lshl_add_u32 v32, v32, 4, v4
    v_xor_b32 v33, 0, v5
    v_lshl_add_u32 v33, v33, 4, v4
    v_add_u32 v33, 26624, v33
    v_xor_b32 v34, 4, v5
    v_lshl_add_u32 v34, v34, 4, v4
    v_xor_b32 v35, 4, v5
    v_lshl_add_u32 v35, v35, 4, v4
    v_add_u32 v35, 26624, v35
    s_mov_b32 s64, 0
LB_p:
    buffer_load_dword v39, v38, s[8:11], s48 offen offset:0 sc1
    s_add_u32 s64, s64, 1
    s_waitcnt vmcnt(0)
    v_cmp_ne_u32 vcc, s97, v39
    s_nop 0
    s_cmp_eq_u64 vcc, 0
    s_cbranch_scc1 LB_pd
    s_cmp_lt_u32 s64, 200000
    s_cbranch_scc1 LB_p
LB_pd:
    s_cmp_eq_u32 s6, 0
    s_cbranch_scc1 LB_pf
    buffer_inv sc1
    s_waitcnt vmcnt(0)
LB_pf:
    s_cmp_eq_u32 s6, 0
    s_cbranch_scc1 LB2_pf
    s_mov_b32 s64, 0
LB2_p:
    buffer_load_dword v39, v38, s[8:11], s48 offen offset:2560 sc1
    s_add_u32 s64, s64, 1
    s_waitcnt vmcnt(0)
    v_cmp_ne_u32 vcc, s97, v39
    s_nop 0
    s_cmp_eq_u64 vcc, 0
    s_cbranch_scc1 LB2_pd
    s_cmp_lt_u32 s64, 200000
    s_cbranch_scc1 LB2_p
LB2_pd:
    s_cmp_eq_u32 s6, 0
    s_cbranch_scc1 LB2_pf
    buffer_inv sc1
    s_waitcnt vmcnt(0)
LB2_pf:
    s_add_u32 s60, s52, 0
    buffer_load_dwordx4 a[64:67], v2, s[8:11], s60 offen offset:0 sc1
    buffer_load_dwordx4 a[68:71], v2, s[8:11], s60 offen offset:1024 sc1
    buffer_load_dwordx4 a[72:75], v2, s[8:11], s60 offen offset:2048 sc1
    buffer_load_dwordx4 a[76:79], v2, s[8:11], s60 offen offset:3072 sc1
    s_add_u32 s60, s52, 131072
    buffer_load_dwordx4 a[80:83], v2, s[8:11], s60 offen offset:0 sc1
    buffer_load_dwordx4 a[84:87], v2, s[8:11], s60 offen offset:1024 sc1
    buffer_load_dwordx4 a[88:91], v2, s[8:11], s60 offen offset:2048 sc1
    buffer_load_dwordx4 a[92:95], v2, s[8:11], s60 offen offset:3072 sc1
    s_waitcnt vmcnt(7) lgkmcnt(15)
    v_mfma_f32_32x32x16_bf16 v[40:55], a[0:3], a[64:67], 0
    ds_read_b64_tr_b16 a[40:41], v253 offset:51200
    ds_read_b64_tr_b16 a[42:43], v253 offset:52480
    v_mov_b32 v36, s97
    s_add_u32 s60, s52, 262144
    v_mfma_f32_32x32x16_bf16 v[56:71], a[4:7], a[64:67], 0
    ds_read_b64_tr_b16 a[44:45], v253 offset:51264
    ds_read_b64_tr_b16 a[46:47], v253 offset:52544
    buffer_load_dwordx4 a[96:99], v2, s[8:11], s60 offen offset:0 sc1
    s_waitcnt lgkmcnt(15)
    v_mfma_f32_32x32x16_bf16 v[72:87], a[8:11], a[64:67], 0
    ds_read_b64_tr_b16 a[48:49], v253 offset:51328
    ds_read_b64_tr_b16 a[50:51], v253 offset:52608
    v_mfma_f32_32x32x16_bf16 v[88:103], a[12:15], a[64:67], 0
    ds_read_b64_tr_b16 a[52:53], v253 offset:51392
    ds_read_b64_tr_b16 a[54:55], v253 offset:52672
    buffer_load_dwordx4 a[100:103], v2, s[8:11], s60 offen offset:1024 sc1
    s_waitcnt lgkmcnt(15)
    v_mfma_f32_32x32x16_bf16 v[104:119], a[16:19], a[64:67], 0
    ds_read_b64_tr_b16 a[56:57], v253 offset:51456
    ds_read_b64_tr_b16 a[58:59], v253 offset:52736
    buffer_store_dword v36, off, s[8:11], s99 offset:2560
    s_waitcnt vmcnt(9) lgkmcnt(10)
    v_mfma_f32_32x32x16_bf16 v[40:55], a[20:23], a[68:71], v[40:55]
    ds_read_b64_tr_b16 a[60:61], v253 offset:56320
    ds_read_b64_tr_b16 a[62:63], v253 offset:57600
    v_mfma_f32_32x32x16_bf16 v[56:71], a[24:27], a[68:71], v[56:71]
    ds_read_b64_tr_b16 a[0:1], v253 offset:56384
    ds_read_b64_tr_b16 a[2:3], v253 offset:57664
    buffer_load_dwordx4 a[104:107], v2, s[8:11], s60 offen offset:2048 sc1
    v_mfma_f32_32x32x16_bf16 v[72:87], a[28:31], a[68:71], v[72:87]
    ds_read_b64_tr_b16 a[4:5], v253 offset:56448
    ds_read_b64_tr_b16 a[6:7], v253 offset:57728
    v_mfma_f32_32x32x16_bf16 v[88:103], a[32:35], a[68:71], v[88:103]
    ds_read_b64_tr_b16 a[8:9], v253 offset:56512
    ds_read_b64_tr_b16 a[10:11], v253 offset:57792
    buffer_load_dwordx4 a[108:111], v2, s[8:11], s60 offen offset:3072 sc1
    v_mfma_f32_32x32x16_bf16 v[104:119], a[36:39], a[68:71], v[104:119]
    ds_read_b64_tr_b16 a[12:13], v253 offset:56576
    ds_read_b64_tr_b16 a[14:15], v253 offset:57856
    s_waitcnt vmcnt(10) lgkmcnt(10)
    v_mfma_f32_32x32x16_bf16 v[40:55], a[40:43], a[72:75], v[40:55]
    ds_read_b64_tr_b16 a[16:17], v253 offset:61440
    ds_read_b64_tr_b16 a[18:19], v253 offset:62720
    s_add_u32 s60, s52, 393216
    v_mfma_f32_32x32x16_bf16 v[56:71], a[44:47], a[72:75], v[56:71]
    ds_read_b64_tr_b16 a[20:21], v253 offset:61504
    ds_read_b64_tr_b16 a[22:23], v253 offset:62784
    buffer_load_dwordx4 a[112:115], v2, s[8:11], s60 offen offset:0 sc1
    v_mfma_f32_32x32x16_bf16 v[72:87], a[48:51], a[72:75], v[72:87]
    ds_read_b64_tr_b16 a[24:25], v253 offset:61568
    ds_read_b64_tr_b16 a[26:27], v253 offset:62848
    v_mfma_f32_32x32x16_bf16 v[88:103], a[52:55], a[72:75], v[88:103]
    ds_read_b64_tr_b16 a[28:29], v253 offset:61632
    ds_read_b64_tr_b16 a[30:31], v253 offset:62912
    buffer_load_dwordx4 a[116:119], v2, s[8:11], s60 offen offset:1024 sc1
    v_mfma_f32_32x32x16_bf16 v[104:119], a[56:59], a[72:75], v[104:119]
    ds_read_b64_tr_b16 a[32:33], v253 offset:61696
    ds_read_b64_tr_b16 a[34:35], v253 offset:62976
    s_waitcnt vmcnt(11) lgkmcnt(10)
    v_mfma_f32_32x32x16_bf16 v[40:55], a[60:63], a[76:79], v[40:55]
    ds_read_b64_tr_b16 a[36:37], v254 offset:1024
    ds_read_b64_tr_b16 a[38:39], v254 offset:2304
    v_mfma_f32_32x32x16_bf16 v[56:71], a[0:3], a[76:79], v[56:71]
    ds_read_b64_tr_b16 a[40:41], v254 offset:1088
    ds_read_b64_tr_b16 a[42:43], v254 offset:2368
    buffer_load_dwordx4 a[120:123], v2, s[8:11], s60 offen offset:2048 sc1
    v_mfma_f32_32x32x16_bf16 v[72:87], a[4:7], a[76:79], v[72:87]
    ds_read_b64_tr_b16 a[44:45], v254 offset:1152
    ds_read_b64_tr_b16 a[46:47], v254 offset:2432
    v_mfma_f32_32x32x16_bf16 v[88:103], a[8:11], a[76:79], v[88:103]
    ds_read_b64_tr_b16 a[48:49], v254 offset:1216
    ds_read_b64_tr_b16 a[50:51], v254 offset:2496
    buffer_load_dwordx4 a[124:127], v2, s[8:11], s60 offen offset:3072 sc1
    v_mfma_f32_32x32x16_bf16 v[104:119], a[12:15], a[76:79], v[104:119]
    ds_read_b64_tr_b16 a[52:53], v254 offset:1280
    ds_read_b64_tr_b16 a[54:55], v254 offset:2560
    s_waitcnt vmcnt(12) lgkmcnt(10)
    v_mfma_f32_32x32x16_bf16 v[40:55], a[16:19], a[80:83], v[40:55]
    ds_read_b64_tr_b16 a[56:57], v254 offset:6144
    ds_read_b64_tr_b16 a[58:59], v254 offset:7424
    s_add_u32 s60, s52, 524288
    v_mfma_f32_32x32x16_bf16 v[56:71], a[20:23], a[80:83], v[56:71]
    ds_read_b64_tr_b16 a[60:61], v254 offset:6208
    ds_read_b64_tr_b16 a[62:63], v254 offset:7488
    buffer_load_dwordx4 a[128:131], v2, s[8:11], s60 offen offset:0 sc1
    v_mfma_f32_32x32x16_bf16 v[72:87], a[24:27], a[80:83], v[72:87]
    ds_read_b64_tr_b16 a[0:1], v254 offset:6272
    ds_read_b64_tr_b16 a[2:3], v254 offset:7552
    v_mfma_f32_32x32x16_bf16 v[88:103], a[28:31], a[80:83], v[88:103]
    ds_read_b64_tr_b16 a[4:5], v254 offset:6336
    ds_read_b64_tr_b16 a[6:7], v254 offset:7616
    buffer_load_dwordx4 a[132:135], v2, s[8:11], s60 offen offset:1024 sc1
    v_mfma_f32_32x32x16_bf16 v[104:119], a[32:35], a[80:83], v[104:119]
    ds_read_b64_tr_b16 a[8:9], v254 offset:6400
    ds_read_b64_tr_b16 a[10:11], v254 offset:7680
    s_waitcnt vmcnt(13) lgkmcnt(10)
    v_mfma_f32_32x32x16_bf16 v[40:55], a[36:39], a[84:87], v[40:55]
    ds_read_b64_tr_b16 a[12:13], v254 offset:11264
    ds_read_b64_tr_b16 a[14:15], v254 offset:12544
    v_mfma_f32_32x32x16_bf16 v[56:71], a[40:43], a[84:87], v[56:71]
    ds_read_b64_tr_b16 a[16:17], v254 offset:11328
    ds_read_b64_tr_b16 a[18:19], v254 offset:12608
    buffer_load_dwordx4 a[136:139], v2, s[8:11], s60 offen offset:2048 sc1
    v_mfma_f32_32x32x16_bf16 v[72:87], a[44:47], a[84:87], v[72:87]
    ds_read_b64_tr_b16 a[20:21], v254 offset:11392
    ds_read_b64_tr_b16 a[22:23], v254 offset:12672
    v_mfma_f32_32x32x16_bf16 v[88:103], a[48:51], a[84:87], v[88:103]
    ds_read_b64_tr_b16 a[24:25], v254 offset:11456
    ds_read_b64_tr_b16 a[26:27], v254 offset:12736
    buffer_load_dwordx4 a[140:143], v2, s[8:11], s60 offen offset:3072 sc1
    v_mfma_f32_32x32x16_bf16 v[104:119], a[52:55], a[84:87], v[104:119]
    ds_read_b64_tr_b16 a[28:29], v254 offset:11520
    ds_read_b64_tr_b16 a[30:31], v254 offset:12800
    s_waitcnt vmcnt(14) lgkmcnt(10)
    v_mfma_f32_32x32x16_bf16 v[40:55], a[56:59], a[88:91], v[40:55]
    ds_read_b64_tr_b16 a[32:33], v254 offset:16384
    ds_read_b64_tr_b16 a[34:35], v254 offset:17664
    s_add_u32 s60, s52, 655360
    v_mfma_f32_32x32x16_bf16 v[56:71], a[60:63], a[88:91], v[56:71]
    ds_read_b64_tr_b16 a[36:37], v254 offset:16448
    ds_read_b64_tr_b16 a[38:39], v254 offset:17728
    buffer_load_dwordx4 a[144:147], v2, s[8:11], s60 offen offset:0 sc1
    v_mfma_f32_32x32x16_bf16 v[72:87], a[0:3], a[88:91], v[72:87]
    ds_read_b64_tr_b16 a[40:41], v254 offset:16512
    ds_read_b64_tr_b16 a[42:43], v254 offset:17792
    v_mfma_f32_32x32x16_bf16 v[88:103], a[4:7], a[88:91], v[88:103]
    ds_read_b64_tr_b16 a[44:45], v254 offset:16576
    ds_read_b64_tr_b16 a[46:47], v254 offset:17856
    buffer_load_dwordx4 a[148:151], v2, s[8:11], s60 offen offset:1024 sc1
    v_mfma_f32_32x32x16_bf16 v[104:119], a[8:11], a[88:91], v[104:119]
    ds_read_b64_tr_b16 a[48:49], v254 offset:16640
    ds_read_b64_tr_b16 a[50:51], v254 offset:17920
    s_waitcnt vmcnt(15) lgkmcnt(10)
    v_mfma_f32_32x32x16_bf16 v[40:55], a[12:15], a[92:95], v[40:55]
    ds_read_b64_tr_b16 a[52:53], v254 offset:21504
    ds_read_b64_tr_b16 a[54:55], v254 offset:22784
    v_mfma_f32_32x32x16_bf16 v[56:71], a[16:19], a[92:95], v[56:71]
    ds_read_b64_tr_b16 a[56:57], v254 offset:21568
    ds_read_b64_tr_b16 a[58:59], v254 offset:22848
    buffer_load_dwordx4 a[152:155], v2, s[8:11], s60 offen offset:2048 sc1
    v_mfma_f32_32x32x16_bf16 v[72:87], a[20:23], a[92:95], v[72:87]
    ds_read_b64_tr_b16 a[60:61], v254 offset:21632
    ds_read_b64_tr_b16 a[62:63], v254 offset:22912
    v_mfma_f32_32x32x16_bf16 v[88:103], a[24:27], a[92:95], v[88:103]
    ds_read_b64_tr_b16 a[0:1], v254 offset:21696
    ds_read_b64_tr_b16 a[2:3], v254 offset:22976
    buffer_load_dwordx4 a[156:159], v2, s[8:11], s60 offen offset:3072 sc1
    v_mfma_f32_32x32x16_bf16 v[104:119], a[28:31], a[92:95], v[104:119]
    ds_read_b64_tr_b16 a[4:5], v254 offset:21760
    ds_read_b64_tr_b16 a[6:7], v254 offset:23040
    s_waitcnt vmcnt(16) lgkmcnt(10)
    v_mfma_f32_32x32x16_bf16 v[40:55], a[32:35], a[96:99], v[40:55]
    s_barrier
    ds_read_b64_tr_b16 a[8:9], v254 offset:26624
    ds_read_b64_tr_b16 a[10:11], v254 offset:27904
    s_add_u32 m0, s89, 40960
    s_add_u32 s62, s88, 1146880
    v_mfma_f32_32x32x16_bf16 v[56:71], a[36:39], a[96:99], v[56:71]
    ds_read_b64_tr_b16 a[12:13], v254 offset:26688
    ds_read_b64_tr_b16 a[14:15], v254 offset:27968
    buffer_load_dwordx4 v227, s[24:27], s62 offen offset:0 lds
    v_mfma_f32_32x32x16_bf16 v[72:87], a[40:43], a[96:99], v[72:87]
    ds_read_b64_tr_b16 a[16:17], v254 offset:26752
    ds_read_b64_tr_b16 a[18:19], v254 offset:28032
    v_mfma_f32_32x32x16_bf16 v[88:103], a[44:47], a[96:99], v[88:103]
    ds_read_b64_tr_b16 a[20:21], v254 offset:26816
    ds_read_b64_tr_b16 a[22:23], v254 offset:28096
    buffer_load_dwordx4 v228, s[24:27], s62 offen offset:1024 lds
    v_mfma_f32_32x32x16_bf16 v[104:119], a[48:51], a[96:99], v[104:119]
    ds_read_b64_tr_b16 a[24:25], v254 offset:26880
    ds_read_b64_tr_b16 a[26:27], v254 offset:28160
    s_waitcnt vmcnt(17) lgkmcnt(10)
    v_mfma_f32_32x32x16_bf16 v[40:55], a[52:55], a[100:103], v[40:55]
    ds_read_b64_tr_b16 a[28:29], v254 offset:31744
    ds_read_b64_tr_b16 a[30:31], v254 offset:33024
    s_add_u32 s60, s52, 786432
    v_mfma_f32_32x32x16_bf16 v[56:71], a[56:59], a[100:103], v[56:71]
    ds_read_b64_tr_b16 a[32:33], v254 offset:31808
    ds_read_b64_tr_b16 a[34:35], v254 offset:33088
    buffer_load_dwordx4 a[160:163], v2, s[8:11], s60 offen offset:0 sc1
    v_mfma_f32_32x32x16_bf16 v[72:87], a[60:63], a[100:103], v[72:87]
    ds_read_b64_tr_b16 a[36:37], v254 offset:31872
    ds_read_b64_tr_b16 a[38:39], v254 offset:33152
    v_mfma_f32_32x32x16_bf16 v[88:103], a[0:3], a[100:103], v[88:103]
    ds_read_b64_tr_b16 a[40:41], v254 offset:31936
    ds_read_b64_tr_b16 a[42:43], v254 offset:33216
    buffer_load_dwordx4 v229, s[24:27], s62 offen offset:2048 lds
    v_mfma_f32_32x32x16_bf16 v[104:119], a[4:7], a[100:103], v[104:119]
    ds_read_b64_tr_b16 a[44:45], v254 offset:32000
    ds_read_b64_tr_b16 a[46:47], v254 offset:33280
    buffer_load_dword v39, v38, s[8:11], s48 offen offset:2560 sc1
    s_waitcnt vmcnt(18) lgkmcnt(10)
    v_mfma_f32_32x32x16_bf16 v[40:55], a[8:11], a[104:107], v[40:55]
    ds_read_b64_tr_b16 a[48:49], v254 offset:36864
    ds_read_b64_tr_b16 a[50:51], v254 offset:38144
    v_mfma_f32_32x32x16_bf16 v[56:71], a[12:15], a[104:107], v[56:71]
    ds_read_b64_tr_b16 a[52:53], v254 offset:36928
    ds_read_b64_tr_b16 a[54:55], v254 offset:38208
    buffer_load_dwordx4 a[164:167], v2, s[8:11], s60 offen offset:1024 sc1
    v_mfma_f32_32x32x16_bf16 v[72:87], a[16:19], a[104:107], v[72:87]
    ds_read_b64_tr_b16 a[56:57], v254 offset:36992
    ds_read_b64_tr_b16 a[58:59], v254 offset:38272
    v_mfma_f32_32x32x16_bf16 v[88:103], a[20:23], a[104:107], v[88:103]
    ds_read_b64_tr_b16 a[60:61], v254 offset:37056
    ds_read_b64_tr_b16 a[62:63], v254 offset:38336
    buffer_load_dwordx4 v230, s[24:27], s62 offen offset:3072 lds
    v_mfma_f32_32x32x16_bf16 v[104:119], a[24:27], a[104:107], v[104:119]
    ds_read_b64_tr_b16 a[0:1], v254 offset:37120
    ds_read_b64_tr_b16 a[2:3], v254 offset:38400
    s_waitcnt vmcnt(19) lgkmcnt(10)
    v_mfma_f32_32x32x16_bf16 v[40:55], a[28:31], a[108:111], v[40:55]
    ds_read_b64_tr_b16 a[4:5], v254 offset:41984
    ds_read_b64_tr_b16 a[6:7], v254 offset:43264
    v_mfma_f32_32x32x16_bf16 v[56:71], a[32:35], a[108:111], v[56:71]
    ds_read_b64_tr_b16 a[8:9], v254 offset:42048
    ds_read_b64_tr_b16 a[10:11], v254 offset:43328
    buffer_load_dwordx4 a[168:171], v2, s[8:11], s60 offen offset:2048 sc1
    v_mfma_f32_32x32x16_bf16 v[72:87], a[36:39], a[108:111], v[72:87]
    ds_read_b64_tr_b16 a[12:13], v254 offset:42112
    ds_read_b64_tr_b16 a[14:15], v254 offset:43392
    s_add_u32 m0, s89, 45056
    v_mfma_f32_32x32x16_bf16 v[88:103], a[40:43], a[108:111], v[88:103]
    ds_read_b64_tr_b16 a[16:17], v254 offset:42176
    ds_read_b64_tr_b16 a[18:19], v254 offset:43456
    buffer_load_dwordx4 v231, s[24:27], s62 offen offset:0 lds
    v_mfma_f32_32x32x16_bf16 v[104:119], a[44:47], a[108:111], v[104:119]
    ds_read_b64_tr_b16 a[20:21], v254 offset:42240
    ds_read_b64_tr_b16 a[22:23], v254 offset:43520
    s_waitcnt vmcnt(20) lgkmcnt(10)
    v_mfma_f32_32x32x16_bf16 v[40:55], a[48:51], a[112:115], v[40:55]
    ds_read_b64_tr_b16 a[24:25], v254 offset:47104
    ds_read_b64_tr_b16 a[26:27], v254 offset:48384
    s_add_u32 m0, s89, 61440
    s_add_u32 s62, s88, 81920
    v_mfma_f32_32x32x16_bf16 v[56:71], a[52:55], a[112:115], v[56:71]
    ds_read_b64_tr_b16 a[28:29], v254 offset:47168
    ds_read_b64_tr_b16 a[30:31], v254 offset:48448
    buffer_load_dwordx4 v227, s[24:27], s62 offen offset:0 lds
    v_mfma_f32_32x32x16_bf16 v[72:87], a[56:59], a[112:115], v[72:87]
    ds_read_b64_tr_b16 a[32:33], v254 offset:47232
    ds_read_b64_tr_b16 a[34:35], v254 offset:48512
    v_mfma_f32_32x32x16_bf16 v[88:103], a[60:63], a[112:115], v[88:103]
    ds_read_b64_tr_b16 a[36:37], v254 offset:47296
    ds_read_b64_tr_b16 a[38:39], v254 offset:48576
    buffer_load_dwordx4 v228, s[24:27], s62 offen offset:1024 lds
    v_mfma_f32_32x32x16_bf16 v[104:119], a[0:3], a[112:115], v[104:119]
    ds_read_b64_tr_b16 a[40:41], v254 offset:47360
    ds_read_b64_tr_b16 a[42:43], v254 offset:48640
    s_waitcnt vmcnt(21) lgkmcnt(10)
    v_mfma_f32_32x32x16_bf16 v[40:55], a[4:7], a[116:119], v[40:55]
    ds_read_b64_tr_b16 a[44:45], v254 offset:52224
    ds_read_b64_tr_b16 a[46:47], v254 offset:53504
    v_mfma_f32_32x32x16_bf16 v[56:71], a[8:11], a[116:119], v[56:71]
    ds_read_b64_tr_b16 a[48:49], v254 offset:52288
    ds_read_b64_tr_b16 a[50:51], v254 offset:53568
    buffer_load_dwordx4 a[172:175], v2, s[8:11], s60 offen offset:3072 sc1
    v_mfma_f32_32x32x16_bf16 v[72:87], a[12:15], a[116:119], v[72:87]
    ds_read_b64_tr_b16 a[52:53], v254 offset:52352
    ds_read_b64_tr_b16 a[54:55], v254 offset:53632
    s_waitcnt vmcnt(7)
    v_cmp_ne_u32 vcc, s97, v39
    v_mfma_f32_32x32x16_bf16 v[88:103], a[16:19], a[116:119], v[88:103]
    ds_read_b64_tr_b16 a[56:57], v254 offset:52416
    ds_read_b64_tr_b16 a[58:59], v254 offset:53696
    buffer_load_dwordx4 v229, s[24:27], s62 offen offset:2048 lds
    s_cmp_eq_u64 vcc, 0
    s_cbranch_scc0 LB3_spin
LB3_back:
    v_mfma_f32_32x32x16_bf16 v[104:119], a[20:23], a[116:119], v[104:119]
    ds_read_b64_tr_b16 a[60:61], v254 offset:52480
    ds_read_b64_tr_b16 a[62:63], v254 offset:53760
    s_waitcnt lgkmcnt(10)
    v_mfma_f32_32x32x16_bf16 v[40:55], a[24:27], a[120:123], v[40:55]
    ds_read_b64_tr_b16 a[0:1], v254 offset:57344
    ds_read_b64_tr_b16 a[2:3], v254 offset:58624
    s_add_u32 s60, s52, 917504
    v_mfma_f32_32x32x16_bf16 v[56:71], a[28:31], a[120:123], v[56:71]
    ds_read_b64_tr_b16 a[4:5], v254 offset:57408
    ds_read_b64_tr_b16 a[6:7], v254 offset:58688
    buffer_load_dwordx4 a[176:179], v2, s[8:11], s60 offen offset:0 sc1
    v_mfma_f32_32x32x16_bf16 v[72:87], a[32:35], a[120:123], v[72:87]
    ds_read_b64_tr_b16 a[8:9], v254 offset:57472
    ds_read_b64_tr_b16 a[10:11], v254 offset:58752
    v_mfma_f32_32x32x16_bf16 v[88:103], a[36:39], a[120:123], v[88:103]
    ds_read_b64_tr_b16 a[12:13], v254 offset:57536
    ds_read_b64_tr_b16 a[14:15], v254 offset:58816
    buffer_load_dwordx4 v230, s[24:27], s62 offen offset:3072 lds
    v_mfma_f32_32x32x16_bf16 v[104:119], a[40:43], a[120:123], v[104:119]
    ds_read_b64_tr_b16 a[16:17], v254 offset:57600
    ds_read_b64_tr_b16 a[18:19], v254 offset:58880
    s_waitcnt lgkmcnt(10)
    v_mfma_f32_32x32x16_bf16 v[40:55], a[44:47], a[124:127], v[40:55]
    ds_read_b64_tr_b16 a[20:21], v254 offset:62464
    ds_read_b64_tr_b16 a[22:23], v254 offset:63744
    v_mfma_f32_32x32x16_bf16 v[56:71], a[48:51], a[124:127], v[56:71]
    ds_read_b64_tr_b16 a[24:25], v254 offset:62528
    ds_read_b64_tr_b16 a[26:27], v254 offset:63808
    buffer_load_dwordx4 a[180:183], v2, s[8:11], s60 offen offset:1024 sc1
    v_mfma_f32_32x32x16_bf16 v[72:87], a[52:55], a[124:127], v[72:87]
    ds_read_b64_tr_b16 a[28:29], v254 offset:62592
    ds_read_b64_tr_b16 a[30:31], v254 offset:63872
    s_add_u32 m0, s89, 65536
    v_mfma_f32_32x32x16_bf16 v[88:103], a[56:59], a[124:127], v[88:103]
    ds_read_b64_tr_b16 a[32:33], v254 offset:62656
    ds_read_b64_tr_b16 a[34:35], v254 offset:63936
    buffer_load_dwordx4 v231, s[24:27], s62 offen offset:0 lds
    v_mfma_f32_32x32x16_bf16 v[104:119], a[60:63], a[124:127], v[104:119]
    ds_read_b64_tr_b16 a[36:37], v254 offset:62720
    ds_read_b64_tr_b16 a[38:39], v254 offset:64000
    s_waitcnt lgkmcnt(10)
    v_mfma_f32_32x32x16_bf16 v[40:55], a[0:3], a[128:131], v[40:55]
    s_barrier
    ds_read_b64_tr_b16 a[40:41], v255 offset:2048
    ds_read_b64_tr_b16 a[42:43], v255 offset:3328
    s_add_u32 m0, s89, 81920
    s_add_u32 s62, s88, 245760
    v_mfma_f32_32x32x16_bf16 v[56:71], a[4:7], a[128:131], v[56:71]
    ds_read_b64_tr_b16 a[44:45], v255 offset:2112
    ds_read_b64_tr_b16 a[46:47], v255 offset:3392
    buffer_load_dwordx4 v227, s[24:27], s62 offen offset:0 lds
    v_mfma_f32_32x32x16_bf16 v[72:87], a[8:11], a[128:131], v[72:87]
    ds_read_b64_tr_b16 a[48:49], v255 offset:2176
    ds_read_b64_tr_b16 a[50:51], v255 offset:3456
    v_mfma_f32_32x32x16_bf16 v[88:103], a[12:15], a[128:131], v[88:103]
    ds_read_b64_tr_b16 a[52:53], v255 offset:2240
    ds_read_b64_tr_b16 a[54:55], v255 offset:3520
    buffer_load_dwordx4 v228, s[24:27], s62 offen offset:1024 lds
    v_mfma_f32_32x32x16_bf16 v[104:119], a[16:19], a[128:131], v[104:119]
    ds_read_b64_tr_b16 a[56:57], v255 offset:2304
    ds_read_b64_tr_b16 a[58:59], v255 offset:3584
    s_waitcnt lgkmcnt(10)
    v_mfma_f32_32x32x16_bf16 v[40:55], a[20:23], a[132:135], v[40:55]
    ds_read_b64_tr_b16 a[60:61], v255 offset:7168
    ds_read_b64_tr_b16 a[62:63], v255 offset:8448
    v_mfma_f32_32x32x16_bf16 v[56:71], a[24:27], a[132:135], v[56:71]
    ds_read_b64_tr_b16 a[0:1], v255 offset:7232
    ds_read_b64_tr_b16 a[2:3], v255 offset:8512
    buffer_load_dwordx4 a[184:187], v2, s[8:11], s60 offen offset:2048 sc1
    v_mfma_f32_32x32x16_bf16 v[72:87], a[28:31], a[132:135], v[72:87]
    ds_read_b64_tr_b16 a[4:5], v255 offset:7296
    ds_read_b64_tr_b16 a[6:7], v255 offset:8576
    v_mfma_f32_32x32x16_bf16 v[88:103], a[32:35], a[132:135], v[88:103]
    ds_read_b64_tr_b16 a[8:9], v255 offset:7360
    ds_read_b64_tr_b16 a[10:11], v255 offset:8640
    buffer_load_dwordx4 v229, s[24:27], s62 offen offset:2048 lds
    v_mfma_f32_32x32x16_bf16 v[104:119], a[36:39], a[132:135], v[104:119]
    ds_read_b64_tr_b16 a[12:13], v255 offset:7424
    ds_read_b64_tr_b16 a[14:15], v255 offset:8704
    s_waitcnt lgkmcnt(10)
    v_mfma_f32_32x32x16_bf16 v[40:55], a[40:43], a[136:139], v[40:55]
    ds_read_b64_tr_b16 a[16:17], v253 offset:0
    ds_read_b64_tr_b16 a[18:19], v253 offset:1280
    v_mfma_f32_32x32x16_bf16 v[56:71], a[44:47], a[136:139], v[56:71]
    ds_read_b64_tr_b16 a[20:21], v253 offset:64
    ds_read_b64_tr_b16 a[22:23], v253 offset:1344
    buffer_load_dwordx4 a[188:191], v2, s[8:11], s60 offen offset:3072 sc1
    v_mfma_f32_32x32x16_bf16 v[72:87], a[48:51], a[136:139], v[72:87]
    ds_read_b64_tr_b16 a[24:25], v253 offset:128
    ds_read_b64_tr_b16 a[26:27], v253 offset:1408
    v_mfma_f32_32x32x16_bf16 v[88:103], a[52:55], a[136:139], v[88:103]
    ds_read_b64_tr_b16 a[28:29], v253 offset:192
    ds_read_b64_tr_b16 a[30:31], v253 offset:1472
    buffer_load_dwordx4 v230, s[24:27], s62 offen offset:3072 lds
    v_mfma_f32_32x32x16_bf16 v[104:119], a[56:59], a[136:139], v[104:119]
    ds_read_b64_tr_b16 a[32:33], v253 offset:256
    ds_read_b64_tr_b16 a[34:35], v253 offset:1536
    s_waitcnt lgkmcnt(10)
    v_mfma_f32_32x32x16_bf16 v[40:55], a[60:63], a[140:143], v[40:55]
    ds_read_b64_tr_b16 a[36:37], v253 offset:5120
    ds_read_b64_tr_b16 a[38:39], v253 offset:6400
    s_add_u32 s60, s52, 1048576
    v_mfma_f32_32x32x16_bf16 v[56:71], a[0:3], a[140:143], v[56:71]
    ds_read_b64_tr_b16 a[40:41], v253 offset:5184
    ds_read_b64_tr_b16 a[42:43], v253 offset:6464
    buffer_load_dwordx4 a[192:195], v2, s[8:11], s60 offen offset:0 sc1
    v_mfma_f32_32x32x16_bf16 v[72:87], a[4:7], a[140:143], v[72:87]
    ds_read_b64_tr_b16 a[44:45], v253 offset:5248
    ds_read_b64_tr_b16 a[46:47], v253 offset:6528
    s_add_u32 m0, s89, 86016
    v_mfma_f32_32x32x16_bf16 v[88:103], a[8:11], a[140:143], v[88:103]
    ds_read_b64_tr_b16 a[48:49], v253 offset:5312
    ds_read_b64_tr_b16 a[50:51], v253 offset:6592
    buffer_load_dwordx4 v231, s[24:27], s62 offen offset:0 lds
    v_mfma_f32_32x32x16_bf16 v[104:119], a[12:15], a[140:143], v[104:119]
    ds_read_b64_tr_b16 a[52:53], v253 offset:5376
    ds_read_b64_tr_b16 a[54:55], v253 offset:6656
    s_waitcnt lgkmcnt(10)
    v_mfma_f32_32x32x16_bf16 v[40:55], a[16:19], a[144:147], v[40:55]
    ds_read_b64_tr_b16 a[56:57], v253 offset:10240
    ds_read_b64_tr_b16 a[58:59], v253 offset:11520
    s_add_u32 m0, s89, 102400
    s_add_u32 s62, s88, 409600
    v_mfma_f32_32x32x16_bf16 v[56:71], a[20:23], a[144:147], v[56:71]
    ds_read_b64_tr_b16 a[60:61], v253 offset:10304
    ds_read_b64_tr_b16 a[62:63], v253 offset:11584
    buffer_load_dwordx4 v227, s[24:27], s62 offen offset:0 lds
    v_mfma_f32_32x32x16_bf16 v[72:87], a[24:27], a[144:147], v[72:87]
    ds_read_b64_tr_b16 a[0:1], v253 offset:10368
    ds_read_b64_tr_b16 a[2:3], v253 offset:11648
    v_mfma_f32_32x32x16_bf16 v[88:103], a[28:31], a[144:147], v[88:103]
    ds_read_b64_tr_b16 a[4:5], v253 offset:10432
    ds_read_b64_tr_b16 a[6:7], v253 offset:11712
    buffer_load_dwordx4 v228, s[24:27], s62 offen offset:1024 lds
    v_mfma_f32_32x32x16_bf16 v[104:119], a[32:35], a[144:147], v[104:119]
    ds_read_b64_tr_b16 a[8:9], v253 offset:10496
    ds_read_b64_tr_b16 a[10:11], v253 offset:11776
    s_waitcnt lgkmcnt(10)
    v_mfma_f32_32x32x16_bf16 v[40:55], a[36:39], a[148:151], v[40:55]
    ds_read_b64_tr_b16 a[12:13], v253 offset:15360
    ds_read_b64_tr_b16 a[14:15], v253 offset:16640
    v_mfma_f32_32x32x16_bf16 v[56:71], a[40:43], a[148:151], v[56:71]
    ds_read_b64_tr_b16 a[16:17], v253 offset:15424
    ds_read_b64_tr_b16 a[18:19], v253 offset:16704
    buffer_load_dwordx4 a[196:199], v2, s[8:11], s60 offen offset:1024 sc1
    v_mfma_f32_32x32x16_bf16 v[72:87], a[44:47], a[148:151], v[72:87]
    ds_read_b64_tr_b16 a[20:21], v253 offset:15488
    ds_read_b64_tr_b16 a[22:23], v253 offset:16768
    v_mfma_f32_32x32x16_bf16 v[88:103], a[48:51], a[148:151], v[88:103]
    ds_read_b64_tr_b16 a[24:25], v253 offset:15552
    ds_read_b64_tr_b16 a[26:27], v253 offset:16832
    buffer_load_dwordx4 v229, s[24:27], s62 offen offset:2048 lds
    v_mfma_f32_32x32x16_bf16 v[104:119], a[52:55], a[148:151], v[104:119]
    ds_read_b64_tr_b16 a[28:29], v253 offset:15616
    ds_read_b64_tr_b16 a[30:31], v253 offset:16896
    s_waitcnt lgkmcnt(10)
    v_mfma_f32_32x32x16_bf16 v[40:55], a[56:59], a[152:155], v[40:55]
    ds_read_b64_tr_b16 a[32:33], v253 offset:20480
    ds_read_b64_tr_b16 a[34:35], v253 offset:21760
    v_mfma_f32_32x32x16_bf16 v[56:71], a[60:63], a[152:155], v[56:71]
    ds_read_b64_tr_b16 a[36:37], v253 offset:20544
    ds_read_b64_tr_b16 a[38:39], v253 offset:21824
    buffer_load_dwordx4 a[200:203], v2, s[8:11], s60 offen offset:2048 sc1
    v_mfma_f32_32x32x16_bf16 v[72:87], a[0:3], a[152:155], v[72:87]
    ds_read_b64_tr_b16 a[40:41], v253 offset:20608
    ds_read_b64_tr_b16 a[42:43], v253 offset:21888
    v_mfma_f32_32x32x16_bf16 v[88:103], a[4:7], a[152:155], v[88:103]
    ds_read_b64_tr_b16 a[44:45], v253 offset:20672
    ds_read_b64_tr_b16 a[46:47], v253 offset:21952
    buffer_load_dwordx4 v230, s[24:27], s62 offen offset:3072 lds
    v_mfma_f32_32x32x16_bf16 v[104:119], a[8:11], a[152:155], v[104:119]
    ds_read_b64_tr_b16 a[48:49], v253 offset:20736
    ds_read_b64_tr_b16 a[50:51], v253 offset:22016
    s_waitcnt lgkmcnt(10)
    v_mfma_f32_32x32x16_bf16 v[40:55], a[12:15], a[156:159], v[40:55]
    ds_read_b64_tr_b16 a[52:53], v253 offset:25600
    ds_read_b64_tr_b16 a[54:55], v253 offset:26880
    v_mfma_f32_32x32x16_bf16 v[56:71], a[16:19], a[156:159], v[56:71]
    ds_read_b64_tr_b16 a[56:57], v253 offset:25664
    ds_read_b64_tr_b16 a[58:59], v253 offset:26944
    buffer_load_dwordx4 a[204:207], v2, s[8:11], s60 offen offset:3072 sc1
    v_mfma_f32_32x32x16_bf16 v[72:87], a[20:23], a[156:159], v[72:87]
    ds_read_b64_tr_b16 a[60:61], v253 offset:25728
    ds_read_b64_tr_b16 a[62:63], v253 offset:27008
    s_add_u32 m0, s89, 106496
    v_mfma_f32_32x32x16_bf16 v[88:103], a[24:27], a[156:159], v[88:103]
    ds_read_b64_tr_b16 a[0:1], v253 offset:25792
    ds_read_b64_tr_b16 a[2:3], v253 offset:27072
    buffer_load_dwordx4 v231, s[24:27], s62 offen offset:0 lds
    v_mfma_f32_32x32x16_bf16 v[104:119], a[28:31], a[156:159], v[104:119]
    ds_read_b64_tr_b16 a[4:5], v253 offset:25856
    ds_read_b64_tr_b16 a[6:7], v253 offset:27136
    s_waitcnt vmcnt(16) lgkmcnt(10)
    v_mfma_f32_32x32x16_bf16 v[40:55], a[32:35], a[160:163], v[40:55]
    s_barrier
    ds_read_b64_tr_b16 a[8:9], v253 offset:30720
    ds_read_b64_tr_b16 a[10:11], v253 offset:32000
    s_add_u32 m0, s89, 122880
    s_add_u32 s62, s88, 573440
    v_mfma_f32_32x32x16_bf16 v[56:71], a[36:39], a[160:163], v[56:71]
    ds_read_b64_tr_b16 a[12:13], v253 offset:30784
    ds_read_b64_tr_b16 a[14:15], v253 offset:32064
    buffer_load_dwordx4 v227, s[24:27], s62 offen offset:0 lds
    v_mfma_f32_32x32x16_bf16 v[72:87], a[40:43], a[160:163], v[72:87]
    ds_read_b64_tr_b16 a[16:17], v253 offset:30848
    ds_read_b64_tr_b16 a[18:19], v253 offset:32128
    v_mfma_f32_32x32x16_bf16 v[88:103], a[44:47], a[160:163], v[88:103]
    ds_read_b64_tr_b16 a[20:21], v253 offset:30912
    ds_read_b64_tr_b16 a[22:23], v253 offset:32192
    buffer_load_dwordx4 v228, s[24:27], s62 offen offset:1024 lds
    v_mfma_f32_32x32x16_bf16 v[104:119], a[48:51], a[160:163], v[104:119]
    ds_read_b64_tr_b16 a[24:25], v253 offset:30976
    ds_read_b64_tr_b16 a[26:27], v253 offset:32256
    s_waitcnt lgkmcnt(10)
    v_mfma_f32_32x32x16_bf16 v[40:55], a[52:55], a[164:167], v[40:55]
    ds_read_b64_tr_b16 a[28:29], v253 offset:35840
    ds_read_b64_tr_b16 a[30:31], v253 offset:37120
    s_add_u32 s60, s52, 1179648
    v_mfma_f32_32x32x16_bf16 v[56:71], a[56:59], a[164:167], v[56:71]
    ds_read_b64_tr_b16 a[32:33], v253 offset:35904
    ds_read_b64_tr_b16 a[34:35], v253 offset:37184
    buffer_load_dwordx4 a[208:211], v2, s[8:11], s60 offen offset:0 sc1
    v_mfma_f32_32x32x16_bf16 v[72:87], a[60:63], a[164:167], v[72:87]
    ds_read_b64_tr_b16 a[36:37], v253 offset:35968
    ds_read_b64_tr_b16 a[38:39], v253 offset:37248
    v_mfma_f32_32x32x16_bf16 v[88:103], a[0:3], a[164:167], v[88:103]
    ds_read_b64_tr_b16 a[40:41], v253 offset:36032
    ds_read_b64_tr_b16 a[42:43], v253 offset:37312
    buffer_load_dwordx4 v229, s[24:27], s62 offen offset:2048 lds
    v_mfma_f32_32x32x16_bf16 v[104:119], a[4:7], a[164:167], v[104:119]
    ds_read_b64_tr_b16 a[44:45], v253 offset:36096
    ds_read_b64_tr_b16 a[46:47], v253 offset:37376
    s_waitcnt lgkmcnt(10)
    v_mfma_f32_32x32x16_bf16 v[40:55], a[8:11], a[168:171], v[40:55]
    ds_read_b64_tr_b16 a[48:49], v253 offset:40960
    ds_read_b64_tr_b16 a[50:51], v253 offset:42240
    v_mfma_f32_32x32x16_bf16 v[56:71], a[12:15], a[168:171], v[56:71]
    ds_read_b64_tr_b16 a[52:53], v253 offset:41024
    ds_read_b64_tr_b16 a[54:55], v253 offset:42304
    buffer_load_dwordx4 a[212:215], v2, s[8:11], s60 offen offset:1024 sc1
    v_mfma_f32_32x32x16_bf16 v[72:87], a[16:19], a[168:171], v[72:87]
    ds_read_b64_tr_b16 a[56:57], v253 offset:41088
    ds_read_b64_tr_b16 a[58:59], v253 offset:42368
    v_mfma_f32_32x32x16_bf16 v[88:103], a[20:23], a[168:171], v[88:103]
    ds_read_b64_tr_b16 a[60:61], v253 offset:41152
    ds_read_b64_tr_b16 a[62:63], v253 offset:42432
    buffer_load_dwordx4 v230, s[24:27], s62 offen offset:3072 lds
    v_mfma_f32_32x32x16_bf16 v[104:119], a[24:27], a[168:171], v[104:119]
    ds_read_b64_tr_b16 a[0:1], v253 offset:41216
    ds_read_b64_tr_b16 a[2:3], v253 offset:42496
    s_waitcnt lgkmcnt(10)
    v_mfma_f32_32x32x16_bf16 v[40:55], a[28:31], a[172:175], v[40:55]
    ds_read_b64_tr_b16 a[4:5], v253 offset:46080
    ds_read_b64_tr_b16 a[6:7], v253 offset:47360
    v_mfma_f32_32x32x16_bf16 v[56:71], a[32:35], a[172:175], v[56:71]
    ds_read_b64_tr_b16 a[8:9], v253 offset:46144
    ds_read_b64_tr_b16 a[10:11], v253 offset:47424
    buffer_load_dwordx4 a[216:219], v2, s[8:11], s60 offen offset:2048 sc1
    v_mfma_f32_32x32x16_bf16 v[72:87], a[36:39], a[172:175], v[72:87]
    ds_read_b64_tr_b16 a[12:13], v253 offset:46208
    ds_read_b64_tr_b16 a[14:15], v253 offset:47488
    s_add_u32 m0, s89, 126976
    v_mfma_f32_32x32x16_bf16 v[88:103], a[40:43], a[172:175], v[88:103]
    ds_read_b64_tr_b16 a[16:17], v253 offset:46272
    ds_read_b64_tr_b16 a[18:19], v253 offset:47552
    buffer_load_dwordx4 v231, s[24:27], s62 offen offset:0 lds
    v_mfma_f32_32x32x16_bf16 v[104:119], a[44:47], a[172:175], v[104:119]
    ds_read_b64_tr_b16 a[20:21], v253 offset:46336
    ds_read_b64_tr_b16 a[22:23], v253 offset:47616
    s_waitcnt lgkmcnt(10)
    v_mfma_f32_32x32x16_bf16 v[40:55], a[48:51], a[176:179], v[40:55]
    ds_read_b64_tr_b16 a[24:25], v253 offset:51200
    ds_read_b64_tr_b16 a[26:27], v253 offset:52480
    s_add_u32 m0, s89, 0
    s_add_u32 s62, s88, 737280
    v_mfma_f32_32x32x16_bf16 v[56:71], a[52:55], a[176:179], v[56:71]
    ds_read_b64_tr_b16 a[28:29], v253 offset:51264
    ds_read_b64_tr_b16 a[30:31], v253 offset:52544
    buffer_load_dwordx4 v227, s[24:27], s62 offen offset:0 lds
    v_mfma_f32_32x32x16_bf16 v[72:87], a[56:59], a[176:179], v[72:87]
    ds_read_b64_tr_b16 a[32:33], v253 offset:51328
    ds_read_b64_tr_b16 a[34:35], v253 offset:52608
    v_mfma_f32_32x32x16_bf16 v[88:103], a[60:63], a[176:179], v[88:103]
    ds_read_b64_tr_b16 a[36:37], v253 offset:51392
    ds_read_b64_tr_b16 a[38:39], v253 offset:52672
    buffer_load_dwordx4 v228, s[24:27], s62 offen offset:1024 lds
    v_mfma_f32_32x32x16_bf16 v[104:119], a[0:3], a[176:179], v[104:119]
    ds_read_b64_tr_b16 a[40:41], v253 offset:51456
    ds_read_b64_tr_b16 a[42:43], v253 offset:52736
    s_waitcnt lgkmcnt(10)
    v_mfma_f32_32x32x16_bf16 v[40:55], a[4:7], a[180:183], v[40:55]
    ds_read_b64_tr_b16 a[44:45], v253 offset:56320
    ds_read_b64_tr_b16 a[46:47], v253 offset:57600
    v_mfma_f32_32x32x16_bf16 v[56:71], a[8:11], a[180:183], v[56:71]
    ds_read_b64_tr_b16 a[48:49], v253 offset:56384
    ds_read_b64_tr_b16 a[50:51], v253 offset:57664
    buffer_load_dwordx4 a[220:223], v2, s[8:11], s60 offen offset:3072 sc1
    v_mfma_f32_32x32x16_bf16 v[72:87], a[12:15], a[180:183], v[72:87]
    ds_read_b64_tr_b16 a[52:53], v253 offset:56448
    ds_read_b64_tr_b16 a[54:55], v253 offset:57728
    v_mfma_f32_32x32x16_bf16 v[88:103], a[16:19], a[180:183], v[88:103]
    ds_read_b64_tr_b16 a[56:57], v253 offset:56512
    ds_read_b64_tr_b16 a[58:59], v253 offset:57792
    buffer_load_dwordx4 v229, s[24:27], s62 offen offset:2048 lds
    v_mfma_f32_32x32x16_bf16 v[104:119], a[20:23], a[180:183], v[104:119]
    ds_read_b64_tr_b16 a[60:61], v253 offset:56576
    ds_read_b64_tr_b16 a[62:63], v253 offset:57856
    s_waitcnt vmcnt(25) lgkmcnt(10)
    v_mfma_f32_32x32x16_bf16 v[40:55], a[24:27], a[184:187], v[40:55]
    ds_read_b64_tr_b16 a[0:1], v253 offset:61440
    ds_read_b64_tr_b16 a[2:3], v253 offset:62720
    s_add_u32 s60, s52, 1310720
    v_mfma_f32_32x32x16_bf16 v[56:71], a[28:31], a[184:187], v[56:71]
    ds_read_b64_tr_b16 a[4:5], v253 offset:61504
    ds_read_b64_tr_b16 a[6:7], v253 offset:62784
    buffer_load_dwordx4 a[224:227], v2, s[8:11], s60 offen offset:0 sc1
    v_mfma_f32_32x32x16_bf16 v[72:87], a[32:35], a[184:187], v[72:87]
    ds_read_b64_tr_b16 a[8:9], v253 offset:61568
    ds_read_b64_tr_b16 a[10:11], v253 offset:62848
    v_mfma_f32_32x32x16_bf16 v[88:103], a[36:39], a[184:187], v[88:103]
    ds_read_b64_tr_b16 a[12:13], v253 offset:61632
    ds_read_b64_tr_b16 a[14:15], v253 offset:62912
    buffer_load_dwordx4 v230, s[24:27], s62 offen offset:3072 lds
    v_mfma_f32_32x32x16_bf16 v[104:119], a[40:43], a[184:187], v[104:119]
    ds_read_b64_tr_b16 a[16:17], v253 offset:61696
    ds_read_b64_tr_b16 a[18:19], v253 offset:62976
    s_waitcnt vmcnt(25) lgkmcnt(10)
    v_mfma_f32_32x32x16_bf16 v[40:55], a[44:47], a[188:191], v[40:55]
    ds_read_b64_tr_b16 a[20:21], v254 offset:1024
    ds_read_b64_tr_b16 a[22:23], v254 offset:2304
    v_mfma_f32_32x32x16_bf16 v[56:71], a[48:51], a[188:191], v[56:71]
    ds_read_b64_tr_b16 a[24:25], v254 offset:1088
    ds_read_b64_tr_b16 a[26:27], v254 offset:2368
    buffer_load_dwordx4 a[228:231], v2, s[8:11], s60 offen offset:1024 sc1
    v_mfma_f32_32x32x16_bf16 v[72:87], a[52:55], a[188:191], v[72:87]
    ds_read_b64_tr_b16 a[28:29], v254 offset:1152
    ds_read_b64_tr_b16 a[30:31], v254 offset:2432
    s_add_u32 m0, s89, 4096
    v_mfma_f32_32x32x16_bf16 v[88:103], a[56:59], a[188:191], v[88:103]
    ds_read_b64_tr_b16 a[32:33], v254 offset:1216
    ds_read_b64_tr_b16 a[34:35], v254 offset:2496
    buffer_load_dwordx4 v231, s[24:27], s62 offen offset:0 lds
    v_mfma_f32_32x32x16_bf16 v[104:119], a[60:63], a[188:191], v[104:119]
    ds_read_b64_tr_b16 a[36:37], v254 offset:1280
    ds_read_b64_tr_b16 a[38:39], v254 offset:2560
    s_waitcnt vmcnt(16) lgkmcnt(10)
    v_mfma_f32_32x32x16_bf16 v[40:55], a[0:3], a[192:195], v[40:55]
    s_barrier
    ds_read_b64_tr_b16 a[40:41], v254 offset:6144
    ds_read_b64_tr_b16 a[42:43], v254 offset:7424
    s_add_u32 m0, s89, 20480
    s_add_u32 s62, s88, 901120
    v_mfma_f32_32x32x16_bf16 v[56:71], a[4:7], a[192:195], v[56:71]
    ds_read_b64_tr_b16 a[44:45], v254 offset:6208
    ds_read_b64_tr_b16 a[46:47], v254 offset:7488
    buffer_load_dwordx4 v227, s[24:27], s62 offen offset:0 lds
    v_mfma_f32_32x32x16_bf16 v[72:87], a[8:11], a[192:195], v[72:87]
    ds_read_b64_tr_b16 a[48:49], v254 offset:6272
    ds_read_b64_tr_b16 a[50:51], v254 offset:7552
    v_mfma_f32_32x32x16_bf16 v[88:103], a[12:15], a[192:195], v[88:103]
    ds_read_b64_tr_b16 a[52:53], v254 offset:6336
    ds_read_b64_tr_b16 a[54:55], v254 offset:7616
    buffer_load_dwordx4 v228, s[24:27], s62 offen offset:1024 lds
    v_mfma_f32_32x32x16_bf16 v[104:119], a[16:19], a[192:195], v[104:119]
    ds_read_b64_tr_b16 a[56:57], v254 offset:6400
    ds_read_b64_tr_b16 a[58:59], v254 offset:7680
    s_waitcnt lgkmcnt(10)
    v_mfma_f32_32x32x16_bf16 v[40:55], a[20:23], a[196:199], v[40:55]
    ds_read_b64_tr_b16 a[60:61], v254 offset:11264
    ds_read_b64_tr_b16 a[62:63], v254 offset:12544
    v_mfma_f32_32x32x16_bf16 v[56:71], a[24:27], a[196:199], v[56:71]
    ds_read_b64_tr_b16 a[0:1], v254 offset:11328
    ds_read_b64_tr_b16 a[2:3], v254 offset:12608
    buffer_load_dwordx4 a[232:235], v2, s[8:11], s60 offen offset:2048 sc1
    v_mfma_f32_32x32x16_bf16 v[72:87], a[28:31], a[196:199], v[72:87]
    ds_read_b64_tr_b16 a[4:5], v254 offset:11392
    ds_read_b64_tr_b16 a[6:7], v254 offset:12672
    v_mfma_f32_32x32x16_bf16 v[88:103], a[32:35], a[196:199], v[88:103]
    ds_read_b64_tr_b16 a[8:9], v254 offset:11456
    ds_read_b64_tr_b16 a[10:11], v254 offset:12736
    buffer_load_dwordx4 v229, s[24:27], s62 offen offset:2048 lds
    v_mfma_f32_32x32x16_bf16 v[104:119], a[36:39], a[196:199], v[104:119]
    ds_read_b64_tr_b16 a[12:13], v254 offset:11520
    ds_read_b64_tr_b16 a[14:15], v254 offset:12800
    s_waitcnt lgkmcnt(10)
    v_mfma_f32_32x32x16_bf16 v[40:55], a[40:43], a[200:203], v[40:55]
    ds_read_b64_tr_b16 a[16:17], v254 offset:16384
    ds_read_b64_tr_b16 a[18:19], v254 offset:17664
    v_mfma_f32_32x32x16_bf16 v[56:71], a[44:47], a[200:203], v[56:71]
    ds_read_b64_tr_b16 a[20:21], v254 offset:16448
    ds_read_b64_tr_b16 a[22:23], v254 offset:17728
    buffer_load_dwordx4 a[236:239], v2, s[8:11], s60 offen offset:3072 sc1
    v_mfma_f32_32x32x16_bf16 v[72:87], a[48:51], a[200:203], v[72:87]
    ds_read_b64_tr_b16 a[24:25], v254 offset:16512
    ds_read_b64_tr_b16 a[26:27], v254 offset:17792
    v_mfma_f32_32x32x16_bf16 v[88:103], a[52:55], a[200:203], v[88:103]
    ds_read_b64_tr_b16 a[28:29], v254 offset:16576
    ds_read_b64_tr_b16 a[30:31], v254 offset:17856
    buffer_load_dwordx4 v230, s[24:27], s62 offen offset:3072 lds
    v_mfma_f32_32x32x16_bf16 v[104:119], a[56:59], a[200:203], v[104:119]
    ds_read_b64_tr_b16 a[32:33], v254 offset:16640
    ds_read_b64_tr_b16 a[34:35], v254 offset:17920
    s_waitcnt lgkmcnt(10)
    v_mfma_f32_32x32x16_bf16 v[40:55], a[60:63], a[204:207], v[40:55]
    ds_read_b64_tr_b16 a[36:37], v254 offset:21504
    ds_read_b64_tr_b16 a[38:39], v254 offset:22784
    s_add_u32 s60, s52, 1441792
    v_mfma_f32_32x32x16_bf16 v[56:71], a[0:3], a[204:207], v[56:71]
    ds_read_b64_tr_b16 a[40:41], v254 offset:21568
    ds_read_b64_tr_b16 a[42:43], v254 offset:22848
    buffer_load_dwordx4 a[240:243], v2, s[8:11], s60 offen offset:0 sc1
    v_mfma_f32_32x32x16_bf16 v[72:87], a[4:7], a[204:207], v[72:87]
    ds_read_b64_tr_b16 a[44:45], v254 offset:21632
    ds_read_b64_tr_b16 a[46:47], v254 offset:22912
    s_add_u32 m0, s89, 24576
    v_mfma_f32_32x32x16_bf16 v[88:103], a[8:11], a[204:207], v[88:103]
    ds_read_b64_tr_b16 a[48:49], v254 offset:21696
    ds_read_b64_tr_b16 a[50:51], v254 offset:22976
    buffer_load_dwordx4 v231, s[24:27], s62 offen offset:0 lds
    v_mfma_f32_32x32x16_bf16 v[104:119], a[12:15], a[204:207], v[104:119]
    ds_read_b64_tr_b16 a[52:53], v254 offset:21760
    ds_read_b64_tr_b16 a[54:55], v254 offset:23040
    s_waitcnt vmcnt(21) lgkmcnt(10)
    v_mfma_f32_32x32x16_bf16 v[40:55], a[16:19], a[208:211], v[40:55]
    ds_read_b64_tr_b16 a[56:57], v254 offset:26624
    ds_read_b64_tr_b16 a[58:59], v254 offset:27904
    s_add_u32 m0, s89, 40960
    s_add_u32 s62, s88, 1064960
    v_mfma_f32_32x32x16_bf16 v[56:71], a[20:23], a[208:211], v[56:71]
    ds_read_b64_tr_b16 a[60:61], v254 offset:26688
    ds_read_b64_tr_b16 a[62:63], v254 offset:27968
    buffer_load_dwordx4 v227, s[24:27], s62 offen offset:0 lds
    v_mfma_f32_32x32x16_bf16 v[72:87], a[24:27], a[208:211], v[72:87]
    ds_read_b64_tr_b16 a[0:1], v254 offset:26752
    ds_read_b64_tr_b16 a[2:3], v254 offset:28032
    v_mfma_f32_32x32x16_bf16 v[88:103], a[28:31], a[208:211], v[88:103]
    ds_read_b64_tr_b16 a[4:5], v254 offset:26816
    ds_read_b64_tr_b16 a[6:7], v254 offset:28096
    buffer_load_dwordx4 v228, s[24:27], s62 offen offset:1024 lds
    v_mfma_f32_32x32x16_bf16 v[104:119], a[32:35], a[208:211], v[104:119]
    ds_read_b64_tr_b16 a[8:9], v254 offset:26880
    ds_read_b64_tr_b16 a[10:11], v254 offset:28160
    s_waitcnt vmcnt(21) lgkmcnt(10)
    v_mfma_f32_32x32x16_bf16 v[40:55], a[36:39], a[212:215], v[40:55]
    ds_read_b64_tr_b16 a[12:13], v254 offset:31744
    ds_read_b64_tr_b16 a[14:15], v254 offset:33024
    v_mfma_f32_32x32x16_bf16 v[56:71], a[40:43], a[212:215], v[56:71]
    ds_read_b64_tr_b16 a[16:17], v254 offset:31808
    ds_read_b64_tr_b16 a[18:19], v254 offset:33088
    buffer_load_dwordx4 a[244:247], v2, s[8:11], s60 offen offset:1024 sc1
    v_mfma_f32_32x32x16_bf16 v[72:87], a[44:47], a[212:215], v[72:87]
    ds_read_b64_tr_b16 a[20:21], v254 offset:31872
    ds_read_b64_tr_b16 a[22:23], v254 offset:33152
    v_mfma_f32_32x32x16_bf16 v[88:103], a[48:51], a[212:215], v[88:103]
    ds_read_b64_tr_b16 a[24:25], v254 offset:31936
    ds_read_b64_tr_b16 a[26:27], v254 offset:33216
    buffer_load_dwordx4 v229, s[24:27], s62 offen offset:2048 lds
    v_mfma_f32_32x32x16_bf16 v[104:119], a[52:55], a[212:215], v[104:119]
    ds_read_b64_tr_b16 a[28:29], v254 offset:32000
    ds_read_b64_tr_b16 a[30:31], v254 offset:33280
    s_waitcnt vmcnt(21) lgkmcnt(10)
    v_mfma_f32_32x32x16_bf16 v[40:55], a[56:59], a[216:219], v[40:55]
    ds_read_b64_tr_b16 a[32:33], v254 offset:36864
    ds_read_b64_tr_b16 a[34:35], v254 offset:38144
    v_mfma_f32_32x32x16_bf16 v[56:71], a[60:63], a[216:219], v[56:71]
    ds_read_b64_tr_b16 a[36:37], v254 offset:36928
    ds_read_b64_tr_b16 a[38:39], v254 offset:38208
    buffer_load_dwordx4 a[248:251], v2, s[8:11], s60 offen offset:2048 sc1
    v_mfma_f32_32x32x16_bf16 v[72:87], a[0:3], a[216:219], v[72:87]
    ds_read_b64_tr_b16 a[40:41], v254 offset:36992
    ds_read_b64_tr_b16 a[42:43], v254 offset:38272
    v_mfma_f32_32x32x16_bf16 v[88:103], a[4:7], a[216:219], v[88:103]
    ds_read_b64_tr_b16 a[44:45], v254 offset:37056
    ds_read_b64_tr_b16 a[46:47], v254 offset:38336
    buffer_load_dwordx4 v230, s[24:27], s62 offen offset:3072 lds
    v_mfma_f32_32x32x16_bf16 v[104:119], a[8:11], a[216:219], v[104:119]
    ds_read_b64_tr_b16 a[48:49], v254 offset:37120
    ds_read_b64_tr_b16 a[50:51], v254 offset:38400
    s_waitcnt vmcnt(19) lgkmcnt(10)
    v_mfma_f32_32x32x16_bf16 v[40:55], a[12:15], a[220:223], v[40:55]
    ds_read_b64_tr_b16 a[52:53], v254 offset:41984
    ds_read_b64_tr_b16 a[54:55], v254 offset:43264
    v_mfma_f32_32x32x16_bf16 v[56:71], a[16:19], a[220:223], v[56:71]
    ds_read_b64_tr_b16 a[56:57], v254 offset:42048
    ds_read_b64_tr_b16 a[58:59], v254 offset:43328
    buffer_load_dwordx4 a[252:255], v2, s[8:11], s60 offen offset:3072 sc1
    v_mfma_f32_32x32x16_bf16 v[72:87], a[20:23], a[220:223], v[72:87]
    ds_read_b64_tr_b16 a[60:61], v254 offset:42112
    ds_read_b64_tr_b16 a[62:63], v254 offset:43392
    s_add_u32 m0, s89, 45056
    v_mfma_f32_32x32x16_bf16 v[88:103], a[24:27], a[220:223], v[88:103]
    ds_read_b64_tr_b16 a[0:1], v254 offset:42176
    ds_read_b64_tr_b16 a[2:3], v254 offset:43456
    buffer_load_dwordx4 v231, s[24:27], s62 offen offset:0 lds
    v_mfma_f32_32x32x16_bf16 v[104:119], a[28:31], a[220:223], v[104:119]
    ds_read_b64_tr_b16 a[4:5], v254 offset:42240
    ds_read_b64_tr_b16 a[6:7], v254 offset:43520
    s_waitcnt vmcnt(16) lgkmcnt(10)
    v_mfma_f32_32x32x16_bf16 v[40:55], a[32:35], a[224:227], v[40:55]
    s_barrier
    ds_read_b64_tr_b16 a[8:9], v254 offset:47104
    ds_read_b64_tr_b16 a[10:11], v254 offset:48384
    s_add_u32 s60, s52, 1572864
    v_mfma_f32_32x32x16_bf16 v[56:71], a[36:39], a[224:227], v[56:71]
    ds_read_b64_tr_b16 a[12:13], v254 offset:47168
    ds_read_b64_tr_b16 a[14:15], v254 offset:48448
    buffer_load_dwordx4 a[64:67], v2, s[8:11], s60 offen offset:0 sc1
    v_mfma_f32_32x32x16_bf16 v[72:87], a[40:43], a[224:227], v[72:87]
    ds_read_b64_tr_b16 a[16:17], v254 offset:47232
    ds_read_b64_tr_b16 a[18:19], v254 offset:48512
    s_add_u32 m0, s89, 61440
    s_add_u32 s62, s88, 1228800
    v_mfma_f32_32x32x16_bf16 v[88:103], a[44:47], a[224:227], v[88:103]
    ds_read_b64_tr_b16 a[20:21], v254 offset:47296
    ds_read_b64_tr_b16 a[22:23], v254 offset:48576
    buffer_load_dwordx4 v227, s[24:27], s62 offen offset:0 lds
    v_mfma_f32_32x32x16_bf16 v[104:119], a[48:51], a[224:227], v[104:119]
    ds_read_b64_tr_b16 a[24:25], v254 offset:47360
    ds_read_b64_tr_b16 a[26:27], v254 offset:48640
    s_waitcnt lgkmcnt(10)
    v_mfma_f32_32x32x16_bf16 v[40:55], a[52:55], a[228:231], v[40:55]
    ds_read_b64_tr_b16 a[28:29], v254 offset:52224
    ds_read_b64_tr_b16 a[30:31], v254 offset:53504
    v_mfma_f32_32x32x16_bf16 v[56:71], a[56:59], a[228:231], v[56:71]
    ds_read_b64_tr_b16 a[32:33], v254 offset:52288
    ds_read_b64_tr_b16 a[34:35], v254 offset:53568
    buffer_load_dwordx4 a[68:71], v2, s[8:11], s60 offen offset:1024 sc1
    v_mfma_f32_32x32x16_bf16 v[72:87], a[60:63], a[228:231], v[72:87]
    ds_read_b64_tr_b16 a[36:37], v254 offset:52352
    ds_read_b64_tr_b16 a[38:39], v254 offset:53632
    v_mfma_f32_32x32x16_bf16 v[88:103], a[0:3], a[228:231], v[88:103]
    ds_read_b64_tr_b16 a[40:41], v254 offset:52416
    ds_read_b64_tr_b16 a[42:43], v254 offset:53696
    buffer_load_dwordx4 v228, s[24:27], s62 offen offset:1024 lds
    v_mfma_f32_32x32x16_bf16 v[104:119], a[4:7], a[228:231], v[104:119]
    ds_read_b64_tr_b16 a[44:45], v254 offset:52480
    ds_read_b64_tr_b16 a[46:47], v254 offset:53760
    s_waitcnt vmcnt(17) lgkmcnt(10)
    v_mfma_f32_32x32x16_bf16 v[40:55], a[8:11], a[232:235], v[40:55]
    ds_read_b64_tr_b16 a[48:49], v254 offset:57344
    ds_read_b64_tr_b16 a[50:51], v254 offset:58624
    v_mfma_f32_32x32x16_bf16 v[56:71], a[12:15], a[232:235], v[56:71]
    ds_read_b64_tr_b16 a[52:53], v254 offset:57408
    ds_read_b64_tr_b16 a[54:55], v254 offset:58688
    buffer_load_dwordx4 a[72:75], v2, s[8:11], s60 offen offset:2048 sc1
    v_mfma_f32_32x32x16_bf16 v[72:87], a[16:19], a[232:235], v[72:87]
    ds_read_b64_tr_b16 a[56:57], v254 offset:57472
    ds_read_b64_tr_b16 a[58:59], v254 offset:58752
    v_mfma_f32_32x32x16_bf16 v[88:103], a[20:23], a[232:235], v[88:103]
    ds_read_b64_tr_b16 a[60:61], v254 offset:57536
    ds_read_b64_tr_b16 a[62:63], v254 offset:58816
    buffer_load_dwordx4 v229, s[24:27], s62 offen offset:2048 lds
    v_mfma_f32_32x32x16_bf16 v[104:119], a[24:27], a[232:235], v[104:119]
    ds_read_b64_tr_b16 a[0:1], v254 offset:57600
    ds_read_b64_tr_b16 a[2:3], v254 offset:58880
    s_waitcnt vmcnt(17) lgkmcnt(10)
    v_mfma_f32_32x32x16_bf16 v[40:55], a[28:31], a[236:239], v[40:55]
    ds_read_b64_tr_b16 a[4:5], v254 offset:62464
    ds_read_b64_tr_b16 a[6:7], v254 offset:63744
    v_mfma_f32_32x32x16_bf16 v[56:71], a[32:35], a[236:239], v[56:71]
    ds_read_b64_tr_b16 a[8:9], v254 offset:62528
    ds_read_b64_tr_b16 a[10:11], v254 offset:63808
    buffer_load_dwordx4 a[76:79], v2, s[8:11], s60 offen offset:3072 sc1
    v_mfma_f32_32x32x16_bf16 v[72:87], a[36:39], a[236:239], v[72:87]
    ds_read_b64_tr_b16 a[12:13], v254 offset:62592
    ds_read_b64_tr_b16 a[14:15], v254 offset:63872
    v_mfma_f32_32x32x16_bf16 v[88:103], a[40:43], a[236:239], v[88:103]
    ds_read_b64_tr_b16 a[16:17], v254 offset:62656
    ds_read_b64_tr_b16 a[18:19], v254 offset:63936
    buffer_load_dwordx4 v230, s[24:27], s62 offen offset:3072 lds
    v_mfma_f32_32x32x16_bf16 v[104:119], a[44:47], a[236:239], v[104:119]
    ds_read_b64_tr_b16 a[20:21], v254 offset:62720
    ds_read_b64_tr_b16 a[22:23], v254 offset:64000
    s_waitcnt vmcnt(17) lgkmcnt(10)
    v_mfma_f32_32x32x16_bf16 v[40:55], a[48:51], a[240:243], v[40:55]
    ds_read_b64_tr_b16 a[24:25], v255 offset:2048
    ds_read_b64_tr_b16 a[26:27], v255 offset:3328
    s_add_u32 s60, s52, 1703936
    v_mfma_f32_32x32x16_bf16 v[56:71], a[52:55], a[240:243], v[56:71]
    ds_read_b64_tr_b16 a[28:29], v255 offset:2112
    ds_read_b64_tr_b16 a[30:31], v255 offset:3392
    buffer_load_dwordx4 a[80:83], v2, s[8:11], s60 offen offset:0 sc1
    v_mfma_f32_32x32x16_bf16 v[72:87], a[56:59], a[240:243], v[72:87]
    ds_read_b64_tr_b16 a[32:33], v255 offset:2176
    ds_read_b64_tr_b16 a[34:35], v255 offset:3456
    buffer_load_dwordx4 a[84:87], v2, s[8:11], s60 offen offset:1024 sc1
    s_add_u32 m0, s89, 65536
    v_mfma_f32_32x32x16_bf16 v[88:103], a[60:63], a[240:243], v[88:103]
    ds_read_b64_tr_b16 a[36:37], v255 offset:2240
    ds_read_b64_tr_b16 a[38:39], v255 offset:3520
    buffer_load_dwordx4 v231, s[24:27], s62 offen offset:0 lds
    v_mfma_f32_32x32x16_bf16 v[104:119], a[0:3], a[240:243], v[104:119]
    ds_read_b64_tr_b16 a[40:41], v255 offset:2304
    ds_read_b64_tr_b16 a[42:43], v255 offset:3584
    s_waitcnt vmcnt(16) lgkmcnt(10)
    v_mfma_f32_32x32x16_bf16 v[40:55], a[4:7], a[244:247], v[40:55]
    ds_read_b64_tr_b16 a[44:45], v255 offset:7168
    ds_read_b64_tr_b16 a[46:47], v255 offset:8448
    v_mfma_f32_32x32x16_bf16 v[56:71], a[8:11], a[244:247], v[56:71]
    ds_read_b64_tr_b16 a[48:49], v255 offset:7232
    ds_read_b64_tr_b16 a[50:51], v255 offset:8512
    buffer_load_dwordx4 a[88:91], v2, s[8:11], s60 offen offset:2048 sc1
    v_mfma_f32_32x32x16_bf16 v[72:87], a[12:15], a[244:247], v[72:87]
    ds_read_b64_tr_b16 a[52:53], v255 offset:7296
    ds_read_b64_tr_b16 a[54:55], v255 offset:8576
    v_mfma_f32_32x32x16_bf16 v[88:103], a[16:19], a[244:247], v[88:103]
    ds_read_b64_tr_b16 a[56:57], v255 offset:7360
    ds_read_b64_tr_b16 a[58:59], v255 offset:8640
    buffer_load_dwordx4 a[92:95], v2, s[8:11], s60 offen offset:3072 sc1
    v_mfma_f32_32x32x16_bf16 v[104:119], a[20:23], a[244:247], v[104:119]
    ds_read_b64_tr_b16 a[60:61], v255 offset:7424
    ds_read_b64_tr_b16 a[62:63], v255 offset:8704
    s_waitcnt vmcnt(16) lgkmcnt(10)
    v_mfma_f32_32x32x16_bf16 v[40:55], a[24:27], a[248:251], v[40:55]
    ds_read_b64_tr_b16 a[0:1], v253 offset:0
    ds_read_b64_tr_b16 a[2:3], v253 offset:1280
    s_add_u32 s60, s52, 1835008
    v_mfma_f32_32x32x16_bf16 v[56:71], a[28:31], a[248:251], v[56:71]
    ds_read_b64_tr_b16 a[4:5], v253 offset:64
    ds_read_b64_tr_b16 a[6:7], v253 offset:1344
    buffer_load_dwordx4 a[96:99], v2, s[8:11], s60 offen offset:0 sc1
    v_mfma_f32_32x32x16_bf16 v[72:87], a[32:35], a[248:251], v[72:87]
    ds_read_b64_tr_b16 a[8:9], v253 offset:128
    ds_read_b64_tr_b16 a[10:11], v253 offset:1408
    v_mfma_f32_32x32x16_bf16 v[88:103], a[36:39], a[248:251], v[88:103]
    ds_read_b64_tr_b16 a[12:13], v253 offset:192
    ds_read_b64_tr_b16 a[14:15], v253 offset:1472
    buffer_load_dwordx4 a[100:103], v2, s[8:11], s60 offen offset:1024 sc1
    v_mfma_f32_32x32x16_bf16 v[104:119], a[40:43], a[248:251], v[104:119]
    ds_read_b64_tr_b16 a[16:17], v253 offset:256
    ds_read_b64_tr_b16 a[18:19], v253 offset:1536
    s_waitcnt vmcnt(16) lgkmcnt(10)
    v_mfma_f32_32x32x16_bf16 v[40:55], a[44:47], a[252:255], v[40:55]
    ds_read_b64_tr_b16 a[20:21], v253 offset:5120
    ds_read_b64_tr_b16 a[22:23], v253 offset:6400
    v_mfma_f32_32x32x16_bf16 v[56:71], a[48:51], a[252:255], v[56:71]
    ds_read_b64_tr_b16 a[24:25], v253 offset:5184
    ds_read_b64_tr_b16 a[26:27], v253 offset:6464
    buffer_load_dwordx4 a[104:107], v2, s[8:11], s60 offen offset:2048 sc1
    v_mfma_f32_32x32x16_bf16 v[72:87], a[52:55], a[252:255], v[72:87]
    ds_read_b64_tr_b16 a[28:29], v253 offset:5248
    ds_read_b64_tr_b16 a[30:31], v253 offset:6528
    v_mfma_f32_32x32x16_bf16 v[88:103], a[56:59], a[252:255], v[88:103]
    ds_read_b64_tr_b16 a[32:33], v253 offset:5312
    ds_read_b64_tr_b16 a[34:35], v253 offset:6592
    buffer_load_dwordx4 a[108:111], v2, s[8:11], s60 offen offset:3072 sc1
    v_mfma_f32_32x32x16_bf16 v[104:119], a[60:63], a[252:255], v[104:119]
    ds_read_b64_tr_b16 a[36:37], v253 offset:5376
    ds_read_b64_tr_b16 a[38:39], v253 offset:6656
    s_waitcnt vmcnt(16) lgkmcnt(10)
    v_mfma_f32_32x32x16_bf16 v[40:55], a[0:3], a[64:67], v[40:55]
    s_barrier
    ds_read_b64_tr_b16 a[40:41], v253 offset:10240
    ds_read_b64_tr_b16 a[42:43], v253 offset:11520
    s_add_u32 s60, s52, 1966080
    v_mfma_f32_32x32x16_bf16 v[56:71], a[4:7], a[64:67], v[56:71]
    ds_read_b64_tr_b16 a[44:45], v253 offset:10304
    ds_read_b64_tr_b16 a[46:47], v253 offset:11584
    buffer_load_dwordx4 a[112:115], v2, s[8:11], s60 offen offset:0 sc1
    v_mfma_f32_32x32x16_bf16 v[72:87], a[8:11], a[64:67], v[72:87]
    ds_read_b64_tr_b16 a[48:49], v253 offset:10368
    ds_read_b64_tr_b16 a[50:51], v253 offset:11648
    buffer_load_dwordx4 a[116:119], v2, s[8:11], s60 offen offset:1024 sc1
    s_add_u32 m0, s58, 81920
    s_add_u32 s62, s57, 0
    v_mfma_f32_32x32x16_bf16 v[88:103], a[12:15], a[64:67], v[88:103]
    ds_read_b64_tr_b16 a[52:53], v253 offset:10432
    ds_read_b64_tr_b16 a[54:55], v253 offset:11712
    buffer_load_dwordx4 v32, s[28:31], s62 offen offset:0 lds
    v_mfma_f32_32x32x16_bf16 v[104:119], a[16:19], a[64:67], v[104:119]
    ds_read_b64_tr_b16 a[56:57], v253 offset:10496
    ds_read_b64_tr_b16 a[58:59], v253 offset:11776
    s_waitcnt vmcnt(17) lgkmcnt(10)
    v_mfma_f32_32x32x16_bf16 v[40:55], a[20:23], a[68:71], v[40:55]
    ds_read_b64_tr_b16 a[60:61], v253 offset:15360
    ds_read_b64_tr_b16 a[62:63], v253 offset:16640
    v_mfma_f32_32x32x16_bf16 v[56:71], a[24:27], a[68:71], v[56:71]
    ds_read_b64_tr_b16 a[0:1], v253 offset:15424
    ds_read_b64_tr_b16 a[2:3], v253 offset:16704
    buffer_load_dwordx4 a[120:123], v2, s[8:11], s60 offen offset:2048 sc1
    v_mfma_f32_32x32x16_bf16 v[72:87], a[28:31], a[68:71], v[72:87]
    ds_read_b64_tr_b16 a[4:5], v253 offset:15488
    ds_read_b64_tr_b16 a[6:7], v253 offset:16768
    buffer_load_dwordx4 a[124:127], v2, s[8:11], s60 offen offset:3072 sc1
    v_mfma_f32_32x32x16_bf16 v[88:103], a[32:35], a[68:71], v[88:103]
    ds_read_b64_tr_b16 a[8:9], v253 offset:15552
    ds_read_b64_tr_b16 a[10:11], v253 offset:16832
    buffer_load_dwordx4 v33, s[28:31], s62 offen offset:1024 lds
    v_mfma_f32_32x32x16_bf16 v[104:119], a[36:39], a[68:71], v[104:119]
    ds_read_b64_tr_b16 a[12:13], v253 offset:15616
    ds_read_b64_tr_b16 a[14:15], v253 offset:16896
    s_waitcnt vmcnt(18) lgkmcnt(10)
    v_mfma_f32_32x32x16_bf16 v[40:55], a[40:43], a[72:75], v[40:55]
    ds_read_b64_tr_b16 a[16:17], v253 offset:20480
    ds_read_b64_tr_b16 a[18:19], v253 offset:21760
    s_add_u32 m0, s58, 90112
    v_mfma_f32_32x32x16_bf16 v[56:71], a[44:47], a[72:75], v[56:71]
    ds_read_b64_tr_b16 a[20:21], v253 offset:20544
    ds_read_b64_tr_b16 a[22:23], v253 offset:21824
    buffer_load_dwordx4 v34, s[32:35], s62 offen offset:0 lds
    v_mfma_f32_32x32x16_bf16 v[72:87], a[48:51], a[72:75], v[72:87]
    ds_read_b64_tr_b16 a[24:25], v253 offset:20608
    ds_read_b64_tr_b16 a[26:27], v253 offset:21888
    v_mfma_f32_32x32x16_bf16 v[88:103], a[52:55], a[72:75], v[88:103]
    ds_read_b64_tr_b16 a[28:29], v253 offset:20672
    ds_read_b64_tr_b16 a[30:31], v253 offset:21952
    buffer_load_dwordx4 v35, s[32:35], s62 offen offset:1024 lds
    v_mfma_f32_32x32x16_bf16 v[104:119], a[56:59], a[72:75], v[104:119]
    ds_read_b64_tr_b16 a[32:33], v253 offset:20736
    ds_read_b64_tr_b16 a[34:35], v253 offset:22016
    s_waitcnt vmcnt(18) lgkmcnt(10)
    v_mfma_f32_32x32x16_bf16 v[40:55], a[60:63], a[76:79], v[40:55]
    ds_read_b64_tr_b16 a[36:37], v253 offset:25600
    ds_read_b64_tr_b16 a[38:39], v253 offset:26880
    s_add_u32 m0, s58, 98304
    s_add_u32 s62, s57, 221184
    v_mfma_f32_32x32x16_bf16 v[56:71], a[0:3], a[76:79], v[56:71]
    ds_read_b64_tr_b16 a[40:41], v253 offset:25664
    ds_read_b64_tr_b16 a[42:43], v253 offset:26944
    buffer_load_dwordx4 v32, s[28:31], s62 offen offset:0 lds
    v_mfma_f32_32x32x16_bf16 v[72:87], a[4:7], a[76:79], v[72:87]
    ds_read_b64_tr_b16 a[44:45], v253 offset:25728
    ds_read_b64_tr_b16 a[46:47], v253 offset:27008
    v_mfma_f32_32x32x16_bf16 v[88:103], a[8:11], a[76:79], v[88:103]
    ds_read_b64_tr_b16 a[48:49], v253 offset:25792
    ds_read_b64_tr_b16 a[50:51], v253 offset:27072
    buffer_load_dwordx4 v33, s[28:31], s62 offen offset:1024 lds
    v_mfma_f32_32x32x16_bf16 v[104:119], a[12:15], a[76:79], v[104:119]
    ds_read_b64_tr_b16 a[52:53], v253 offset:25856
    ds_read_b64_tr_b16 a[54:55], v253 offset:27136
    s_waitcnt vmcnt(18) lgkmcnt(10)
    v_mfma_f32_32x32x16_bf16 v[40:55], a[16:19], a[80:83], v[40:55]
    ds_read_b64_tr_b16 a[56:57], v253 offset:30720
    ds_read_b64_tr_b16 a[58:59], v253 offset:32000
    s_add_u32 m0, s58, 106496
    v_mfma_f32_32x32x16_bf16 v[56:71], a[20:23], a[80:83], v[56:71]
    ds_read_b64_tr_b16 a[60:61], v253 offset:30784
    ds_read_b64_tr_b16 a[62:63], v253 offset:32064
    buffer_load_dwordx4 v34, s[32:35], s62 offen offset:0 lds
    v_mfma_f32_32x32x16_bf16 v[72:87], a[24:27], a[80:83], v[72:87]
    ds_read_b64_tr_b16 a[0:1], v253 offset:30848
    ds_read_b64_tr_b16 a[2:3], v253 offset:32128
    v_mfma_f32_32x32x16_bf16 v[88:103], a[28:31], a[80:83], v[88:103]
    ds_read_b64_tr_b16 a[4:5], v253 offset:30912
    ds_read_b64_tr_b16 a[6:7], v253 offset:32192
    buffer_load_dwordx4 v35, s[32:35], s62 offen offset:1024 lds
    v_mfma_f32_32x32x16_bf16 v[104:119], a[32:35], a[80:83], v[104:119]
    ds_read_b64_tr_b16 a[8:9], v253 offset:30976
    ds_read_b64_tr_b16 a[10:11], v253 offset:32256
    s_waitcnt vmcnt(19) lgkmcnt(10)
    v_mfma_f32_32x32x16_bf16 v[40:55], a[36:39], a[84:87], v[40:55]
    ds_read_b64_tr_b16 a[12:13], v253 offset:35840
    ds_read_b64_tr_b16 a[14:15], v253 offset:37120
    s_add_u32 m0, s58, 114688
    s_add_u32 s62, s57, 442368
    v_mfma_f32_32x32x16_bf16 v[56:71], a[40:43], a[84:87], v[56:71]
    ds_read_b64_tr_b16 a[16:17], v253 offset:35904
    ds_read_b64_tr_b16 a[18:19], v253 offset:37184
    buffer_load_dwordx4 v32, s[28:31], s62 offen offset:0 lds
    v_mfma_f32_32x32x16_bf16 v[72:87], a[44:47], a[84:87], v[72:87]
    ds_read_b64_tr_b16 a[20:21], v253 offset:35968
    ds_read_b64_tr_b16 a[22:23], v253 offset:37248
    v_mfma_f32_32x32x16_bf16 v[88:103], a[48:51], a[84:87], v[88:103]
    ds_read_b64_tr_b16 a[24:25], v253 offset:36032
    ds_read_b64_tr_b16 a[26:27], v253 offset:37312
    buffer_load_dwordx4 v33, s[28:31], s62 offen offset:1024 lds
    v_mfma_f32_32x32x16_bf16 v[104:119], a[52:55], a[84:87], v[104:119]
    ds_read_b64_tr_b16 a[28:29], v253 offset:36096
    ds_read_b64_tr_b16 a[30:31], v253 offset:37376
    s_waitcnt vmcnt(19) lgkmcnt(10)
    v_mfma_f32_32x32x16_bf16 v[40:55], a[56:59], a[88:91], v[40:55]
    s_barrier
    ds_read_b64_tr_b16 a[32:33], v253 offset:40960
    ds_read_b64_tr_b16 a[34:35], v253 offset:42240
    s_add_u32 m0, s58, 122880
    v_mfma_f32_32x32x16_bf16 v[56:71], a[60:63], a[88:91], v[56:71]
    ds_read_b64_tr_b16 a[36:37], v253 offset:46080
    ds_read_b64_tr_b16 a[38:39], v253 offset:47360
    buffer_load_dwordx4 v34, s[32:35], s62 offen offset:0 lds
    v_mfma_f32_32x32x16_bf16 v[72:87], a[0:3], a[88:91], v[72:87]
    ds_read_b64_tr_b16 a[40:41], v253 offset:51200
    ds_read_b64_tr_b16 a[42:43], v253 offset:52480
    v_mfma_f32_32x32x16_bf16 v[88:103], a[4:7], a[88:91], v[88:103]
    ds_read_b64_tr_b16 a[44:45], v253 offset:56320
    ds_read_b64_tr_b16 a[46:47], v253 offset:57600
    buffer_load_dwordx4 v35, s[32:35], s62 offen offset:1024 lds
    v_mfma_f32_32x32x16_bf16 v[104:119], a[8:11], a[88:91], v[104:119]
    ds_read_b64_tr_b16 a[48:49], v253 offset:61440
    ds_read_b64_tr_b16 a[50:51], v253 offset:62720
    s_waitcnt vmcnt(20) lgkmcnt(10)
    v_mfma_f32_32x32x16_bf16 v[40:55], a[12:15], a[92:95], v[40:55]
    ds_read_b64_tr_b16 a[52:53], v254 offset:1024
    ds_read_b64_tr_b16 a[54:55], v254 offset:2304
    s_add_u32 m0, s58, 0
    s_add_u32 s62, s57, 663552
    v_mfma_f32_32x32x16_bf16 v[56:71], a[16:19], a[92:95], v[56:71]
    ds_read_b64_tr_b16 a[56:57], v254 offset:6144
    ds_read_b64_tr_b16 a[58:59], v254 offset:7424
    buffer_load_dwordx4 v32, s[28:31], s62 offen offset:0 lds
    v_mfma_f32_32x32x16_bf16 v[72:87], a[20:23], a[92:95], v[72:87]
    ds_read_b64_tr_b16 a[60:61], v254 offset:11264
    ds_read_b64_tr_b16 a[62:63], v254 offset:12544
    v_mfma_f32_32x32x16_bf16 v[88:103], a[24:27], a[92:95], v[88:103]
    ds_read_b64_tr_b16 a[0:1], v253 offset:41024
    ds_read_b64_tr_b16 a[2:3], v253 offset:42304
    buffer_load_dwordx4 v33, s[28:31], s62 offen offset:1024 lds
    v_mfma_f32_32x32x16_bf16 v[104:119], a[28:31], a[92:95], v[104:119]
    ds_read_b64_tr_b16 a[4:5], v253 offset:46144
    ds_read_b64_tr_b16 a[6:7], v253 offset:47424
    s_waitcnt vmcnt(17) lgkmcnt(10)
    v_mfma_f32_32x32x16_bf16 v[40:55], a[32:35], a[96:99], v[40:55]
    ds_read_b64_tr_b16 a[8:9], v253 offset:51264
    ds_read_b64_tr_b16 a[10:11], v253 offset:52544
    s_add_u32 m0, s58, 8192
    v_mfma_f32_32x32x16_bf16 v[40:55], a[36:39], a[100:103], v[40:55]
    ds_read_b64_tr_b16 a[12:13], v253 offset:56384
    ds_read_b64_tr_b16 a[14:15], v253 offset:57664
    buffer_load_dwordx4 v34, s[32:35], s62 offen offset:0 lds
    v_mfma_f32_32x32x16_bf16 v[40:55], a[40:43], a[104:107], v[40:55]
    ds_read_b64_tr_b16 a[16:17], v253 offset:61504
    ds_read_b64_tr_b16 a[18:19], v253 offset:62784
    v_mfma_f32_32x32x16_bf16 v[40:55], a[44:47], a[108:111], v[40:55]
    ds_read_b64_tr_b16 a[20:21], v254 offset:1088
    ds_read_b64_tr_b16 a[22:23], v254 offset:2368
    buffer_load_dwordx4 v35, s[32:35], s62 offen offset:1024 lds
    v_mfma_f32_32x32x16_bf16 v[40:55], a[48:51], a[112:115], v[40:55]
    ds_read_b64_tr_b16 a[24:25], v254 offset:6208
    ds_read_b64_tr_b16 a[26:27], v254 offset:7488
    s_waitcnt vmcnt(15) lgkmcnt(10)
    v_mfma_f32_32x32x16_bf16 v[40:55], a[52:55], a[116:119], v[40:55]
    ds_read_b64_tr_b16 a[28:29], v254 offset:11328
    ds_read_b64_tr_b16 a[30:31], v254 offset:12608
    v_mfma_f32_32x32x16_bf16 v[40:55], a[56:59], a[120:123], v[40:55]
    ds_read_b64_tr_b16 a[32:33], v253 offset:41088
    ds_read_b64_tr_b16 a[34:35], v253 offset:42368
    v_mfma_f32_32x32x16_bf16 v[40:55], a[60:63], a[124:127], v[40:55]
    ds_read_b64_tr_b16 a[36:37], v253 offset:46208
    ds_read_b64_tr_b16 a[38:39], v253 offset:47488
    v_mfma_f32_32x32x16_bf16 v[56:71], a[0:3], a[96:99], v[56:71]
    ds_read_b64_tr_b16 a[40:41], v253 offset:51328
    ds_read_b64_tr_b16 a[42:43], v253 offset:52608
    v_mfma_f32_32x32x16_bf16 v[56:71], a[4:7], a[100:103], v[56:71]
    ds_read_b64_tr_b16 a[44:45], v253 offset:56448
    ds_read_b64_tr_b16 a[46:47], v253 offset:57728
    s_waitcnt lgkmcnt(10)
    v_mfma_f32_32x32x16_bf16 v[56:71], a[8:11], a[104:107], v[56:71]
    ds_read_b64_tr_b16 a[48:49], v253 offset:61568
    ds_read_b64_tr_b16 a[50:51], v253 offset:62848
    v_cvt_pk_bf16_f32 v120, v40, v41
    v_cvt_pk_bf16_f32 v121, v42, v43
    v_cvt_pk_bf16_f32 v122, v44, v45
    v_cvt_pk_bf16_f32 v123, v46, v47
    v_mfma_f32_32x32x16_bf16 v[56:71], a[12:15], a[108:111], v[56:71]
    ds_read_b64_tr_b16 a[52:53], v254 offset:1152
    ds_read_b64_tr_b16 a[54:55], v254 offset:2432
    buffer_store_dwordx4 v[120:123], v136, s[8:11], s51 offen offset:0 sc0 sc1
    v_cvt_pk_bf16_f32 v124, v48, v49
    v_cvt_pk_bf16_f32 v125, v50, v51
    v_cvt_pk_bf16_f32 v126, v52, v53
    v_cvt_pk_bf16_f32 v127, v54, v55
    v_mfma_f32_32x32x16_bf16 v[56:71], a[16:19], a[112:115], v[56:71]
    ds_read_b64_tr_b16 a[56:57], v254 offset:6272
    ds_read_b64_tr_b16 a[58:59], v254 offset:7552
    buffer_store_dwordx4 v[124:127], v136, s[8:11], s51 offen offset:256 sc0 sc1
    v_mfma_f32_32x32x16_bf16 v[56:71], a[20:23], a[116:119], v[56:71]
    ds_read_b64_tr_b16 a[60:61], v254 offset:11392
    ds_read_b64_tr_b16 a[62:63], v254 offset:12672
    v_mfma_f32_32x32x16_bf16 v[56:71], a[24:27], a[120:123], v[56:71]
    ds_read_b64_tr_b16 a[0:1], v253 offset:41152
    ds_read_b64_tr_b16 a[2:3], v253 offset:42432
    s_waitcnt lgkmcnt(10)
    v_mfma_f32_32x32x16_bf16 v[56:71], a[28:31], a[124:127], v[56:71]
    ds_read_b64_tr_b16 a[4:5], v253 offset:46272
    ds_read_b64_tr_b16 a[6:7], v253 offset:47552
    v_mfma_f32_32x32x16_bf16 v[72:87], a[32:35], a[96:99], v[72:87]
    ds_read_b64_tr_b16 a[8:9], v253 offset:51392
    ds_read_b64_tr_b16 a[10:11], v253 offset:52672
    v_mfma_f32_32x32x16_bf16 v[72:87], a[36:39], a[100:103], v[72:87]
    ds_read_b64_tr_b16 a[12:13], v253 offset:56512
    ds_read_b64_tr_b16 a[14:15], v253 offset:57792
    v_mfma_f32_32x32x16_bf16 v[72:87], a[40:43], a[104:107], v[72:87]
    ds_read_b64_tr_b16 a[16:17], v253 offset:61632
    ds_read_b64_tr_b16 a[18:19], v253 offset:62912
    s_nop 0
    v_cvt_pk_bf16_f32 v128, v56, v57
    v_cvt_pk_bf16_f32 v129, v58, v59
    v_cvt_pk_bf16_f32 v130, v60, v61
    v_cvt_pk_bf16_f32 v131, v62, v63
    v_mfma_f32_32x32x16_bf16 v[72:87], a[44:47], a[108:111], v[72:87]
    ds_read_b64_tr_b16 a[20:21], v254 offset:1216
    ds_read_b64_tr_b16 a[22:23], v254 offset:2496
    buffer_store_dwordx4 v[128:131], v136, s[8:11], s51 offen offset:512 sc0 sc1
    v_cvt_pk_bf16_f32 v132, v64, v65
    v_cvt_pk_bf16_f32 v133, v66, v67
    v_cvt_pk_bf16_f32 v134, v68, v69
    v_cvt_pk_bf16_f32 v135, v70, v71
    s_waitcnt lgkmcnt(10)
    v_mfma_f32_32x32x16_bf16 v[72:87], a[48:51], a[112:115], v[72:87]
    ds_read_b64_tr_b16 a[24:25], v254 offset:6336
    ds_read_b64_tr_b16 a[26:27], v254 offset:7616
    buffer_store_dwordx4 v[132:135], v136, s[8:11], s51 offen offset:768 sc0 sc1
    v_mfma_f32_32x32x16_bf16 v[72:87], a[52:55], a[116:119], v[72:87]
    ds_read_b64_tr_b16 a[28:29], v254 offset:11456
    ds_read_b64_tr_b16 a[30:31], v254 offset:12736
    v_mfma_f32_32x32x16_bf16 v[72:87], a[56:59], a[120:123], v[72:87]
    ds_read_b64_tr_b16 a[32:33], v253 offset:41216
    ds_read_b64_tr_b16 a[34:35], v253 offset:42496
    v_mfma_f32_32x32x16_bf16 v[72:87], a[60:63], a[124:127], v[72:87]
    ds_read_b64_tr_b16 a[36:37], v253 offset:46336
    ds_read_b64_tr_b16 a[38:39], v253 offset:47616
    v_mfma_f32_32x32x16_bf16 v[88:103], a[0:3], a[96:99], v[88:103]
    ds_read_b64_tr_b16 a[40:41], v253 offset:51456
    ds_read_b64_tr_b16 a[42:43], v253 offset:52736
    s_waitcnt lgkmcnt(10)
    v_mfma_f32_32x32x16_bf16 v[88:103], a[4:7], a[100:103], v[88:103]
    ds_read_b64_tr_b16 a[44:45], v253 offset:56576
    ds_read_b64_tr_b16 a[46:47], v253 offset:57856
    v_mfma_f32_32x32x16_bf16 v[88:103], a[8:11], a[104:107], v[88:103]
    ds_read_b64_tr_b16 a[48:49], v253 offset:61696
    ds_read_b64_tr_b16 a[50:51], v253 offset:62976
    v_cvt_pk_bf16_f32 v120, v72, v73
    v_cvt_pk_bf16_f32 v121, v74, v75
    v_cvt_pk_bf16_f32 v122, v76, v77
    v_cvt_pk_bf16_f32 v123, v78, v79
    v_mfma_f32_32x32x16_bf16 v[88:103], a[12:15], a[108:111], v[88:103]
    ds_read_b64_tr_b16 a[52:53], v254 offset:1280
    ds_read_b64_tr_b16 a[54:55], v254 offset:2560
    buffer_store_dwordx4 v[120:123], v136, s[8:11], s51 offen offset:1024 sc0 sc1
    v_cvt_pk_bf16_f32 v124, v80, v81
    v_cvt_pk_bf16_f32 v125, v82, v83
    v_cvt_pk_bf16_f32 v126, v84, v85
    v_cvt_pk_bf16_f32 v127, v86, v87
    v_mfma_f32_32x32x16_bf16 v[88:103], a[16:19], a[112:115], v[88:103]
    ds_read_b64_tr_b16 a[56:57], v254 offset:6400
    ds_read_b64_tr_b16 a[58:59], v254 offset:7680
    buffer_store_dwordx4 v[124:127], v136, s[8:11], s51 offen offset:1280 sc0 sc1
    v_mfma_f32_32x32x16_bf16 v[88:103], a[20:23], a[116:119], v[88:103]
    ds_read_b64_tr_b16 a[60:61], v254 offset:11520
    ds_read_b64_tr_b16 a[62:63], v254 offset:12800
    s_waitcnt lgkmcnt(10)
    v_mfma_f32_32x32x16_bf16 v[88:103], a[24:27], a[120:123], v[88:103]
    v_mfma_f32_32x32x16_bf16 v[88:103], a[28:31], a[124:127], v[88:103]
    v_mfma_f32_32x32x16_bf16 v[104:119], a[32:35], a[96:99], v[104:119]
    v_mfma_f32_32x32x16_bf16 v[104:119], a[36:39], a[100:103], v[104:119]
    v_mfma_f32_32x32x16_bf16 v[104:119], a[40:43], a[104:107], v[104:119]
    s_nop 8
    v_cvt_pk_bf16_f32 v128, v88, v89
    v_cvt_pk_bf16_f32 v129, v90, v91
    v_cvt_pk_bf16_f32 v130, v92, v93
    v_cvt_pk_bf16_f32 v131, v94, v95
    s_waitcnt lgkmcnt(0)
    v_mfma_f32_32x32x16_bf16 v[104:119], a[44:47], a[108:111], v[104:119]
    buffer_store_dwordx4 v[128:131], v136, s[8:11], s51 offen offset:1536 sc0 sc1
    v_cvt_pk_bf16_f32 v132, v96, v97
    v_cvt_pk_bf16_f32 v133, v98, v99
    v_cvt_pk_bf16_f32 v134, v100, v101
    v_cvt_pk_bf16_f32 v135, v102, v103
    v_mfma_f32_32x32x16_bf16 v[104:119], a[48:51], a[112:115], v[104:119]
    buffer_store_dwordx4 v[132:135], v136, s[8:11], s51 offen offset:1792 sc0 sc1
    v_mfma_f32_32x32x16_bf16 v[104:119], a[52:55], a[116:119], v[104:119]
    v_mfma_f32_32x32x16_bf16 v[104:119], a[56:59], a[120:123], v[104:119]
    v_mfma_f32_32x32x16_bf16 v[104:119], a[60:63], a[124:127], v[104:119]
    s_nop 11
    v_cvt_pk_bf16_f32 v120, v104, v105
    v_cvt_pk_bf16_f32 v121, v106, v107
    v_cvt_pk_bf16_f32 v122, v108, v109
    v_cvt_pk_bf16_f32 v123, v110, v111
    buffer_store_dwordx4 v[120:123], v136, s[8:11], s51 offen offset:2048 sc0 sc1
    v_cvt_pk_bf16_f32 v124, v112, v113
    v_cvt_pk_bf16_f32 v125, v114, v115
    v_cvt_pk_bf16_f32 v126, v116, v117
    v_cvt_pk_bf16_f32 v127, v118, v119
    buffer_store_dwordx4 v[124:127], v136, s[8:11], s51 offen offset:2304 sc0 sc1
    s_mov_b32 s64, s91
    v_mov_b32 v39, s97
    s_cmp_eq_u32 s6, 0
    s_waitcnt vmcnt(0)
    s_cbranch_scc1 LB_sf
    buffer_wbl2 sc1
    s_waitcnt vmcnt(0)
    buffer_store_dword v39, off, s[8:11], s64 offset:512 sc0 sc1
    s_branch LB_sd
LB_sf:
    buffer_store_dword v39, off, s[8:11], s64 offset:512 sc0 sc1
LB_sd:
    v_lshlrev_b32 v40, 4, v0
    v_lshrrev_b32 v4, 4, v0
    v_lshlrev_b32 v41, 7, v4
    v_and_b32 v5, 7, v0
    v_lshl_add_u32 v41, v5, 4, v41
    v_and_b32 v6, 8, v0
    v_add_u32 v41, v41, v6
    v_mul_u32_u24 v43, 1280, v5
    v_and_b32 v7, 0xf8, v0
    v_lshl_add_u32 v42, v7, 1, v43
    v_add_u32 v43, v43, v7
    v_lshlrev_b32 v44, 2, v7
    v_add_u32 v44, 147456, v44
    v_lshlrev_b32 v45, 1, v7
    v_add_u32 v45, 147456, v45
    s_mul_i32 s68, s59, 10240
    ds_read_b128 v[132:135], v44 offset:5120
    ds_read_b128 v[136:139], v44 offset:5136
    ds_read_b128 v[140:143], v44 offset:6144
    ds_read_b128 v[144:147], v44 offset:6160
    ds_read_b128 v[148:151], v45 offset:7168
    ds_read_b128 v[172:175], v44 offset:7680
    ds_read_b128 v[176:179], v44 offset:7696
    ds_read_b128 v[180:183], v44 offset:8704
    ds_read_b128 v[184:187], v44 offset:8720
    ds_read_b128 v[188:191], v45 offset:9728
    ds_read_b128 v[152:155], v44 offset:10240
    ds_read_b128 v[156:159], v44 offset:10256
    ds_read_b128 v[160:163], v44 offset:11264
    ds_read_b128 v[164:167], v44 offset:11280
    ds_read_b128 v[168:171], v45 offset:12288
    v_and_b32 v4, 15, v1
    s_lshr_b32 s64, s5, 2
    s_lshl_b32 s64, s64, 11
    v_lshl_add_u32 v38, v4, 7, s64
    s_lshl_b32 s76, s4, 14
    s_add_u32 s76, s76, 262144
    s_lshl_b32 s69, s4, 22
    s_mul_i32 s70, s5, 10240
    s_add_u32 s69, s69, s70
    s_add_u32 s69, s69, 6291456
    v_lshlrev_b32 v192, 16, v240
    v_and_b32 v193, 0xffff0000, v240
    v_lshlrev_b32 v194, 16, v241
    v_and_b32 v195, 0xffff0000, v241
    v_lshlrev_b32 v196, 16, v242
    v_and_b32 v197, 0xffff0000, v242
    v_lshlrev_b32 v198, 16, v243
    v_and_b32 v199, 0xffff0000, v243
    v_lshlrev_b32 v200, 16, v244
    v_and_b32 v201, 0xffff0000, v244
    v_lshlrev_b32 v202, 16, v245
    v_and_b32 v203, 0xffff0000, v245
    v_lshlrev_b32 v204, 16, v246
    v_and_b32 v205, 0xffff0000, v246
    v_lshlrev_b32 v206, 16, v247
    v_and_b32 v207, 0xffff0000, v247
    v_lshlrev_b32 v208, 16, v248
    v_and_b32 v209, 0xffff0000, v248
    v_lshlrev_b32 v210, 16, v249
    v_and_b32 v211, 0xffff0000, v249
    v_lshrrev_b32 v4, 4, v0
    v_lshlrev_b32 v42, 10, v4
    v_bfe_u32 v4, v0, 3, 1
    v_lshl_add_u32 v42, v4, 9, v42
    v_and_b32 v5, 7, v0
    v_lshl_add_u32 v42, v5, 4, v42
    v_lshrrev_b32 v43, 5, v0
    v_lshlrev_b32 v43, 10, v43
    v_lshl_add_u32 v43, v4, 3, v43
    v_bfe_u32 v4, v0, 4, 1
    v_lshl_add_u32 v43, v4, 9, v43
    v_lshl_add_u32 v43, v5, 4, v43
    v_lshlrev_b32 v44, 5, v5
    v_add_u32 v44, 147008, v44
    v_lshl_add_u32 v45, s3, 3, v44
    s_lshr_b32 s64, s59, 2
    s_mul_i32 s64, s64, 40960
    s_and_b32 s65, s5, 3
    s_lshl_b32 s65, s65, 7
    s_add_u32 s64, s64, s65
    s_add_u32 s73, s64, 1048576
    s_add_u32 s74, s73, 16384
    s_add_u32 s75, s73, 32768
    s_mov_b32 s64, 0
    s_mov_b32 s65, 0
LR_p:
    buffer_load_dword v39, v38, s[8:11], s76 offen sc1
    s_add_u32 s64, s64, 1
    s_waitcnt vmcnt(0)
    v_cmp_eq_u32 vcc, s97, v39
    s_nop 0
    s_andn2_b32 s66, vcc_lo, s65
    s_and_b32 s67, s66, 15
    s_cmp_eq_u32 s67, 15
    s_cbranch_scc0 LR_c1
    s_add_u32 s70, s69, 0
    s_add_u32 s71, s69, 4096
    s_add_u32 s72, s69, 8192
    buffer_load_dwordx4 v[48:51], v40, s[8:11], s70 offen sc1
    buffer_load_dwordx4 v[52:55], v40, s[8:11], s71 offen sc1
    buffer_load_dwordx2 v[56:57], v41, s[8:11], s72 offen sc1
    s_or_b32 s65, s65, 15
LR_c1:
    s_and_b32 s67, s66, 240
    s_cmp_eq_u32 s67, 240
    s_cbranch_scc0 LR_c2
    s_add_u32 s70, s69, 327680
    s_add_u32 s71, s69, 331776
    s_add_u32 s72, s69, 335872
    buffer_load_dwordx4 v[58:61], v40, s[8:11], s70 offen sc1
    buffer_load_dwordx4 v[62:65], v40, s[8:11], s71 offen sc1
    buffer_load_dwordx2 v[66:67], v41, s[8:11], s72 offen sc1
    s_or_b32 s65, s65, 240
LR_c2:
    s_and_b32 s67, s66, 3840
    s_cmp_eq_u32 s67, 3840
    s_cbranch_scc0 LR_c3
    s_add_u32 s70, s69, 655360
    s_add_u32 s71, s69, 659456
    s_add_u32 s72, s69, 663552
    buffer_load_dwordx4 v[68:71], v40, s[8:11], s70 offen sc1
    buffer_load_dwordx4 v[72:75], v40, s[8:11], s71 offen sc1
    buffer_load_dwordx2 v[76:77], v41, s[8:11], s72 offen sc1
    s_or_b32 s65, s65, 3840
LR_c3:
    s_and_b32 s67, s66, 61440
    s_cmp_eq_u32 s67, 61440
    s_cbranch_scc0 LR_c4
    s_add_u32 s70, s69, 983040
    s_add_u32 s71, s69, 987136
    s_add_u32 s72, s69, 991232
    buffer_load_dwordx4 v[78:81], v40, s[8:11], s70 offen sc1
    buffer_load_dwordx4 v[82:85], v40, s[8:11], s71 offen sc1
    buffer_load_dwordx2 v[86:87], v41, s[8:11], s72 offen sc1
    s_or_b32 s65, s65, 61440
LR_c4:
    s_cmp_eq_u32 s65, 0xffff
    s_cbranch_scc1 LR_go
    s_cmp_lt_u32 s64, 200000
    s_cbranch_scc1 LR_p
LR_go:
    s_waitcnt vmcnt(0)
    v_lshlrev_b32 v92, 16, v48
    v_and_b32 v93, 0xffff0000, v48
    v_lshlrev_b32 v94, 16, v49
    v_and_b32 v95, 0xffff0000, v49
    v_lshlrev_b32 v96, 16, v50
    v_and_b32 v97, 0xffff0000, v50
    v_lshlrev_b32 v98, 16, v51
    v_and_b32 v99, 0xffff0000, v51
    v_lshlrev_b32 v100, 16, v52
    v_and_b32 v101, 0xffff0000, v52
    v_lshlrev_b32 v102, 16, v53
    v_and_b32 v103, 0xffff0000, v53
    v_lshlrev_b32 v104, 16, v54
    v_and_b32 v105, 0xffff0000, v54
    v_lshlrev_b32 v106, 16, v55
    v_and_b32 v107, 0xffff0000, v55
    v_lshlrev_b32 v108, 16, v56
    v_and_b32 v109, 0xffff0000, v56
    v_lshlrev_b32 v110, 16, v57
    v_and_b32 v111, 0xffff0000, v57
    v_lshlrev_b32 v112, 16, v58
    v_and_b32 v113, 0xffff0000, v58
    v_lshlrev_b32 v114, 16, v59
    v_and_b32 v115, 0xffff0000, v59
    v_lshlrev_b32 v116, 16, v60
    v_and_b32 v117, 0xffff0000, v60
    v_lshlrev_b32 v118, 16, v61
    v_and_b32 v119, 0xffff0000, v61
    v_lshlrev_b32 v120, 16, v62
    v_and_b32 v121, 0xffff0000, v62
    v_lshlrev_b32 v122, 16, v63
    v_and_b32 v123, 0xffff0000, v63
    v_lshlrev_b32 v124, 16, v64
    v_and_b32 v125, 0xffff0000, v64
    v_lshlrev_b32 v126, 16, v65
    v_and_b32 v127, 0xffff0000, v65
    v_lshlrev_b32 v128, 16, v66
    v_and_b32 v129, 0xffff0000, v66
    v_lshlrev_b32 v130, 16, v67
    v_and_b32 v131, 0xffff0000, v67
    v_pk_add_f32 v[92:93], v[92:93], v[112:113]
    v_pk_add_f32 v[94:95], v[94:95], v[114:115]
    v_pk_add_f32 v[96:97], v[96:97], v[116:117]
    v_pk_add_f32 v[98:99], v[98:99], v[118:119]
    v_pk_add_f32 v[100:101], v[100:101], v[120:121]
    v_pk_add_f32 v[102:103], v[102:103], v[122:123]
    v_pk_add_f32 v[104:105], v[104:105], v[124:125]
    v_pk_add_f32 v[106:107], v[106:107], v[126:127]
    v_pk_add_f32 v[108:109], v[108:109], v[128:129]
    v_pk_add_f32 v[110:111], v[110:111], v[130:131]
    v_lshlrev_b32 v112, 16, v68
    v_and_b32 v113, 0xffff0000, v68
    v_lshlrev_b32 v114, 16, v69
    v_and_b32 v115, 0xffff0000, v69
    v_lshlrev_b32 v116, 16, v70
    v_and_b32 v117, 0xffff0000, v70
    v_lshlrev_b32 v118, 16, v71
    v_and_b32 v119, 0xffff0000, v71
    v_lshlrev_b32 v120, 16, v72
    v_and_b32 v121, 0xffff0000, v72
    v_lshlrev_b32 v122, 16, v73
    v_and_b32 v123, 0xffff0000, v73
    v_lshlrev_b32 v124, 16, v74
    v_and_b32 v125, 0xffff0000, v74
    v_lshlrev_b32 v126, 16, v75
    v_and_b32 v127, 0xffff0000, v75
    v_lshlrev_b32 v128, 16, v76
    v_and_b32 v129, 0xffff0000, v76
    v_lshlrev_b32 v130, 16, v77
    v_and_b32 v131, 0xffff0000, v77
    v_pk_add_f32 v[92:93], v[92:93], v[112:113]
    v_pk_add_f32 v[94:95], v[94:95], v[114:115]
    v_pk_add_f32 v[96:97], v[96:97], v[116:117]
    v_pk_add_f32 v[98:99], v[98:99], v[118:119]
    v_pk_add_f32 v[100:101], v[100:101], v[120:121]
    v_pk_add_f32 v[102:103], v[102:103], v[122:123]
    v_pk_add_f32 v[104:105], v[104:105], v[124:125]
    v_pk_add_f32 v[106:107], v[106:107], v[126:127]
    v_pk_add_f32 v[108:109], v[108:109], v[128:129]
    v_pk_add_f32 v[110:111], v[110:111], v[130:131]
    v_lshlrev_b32 v112, 16, v78
    v_and_b32 v113, 0xffff0000, v78
    v_lshlrev_b32 v114, 16, v79
    v_and_b32 v115, 0xffff0000, v79
    v_lshlrev_b32 v116, 16, v80
    v_and_b32 v117, 0xffff0000, v80
    v_lshlrev_b32 v118, 16, v81
    v_and_b32 v119, 0xffff0000, v81
    v_lshlrev_b32 v120, 16, v82
    v_and_b32 v121, 0xffff0000, v82
    v_lshlrev_b32 v122, 16, v83
    v_and_b32 v123, 0xffff0000, v83
    v_lshlrev_b32 v124, 16, v84
    v_and_b32 v125, 0xffff0000, v84
    v_lshlrev_b32 v126, 16, v85
    v_and_b32 v127, 0xffff0000, v85
    v_lshlrev_b32 v128, 16, v86
    v_and_b32 v129, 0xffff0000, v86
    v_lshlrev_b32 v130, 16, v87
    v_and_b32 v131, 0xffff0000, v87
    v_pk_add_f32 v[92:93], v[92:93], v[112:113]
    v_pk_add_f32 v[94:95], v[94:95], v[114:115]
    v_pk_add_f32 v[96:97], v[96:97], v[116:117]
    v_pk_add_f32 v[98:99], v[98:99], v[118:119]
    v_pk_add_f32 v[100:101], v[100:101], v[120:121]
    v_pk_add_f32 v[102:103], v[102:103], v[122:123]
    v_pk_add_f32 v[104:105], v[104:105], v[124:125]
    v_pk_add_f32 v[106:107], v[106:107], v[126:127]
    v_pk_add_f32 v[108:109], v[108:109], v[128:129]
    v_pk_add_f32 v[110:111], v[110:111], v[130:131]
    s_waitcnt lgkmcnt(14)
    v_pk_fma_f32 v[92:93], v[92:93], v[132:133], v[192:193]
    v_pk_fma_f32 v[94:95], v[94:95], v[134:135], v[194:195]
    s_waitcnt lgkmcnt(13)
    v_pk_fma_f32 v[96:97], v[96:97], v[136:137], v[196:197]
    v_pk_fma_f32 v[98:99], v[98:99], v[138:139], v[198:199]
    s_waitcnt lgkmcnt(12)
    v_pk_fma_f32 v[100:101], v[100:101], v[140:141], v[200:201]
    v_pk_fma_f32 v[102:103], v[102:103], v[142:143], v[202:203]
    s_waitcnt lgkmcnt(11)
    v_pk_fma_f32 v[104:105], v[104:105], v[144:145], v[204:205]
    v_pk_fma_f32 v[106:107], v[106:107], v[146:147], v[206:207]
    s_waitcnt lgkmcnt(10)
    v_pk_fma_f32 v[108:109], v[108:109], v[148:149], v[208:209]
    v_pk_fma_f32 v[110:111], v[110:111], v[150:151], v[210:211]
    v_cvt_pk_bf16_f32 v240, v92, v93
    v_cvt_pk_bf16_f32 v241, v94, v95
    v_cvt_pk_bf16_f32 v242, v96, v97
    v_cvt_pk_bf16_f32 v243, v98, v99
    v_cvt_pk_bf16_f32 v244, v100, v101
    v_cvt_pk_bf16_f32 v245, v102, v103
    v_cvt_pk_bf16_f32 v246, v104, v105
    v_cvt_pk_bf16_f32 v247, v106, v107
    v_cvt_pk_bf16_f32 v248, v108, v109
    v_cvt_pk_bf16_f32 v249, v110, v111
    v_lshlrev_b32 v92, 16, v240
    v_and_b32 v93, 0xffff0000, v240
    v_lshlrev_b32 v94, 16, v241
    v_and_b32 v95, 0xffff0000, v241
    v_lshlrev_b32 v96, 16, v242
    v_and_b32 v97, 0xffff0000, v242
    v_lshlrev_b32 v98, 16, v243
    v_and_b32 v99, 0xffff0000, v243
    v_lshlrev_b32 v100, 16, v244
    v_and_b32 v101, 0xffff0000, v244
    v_lshlrev_b32 v102, 16, v245
    v_and_b32 v103, 0xffff0000, v245
    v_lshlrev_b32 v104, 16, v246
    v_and_b32 v105, 0xffff0000, v246
    v_lshlrev_b32 v106, 16, v247
    v_and_b32 v107, 0xffff0000, v247
    v_lshlrev_b32 v108, 16, v248
    v_and_b32 v109, 0xffff0000, v248
    v_lshlrev_b32 v110, 16, v249
    v_and_b32 v111, 0xffff0000, v249
    v_pk_add_f32 v[4:5], v[92:93], v[94:95]
    v_pk_add_f32 v[4:5], v[4:5], v[96:97]
    v_pk_add_f32 v[4:5], v[4:5], v[98:99]
    v_pk_add_f32 v[4:5], v[4:5], v[100:101]
    v_pk_add_f32 v[4:5], v[4:5], v[102:103]
    v_pk_add_f32 v[4:5], v[4:5], v[104:105]
    v_pk_add_f32 v[4:5], v[4:5], v[106:107]
    v_pk_add_f32 v[4:5], v[4:5], v[108:109]
    v_pk_add_f32 v[4:5], v[4:5], v[110:111]
    v_add_f32 v4, v4, v5
    s_nop 1
    v_add_f32_dpp v4, v4, v4 row_ror:8 row_mask:0xf bank_mask:0xf
    v_mov_b32 v7, v4
    s_nop 1
    v_permlane16_swap_b32 v4, v7
    v_add_f32 v4, v4, v7
    v_mov_b32 v7, v4
    s_nop 1
    v_permlane32_swap_b32 v4, v7
    v_add_f32 v4, v4, v7
    v_mul_f32 v8, 0xbbcccccd, v4
    v_mov_b32 v9, v8
    v_pk_add_f32 v[112:113], v[92:93], v[8:9]
    v_pk_add_f32 v[114:115], v[94:95], v[8:9]
    v_pk_add_f32 v[116:117], v[96:97], v[8:9]
    v_pk_add_f32 v[118:119], v[98:99], v[8:9]
    v_pk_add_f32 v[120:121], v[100:101], v[8:9]
    v_pk_add_f32 v[122:123], v[102:103], v[8:9]
    v_pk_add_f32 v[124:125], v[104:105], v[8:9]
    v_pk_add_f32 v[126:127], v[106:107], v[8:9]
    v_pk_add_f32 v[128:129], v[108:109], v[8:9]
    v_pk_add_f32 v[130:131], v[110:111], v[8:9]
    v_pk_mul_f32 v[4:5], v[112:113], v[112:113]
    v_pk_fma_f32 v[4:5], v[114:115], v[114:115], v[4:5]
    v_pk_fma_f32 v[4:5], v[116:117], v[116:117], v[4:5]
    v_pk_fma_f32 v[4:5], v[118:119], v[118:119], v[4:5]
    v_pk_fma_f32 v[4:5], v[120:121], v[120:121], v[4:5]
    v_pk_fma_f32 v[4:5], v[122:123], v[122:123], v[4:5]
    v_pk_fma_f32 v[4:5], v[124:125], v[124:125], v[4:5]
    v_pk_fma_f32 v[4:5], v[126:127], v[126:127], v[4:5]
    v_pk_fma_f32 v[4:5], v[128:129], v[128:129], v[4:5]
    v_pk_fma_f32 v[4:5], v[130:131], v[130:131], v[4:5]
    v_add_f32 v9, v4, v5
    s_nop 1
    v_add_f32_dpp v9, v9, v9 row_ror:8 row_mask:0xf bank_mask:0xf
    v_mov_b32 v7, v9
    s_nop 1
    v_permlane16_swap_b32 v9, v7
    v_add_f32 v9, v9, v7
    v_mov_b32 v7, v9
    s_nop 1
    v_permlane32_swap_b32 v9, v7
    v_add_f32 v9, v9, v7
    ds_write_b64 v45, v[8:9]
    s_waitcnt lgkmcnt(0)
    s_barrier
    ds_read_b128 v[48:51], v44
    ds_read_b128 v[52:55], v44 offset:16
    s_waitcnt lgkmcnt(1)
    v_pk_add_f32 v[4:5], v[48:49], v[50:51]
    s_waitcnt lgkmcnt(0)
    v_pk_add_f32 v[8:9], v[52:53], v[54:55]
    v_pk_add_f32 v[4:5], v[4:5], v[8:9]
    v_mul_f32 v4, 0x3e800000, v4
    v_sub_f32 v48, v48, v4
    v_sub_f32 v50, v50, v4
    v_sub_f32 v52, v52, v4
    v_sub_f32 v54, v54, v4
    v_mul_f32 v8, v48, v48
    v_fmac_f32 v8, v50, v50
    v_fmac_f32 v8, v52, v52
    v_fmac_f32 v8, v54, v54
    v_fmac_f32 v5, 0x43200000, v8
    v_mov_b32 v8, 0x3727c5ac
    v_fmac_f32 v8, 0x3acccccd, v5
    v_rsq_f32 v8, v8
    v_mov_b32 v5, v4
    v_pk_add_f32 v[92:93], v[92:93], v[4:5]
    v_pk_add_f32 v[94:95], v[94:95], v[4:5]
    v_pk_add_f32 v[96:97], v[96:97], v[4:5]
    v_pk_add_f32 v[98:99], v[98:99], v[4:5]
    v_pk_add_f32 v[100:101], v[100:101], v[4:5]
    v_pk_add_f32 v[102:103], v[102:103], v[4:5]
    v_pk_add_f32 v[104:105], v[104:105], v[4:5]
    v_pk_add_f32 v[106:107], v[106:107], v[4:5]
    v_pk_add_f32 v[108:109], v[108:109], v[4:5]
    v_pk_add_f32 v[110:111], v[110:111], v[4:5]
    v_mov_b32 v9, v8
    v_pk_mul_f32 v[92:93], v[92:93], v[8:9]
    v_pk_mul_f32 v[94:95], v[94:95], v[8:9]
    v_pk_mul_f32 v[96:97], v[96:97], v[8:9]
    v_pk_mul_f32 v[98:99], v[98:99], v[8:9]
    v_pk_mul_f32 v[100:101], v[100:101], v[8:9]
    v_pk_mul_f32 v[102:103], v[102:103], v[8:9]
    v_pk_mul_f32 v[104:105], v[104:105], v[8:9]
    v_pk_mul_f32 v[106:107], v[106:107], v[8:9]
    v_pk_mul_f32 v[108:109], v[108:109], v[8:9]
    v_pk_mul_f32 v[110:111], v[110:111], v[8:9]
    v_pk_fma_f32 v[92:93], v[92:93], v[152:153], v[172:173]
    v_pk_fma_f32 v[94:95], v[94:95], v[154:155], v[174:175]
    v_pk_fma_f32 v[96:97], v[96:97], v[156:157], v[176:177]
    v_pk_fma_f32 v[98:99], v[98:99], v[158:159], v[178:179]
    v_pk_fma_f32 v[100:101], v[100:101], v[160:161], v[180:181]
    v_pk_fma_f32 v[102:103], v[102:103], v[162:163], v[182:183]
    v_pk_fma_f32 v[104:105], v[104:105], v[164:165], v[184:185]
    v_pk_fma_f32 v[106:107], v[106:107], v[166:167], v[186:187]
    v_pk_fma_f32 v[108:109], v[108:109], v[168:169], v[188:189]
    v_pk_fma_f32 v[110:111], v[110:111], v[170:171], v[190:191]
    v_cvt_pk_bf16_f32 v112, v92, v93
    v_cvt_pk_bf16_f32 v113, v94, v95
    v_cvt_pk_bf16_f32 v114, v96, v97
    v_cvt_pk_bf16_f32 v115, v98, v99
    v_cvt_pk_bf16_f32 v116, v100, v101
    v_cvt_pk_bf16_f32 v117, v102, v103
    v_cvt_pk_bf16_f32 v118, v104, v105
    v_cvt_pk_bf16_f32 v119, v106, v107
    v_cvt_pk_bf16_f32 v120, v108, v109
    v_cvt_pk_bf16_f32 v121, v110, v111
    buffer_store_dwordx4 v[112:115], v42, s[8:11], s73 offen
    buffer_store_dwordx4 v[116:119], v42, s[8:11], s74 offen
    buffer_store_dwordx2 v[120:121], v43, s[8:11], s75 offen
    s_mov_b32 s64, s99
    v_mov_b32 v39, s97
    s_cmp_eq_u32 s6, 0
    s_waitcnt vmcnt(0)
    s_cbranch_scc1 LR_sf
    buffer_wbl2 sc1
    s_waitcnt vmcnt(0)
    buffer_store_dword v39, off, s[8:11], s64 offset:1024 sc0 sc1
    s_branch LR_sd
LR_sf:
    buffer_store_dword v39, off, s[8:11], s64 offset:1024
LR_sd:
    s_cmp_ge_u32 s5, 27
    s_cbranch_scc1 LC_skip
    v_and_b32 v4, 31, v1
    s_lshl_b32 s64, s3, 7
    v_lshl_add_u32 v38, v4, 2, s64
    v_bfe_u32 v4, v1, 4, 1
    v_bfe_u32 v5, v1, 3, 1
    v_lshl_add_u32 v5, v4, 1, v5
    v_and_b32 v6, 1, v1
    v_lshl_add_u32 v5, v5, 1, v6
    v_lshlrev_b32 v4, 13, v4
    v_lshrrev_b32 v6, 5, v1
    v_lshl_add_u32 v4, v6, 10, v4
    v_bfe_u32 v6, v1, 2, 2
    v_lshl_add_u32 v4, v6, 7, v4
    v_bfe_u32 v6, v1, 1, 1
    v_lshl_add_u32 v4, v6, 3, v4
    v_xor_b32 v232, 0, v5
    v_lshl_add_u32 v232, v232, 4, v4
    v_add_u32 v236, 0x10000, v232
    v_xor_b32 v233, 2, v5
    v_lshl_add_u32 v233, v233, 4, v4
    v_add_u32 v237, 0x10000, v233
    v_xor_b32 v234, 4, v5
    v_lshl_add_u32 v234, v234, 4, v4
    v_add_u32 v238, 0x10000, v234
    v_xor_b32 v235, 6, v5
    v_lshl_add_u32 v235, v235, 4, v4
    v_add_u32 v239, 0x10000, v235
    s_mul_i32 s50, s4, 4194304
    s_mul_i32 s64, s3, 221184
    s_add_u32 s50, s50, s64
    s_lshl_b32 s64, s5, 12
    s_add_u32 s50, s50, s64
    s_add_u32 s50, s50, 6619136
    s_add_u32 s51, s50, 110592
    s_lshl_b32 s52, s4, 2
    s_add_u32 s52, s52, s3
    s_mul_i32 s52, s52, 81920
    s_add_u32 s52, s52, 1048576
    v_min_u32 v252, 31, v1
    v_lshlrev_b32 v252, 7, v252
    ds_read_b64_tr_b16 a[0:1], v236 offset:16384
    ds_read_b64_tr_b16 a[2:3], v236 offset:16896
    ds_read_b64_tr_b16 a[4:5], v237 offset:16384
    ds_read_b64_tr_b16 a[6:7], v237 offset:16896
    ds_read_b64_tr_b16 a[8:9], v238 offset:16384
    ds_read_b64_tr_b16 a[10:11], v238 offset:16896
    ds_read_b64_tr_b16 a[12:13], v239 offset:16384
    ds_read_b64_tr_b16 a[14:15], v239 offset:16896
    ds_read_b64_tr_b16 a[16:17], v236 offset:18432
    ds_read_b64_tr_b16 a[18:19], v236 offset:18944
    s_cmp_eq_u32 s6, 0
    s_cselect_b32 s90, 3, 7
    s_lshl_b32 s90, s90, 9
    s_add_u32 s90, s90, s99
    s_mov_b32 s64, 0
LC_p:
    buffer_load_dword v39, v38, s[8:11], s48 offen offset:1024 sc1
    s_add_u32 s64, s64, 1
    s_waitcnt vmcnt(0)
    v_cmp_ne_u32 vcc, s97, v39
    s_nop 0
    s_cmp_eq_u64 vcc, 0
    s_cbranch_scc1 LC_pd
    s_cmp_lt_u32 s64, 200000
    s_cbranch_scc1 LC_p
LC_pd:
    s_cmp_eq_u32 s6, 0
    s_cbranch_scc1 LC_pf
    buffer_inv sc1
    s_waitcnt vmcnt(0)
LC_pf:
    s_add_u32 s60, s52, 0
    s_add_u32 s61, s52, 40960
    buffer_load_dwordx4 a[32:35], v2, s[8:11], s60 offen offset:0 sc1
    buffer_load_dwordx4 a[36:39], v2, s[8:11], s61 offen offset:0 sc1
    buffer_load_dwordx4 a[40:43], v2, s[8:11], s60 offen offset:1024 sc1
    buffer_load_dwordx4 a[44:47], v2, s[8:11], s61 offen offset:1024 sc1
    buffer_load_dwordx4 a[48:51], v2, s[8:11], s60 offen offset:2048 sc1
    buffer_load_dwordx4 a[52:55], v2, s[8:11], s61 offen offset:2048 sc1
    buffer_load_dwordx4 a[56:59], v2, s[8:11], s60 offen offset:3072 sc1
    buffer_load_dwordx4 a[60:63], v2, s[8:11], s61 offen offset:3072 sc1
    s_waitcnt vmcnt(7) lgkmcnt(8)
    v_mfma_f32_32x32x16_bf16 v[40:55], a[0:3], a[32:35], 0
    ds_read_b64_tr_b16 a[20:21], v237 offset:18432
    ds_read_b64_tr_b16 a[22:23], v237 offset:18944
    s_add_u32 s60, s52, 4096
    s_add_u32 s61, s52, 45056
    s_waitcnt vmcnt(6)
    v_mfma_f32_32x32x16_bf16 v[56:71], a[0:3], a[36:39], 0
    buffer_load_dwordx4 a[64:67], v2, s[8:11], s60 offen offset:0 sc1
    s_waitcnt lgkmcnt(8)
    v_mfma_f32_32x32x16_bf16 v[72:87], a[4:7], a[32:35], 0
    ds_read_b64_tr_b16 a[24:25], v238 offset:18432
    ds_read_b64_tr_b16 a[26:27], v238 offset:18944
    v_mfma_f32_32x32x16_bf16 v[88:103], a[4:7], a[36:39], 0
    buffer_load_dwordx4 a[68:71], v2, s[8:11], s61 offen offset:0 sc1
    s_waitcnt lgkmcnt(6)
    v_mfma_f32_32x32x16_bf16 v[104:119], a[8:11], a[32:35], 0
    ds_read_b64_tr_b16 a[28:29], v239 offset:18432
    ds_read_b64_tr_b16 a[30:31], v239 offset:18944
    v_mfma_f32_32x32x16_bf16 v[120:135], a[8:11], a[36:39], 0
    buffer_load_dwordx4 a[72:75], v2, s[8:11], s60 offen offset:1024 sc1
    v_mfma_f32_32x32x16_bf16 v[136:151], a[12:15], a[32:35], 0
    ds_read_b64_tr_b16 a[0:1], v236 offset:20480
    ds_read_b64_tr_b16 a[2:3], v236 offset:20992
    v_mfma_f32_32x32x16_bf16 v[152:167], a[12:15], a[36:39], 0
    buffer_load_dwordx4 a[76:79], v2, s[8:11], s61 offen offset:1024 sc1
    s_waitcnt vmcnt(8) lgkmcnt(6)
    v_mfma_f32_32x32x16_bf16 v[40:55], a[16:19], a[40:43], v[40:55]
    ds_read_b64_tr_b16 a[4:5], v237 offset:20480
    ds_read_b64_tr_b16 a[6:7], v237 offset:20992
    v_mfma_f32_32x32x16_bf16 v[56:71], a[16:19], a[44:47], v[56:71]
    buffer_load_dwordx4 a[80:83], v2, s[8:11], s60 offen offset:2048 sc1
    v_mfma_f32_32x32x16_bf16 v[72:87], a[20:23], a[40:43], v[72:87]
    ds_read_b64_tr_b16 a[8:9], v238 offset:20480
    ds_read_b64_tr_b16 a[10:11], v238 offset:20992
    v_mfma_f32_32x32x16_bf16 v[88:103], a[20:23], a[44:47], v[88:103]
    buffer_load_dwordx4 a[84:87], v2, s[8:11], s61 offen offset:2048 sc1
    s_waitcnt lgkmcnt(6)
    v_mfma_f32_32x32x16_bf16 v[104:119], a[24:27], a[40:43], v[104:119]
    ds_read_b64_tr_b16 a[12:13], v239 offset:20480
    ds_read_b64_tr_b16 a[14:15], v239 offset:20992
    v_mfma_f32_32x32x16_bf16 v[120:135], a[24:27], a[44:47], v[120:135]
    buffer_load_dwordx4 a[88:91], v2, s[8:11], s60 offen offset:3072 sc1
    v_mfma_f32_32x32x16_bf16 v[136:151], a[28:31], a[40:43], v[136:151]
    ds_read_b64_tr_b16 a[16:17], v236 offset:22528
    ds_read_b64_tr_b16 a[18:19], v236 offset:23040
    v_mfma_f32_32x32x16_bf16 v[152:167], a[28:31], a[44:47], v[152:167]
    buffer_load_dwordx4 a[92:95], v2, s[8:11], s61 offen offset:3072 sc1
    s_waitcnt vmcnt(10) lgkmcnt(6)
    v_mfma_f32_32x32x16_bf16 v[40:55], a[0:3], a[48:51], v[40:55]
    ds_read_b64_tr_b16 a[20:21], v237 offset:22528
    ds_read_b64_tr_b16 a[22:23], v237 offset:23040
    s_add_u32 s60, s52, 8192
    s_add_u32 s61, s52, 49152
    v_mfma_f32_32x32x16_bf16 v[56:71], a[0:3], a[52:55], v[56:71]
    buffer_load_dwordx4 a[96:99], v2, s[8:11], s60 offen offset:0 sc1
    v_mfma_f32_32x32x16_bf16 v[72:87], a[4:7], a[48:51], v[72:87]
    ds_read_b64_tr_b16 a[24:25], v238 offset:22528
    ds_read_b64_tr_b16 a[26:27], v238 offset:23040
    buffer_load_dwordx4 a[100:103], v2, s[8:11], s61 offen offset:0 sc1
    v_mfma_f32_32x32x16_bf16 v[88:103], a[4:7], a[52:55], v[88:103]
    buffer_load_dwordx4 a[104:107], v2, s[8:11], s60 offen offset:1024 sc1
    s_waitcnt lgkmcnt(6)
    v_mfma_f32_32x32x16_bf16 v[104:119], a[8:11], a[48:51], v[104:119]
    ds_read_b64_tr_b16 a[28:29], v239 offset:22528
    ds_read_b64_tr_b16 a[30:31], v239 offset:23040
    v_mfma_f32_32x32x16_bf16 v[120:135], a[8:11], a[52:55], v[120:135]
    buffer_load_dwordx4 a[108:111], v2, s[8:11], s61 offen offset:1024 sc1
    v_mfma_f32_32x32x16_bf16 v[136:151], a[12:15], a[48:51], v[136:151]
    ds_read_b64_tr_b16 a[0:1], v236 offset:32768
    ds_read_b64_tr_b16 a[2:3], v236 offset:33280
    s_add_u32 m0, s58, 16384
    s_add_u32 s62, s57, 884736
    v_mfma_f32_32x32x16_bf16 v[152:167], a[12:15], a[52:55], v[152:167]
    buffer_load_dwordx4 v32, s[28:31], s62 offen offset:0 lds
    s_waitcnt vmcnt(13) lgkmcnt(6)
    v_mfma_f32_32x32x16_bf16 v[40:55], a[16:19], a[56:59], v[40:55]
    ds_read_b64_tr_b16 a[4:5], v237 offset:32768
    ds_read_b64_tr_b16 a[6:7], v237 offset:33280
    v_mfma_f32_32x32x16_bf16 v[56:71], a[16:19], a[60:63], v[56:71]
    buffer_load_dwordx4 a[112:115], v2, s[8:11], s60 offen offset:2048 sc1
    v_mfma_f32_32x32x16_bf16 v[72:87], a[20:23], a[56:59], v[72:87]
    ds_read_b64_tr_b16 a[8:9], v238 offset:32768
    ds_read_b64_tr_b16 a[10:11], v238 offset:33280
    v_mfma_f32_32x32x16_bf16 v[88:103], a[20:23], a[60:63], v[88:103]
    buffer_load_dwordx4 a[116:119], v2, s[8:11], s61 offen offset:2048 sc1
    s_waitcnt lgkmcnt(6)
    v_mfma_f32_32x32x16_bf16 v[104:119], a[24:27], a[56:59], v[104:119]
    ds_read_b64_tr_b16 a[12:13], v239 offset:32768
    ds_read_b64_tr_b16 a[14:15], v239 offset:33280
    v_mfma_f32_32x32x16_bf16 v[120:135], a[24:27], a[60:63], v[120:135]
    buffer_load_dwordx4 v33, s[28:31], s62 offen offset:1024 lds
    v_mfma_f32_32x32x16_bf16 v[136:151], a[28:31], a[56:59], v[136:151]
    ds_read_b64_tr_b16 a[16:17], v236 offset:34816
    ds_read_b64_tr_b16 a[18:19], v236 offset:35328
    v_mfma_f32_32x32x16_bf16 v[152:167], a[28:31], a[60:63], v[152:167]
    s_waitcnt vmcnt(14) lgkmcnt(6)
    v_mfma_f32_32x32x16_bf16 v[40:55], a[0:3], a[64:67], v[40:55]
    ds_read_b64_tr_b16 a[20:21], v237 offset:34816
    ds_read_b64_tr_b16 a[22:23], v237 offset:35328
    v_mfma_f32_32x32x16_bf16 v[56:71], a[0:3], a[68:71], v[56:71]
    buffer_load_dwordx4 a[120:123], v2, s[8:11], s60 offen offset:3072 sc1
    v_mfma_f32_32x32x16_bf16 v[72:87], a[4:7], a[64:67], v[72:87]
    ds_read_b64_tr_b16 a[24:25], v238 offset:34816
    ds_read_b64_tr_b16 a[26:27], v238 offset:35328
    v_mfma_f32_32x32x16_bf16 v[88:103], a[4:7], a[68:71], v[88:103]
    buffer_load_dwordx4 a[124:127], v2, s[8:11], s61 offen offset:3072 sc1
    s_waitcnt lgkmcnt(6)
    v_mfma_f32_32x32x16_bf16 v[104:119], a[8:11], a[64:67], v[104:119]
    ds_read_b64_tr_b16 a[28:29], v239 offset:34816
    ds_read_b64_tr_b16 a[30:31], v239 offset:35328
    s_add_u32 m0, s58, 24576
    v_mfma_f32_32x32x16_bf16 v[120:135], a[8:11], a[68:71], v[120:135]
    buffer_load_dwordx4 v34, s[32:35], s62 offen offset:0 lds
    v_mfma_f32_32x32x16_bf16 v[136:151], a[12:15], a[64:67], v[136:151]
    ds_read_b64_tr_b16 a[0:1], v236 offset:36864
    ds_read_b64_tr_b16 a[2:3], v236 offset:37376
    v_mfma_f32_32x32x16_bf16 v[152:167], a[12:15], a[68:71], v[152:167]
    s_waitcnt vmcnt(15) lgkmcnt(6)
    v_mfma_f32_32x32x16_bf16 v[40:55], a[16:19], a[72:75], v[40:55]
    ds_read_b64_tr_b16 a[4:5], v237 offset:36864
    ds_read_b64_tr_b16 a[6:7], v237 offset:37376
    s_add_u32 s60, s52, 12288
    s_add_u32 s61, s52, 53248
    v_mfma_f32_32x32x16_bf16 v[56:71], a[16:19], a[76:79], v[56:71]
    buffer_load_dwordx4 a[128:131], v2, s[8:11], s60 offen offset:0 sc1
    v_mfma_f32_32x32x16_bf16 v[72:87], a[20:23], a[72:75], v[72:87]
    ds_read_b64_tr_b16 a[8:9], v238 offset:36864
    ds_read_b64_tr_b16 a[10:11], v238 offset:37376
    buffer_load_dwordx4 a[132:135], v2, s[8:11], s61 offen offset:0 sc1
    v_mfma_f32_32x32x16_bf16 v[88:103], a[20:23], a[76:79], v[88:103]
    buffer_load_dwordx4 a[136:139], v2, s[8:11], s60 offen offset:1024 sc1
    s_waitcnt lgkmcnt(6)
    v_mfma_f32_32x32x16_bf16 v[104:119], a[24:27], a[72:75], v[104:119]
    ds_read_b64_tr_b16 a[12:13], v239 offset:36864
    ds_read_b64_tr_b16 a[14:15], v239 offset:37376
    v_mfma_f32_32x32x16_bf16 v[120:135], a[24:27], a[76:79], v[120:135]
    buffer_load_dwordx4 a[140:143], v2, s[8:11], s61 offen offset:1024 sc1
    v_mfma_f32_32x32x16_bf16 v[136:151], a[28:31], a[72:75], v[136:151]
    ds_read_b64_tr_b16 a[16:17], v236 offset:38912
    ds_read_b64_tr_b16 a[18:19], v236 offset:39424
    buffer_load_dwordx4 v35, s[32:35], s62 offen offset:1024 lds
    s_add_u32 m0, s58, 32768
    s_add_u32 s62, s57, 1105920
    v_mfma_f32_32x32x16_bf16 v[152:167], a[28:31], a[76:79], v[152:167]
    buffer_load_dwordx4 v32, s[28:31], s62 offen offset:0 lds
    s_waitcnt vmcnt(19) lgkmcnt(6)
    v_mfma_f32_32x32x16_bf16 v[40:55], a[0:3], a[80:83], v[40:55]
    ds_read_b64_tr_b16 a[20:21], v237 offset:38912
    ds_read_b64_tr_b16 a[22:23], v237 offset:39424
    v_mfma_f32_32x32x16_bf16 v[56:71], a[0:3], a[84:87], v[56:71]
    buffer_load_dwordx4 a[144:147], v2, s[8:11], s60 offen offset:2048 sc1
    v_mfma_f32_32x32x16_bf16 v[72:87], a[4:7], a[80:83], v[72:87]
    ds_read_b64_tr_b16 a[24:25], v238 offset:38912
    ds_read_b64_tr_b16 a[26:27], v238 offset:39424
    buffer_load_dwordx4 a[148:151], v2, s[8:11], s61 offen offset:2048 sc1
    v_mfma_f32_32x32x16_bf16 v[88:103], a[4:7], a[84:87], v[88:103]
    buffer_load_dwordx4 a[152:155], v2, s[8:11], s60 offen offset:3072 sc1
    s_waitcnt lgkmcnt(6)
    v_mfma_f32_32x32x16_bf16 v[104:119], a[8:11], a[80:83], v[104:119]
    ds_read_b64_tr_b16 a[28:29], v239 offset:38912
    ds_read_b64_tr_b16 a[30:31], v239 offset:39424
    v_mfma_f32_32x32x16_bf16 v[120:135], a[8:11], a[84:87], v[120:135]
    buffer_load_dwordx4 a[156:159], v2, s[8:11], s61 offen offset:3072 sc1
    v_mfma_f32_32x32x16_bf16 v[136:151], a[12:15], a[80:83], v[136:151]
    ds_read_b64_tr_b16 a[0:1], v236 offset:49152
    ds_read_b64_tr_b16 a[2:3], v236 offset:49664
    v_mfma_f32_32x32x16_bf16 v[152:167], a[12:15], a[84:87], v[152:167]
    buffer_load_dwordx4 v33, s[28:31], s62 offen offset:1024 lds
    s_waitcnt vmcnt(22) lgkmcnt(6)
    v_mfma_f32_32x32x16_bf16 v[40:55], a[16:19], a[88:91], v[40:55]
    ds_read_b64_tr_b16 a[4:5], v237 offset:49152
    ds_read_b64_tr_b16 a[6:7], v237 offset:49664
    s_add_u32 s60, s52, 16384
    s_add_u32 s61, s52, 57344
    v_mfma_f32_32x32x16_bf16 v[56:71], a[16:19], a[92:95], v[56:71]
    buffer_load_dwordx4 a[160:163], v2, s[8:11], s60 offen offset:0 sc1
    v_mfma_f32_32x32x16_bf16 v[72:87], a[20:23], a[88:91], v[72:87]
    ds_read_b64_tr_b16 a[8:9], v238 offset:49152
    ds_read_b64_tr_b16 a[10:11], v238 offset:49664
    v_mfma_f32_32x32x16_bf16 v[88:103], a[20:23], a[92:95], v[88:103]
    buffer_load_dwordx4 a[164:167], v2, s[8:11], s61 offen offset:0 sc1
    s_waitcnt lgkmcnt(6)
    v_mfma_f32_32x32x16_bf16 v[104:119], a[24:27], a[88:91], v[104:119]
    ds_read_b64_tr_b16 a[12:13], v239 offset:49152
    ds_read_b64_tr_b16 a[14:15], v239 offset:49664
    s_add_u32 m0, s58, 40960
    v_mfma_f32_32x32x16_bf16 v[120:135], a[24:27], a[92:95], v[120:135]
    buffer_load_dwordx4 v34, s[32:35], s62 offen offset:0 lds
    v_mfma_f32_32x32x16_bf16 v[136:151], a[28:31], a[88:91], v[136:151]
    ds_read_b64_tr_b16 a[16:17], v236 offset:51200
    ds_read_b64_tr_b16 a[18:19], v236 offset:51712
    v_mfma_f32_32x32x16_bf16 v[152:167], a[28:31], a[92:95], v[152:167]
    s_waitcnt vmcnt(23) lgkmcnt(6)
    v_mfma_f32_32x32x16_bf16 v[40:55], a[0:3], a[96:99], v[40:55]
    ds_read_b64_tr_b16 a[20:21], v237 offset:51200
    ds_read_b64_tr_b16 a[22:23], v237 offset:51712
    v_mfma_f32_32x32x16_bf16 v[56:71], a[0:3], a[100:103], v[56:71]
    buffer_load_dwordx4 a[168:171], v2, s[8:11], s60 offen offset:1024 sc1
    v_mfma_f32_32x32x16_bf16 v[72:87], a[4:7], a[96:99], v[72:87]
    ds_read_b64_tr_b16 a[24:25], v238 offset:51200
    ds_read_b64_tr_b16 a[26:27], v238 offset:51712
    v_mfma_f32_32x32x16_bf16 v[88:103], a[4:7], a[100:103], v[88:103]
    buffer_load_dwordx4 a[172:175], v2, s[8:11], s61 offen offset:1024 sc1
    s_waitcnt lgkmcnt(6)
    v_mfma_f32_32x32x16_bf16 v[104:119], a[8:11], a[96:99], v[104:119]
    ds_read_b64_tr_b16 a[28:29], v239 offset:51200
    ds_read_b64_tr_b16 a[30:31], v239 offset:51712
    v_mfma_f32_32x32x16_bf16 v[120:135], a[8:11], a[100:103], v[120:135]
    buffer_load_dwordx4 v35, s[32:35], s62 offen offset:1024 lds
    v_mfma_f32_32x32x16_bf16 v[136:151], a[12:15], a[96:99], v[136:151]
    ds_read_b64_tr_b16 a[0:1], v236 offset:53248
    ds_read_b64_tr_b16 a[2:3], v236 offset:53760
    s_add_u32 m0, s58, 49152
    s_add_u32 s62, s57, 1327104
    v_mfma_f32_32x32x16_bf16 v[152:167], a[12:15], a[100:103], v[152:167]
    buffer_load_dwordx4 v32, s[28:31], s62 offen offset:0 lds
    s_waitcnt vmcnt(25) lgkmcnt(6)
    v_mfma_f32_32x32x16_bf16 v[40:55], a[16:19], a[104:107], v[40:55]
    ds_read_b64_tr_b16 a[4:5], v237 offset:53248
    ds_read_b64_tr_b16 a[6:7], v237 offset:53760
    v_mfma_f32_32x32x16_bf16 v[56:71], a[16:19], a[108:111], v[56:71]
    buffer_load_dwordx4 a[176:179], v2, s[8:11], s60 offen offset:2048 sc1
    v_mfma_f32_32x32x16_bf16 v[72:87], a[20:23], a[104:107], v[72:87]
    ds_read_b64_tr_b16 a[8:9], v238 offset:53248
    ds_read_b64_tr_b16 a[10:11], v238 offset:53760
    buffer_load_dwordx4 a[180:183], v2, s[8:11], s61 offen offset:2048 sc1
    v_mfma_f32_32x32x16_bf16 v[88:103], a[20:23], a[108:111], v[88:103]
    buffer_load_dwordx4 a[184:187], v2, s[8:11], s60 offen offset:3072 sc1
    s_waitcnt lgkmcnt(6)
    v_mfma_f32_32x32x16_bf16 v[104:119], a[24:27], a[104:107], v[104:119]
    ds_read_b64_tr_b16 a[12:13], v239 offset:53248
    ds_read_b64_tr_b16 a[14:15], v239 offset:53760
    v_mfma_f32_32x32x16_bf16 v[120:135], a[24:27], a[108:111], v[120:135]
    buffer_load_dwordx4 a[188:191], v2, s[8:11], s61 offen offset:3072 sc1
    v_mfma_f32_32x32x16_bf16 v[136:151], a[28:31], a[104:107], v[136:151]
    ds_read_b64_tr_b16 a[16:17], v236 offset:55296
    ds_read_b64_tr_b16 a[18:19], v236 offset:55808
    v_mfma_f32_32x32x16_bf16 v[152:167], a[28:31], a[108:111], v[152:167]
    buffer_load_dwordx4 v33, s[28:31], s62 offen offset:1024 lds
    s_waitcnt vmcnt(27) lgkmcnt(6)
    v_mfma_f32_32x32x16_bf16 v[40:55], a[0:3], a[112:115], v[40:55]
    ds_read_b64_tr_b16 a[20:21], v237 offset:55296
    ds_read_b64_tr_b16 a[22:23], v237 offset:55808
    s_add_u32 s60, s52, 20480
    s_add_u32 s61, s52, 61440
    v_mfma_f32_32x32x16_bf16 v[56:71], a[0:3], a[116:119], v[56:71]
    buffer_load_dwordx4 a[192:195], v2, s[8:11], s60 offen offset:0 sc1
    v_mfma_f32_32x32x16_bf16 v[72:87], a[4:7], a[112:115], v[72:87]
    ds_read_b64_tr_b16 a[24:25], v238 offset:55296
    ds_read_b64_tr_b16 a[26:27], v238 offset:55808
    buffer_load_dwordx4 a[196:199], v2, s[8:11], s61 offen offset:0 sc1
    v_mfma_f32_32x32x16_bf16 v[88:103], a[4:7], a[116:119], v[88:103]
    buffer_load_dwordx4 a[200:203], v2, s[8:11], s60 offen offset:1024 sc1
    s_waitcnt lgkmcnt(6)
    v_mfma_f32_32x32x16_bf16 v[104:119], a[8:11], a[112:115], v[104:119]
    ds_read_b64_tr_b16 a[28:29], v239 offset:55296
    ds_read_b64_tr_b16 a[30:31], v239 offset:55808
    v_mfma_f32_32x32x16_bf16 v[120:135], a[8:11], a[116:119], v[120:135]
    buffer_load_dwordx4 a[204:207], v2, s[8:11], s61 offen offset:1024 sc1
    v_mfma_f32_32x32x16_bf16 v[136:151], a[12:15], a[112:115], v[136:151]
    ds_read_b64_tr_b16 a[0:1], v232 offset:0
    ds_read_b64_tr_b16 a[2:3], v232 offset:512
    s_add_u32 m0, s58, 57344
    v_mfma_f32_32x32x16_bf16 v[152:167], a[12:15], a[116:119], v[152:167]
    buffer_load_dwordx4 v34, s[32:35], s62 offen offset:0 lds
    s_waitcnt vmcnt(29) lgkmcnt(6)
    v_mfma_f32_32x32x16_bf16 v[40:55], a[16:19], a[120:123], v[40:55]
    ds_read_b64_tr_b16 a[4:5], v233 offset:0
    ds_read_b64_tr_b16 a[6:7], v233 offset:512
    v_mfma_f32_32x32x16_bf16 v[56:71], a[16:19], a[124:127], v[56:71]
    buffer_load_dwordx4 a[208:211], v2, s[8:11], s60 offen offset:2048 sc1
    v_mfma_f32_32x32x16_bf16 v[72:87], a[20:23], a[120:123], v[72:87]
    ds_read_b64_tr_b16 a[8:9], v234 offset:0
    ds_read_b64_tr_b16 a[10:11], v234 offset:512
    v_mfma_f32_32x32x16_bf16 v[88:103], a[20:23], a[124:127], v[88:103]
    buffer_load_dwordx4 a[212:215], v2, s[8:11], s61 offen offset:2048 sc1
    s_waitcnt lgkmcnt(6)
    v_mfma_f32_32x32x16_bf16 v[104:119], a[24:27], a[120:123], v[104:119]
    ds_read_b64_tr_b16 a[12:13], v235 offset:0
    ds_read_b64_tr_b16 a[14:15], v235 offset:512
    v_mfma_f32_32x32x16_bf16 v[120:135], a[24:27], a[124:127], v[120:135]
    buffer_load_dwordx4 v35, s[32:35], s62 offen offset:1024 lds
    v_mfma_f32_32x32x16_bf16 v[136:151], a[28:31], a[120:123], v[136:151]
    ds_read_b64_tr_b16 a[16:17], v232 offset:2048
    ds_read_b64_tr_b16 a[18:19], v232 offset:2560
    s_add_u32 m0, s58, 65536
    s_add_u32 s62, s57, 1548288
    v_mfma_f32_32x32x16_bf16 v[152:167], a[28:31], a[124:127], v[152:167]
    buffer_load_dwordx4 v32, s[28:31], s62 offen offset:0 lds
    s_waitcnt vmcnt(30) lgkmcnt(6)
    v_mfma_f32_32x32x16_bf16 v[40:55], a[0:3], a[128:131], v[40:55]
    ds_read_b64_tr_b16 a[20:21], v233 offset:2048
    ds_read_b64_tr_b16 a[22:23], v233 offset:2560
    v_mfma_f32_32x32x16_bf16 v[56:71], a[0:3], a[132:135], v[56:71]
    buffer_load_dwordx4 a[216:219], v2, s[8:11], s60 offen offset:3072 sc1
    v_mfma_f32_32x32x16_bf16 v[72:87], a[4:7], a[128:131], v[72:87]
    ds_read_b64_tr_b16 a[24:25], v234 offset:2048
    ds_read_b64_tr_b16 a[26:27], v234 offset:2560
    v_mfma_f32_32x32x16_bf16 v[88:103], a[4:7], a[132:135], v[88:103]
    buffer_load_dwordx4 a[220:223], v2, s[8:11], s61 offen offset:3072 sc1
    s_waitcnt lgkmcnt(6)
    v_mfma_f32_32x32x16_bf16 v[104:119], a[8:11], a[128:131], v[104:119]
    ds_read_b64_tr_b16 a[28:29], v235 offset:2048
    ds_read_b64_tr_b16 a[30:31], v235 offset:2560
    v_mfma_f32_32x32x16_bf16 v[120:135], a[8:11], a[132:135], v[120:135]
    buffer_load_dwordx4 v33, s[28:31], s62 offen offset:1024 lds
    v_mfma_f32_32x32x16_bf16 v[136:151], a[12:15], a[128:131], v[136:151]
    ds_read_b64_tr_b16 a[0:1], v232 offset:4096
    ds_read_b64_tr_b16 a[2:3], v232 offset:4608
    v_mfma_f32_32x32x16_bf16 v[152:167], a[12:15], a[132:135], v[152:167]
    s_waitcnt vmcnt(31) lgkmcnt(6)
    v_mfma_f32_32x32x16_bf16 v[40:55], a[16:19], a[136:139], v[40:55]
    ds_read_b64_tr_b16 a[4:5], v233 offset:4096
    ds_read_b64_tr_b16 a[6:7], v233 offset:4608
    s_add_u32 s60, s52, 24576
    s_add_u32 s61, s52, 65536
    v_mfma_f32_32x32x16_bf16 v[56:71], a[16:19], a[140:143], v[56:71]
    buffer_load_dwordx4 a[32:35], v2, s[8:11], s60 offen offset:0 sc1
    v_mfma_f32_32x32x16_bf16 v[72:87], a[20:23], a[136:139], v[72:87]
    ds_read_b64_tr_b16 a[8:9], v234 offset:4096
    ds_read_b64_tr_b16 a[10:11], v234 offset:4608
    buffer_load_dwordx4 a[36:39], v2, s[8:11], s61 offen offset:0 sc1
    v_mfma_f32_32x32x16_bf16 v[88:103], a[20:23], a[140:143], v[88:103]
    buffer_load_dwordx4 a[40:43], v2, s[8:11], s60 offen offset:1024 sc1
    s_waitcnt lgkmcnt(6)
    v_mfma_f32_32x32x16_bf16 v[104:119], a[24:27], a[136:139], v[104:119]
    ds_read_b64_tr_b16 a[12:13], v235 offset:4096
    ds_read_b64_tr_b16 a[14:15], v235 offset:4608
    v_mfma_f32_32x32x16_bf16 v[120:135], a[24:27], a[140:143], v[120:135]
    buffer_load_dwordx4 a[44:47], v2, s[8:11], s61 offen offset:1024 sc1
    v_mfma_f32_32x32x16_bf16 v[136:151], a[28:31], a[136:139], v[136:151]
    ds_read_b64_tr_b16 a[16:17], v232 offset:6144
    ds_read_b64_tr_b16 a[18:19], v232 offset:6656
    s_add_u32 m0, s58, 73728
    v_mfma_f32_32x32x16_bf16 v[152:167], a[28:31], a[140:143], v[152:167]
    buffer_load_dwordx4 v34, s[32:35], s62 offen offset:0 lds
    s_waitcnt vmcnt(23) lgkmcnt(6)
    v_mfma_f32_32x32x16_bf16 v[40:55], a[0:3], a[144:147], v[40:55]
    s_barrier
    v_mfma_f32_32x32x16_bf16 v[56:71], a[0:3], a[148:151], v[56:71]
    ds_read_b64_tr_b16 a[20:21], v233 offset:6144
    ds_read_b64_tr_b16 a[22:23], v233 offset:6656
    buffer_load_dwordx4 a[48:51], v2, s[8:11], s60 offen offset:2048 sc1
    v_mfma_f32_32x32x16_bf16 v[72:87], a[4:7], a[144:147], v[72:87]
    ds_read_b64_tr_b16 a[24:25], v234 offset:6144
    ds_read_b64_tr_b16 a[26:27], v234 offset:6656
    v_mfma_f32_32x32x16_bf16 v[88:103], a[4:7], a[148:151], v[88:103]
    buffer_load_dwordx4 a[52:55], v2, s[8:11], s61 offen offset:2048 sc1
    s_waitcnt lgkmcnt(6)
    v_mfma_f32_32x32x16_bf16 v[104:119], a[8:11], a[144:147], v[104:119]
    ds_read_b64_tr_b16 a[28:29], v235 offset:6144
    ds_read_b64_tr_b16 a[30:31], v235 offset:6656
    v_mfma_f32_32x32x16_bf16 v[120:135], a[8:11], a[148:151], v[120:135]
    buffer_load_dwordx4 v35, s[32:35], s62 offen offset:1024 lds
    v_mfma_f32_32x32x16_bf16 v[136:151], a[12:15], a[144:147], v[136:151]
    ds_read_b64_tr_b16 a[0:1], v232 offset:16384
    ds_read_b64_tr_b16 a[2:3], v232 offset:16896
    v_mfma_f32_32x32x16_bf16 v[152:167], a[12:15], a[148:151], v[152:167]
    s_waitcnt lgkmcnt(6)
    v_mfma_f32_32x32x16_bf16 v[40:55], a[16:19], a[152:155], v[40:55]
    ds_read_b64_tr_b16 a[4:5], v233 offset:16384
    ds_read_b64_tr_b16 a[6:7], v233 offset:16896
    v_mfma_f32_32x32x16_bf16 v[56:71], a[16:19], a[156:159], v[56:71]
    buffer_load_dwordx4 a[56:59], v2, s[8:11], s60 offen offset:3072 sc1
    v_mfma_f32_32x32x16_bf16 v[72:87], a[20:23], a[152:155], v[72:87]
    ds_read_b64_tr_b16 a[8:9], v234 offset:16384
    ds_read_b64_tr_b16 a[10:11], v234 offset:16896
    v_mfma_f32_32x32x16_bf16 v[88:103], a[20:23], a[156:159], v[88:103]
    buffer_load_dwordx4 a[60:63], v2, s[8:11], s61 offen offset:3072 sc1
    s_waitcnt lgkmcnt(6)
    v_mfma_f32_32x32x16_bf16 v[104:119], a[24:27], a[152:155], v[104:119]
    ds_read_b64_tr_b16 a[12:13], v235 offset:16384
    ds_read_b64_tr_b16 a[14:15], v235 offset:16896
    s_add_u32 m0, s58, 81920
    s_add_u32 s62, s57, 1769472
    v_mfma_f32_32x32x16_bf16 v[120:135], a[24:27], a[156:159], v[120:135]
    buffer_load_dwordx4 v32, s[28:31], s62 offen offset:0 lds
    v_mfma_f32_32x32x16_bf16 v[136:151], a[28:31], a[152:155], v[136:151]
    ds_read_b64_tr_b16 a[16:17], v232 offset:18432
    ds_read_b64_tr_b16 a[18:19], v232 offset:18944
    v_mfma_f32_32x32x16_bf16 v[152:167], a[28:31], a[156:159], v[152:167]
    s_waitcnt lgkmcnt(6)
    v_mfma_f32_32x32x16_bf16 v[40:55], a[0:3], a[160:163], v[40:55]
    ds_read_b64_tr_b16 a[20:21], v233 offset:18432
    ds_read_b64_tr_b16 a[22:23], v233 offset:18944
    s_add_u32 s60, s52, 28672
    s_add_u32 s61, s52, 69632
    v_mfma_f32_32x32x16_bf16 v[56:71], a[0:3], a[164:167], v[56:71]
    buffer_load_dwordx4 a[64:67], v2, s[8:11], s60 offen offset:0 sc1
    v_mfma_f32_32x32x16_bf16 v[72:87], a[4:7], a[160:163], v[72:87]
    ds_read_b64_tr_b16 a[24:25], v234 offset:18432
    ds_read_b64_tr_b16 a[26:27], v234 offset:18944
    v_mfma_f32_32x32x16_bf16 v[88:103], a[4:7], a[164:167], v[88:103]
    buffer_load_dwordx4 a[68:71], v2, s[8:11], s61 offen offset:0 sc1
    s_waitcnt lgkmcnt(6)
    v_mfma_f32_32x32x16_bf16 v[104:119], a[8:11], a[160:163], v[104:119]
    ds_read_b64_tr_b16 a[28:29], v235 offset:18432
    ds_read_b64_tr_b16 a[30:31], v235 offset:18944
    v_mfma_f32_32x32x16_bf16 v[120:135], a[8:11], a[164:167], v[120:135]
    buffer_load_dwordx4 v33, s[28:31], s62 offen offset:1024 lds
    v_mfma_f32_32x32x16_bf16 v[136:151], a[12:15], a[160:163], v[136:151]
    ds_read_b64_tr_b16 a[0:1], v232 offset:20480
    ds_read_b64_tr_b16 a[2:3], v232 offset:20992
    v_mfma_f32_32x32x16_bf16 v[152:167], a[12:15], a[164:167], v[152:167]
    s_waitcnt lgkmcnt(6)
    v_mfma_f32_32x32x16_bf16 v[40:55], a[16:19], a[168:171], v[40:55]
    ds_read_b64_tr_b16 a[4:5], v233 offset:20480
    ds_read_b64_tr_b16 a[6:7], v233 offset:20992
    v_mfma_f32_32x32x16_bf16 v[56:71], a[16:19], a[172:175], v[56:71]
    buffer_load_dwordx4 a[72:75], v2, s[8:11], s60 offen offset:1024 sc1
    v_mfma_f32_32x32x16_bf16 v[72:87], a[20:23], a[168:171], v[72:87]
    ds_read_b64_tr_b16 a[8:9], v234 offset:20480
    ds_read_b64_tr_b16 a[10:11], v234 offset:20992
    v_mfma_f32_32x32x16_bf16 v[88:103], a[20:23], a[172:175], v[88:103]
    buffer_load_dwordx4 a[76:79], v2, s[8:11], s61 offen offset:1024 sc1
    s_waitcnt lgkmcnt(6)
    v_mfma_f32_32x32x16_bf16 v[104:119], a[24:27], a[168:171], v[104:119]
    ds_read_b64_tr_b16 a[12:13], v235 offset:20480
    ds_read_b64_tr_b16 a[14:15], v235 offset:20992
    s_add_u32 m0, s58, 90112
    v_mfma_f32_32x32x16_bf16 v[120:135], a[24:27], a[172:175], v[120:135]
    buffer_load_dwordx4 v34, s[32:35], s62 offen offset:0 lds
    v_mfma_f32_32x32x16_bf16 v[136:151], a[28:31], a[168:171], v[136:151]
    ds_read_b64_tr_b16 a[16:17], v232 offset:22528
    ds_read_b64_tr_b16 a[18:19], v232 offset:23040
    v_mfma_f32_32x32x16_bf16 v[152:167], a[28:31], a[172:175], v[152:167]
    s_waitcnt vmcnt(32) lgkmcnt(6)
    v_mfma_f32_32x32x16_bf16 v[40:55], a[0:3], a[176:179], v[40:55]
    ds_read_b64_tr_b16 a[20:21], v233 offset:22528
    ds_read_b64_tr_b16 a[22:23], v233 offset:23040
    v_mfma_f32_32x32x16_bf16 v[56:71], a[0:3], a[180:183], v[56:71]
    buffer_load_dwordx4 a[80:83], v2, s[8:11], s60 offen offset:2048 sc1
    v_mfma_f32_32x32x16_bf16 v[72:87], a[4:7], a[176:179], v[72:87]
    ds_read_b64_tr_b16 a[24:25], v234 offset:22528
    ds_read_b64_tr_b16 a[26:27], v234 offset:23040
    v_mfma_f32_32x32x16_bf16 v[88:103], a[4:7], a[180:183], v[88:103]
    buffer_load_dwordx4 a[84:87], v2, s[8:11], s61 offen offset:2048 sc1
    s_waitcnt lgkmcnt(6)
    v_mfma_f32_32x32x16_bf16 v[104:119], a[8:11], a[176:179], v[104:119]
    ds_read_b64_tr_b16 a[28:29], v235 offset:22528
    ds_read_b64_tr_b16 a[30:31], v235 offset:23040
    v_mfma_f32_32x32x16_bf16 v[120:135], a[8:11], a[180:183], v[120:135]
    buffer_load_dwordx4 v35, s[32:35], s62 offen offset:1024 lds
    v_mfma_f32_32x32x16_bf16 v[136:151], a[12:15], a[176:179], v[136:151]
    ds_read_b64_tr_b16 a[0:1], v232 offset:32768
    ds_read_b64_tr_b16 a[2:3], v232 offset:33280
    s_add_u32 m0, s58, 98304
    s_add_u32 s62, s57, 1990656
    v_mfma_f32_32x32x16_bf16 v[152:167], a[12:15], a[180:183], v[152:167]
    buffer_load_dwordx4 v32, s[28:31], s62 offen offset:0 lds
    s_waitcnt vmcnt(34) lgkmcnt(6)
    v_mfma_f32_32x32x16_bf16 v[40:55], a[16:19], a[184:187], v[40:55]
    ds_read_b64_tr_b16 a[4:5], v233 offset:32768
    ds_read_b64_tr_b16 a[6:7], v233 offset:33280
    v_mfma_f32_32x32x16_bf16 v[56:71], a[16:19], a[188:191], v[56:71]
    buffer_load_dwordx4 a[88:91], v2, s[8:11], s60 offen offset:3072 sc1
    v_mfma_f32_32x32x16_bf16 v[72:87], a[20:23], a[184:187], v[72:87]
    ds_read_b64_tr_b16 a[8:9], v234 offset:32768
    ds_read_b64_tr_b16 a[10:11], v234 offset:33280
    v_mfma_f32_32x32x16_bf16 v[88:103], a[20:23], a[188:191], v[88:103]
    buffer_load_dwordx4 a[92:95], v2, s[8:11], s61 offen offset:3072 sc1
    s_waitcnt lgkmcnt(6)
    v_mfma_f32_32x32x16_bf16 v[104:119], a[24:27], a[184:187], v[104:119]
    ds_read_b64_tr_b16 a[12:13], v235 offset:32768
    ds_read_b64_tr_b16 a[14:15], v235 offset:33280
    v_mfma_f32_32x32x16_bf16 v[120:135], a[24:27], a[188:191], v[120:135]
    buffer_load_dwordx4 v33, s[28:31], s62 offen offset:1024 lds
    v_mfma_f32_32x32x16_bf16 v[136:151], a[28:31], a[184:187], v[136:151]
    ds_read_b64_tr_b16 a[16:17], v232 offset:34816
    ds_read_b64_tr_b16 a[18:19], v232 offset:35328
    v_mfma_f32_32x32x16_bf16 v[152:167], a[28:31], a[188:191], v[152:167]
    s_waitcnt vmcnt(34) lgkmcnt(6)
    v_mfma_f32_32x32x16_bf16 v[40:55], a[0:3], a[192:195], v[40:55]
    ds_read_b64_tr_b16 a[20:21], v233 offset:34816
    ds_read_b64_tr_b16 a[22:23], v233 offset:35328
    s_add_u32 s60, s52, 32768
    s_add_u32 s61, s52, 73728
    v_mfma_f32_32x32x16_bf16 v[56:71], a[0:3], a[196:199], v[56:71]
    buffer_load_dwordx4 a[96:99], v2, s[8:11], s60 offen offset:0 sc1
    v_mfma_f32_32x32x16_bf16 v[72:87], a[4:7], a[192:195], v[72:87]
    ds_read_b64_tr_b16 a[24:25], v234 offset:34816
    ds_read_b64_tr_b16 a[26:27], v234 offset:35328
    v_mfma_f32_32x32x16_bf16 v[88:103], a[4:7], a[196:199], v[88:103]
    buffer_load_dwordx4 a[100:103], v2, s[8:11], s61 offen offset:0 sc1
    s_waitcnt lgkmcnt(6)
    v_mfma_f32_32x32x16_bf16 v[104:119], a[8:11], a[192:195], v[104:119]
    ds_read_b64_tr_b16 a[28:29], v235 offset:34816
    ds_read_b64_tr_b16 a[30:31], v235 offset:35328
    s_add_u32 m0, s58, 106496
    v_mfma_f32_32x32x16_bf16 v[120:135], a[8:11], a[196:199], v[120:135]
    buffer_load_dwordx4 v34, s[32:35], s62 offen offset:0 lds
    v_mfma_f32_32x32x16_bf16 v[136:151], a[12:15], a[192:195], v[136:151]
    ds_read_b64_tr_b16 a[0:1], v232 offset:36864
    ds_read_b64_tr_b16 a[2:3], v232 offset:37376
    v_mfma_f32_32x32x16_bf16 v[152:167], a[12:15], a[196:199], v[152:167]
    s_waitcnt vmcnt(35) lgkmcnt(6)
    v_mfma_f32_32x32x16_bf16 v[40:55], a[16:19], a[200:203], v[40:55]
    ds_read_b64_tr_b16 a[4:5], v233 offset:36864
    ds_read_b64_tr_b16 a[6:7], v233 offset:37376
    v_mfma_f32_32x32x16_bf16 v[56:71], a[16:19], a[204:207], v[56:71]
    buffer_load_dwordx4 a[104:107], v2, s[8:11], s60 offen offset:1024 sc1
    v_mfma_f32_32x32x16_bf16 v[72:87], a[20:23], a[200:203], v[72:87]
    ds_read_b64_tr_b16 a[8:9], v234 offset:36864
    ds_read_b64_tr_b16 a[10:11], v234 offset:37376
    v_mfma_f32_32x32x16_bf16 v[88:103], a[20:23], a[204:207], v[88:103]
    buffer_load_dwordx4 a[108:111], v2, s[8:11], s61 offen offset:1024 sc1
    s_waitcnt lgkmcnt(6)
    v_mfma_f32_32x32x16_bf16 v[104:119], a[24:27], a[200:203], v[104:119]
    ds_read_b64_tr_b16 a[12:13], v235 offset:36864
    ds_read_b64_tr_b16 a[14:15], v235 offset:37376
    v_mfma_f32_32x32x16_bf16 v[120:135], a[24:27], a[204:207], v[120:135]
    buffer_load_dwordx4 v35, s[32:35], s62 offen offset:1024 lds
    v_mfma_f32_32x32x16_bf16 v[136:151], a[28:31], a[200:203], v[136:151]
    ds_read_b64_tr_b16 a[16:17], v232 offset:38912
    ds_read_b64_tr_b16 a[18:19], v232 offset:39424
    s_add_u32 m0, s49, 114688
    s_add_u32 s62, s56, 0
    v_mfma_f32_32x32x16_bf16 v[152:167], a[28:31], a[204:207], v[152:167]
    buffer_load_dwordx4 v28, s[36:39], s62 offen offset:0 lds
    s_waitcnt vmcnt(23) lgkmcnt(6)
    v_mfma_f32_32x32x16_bf16 v[40:55], a[0:3], a[208:211], v[40:55]
    s_barrier
    v_mfma_f32_32x32x16_bf16 v[56:71], a[0:3], a[212:215], v[56:71]
    ds_read_b64_tr_b16 a[20:21], v233 offset:38912
    ds_read_b64_tr_b16 a[22:23], v233 offset:39424
    buffer_load_dwordx4 a[112:115], v2, s[8:11], s60 offen offset:2048 sc1
    v_mfma_f32_32x32x16_bf16 v[72:87], a[4:7], a[208:211], v[72:87]
    ds_read_b64_tr_b16 a[24:25], v234 offset:38912
    ds_read_b64_tr_b16 a[26:27], v234 offset:39424
    v_mfma_f32_32x32x16_bf16 v[88:103], a[4:7], a[212:215], v[88:103]
    buffer_load_dwordx4 a[116:119], v2, s[8:11], s61 offen offset:2048 sc1
    s_waitcnt lgkmcnt(6)
    v_mfma_f32_32x32x16_bf16 v[104:119], a[8:11], a[208:211], v[104:119]
    ds_read_b64_tr_b16 a[28:29], v235 offset:38912
    ds_read_b64_tr_b16 a[30:31], v235 offset:39424
    v_mfma_f32_32x32x16_bf16 v[120:135], a[8:11], a[212:215], v[120:135]
    buffer_load_dwordx4 v29, s[36:39], s62 offen offset:1024 lds
    v_mfma_f32_32x32x16_bf16 v[136:151], a[12:15], a[208:211], v[136:151]
    ds_read_b64_tr_b16 a[0:1], v232 offset:49152
    ds_read_b64_tr_b16 a[2:3], v232 offset:49664
    v_mfma_f32_32x32x16_bf16 v[152:167], a[12:15], a[212:215], v[152:167]
    buffer_load_dwordx4 v30, s[36:39], s62 offen offset:2048 lds
    s_waitcnt lgkmcnt(6)
    v_mfma_f32_32x32x16_bf16 v[40:55], a[16:19], a[216:219], v[40:55]
    ds_read_b64_tr_b16 a[4:5], v233 offset:49152
    ds_read_b64_tr_b16 a[6:7], v233 offset:49664
    v_mfma_f32_32x32x16_bf16 v[56:71], a[16:19], a[220:223], v[56:71]
    buffer_load_dwordx4 a[120:123], v2, s[8:11], s60 offen offset:3072 sc1
    v_mfma_f32_32x32x16_bf16 v[72:87], a[20:23], a[216:219], v[72:87]
    ds_read_b64_tr_b16 a[8:9], v234 offset:49152
    ds_read_b64_tr_b16 a[10:11], v234 offset:49664
    v_mfma_f32_32x32x16_bf16 v[88:103], a[20:23], a[220:223], v[88:103]
    buffer_load_dwordx4 a[124:127], v2, s[8:11], s61 offen offset:3072 sc1
    s_waitcnt lgkmcnt(6)
    v_mfma_f32_32x32x16_bf16 v[104:119], a[24:27], a[216:219], v[104:119]
    ds_read_b64_tr_b16 a[12:13], v235 offset:49152
    ds_read_b64_tr_b16 a[14:15], v235 offset:49664
    v_mfma_f32_32x32x16_bf16 v[120:135], a[24:27], a[220:223], v[120:135]
    buffer_load_dwordx4 v31, s[36:39], s62 offen offset:3072 lds
    v_mfma_f32_32x32x16_bf16 v[136:151], a[28:31], a[216:219], v[136:151]
    ds_read_b64_tr_b16 a[16:17], v232 offset:51200
    ds_read_b64_tr_b16 a[18:19], v232 offset:51712
    s_add_u32 m0, s49, 0
    s_add_u32 s62, s56, 163840
    v_mfma_f32_32x32x16_bf16 v[152:167], a[28:31], a[220:223], v[152:167]
    buffer_load_dwordx4 v28, s[36:39], s62 offen offset:0 lds
    s_waitcnt lgkmcnt(6)
    v_mfma_f32_32x32x16_bf16 v[40:55], a[0:3], a[32:35], v[40:55]
    ds_read_b64_tr_b16 a[20:21], v233 offset:51200
    ds_read_b64_tr_b16 a[22:23], v233 offset:51712
    s_add_u32 s60, s52, 36864
    s_add_u32 s61, s52, 77824
    v_mfma_f32_32x32x16_bf16 v[56:71], a[0:3], a[36:39], v[56:71]
    buffer_load_dwordx4 a[128:131], v2, s[8:11], s60 offen offset:0 sc1
    v_mfma_f32_32x32x16_bf16 v[72:87], a[4:7], a[32:35], v[72:87]
    ds_read_b64_tr_b16 a[24:25], v234 offset:51200
    ds_read_b64_tr_b16 a[26:27], v234 offset:51712
    v_mfma_f32_32x32x16_bf16 v[88:103], a[4:7], a[36:39], v[88:103]
    buffer_load_dwordx4 a[132:135], v2, s[8:11], s61 offen offset:0 sc1
    s_waitcnt lgkmcnt(6)
    v_mfma_f32_32x32x16_bf16 v[104:119], a[8:11], a[32:35], v[104:119]
    ds_read_b64_tr_b16 a[28:29], v235 offset:51200
    ds_read_b64_tr_b16 a[30:31], v235 offset:51712
    v_mfma_f32_32x32x16_bf16 v[120:135], a[8:11], a[36:39], v[120:135]
    buffer_load_dwordx4 v29, s[36:39], s62 offen offset:1024 lds
    v_mfma_f32_32x32x16_bf16 v[136:151], a[12:15], a[32:35], v[136:151]
    ds_read_b64_tr_b16 a[0:1], v232 offset:53248
    ds_read_b64_tr_b16 a[2:3], v232 offset:53760
    v_mfma_f32_32x32x16_bf16 v[152:167], a[12:15], a[36:39], v[152:167]
    buffer_load_dwordx4 v30, s[36:39], s62 offen offset:2048 lds
    s_waitcnt lgkmcnt(6)
    v_mfma_f32_32x32x16_bf16 v[40:55], a[16:19], a[40:43], v[40:55]
    ds_read_b64_tr_b16 a[4:5], v233 offset:53248
    ds_read_b64_tr_b16 a[6:7], v233 offset:53760
    v_mfma_f32_32x32x16_bf16 v[56:71], a[16:19], a[44:47], v[56:71]
    buffer_load_dwordx4 a[136:139], v2, s[8:11], s60 offen offset:1024 sc1
    v_mfma_f32_32x32x16_bf16 v[72:87], a[20:23], a[40:43], v[72:87]
    ds_read_b64_tr_b16 a[8:9], v234 offset:53248
    ds_read_b64_tr_b16 a[10:11], v234 offset:53760
    v_mfma_f32_32x32x16_bf16 v[88:103], a[20:23], a[44:47], v[88:103]
    buffer_load_dwordx4 a[140:143], v2, s[8:11], s61 offen offset:1024 sc1
    s_waitcnt lgkmcnt(6)
    v_mfma_f32_32x32x16_bf16 v[104:119], a[24:27], a[40:43], v[104:119]
    ds_read_b64_tr_b16 a[12:13], v235 offset:53248
    ds_read_b64_tr_b16 a[14:15], v235 offset:53760
    v_mfma_f32_32x32x16_bf16 v[120:135], a[24:27], a[44:47], v[120:135]
    buffer_load_dwordx4 v31, s[36:39], s62 offen offset:3072 lds
    v_mfma_f32_32x32x16_bf16 v[136:151], a[28:31], a[40:43], v[136:151]
    ds_read_b64_tr_b16 a[16:17], v232 offset:55296
    ds_read_b64_tr_b16 a[18:19], v232 offset:55808
    s_add_u32 m0, s49, 16384
    s_add_u32 s62, s56, 327680
    v_mfma_f32_32x32x16_bf16 v[152:167], a[28:31], a[44:47], v[152:167]
    buffer_load_dwordx4 v28, s[36:39], s62 offen offset:0 lds
    s_waitcnt lgkmcnt(6)
    v_mfma_f32_32x32x16_bf16 v[40:55], a[0:3], a[48:51], v[40:55]
    s_barrier
    v_mfma_f32_32x32x16_bf16 v[56:71], a[0:3], a[52:55], v[56:71]
    ds_read_b64_tr_b16 a[20:21], v233 offset:55296
    ds_read_b64_tr_b16 a[22:23], v233 offset:55808
    buffer_load_dwordx4 a[144:147], v2, s[8:11], s60 offen offset:2048 sc1
    v_mfma_f32_32x32x16_bf16 v[72:87], a[4:7], a[48:51], v[72:87]
    ds_read_b64_tr_b16 a[24:25], v234 offset:55296
    ds_read_b64_tr_b16 a[26:27], v234 offset:55808
    buffer_load_dwordx4 a[148:151], v2, s[8:11], s61 offen offset:2048 sc1
    v_mfma_f32_32x32x16_bf16 v[88:103], a[4:7], a[52:55], v[88:103]
    buffer_load_dwordx4 v29, s[36:39], s62 offen offset:1024 lds
    s_waitcnt lgkmcnt(6)
    v_mfma_f32_32x32x16_bf16 v[104:119], a[8:11], a[48:51], v[104:119]
    ds_read_b64_tr_b16 a[28:29], v235 offset:55296
    ds_read_b64_tr_b16 a[30:31], v235 offset:55808
    v_mfma_f32_32x32x16_bf16 v[120:135], a[8:11], a[52:55], v[120:135]
    buffer_load_dwordx4 v30, s[36:39], s62 offen offset:2048 lds
    v_mfma_f32_32x32x16_bf16 v[136:151], a[12:15], a[48:51], v[136:151]
    ds_read_b64_tr_b16 a[0:1], v236 offset:0
    ds_read_b64_tr_b16 a[2:3], v236 offset:512
    v_mfma_f32_32x32x16_bf16 v[152:167], a[12:15], a[52:55], v[152:167]
    buffer_load_dword v251, v252, s[8:11], s50 offen
    s_waitcnt vmcnt(42) lgkmcnt(6)
    v_mfma_f32_32x32x16_bf16 v[40:55], a[16:19], a[56:59], v[40:55]
    ds_read_b64_tr_b16 a[4:5], v237 offset:0
    ds_read_b64_tr_b16 a[6:7], v237 offset:512
    v_mfma_f32_32x32x16_bf16 v[56:71], a[16:19], a[60:63], v[56:71]
    buffer_load_dwordx4 a[152:155], v2, s[8:11], s60 offen offset:3072 sc1
    v_mfma_f32_32x32x16_bf16 v[72:87], a[20:23], a[56:59], v[72:87]
    ds_read_b64_tr_b16 a[8:9], v238 offset:0
    ds_read_b64_tr_b16 a[10:11], v238 offset:512
    v_mfma_f32_32x32x16_bf16 v[88:103], a[20:23], a[60:63], v[88:103]
    buffer_load_dwordx4 a[156:159], v2, s[8:11], s61 offen offset:3072 sc1
    s_waitcnt lgkmcnt(6)
    v_mfma_f32_32x32x16_bf16 v[104:119], a[24:27], a[56:59], v[104:119]
    ds_read_b64_tr_b16 a[12:13], v239 offset:0
    ds_read_b64_tr_b16 a[14:15], v239 offset:512
    v_mfma_f32_32x32x16_bf16 v[120:135], a[24:27], a[60:63], v[120:135]
    buffer_load_dwordx4 v31, s[36:39], s62 offen offset:3072 lds
    v_mfma_f32_32x32x16_bf16 v[136:151], a[28:31], a[56:59], v[136:151]
    ds_read_b64_tr_b16 a[16:17], v236 offset:2048
    ds_read_b64_tr_b16 a[18:19], v236 offset:2560
    s_add_u32 m0, s49, 32768
    s_add_u32 s62, s56, 491520
    v_mfma_f32_32x32x16_bf16 v[152:167], a[28:31], a[60:63], v[152:167]
    buffer_load_dwordx4 v28, s[36:39], s62 offen offset:0 lds
    s_waitcnt vmcnt(43) lgkmcnt(6)
    v_mfma_f32_32x32x16_bf16 v[40:55], a[0:3], a[64:67], v[40:55]
    ds_read_b64_tr_b16 a[20:21], v237 offset:2048
    ds_read_b64_tr_b16 a[22:23], v237 offset:2560
    v_mfma_f32_32x32x16_bf16 v[56:71], a[0:3], a[68:71], v[56:71]
    buffer_load_dwordx4 v29, s[36:39], s62 offen offset:1024 lds
    v_mfma_f32_32x32x16_bf16 v[72:87], a[4:7], a[64:67], v[72:87]
    ds_read_b64_tr_b16 a[24:25], v238 offset:2048
    ds_read_b64_tr_b16 a[26:27], v238 offset:2560
    v_mfma_f32_32x32x16_bf16 v[88:103], a[4:7], a[68:71], v[88:103]
    buffer_load_dwordx4 v30, s[36:39], s62 offen offset:2048 lds
    s_waitcnt lgkmcnt(6)
    v_mfma_f32_32x32x16_bf16 v[104:119], a[8:11], a[64:67], v[104:119]
    ds_read_b64_tr_b16 a[28:29], v239 offset:2048
    ds_read_b64_tr_b16 a[30:31], v239 offset:2560
    v_mfma_f32_32x32x16_bf16 v[120:135], a[8:11], a[68:71], v[120:135]
    buffer_load_dword v251, v252, s[8:11], s51 offen
    v_mfma_f32_32x32x16_bf16 v[136:151], a[12:15], a[64:67], v[136:151]
    ds_read_b64_tr_b16 a[0:1], v236 offset:4096
    ds_read_b64_tr_b16 a[2:3], v236 offset:4608
    v_mfma_f32_32x32x16_bf16 v[152:167], a[12:15], a[68:71], v[152:167]
    s_waitcnt vmcnt(43) lgkmcnt(6)
    v_mfma_f32_32x32x16_bf16 v[40:55], a[16:19], a[72:75], v[40:55]
    ds_read_b64_tr_b16 a[4:5], v237 offset:4096
    ds_read_b64_tr_b16 a[6:7], v237 offset:4608
    v_mfma_f32_32x32x16_bf16 v[56:71], a[16:19], a[76:79], v[56:71]
    v_mfma_f32_32x32x16_bf16 v[72:87], a[20:23], a[72:75], v[72:87]
    ds_read_b64_tr_b16 a[8:9], v238 offset:4096
    ds_read_b64_tr_b16 a[10:11], v238 offset:4608
    v_mfma_f32_32x32x16_bf16 v[88:103], a[20:23], a[76:79], v[88:103]
    buffer_load_dwordx4 v31, s[36:39], s62 offen offset:3072 lds
    s_waitcnt lgkmcnt(6)
    v_mfma_f32_32x32x16_bf16 v[104:119], a[24:27], a[72:75], v[104:119]
    ds_read_b64_tr_b16 a[12:13], v239 offset:4096
    ds_read_b64_tr_b16 a[14:15], v239 offset:4608
    v_mfma_f32_32x32x16_bf16 v[120:135], a[24:27], a[76:79], v[120:135]
    v_mfma_f32_32x32x16_bf16 v[136:151], a[28:31], a[72:75], v[136:151]
    ds_read_b64_tr_b16 a[16:17], v236 offset:6144
    ds_read_b64_tr_b16 a[18:19], v236 offset:6656
    v_mfma_f32_32x32x16_bf16 v[152:167], a[28:31], a[76:79], v[152:167]
    s_waitcnt vmcnt(30) lgkmcnt(6)
    v_mfma_f32_32x32x16_bf16 v[40:55], a[0:3], a[80:83], v[40:55]
    s_barrier
    s_add_u32 m0, s49, 49152
    s_add_u32 s62, s98, 655360
    v_mfma_f32_32x32x16_bf16 v[56:71], a[0:3], a[84:87], v[56:71]
    ds_read_b64_tr_b16 a[20:21], v237 offset:6144
    ds_read_b64_tr_b16 a[22:23], v237 offset:6656
    buffer_load_dwordx4 v28, s[36:39], s62 offen offset:0 lds
    v_mfma_f32_32x32x16_bf16 v[72:87], a[4:7], a[80:83], v[72:87]
    ds_read_b64_tr_b16 a[24:25], v238 offset:6144
    ds_read_b64_tr_b16 a[26:27], v238 offset:6656
    v_mfma_f32_32x32x16_bf16 v[88:103], a[4:7], a[84:87], v[88:103]
    s_waitcnt lgkmcnt(6)
    v_mfma_f32_32x32x16_bf16 v[104:119], a[8:11], a[80:83], v[104:119]
    ds_read_b64_tr_b16 a[28:29], v239 offset:6144
    ds_read_b64_tr_b16 a[30:31], v239 offset:6656
    v_mfma_f32_32x32x16_bf16 v[120:135], a[8:11], a[84:87], v[120:135]
    buffer_load_dwordx4 v29, s[36:39], s62 offen offset:1024 lds
    v_mfma_f32_32x32x16_bf16 v[136:151], a[12:15], a[80:83], v[136:151]
    ds_read_b64_tr_b16 a[0:1], v236 offset:16384
    ds_read_b64_tr_b16 a[2:3], v236 offset:16896
    v_mfma_f32_32x32x16_bf16 v[152:167], a[12:15], a[84:87], v[152:167]
    s_waitcnt lgkmcnt(6)
    v_mfma_f32_32x32x16_bf16 v[40:55], a[16:19], a[88:91], v[40:55]
    ds_read_b64_tr_b16 a[4:5], v236 offset:18432
    ds_read_b64_tr_b16 a[6:7], v236 offset:18944
    v_mfma_f32_32x32x16_bf16 v[56:71], a[16:19], a[92:95], v[56:71]
    buffer_load_dwordx4 v30, s[36:39], s62 offen offset:2048 lds
    v_mfma_f32_32x32x16_bf16 v[72:87], a[20:23], a[88:91], v[72:87]
    ds_read_b64_tr_b16 a[8:9], v236 offset:20480
    ds_read_b64_tr_b16 a[10:11], v236 offset:20992
    v_mfma_f32_32x32x16_bf16 v[88:103], a[20:23], a[92:95], v[88:103]
    s_waitcnt lgkmcnt(6)
    v_mfma_f32_32x32x16_bf16 v[104:119], a[24:27], a[88:91], v[104:119]
    ds_read_b64_tr_b16 a[12:13], v236 offset:22528
    ds_read_b64_tr_b16 a[14:15], v236 offset:23040
    v_mfma_f32_32x32x16_bf16 v[120:135], a[24:27], a[92:95], v[120:135]
    buffer_load_dwordx4 v31, s[36:39], s62 offen offset:3072 lds
    v_mfma_f32_32x32x16_bf16 v[136:151], a[28:31], a[88:91], v[136:151]
    ds_read_b64_tr_b16 a[16:17], v236 offset:32768
    ds_read_b64_tr_b16 a[18:19], v236 offset:33280
    v_mfma_f32_32x32x16_bf16 v[152:167], a[28:31], a[92:95], v[152:167]
    s_waitcnt lgkmcnt(6)
    v_mfma_f32_32x32x16_bf16 v[40:55], a[0:3], a[96:99], v[40:55]
    ds_read_b64_tr_b16 a[20:21], v236 offset:34816
    ds_read_b64_tr_b16 a[22:23], v236 offset:35328
    v_mfma_f32_32x32x16_bf16 v[56:71], a[0:3], a[100:103], v[56:71]
    v_mfma_f32_32x32x16_bf16 v[40:55], a[4:7], a[104:107], v[40:55]
    ds_read_b64_tr_b16 a[24:25], v236 offset:36864
    ds_read_b64_tr_b16 a[26:27], v236 offset:37376
    v_mfma_f32_32x32x16_bf16 v[56:71], a[4:7], a[108:111], v[56:71]
    s_waitcnt vmcnt(27) lgkmcnt(6)
    v_mfma_f32_32x32x16_bf16 v[40:55], a[8:11], a[112:115], v[40:55]
    ds_read_b64_tr_b16 a[28:29], v236 offset:38912
    ds_read_b64_tr_b16 a[30:31], v236 offset:39424
    v_mfma_f32_32x32x16_bf16 v[56:71], a[8:11], a[116:119], v[56:71]
    v_mfma_f32_32x32x16_bf16 v[40:55], a[12:15], a[120:123], v[40:55]
    ds_read_b64_tr_b16 a[0:1], v237 offset:16384
    ds_read_b64_tr_b16 a[2:3], v237 offset:16896
    v_mfma_f32_32x32x16_bf16 v[56:71], a[12:15], a[124:127], v[56:71]
    s_waitcnt vmcnt(19) lgkmcnt(6)
    v_mfma_f32_32x32x16_bf16 v[40:55], a[16:19], a[128:131], v[40:55]
    ds_read_b64_tr_b16 a[4:5], v237 offset:18432
    ds_read_b64_tr_b16 a[6:7], v237 offset:18944
    v_mfma_f32_32x32x16_bf16 v[56:71], a[16:19], a[132:135], v[56:71]
    v_mfma_f32_32x32x16_bf16 v[40:55], a[20:23], a[136:139], v[40:55]
    ds_read_b64_tr_b16 a[8:9], v237 offset:20480
    ds_read_b64_tr_b16 a[10:11], v237 offset:20992
    v_mfma_f32_32x32x16_bf16 v[56:71], a[20:23], a[140:143], v[56:71]
    s_waitcnt vmcnt(10) lgkmcnt(6)
    v_mfma_f32_32x32x16_bf16 v[40:55], a[24:27], a[144:147], v[40:55]
    ds_read_b64_tr_b16 a[12:13], v237 offset:22528
    ds_read_b64_tr_b16 a[14:15], v237 offset:23040
    v_mfma_f32_32x32x16_bf16 v[56:71], a[24:27], a[148:151], v[56:71]
    v_mfma_f32_32x32x16_bf16 v[40:55], a[28:31], a[152:155], v[40:55]
    ds_read_b64_tr_b16 a[16:17], v237 offset:32768
    ds_read_b64_tr_b16 a[18:19], v237 offset:33280
    v_mfma_f32_32x32x16_bf16 v[56:71], a[28:31], a[156:159], v[56:71]
    s_waitcnt lgkmcnt(6)
    v_mfma_f32_32x32x16_bf16 v[72:87], a[0:3], a[96:99], v[72:87]
    ds_read_b64_tr_b16 a[20:21], v237 offset:34816
    ds_read_b64_tr_b16 a[22:23], v237 offset:35328
    v_mfma_f32_32x32x16_bf16 v[88:103], a[0:3], a[100:103], v[88:103]
    v_mfma_f32_32x32x16_bf16 v[72:87], a[4:7], a[104:107], v[72:87]
    ds_read_b64_tr_b16 a[24:25], v237 offset:36864
    ds_read_b64_tr_b16 a[26:27], v237 offset:37376
    v_mfma_f32_32x32x16_bf16 v[88:103], a[4:7], a[108:111], v[88:103]
    v_mul_f32 v40, v40, v48
    v_mul_f32 v41, v41, v49
    v_mul_f32 v42, v42, v50
    v_mul_f32 v43, v43, v51
    s_waitcnt lgkmcnt(6)
    v_mfma_f32_32x32x16_bf16 v[72:87], a[8:11], a[112:115], v[72:87]
    ds_read_b64_tr_b16 a[28:29], v237 offset:38912
    ds_read_b64_tr_b16 a[30:31], v237 offset:39424
    v_mul_f32 v44, v44, v52
    v_mul_f32 v45, v45, v53
    v_mul_f32 v46, v46, v54
    v_mul_f32 v47, v47, v55
    v_mfma_f32_32x32x16_bf16 v[88:103], a[8:11], a[116:119], v[88:103]
    v_cvt_pk_bf16_f32 v168, v40, v41
    v_cvt_pk_bf16_f32 v169, v42, v43
    v_cvt_pk_bf16_f32 v170, v44, v45
    v_cvt_pk_bf16_f32 v171, v46, v47
    v_mfma_f32_32x32x16_bf16 v[72:87], a[12:15], a[120:123], v[72:87]
    ds_read_b64_tr_b16 a[0:1], v238 offset:16384
    ds_read_b64_tr_b16 a[2:3], v238 offset:16896
    buffer_store_dwordx4 v[168:171], v2, s[8:11], s50 offen offset:0
    v_mul_f32 v56, v56, v64
    v_mul_f32 v57, v57, v65
    v_mul_f32 v58, v58, v66
    v_mul_f32 v59, v59, v67
    v_mfma_f32_32x32x16_bf16 v[88:103], a[12:15], a[124:127], v[88:103]
    v_mul_f32 v60, v60, v68
    v_mul_f32 v61, v61, v69
    v_mul_f32 v62, v62, v70
    v_mul_f32 v63, v63, v71
    s_waitcnt lgkmcnt(6)
    v_mfma_f32_32x32x16_bf16 v[72:87], a[16:19], a[128:131], v[72:87]
    ds_read_b64_tr_b16 a[4:5], v238 offset:18432
    ds_read_b64_tr_b16 a[6:7], v238 offset:18944
    v_cvt_pk_bf16_f32 v172, v56, v57
    v_cvt_pk_bf16_f32 v173, v58, v59
    v_cvt_pk_bf16_f32 v174, v60, v61
    v_cvt_pk_bf16_f32 v175, v62, v63
    v_mfma_f32_32x32x16_bf16 v[88:103], a[16:19], a[132:135], v[88:103]
    buffer_store_dwordx4 v[172:175], v2, s[8:11], s51 offen offset:0
    v_mfma_f32_32x32x16_bf16 v[72:87], a[20:23], a[136:139], v[72:87]
    ds_read_b64_tr_b16 a[8:9], v238 offset:20480
    ds_read_b64_tr_b16 a[10:11], v238 offset:20992
    v_mfma_f32_32x32x16_bf16 v[88:103], a[20:23], a[140:143], v[88:103]
    s_waitcnt lgkmcnt(6)
    v_mfma_f32_32x32x16_bf16 v[72:87], a[24:27], a[144:147], v[72:87]
    ds_read_b64_tr_b16 a[12:13], v238 offset:22528
    ds_read_b64_tr_b16 a[14:15], v238 offset:23040
    v_mfma_f32_32x32x16_bf16 v[88:103], a[24:27], a[148:151], v[88:103]
    v_mfma_f32_32x32x16_bf16 v[72:87], a[28:31], a[152:155], v[72:87]
    ds_read_b64_tr_b16 a[16:17], v238 offset:32768
    ds_read_b64_tr_b16 a[18:19], v238 offset:33280
    v_mfma_f32_32x32x16_bf16 v[88:103], a[28:31], a[156:159], v[88:103]
    s_waitcnt lgkmcnt(6)
    v_mfma_f32_32x32x16_bf16 v[104:119], a[0:3], a[96:99], v[104:119]
    ds_read_b64_tr_b16 a[20:21], v238 offset:34816
    ds_read_b64_tr_b16 a[22:23], v238 offset:35328
    v_mfma_f32_32x32x16_bf16 v[120:135], a[0:3], a[100:103], v[120:135]
    v_mfma_f32_32x32x16_bf16 v[104:119], a[4:7], a[104:107], v[104:119]
    ds_read_b64_tr_b16 a[24:25], v238 offset:36864
    ds_read_b64_tr_b16 a[26:27], v238 offset:37376
    v_mfma_f32_32x32x16_bf16 v[120:135], a[4:7], a[108:111], v[120:135]
    v_mul_f32 v72, v72, v80
    v_mul_f32 v73, v73, v81
    v_mul_f32 v74, v74, v82
    v_mul_f32 v75, v75, v83
    s_waitcnt lgkmcnt(6)
    v_mfma_f32_32x32x16_bf16 v[104:119], a[8:11], a[112:115], v[104:119]
    ds_read_b64_tr_b16 a[28:29], v238 offset:38912
    ds_read_b64_tr_b16 a[30:31], v238 offset:39424
    v_mul_f32 v76, v76, v84
    v_mul_f32 v77, v77, v85
    v_mul_f32 v78, v78, v86
    v_mul_f32 v79, v79, v87
    v_mfma_f32_32x32x16_bf16 v[120:135], a[8:11], a[116:119], v[120:135]
    v_cvt_pk_bf16_f32 v176, v72, v73
    v_cvt_pk_bf16_f32 v177, v74, v75
    v_cvt_pk_bf16_f32 v178, v76, v77
    v_cvt_pk_bf16_f32 v179, v78, v79
    v_mfma_f32_32x32x16_bf16 v[104:119], a[12:15], a[120:123], v[104:119]
    ds_read_b64_tr_b16 a[0:1], v239 offset:16384
    ds_read_b64_tr_b16 a[2:3], v239 offset:16896
    buffer_store_dwordx4 v[176:179], v2, s[8:11], s50 offen offset:1024
    v_mul_f32 v88, v88, v96
    v_mul_f32 v89, v89, v97
    v_mul_f32 v90, v90, v98
    v_mul_f32 v91, v91, v99
    v_mfma_f32_32x32x16_bf16 v[120:135], a[12:15], a[124:127], v[120:135]
    v_mul_f32 v92, v92, v100
    v_mul_f32 v93, v93, v101
    v_mul_f32 v94, v94, v102
    v_mul_f32 v95, v95, v103
    s_waitcnt lgkmcnt(6)
    v_mfma_f32_32x32x16_bf16 v[104:119], a[16:19], a[128:131], v[104:119]
    ds_read_b64_tr_b16 a[4:5], v239 offset:18432
    ds_read_b64_tr_b16 a[6:7], v239 offset:18944
    v_cvt_pk_bf16_f32 v180, v88, v89
    v_cvt_pk_bf16_f32 v181, v90, v91
    v_cvt_pk_bf16_f32 v182, v92, v93
    v_cvt_pk_bf16_f32 v183, v94, v95
    v_mfma_f32_32x32x16_bf16 v[120:135], a[16:19], a[132:135], v[120:135]
    buffer_store_dwordx4 v[180:183], v2, s[8:11], s51 offen offset:1024
    v_mfma_f32_32x32x16_bf16 v[104:119], a[20:23], a[136:139], v[104:119]
    ds_read_b64_tr_b16 a[8:9], v239 offset:20480
    ds_read_b64_tr_b16 a[10:11], v239 offset:20992
    v_mfma_f32_32x32x16_bf16 v[120:135], a[20:23], a[140:143], v[120:135]
    s_waitcnt lgkmcnt(6)
    v_mfma_f32_32x32x16_bf16 v[104:119], a[24:27], a[144:147], v[104:119]
    ds_read_b64_tr_b16 a[12:13], v239 offset:22528
    ds_read_b64_tr_b16 a[14:15], v239 offset:23040
    v_mfma_f32_32x32x16_bf16 v[120:135], a[24:27], a[148:151], v[120:135]
    v_mfma_f32_32x32x16_bf16 v[104:119], a[28:31], a[152:155], v[104:119]
    ds_read_b64_tr_b16 a[16:17], v239 offset:32768
    ds_read_b64_tr_b16 a[18:19], v239 offset:33280
    v_mfma_f32_32x32x16_bf16 v[120:135], a[28:31], a[156:159], v[120:135]
    s_waitcnt lgkmcnt(6)
    v_mfma_f32_32x32x16_bf16 v[136:151], a[0:3], a[96:99], v[136:151]
    ds_read_b64_tr_b16 a[20:21], v239 offset:34816
    ds_read_b64_tr_b16 a[22:23], v239 offset:35328
    v_mfma_f32_32x32x16_bf16 v[152:167], a[0:3], a[100:103], v[152:167]
    v_mfma_f32_32x32x16_bf16 v[136:151], a[4:7], a[104:107], v[136:151]
    ds_read_b64_tr_b16 a[24:25], v239 offset:36864
    ds_read_b64_tr_b16 a[26:27], v239 offset:37376
    v_mfma_f32_32x32x16_bf16 v[152:167], a[4:7], a[108:111], v[152:167]
    v_mul_f32 v104, v104, v112
    v_mul_f32 v105, v105, v113
    v_mul_f32 v106, v106, v114
    v_mul_f32 v107, v107, v115
    s_waitcnt lgkmcnt(6)
    v_mfma_f32_32x32x16_bf16 v[136:151], a[8:11], a[112:115], v[136:151]
    ds_read_b64_tr_b16 a[28:29], v239 offset:38912
    ds_read_b64_tr_b16 a[30:31], v239 offset:39424
    v_mul_f32 v108, v108, v116
    v_mul_f32 v109, v109, v117
    v_mul_f32 v110, v110, v118
    v_mul_f32 v111, v111, v119
    v_mfma_f32_32x32x16_bf16 v[152:167], a[8:11], a[116:119], v[152:167]
    v_cvt_pk_bf16_f32 v168, v104, v105
    v_cvt_pk_bf16_f32 v169, v106, v107
    v_cvt_pk_bf16_f32 v170, v108, v109
    v_cvt_pk_bf16_f32 v171, v110, v111
    v_mfma_f32_32x32x16_bf16 v[136:151], a[12:15], a[120:123], v[136:151]
    buffer_store_dwordx4 v[168:171], v2, s[8:11], s50 offen offset:2048
    v_mul_f32 v120, v120, v128
    v_mul_f32 v121, v121, v129
    v_mul_f32 v122, v122, v130
    v_mul_f32 v123, v123, v131
    v_mov_b32 v36, s97
    v_mfma_f32_32x32x16_bf16 v[152:167], a[12:15], a[124:127], v[152:167]
    v_mul_f32 v124, v124, v132
    v_mul_f32 v125, v125, v133
    v_mul_f32 v126, v126, v134
    v_mul_f32 v127, v127, v135
    s_waitcnt vmcnt(1) lgkmcnt(4)
    v_mfma_f32_32x32x16_bf16 v[136:151], a[16:19], a[128:131], v[136:151]
    buffer_store_dword v36, off, s[8:11], s90
    v_cvt_pk_bf16_f32 v172, v120, v121
    v_cvt_pk_bf16_f32 v173, v122, v123
    v_cvt_pk_bf16_f32 v174, v124, v125
    v_cvt_pk_bf16_f32 v175, v126, v127
    v_mfma_f32_32x32x16_bf16 v[152:167], a[16:19], a[132:135], v[152:167]
    buffer_store_dwordx4 v[172:175], v2, s[8:11], s51 offen offset:2048
    v_mfma_f32_32x32x16_bf16 v[136:151], a[20:23], a[136:139], v[136:151]
    v_mfma_f32_32x32x16_bf16 v[152:167], a[20:23], a[140:143], v[152:167]
    s_waitcnt lgkmcnt(0)
    v_mfma_f32_32x32x16_bf16 v[136:151], a[24:27], a[144:147], v[136:151]
    v_mfma_f32_32x32x16_bf16 v[152:167], a[24:27], a[148:151], v[152:167]
    v_mfma_f32_32x32x16_bf16 v[136:151], a[28:31], a[152:155], v[136:151]
    v_mfma_f32_32x32x16_bf16 v[152:167], a[28:31], a[156:159], v[152:167]
    s_nop 10
    v_pk_mul_f32 v[136:137], v[136:137], v[144:145]
    v_pk_mul_f32 v[138:139], v[138:139], v[146:147]
    v_pk_mul_f32 v[140:141], v[140:141], v[148:149]
    v_pk_mul_f32 v[142:143], v[142:143], v[150:151]
    v_cvt_pk_bf16_f32 v176, v136, v137
    v_cvt_pk_bf16_f32 v177, v138, v139
    v_cvt_pk_bf16_f32 v178, v140, v141
    v_cvt_pk_bf16_f32 v179, v142, v143
    buffer_store_dwordx4 v[176:179], v2, s[8:11], s50 offen offset:3072
    v_pk_mul_f32 v[152:153], v[152:153], v[160:161]
    v_pk_mul_f32 v[154:155], v[154:155], v[162:163]
    v_pk_mul_f32 v[156:157], v[156:157], v[164:165]
    v_pk_mul_f32 v[158:159], v[158:159], v[166:167]
    v_cvt_pk_bf16_f32 v180, v152, v153
    v_cvt_pk_bf16_f32 v181, v154, v155
    v_cvt_pk_bf16_f32 v182, v156, v157
    v_cvt_pk_bf16_f32 v183, v158, v159
    buffer_store_dwordx4 v[180:183], v2, s[8:11], s51 offen offset:3072
    s_cmp_eq_u32 s6, 0
    s_cbranch_scc1 LC_done
    s_waitcnt vmcnt(0)
    buffer_wbl2 sc1
    s_waitcnt vmcnt(0)
    buffer_store_dword v36, off, s[8:11], s99 offset:1536 sc0 sc1
    buffer_store_dword v36, off, s[8:11], s99 offset:3072 sc0 sc1
    s_branch LC_done
LC_skip:
    s_add_u32 m0, s49, 114688
    s_add_u32 s62, s56, 0
    buffer_load_dwordx4 v28, s[36:39], s62 offen offset:0 lds
    buffer_load_dwordx4 v29, s[36:39], s62 offen offset:1024 lds
    buffer_load_dwordx4 v30, s[36:39], s62 offen offset:2048 lds
    buffer_load_dwordx4 v31, s[36:39], s62 offen offset:3072 lds
    s_add_u32 m0, s49, 0
    s_add_u32 s62, s56, 163840
    buffer_load_dwordx4 v28, s[36:39], s62 offen offset:0 lds
    buffer_load_dwordx4 v29, s[36:39], s62 offen offset:1024 lds
    buffer_load_dwordx4 v30, s[36:39], s62 offen offset:2048 lds
    buffer_load_dwordx4 v31, s[36:39], s62 offen offset:3072 lds
    s_add_u32 m0, s49, 16384
    s_add_u32 s62, s56, 327680
    buffer_load_dwordx4 v28, s[36:39], s62 offen offset:0 lds
    buffer_load_dwordx4 v29, s[36:39], s62 offen offset:1024 lds
    buffer_load_dwordx4 v30, s[36:39], s62 offen offset:2048 lds
    buffer_load_dwordx4 v31, s[36:39], s62 offen offset:3072 lds
    s_add_u32 m0, s49, 32768
    s_add_u32 s62, s56, 491520
    buffer_load_dwordx4 v28, s[36:39], s62 offen offset:0 lds
    buffer_load_dwordx4 v29, s[36:39], s62 offen offset:1024 lds
    buffer_load_dwordx4 v30, s[36:39], s62 offen offset:2048 lds
    buffer_load_dwordx4 v31, s[36:39], s62 offen offset:3072 lds
    s_add_u32 m0, s49, 49152
    s_add_u32 s62, s98, 655360
    buffer_load_dwordx4 v28, s[36:39], s62 offen offset:0 lds
    buffer_load_dwordx4 v29, s[36:39], s62 offen offset:1024 lds
    buffer_load_dwordx4 v30, s[36:39], s62 offen offset:2048 lds
    buffer_load_dwordx4 v31, s[36:39], s62 offen offset:3072 lds
LC_done:
    s_waitcnt vmcnt(0)
    s_barrier
    s_cmp_ge_u32 s5, 30
    s_cbranch_scc1 LD_skip
    ds_read_b64_tr_b16 a[0:1], v20 offset:49152
    ds_read_b64_tr_b16 a[2:3], v21 offset:49152
    ds_read_b64_tr_b16 a[4:5], v22 offset:49152
    ds_read_b64_tr_b16 a[6:7], v23 offset:49152
    ds_read_b64_tr_b16 a[8:9], v24 offset:49152
    ds_read_b64_tr_b16 a[10:11], v25 offset:49152
    ds_read_b64_tr_b16 a[12:13], v26 offset:49152
    ds_read_b64_tr_b16 a[14:15], v27 offset:49152
    ds_read_b64_tr_b16 a[16:17], v20 offset:53248
    ds_read_b64_tr_b16 a[18:19], v21 offset:53248
    ds_read_b64_tr_b16 a[20:21], v22 offset:53248
    ds_read_b64_tr_b16 a[22:23], v23 offset:53248
    ds_read_b64_tr_b16 a[24:25], v24 offset:53248
    ds_read_b64_tr_b16 a[26:27], v25 offset:53248
    ds_read_b64_tr_b16 a[28:29], v26 offset:53248
    ds_read_b64_tr_b16 a[30:31], v27 offset:53248
    s_mul_i32 s64, s55, 9
    v_min_u32 v4, 8, v1
    v_add_u32 v4, s64, v4
    s_lshl_b32 s64, s53, 1
    s_lshr_b32 s65, s3, 1
    s_add_u32 s64, s64, s65
    s_lshl_b32 s64, s64, 2
    v_lshl_add_u32 v38, v4, 4, s64
    s_lshl_b32 s66, s53, 2
    s_add_u32 s66, s66, s3
    s_mul_i32 s52, s66, 110592
    s_mul_i32 s67, s4, 4194304
    s_add_u32 s52, s52, s67
    s_mul_i32 s67, s55, 36864
    s_add_u32 s52, s52, s67
    s_add_u32 s52, s52, 6619136
    s_lshl_b32 s67, s55, 3
    s_add_u32 s66, s66, s67
    s_mul_i32 s66, s66, 40960
    s_lshl_b32 s67, s54, 11
    s_add_u32 s66, s66, s67
    s_mul_i32 s67, s4, 4194304
    s_add_u32 s66, s66, s67
    s_add_u32 s51, s66, 5636096
    v_bfe_u32 v4, v1, 3, 2
    v_mul_u32_u24 v4, 10240, v4
    v_and_b32 v5, 7, v1
    v_lshl_add_u32 v4, v5, 4, v4
    v_lshrrev_b32 v5, 5, v1
    v_lshl_add_u32 v120, v5, 7, v4
    v_lshrrev_b32 v4, 4, v1
    v_mul_u32_u24 v4, 10240, v4
    v_and_b32 v5, 15, v1
    v_lshl_add_u32 v252, v5, 7, v4
    s_mov_b32 s64, 0
LD_p:
    buffer_load_dword v39, v38, s[8:11], s48 offen offset:1536 sc1
    s_add_u32 s64, s64, 1
    s_waitcnt vmcnt(0)
    v_cmp_ne_u32 vcc, s97, v39
    s_nop 0
    s_cmp_eq_u64 vcc, 0
    s_cbranch_scc1 LD_pd
    s_cmp_lt_u32 s64, 200000
    s_cbranch_scc1 LD_p
LD_pd:
    s_cmp_eq_u32 s6, 0
    s_cbranch_scc1 LD_pf
    buffer_inv sc1
    s_waitcnt vmcnt(0)
LD_pf:
    s_cmp_eq_u32 s6, 0
    s_cbranch_scc1 LD2_pf
    s_mov_b32 s64, 0
LD2_p:
    buffer_load_dword v39, v38, s[8:11], s48 offen offset:3072 sc1
    s_add_u32 s64, s64, 1
    s_waitcnt vmcnt(0)
    v_cmp_ne_u32 vcc, s97, v39
    s_nop 0
    s_cmp_eq_u64 vcc, 0
    s_cbranch_scc1 LD2_pd
    s_cmp_lt_u32 s64, 200000
    s_cbranch_scc1 LD2_p
LD2_pd:
    s_cmp_eq_u32 s6, 0
    s_cbranch_scc1 LD2_pf
    buffer_inv sc1
    s_waitcnt vmcnt(0)
LD2_pf:
    s_add_u32 s60, s52, 0
    buffer_load_dwordx4 a[64:67], v2, s[8:11], s60 offen offset:0 sc1
    buffer_load_dwordx4 a[68:71], v2, s[8:11], s60 offen offset:1024 sc1
    s_add_u32 s60, s52, 4096
    buffer_load_dwordx4 a[72:75], v2, s[8:11], s60 offen offset:0 sc1
    buffer_load_dwordx4 a[76:79], v2, s[8:11], s60 offen offset:1024 sc1
    s_add_u32 s60, s52, 8192
    buffer_load_dwordx4 a[80:83], v2, s[8:11], s60 offen offset:0 sc1
    buffer_load_dwordx4 a[84:87], v2, s[8:11], s60 offen offset:1024 sc1
    s_add_u32 s60, s52, 12288
    buffer_load_dwordx4 a[88:91], v2, s[8:11], s60 offen offset:0 sc1
    buffer_load_dwordx4 a[92:95], v2, s[8:11], s60 offen offset:1024 sc1
    s_waitcnt vmcnt(7) lgkmcnt(14)
    v_mfma_f32_32x32x16_bf16 v[40:55], a[0:3], a[64:67], 0
    ds_read_b64_tr_b16 a[32:33], v20 offset:57344
    ds_read_b64_tr_b16 a[34:35], v21 offset:57344
    v_mov_b32 v36, s97
    s_add_u32 s60, s52, 16384
    s_waitcnt lgkmcnt(14)
    v_mfma_f32_32x32x16_bf16 v[56:71], a[4:7], a[64:67], 0
    ds_read_b64_tr_b16 a[36:37], v22 offset:57344
    ds_read_b64_tr_b16 a[38:39], v23 offset:57344
    buffer_load_dwordx4 a[96:99], v2, s[8:11], s60 offen offset:0 sc1
    s_waitcnt lgkmcnt(14)
    v_mfma_f32_32x32x16_bf16 v[72:87], a[8:11], a[64:67], 0
    ds_read_b64_tr_b16 a[40:41], v24 offset:57344
    ds_read_b64_tr_b16 a[42:43], v25 offset:57344
    buffer_store_dword v36, off, s[8:11], s99 offset:3072
    s_waitcnt lgkmcnt(14)
    v_mfma_f32_32x32x16_bf16 v[88:103], a[12:15], a[64:67], 0
    ds_read_b64_tr_b16 a[44:45], v26 offset:57344
    ds_read_b64_tr_b16 a[46:47], v27 offset:57344
    buffer_load_dwordx4 a[100:103], v2, s[8:11], s60 offen offset:1024 sc1
    s_waitcnt vmcnt(9) lgkmcnt(8)
    v_mfma_f32_32x32x16_bf16 v[40:55], a[16:19], a[68:71], v[40:55]
    ds_read_b64_tr_b16 a[48:49], v20 offset:61440
    ds_read_b64_tr_b16 a[50:51], v21 offset:61440
    s_add_u32 s60, s52, 20480
    v_mfma_f32_32x32x16_bf16 v[56:71], a[20:23], a[68:71], v[56:71]
    ds_read_b64_tr_b16 a[52:53], v22 offset:61440
    ds_read_b64_tr_b16 a[54:55], v23 offset:61440
    buffer_load_dwordx4 a[104:107], v2, s[8:11], s60 offen offset:0 sc1
    v_mfma_f32_32x32x16_bf16 v[72:87], a[24:27], a[68:71], v[72:87]
    ds_read_b64_tr_b16 a[56:57], v24 offset:61440
    ds_read_b64_tr_b16 a[58:59], v25 offset:61440
    v_mfma_f32_32x32x16_bf16 v[88:103], a[28:31], a[68:71], v[88:103]
    ds_read_b64_tr_b16 a[60:61], v26 offset:61440
    ds_read_b64_tr_b16 a[62:63], v27 offset:61440
    buffer_load_dwordx4 a[108:111], v2, s[8:11], s60 offen offset:1024 sc1
    s_waitcnt vmcnt(10) lgkmcnt(8)
    v_mfma_f32_32x32x16_bf16 v[40:55], a[32:35], a[72:75], v[40:55]
    ds_read_b64_tr_b16 a[0:1], v12 offset:0
    ds_read_b64_tr_b16 a[2:3], v13 offset:0
    s_add_u32 s60, s52, 24576
    v_mfma_f32_32x32x16_bf16 v[56:71], a[36:39], a[72:75], v[56:71]
    ds_read_b64_tr_b16 a[4:5], v14 offset:0
    ds_read_b64_tr_b16 a[6:7], v15 offset:0
    buffer_load_dwordx4 a[112:115], v2, s[8:11], s60 offen offset:0 sc1
    v_mfma_f32_32x32x16_bf16 v[72:87], a[40:43], a[72:75], v[72:87]
    ds_read_b64_tr_b16 a[8:9], v16 offset:0
    ds_read_b64_tr_b16 a[10:11], v17 offset:0
    v_mfma_f32_32x32x16_bf16 v[88:103], a[44:47], a[72:75], v[88:103]
    ds_read_b64_tr_b16 a[12:13], v18 offset:0
    ds_read_b64_tr_b16 a[14:15], v19 offset:0
    buffer_load_dwordx4 a[116:119], v2, s[8:11], s60 offen offset:1024 sc1
    s_waitcnt vmcnt(11) lgkmcnt(8)
    v_mfma_f32_32x32x16_bf16 v[40:55], a[48:51], a[76:79], v[40:55]
    ds_read_b64_tr_b16 a[16:17], v12 offset:4096
    ds_read_b64_tr_b16 a[18:19], v13 offset:4096
    s_add_u32 s60, s52, 28672
    v_mfma_f32_32x32x16_bf16 v[56:71], a[52:55], a[76:79], v[56:71]
    ds_read_b64_tr_b16 a[20:21], v14 offset:4096
    ds_read_b64_tr_b16 a[22:23], v15 offset:4096
    buffer_load_dwordx4 a[120:123], v2, s[8:11], s60 offen offset:0 sc1
    v_mfma_f32_32x32x16_bf16 v[72:87], a[56:59], a[76:79], v[72:87]
    ds_read_b64_tr_b16 a[24:25], v16 offset:4096
    ds_read_b64_tr_b16 a[26:27], v17 offset:4096
    buffer_load_dwordx4 a[124:127], v2, s[8:11], s60 offen offset:1024 sc1
    s_add_u32 m0, s49, 65536
    s_add_u32 s62, s56, 122880
    v_mfma_f32_32x32x16_bf16 v[88:103], a[60:63], a[76:79], v[88:103]
    ds_read_b64_tr_b16 a[28:29], v18 offset:4096
    ds_read_b64_tr_b16 a[30:31], v19 offset:4096
    buffer_load_dwordx4 v28, s[36:39], s62 offen offset:0 lds
    s_waitcnt vmcnt(13) lgkmcnt(8)
    v_mfma_f32_32x32x16_bf16 v[40:55], a[0:3], a[80:83], v[40:55]
    ds_read_b64_tr_b16 a[32:33], v12 offset:8192
    ds_read_b64_tr_b16 a[34:35], v13 offset:8192
    s_add_u32 s60, s52, 32768
    v_mfma_f32_32x32x16_bf16 v[56:71], a[4:7], a[80:83], v[56:71]
    ds_read_b64_tr_b16 a[36:37], v14 offset:8192
    ds_read_b64_tr_b16 a[38:39], v15 offset:8192
    buffer_load_dwordx4 a[128:131], v2, s[8:11], s60 offen offset:0 sc1
    v_mfma_f32_32x32x16_bf16 v[72:87], a[8:11], a[80:83], v[72:87]
    ds_read_b64_tr_b16 a[40:41], v16 offset:8192
    ds_read_b64_tr_b16 a[42:43], v17 offset:8192
    buffer_load_dwordx4 a[132:135], v2, s[8:11], s60 offen offset:1024 sc1
    v_mfma_f32_32x32x16_bf16 v[88:103], a[12:15], a[80:83], v[88:103]
    ds_read_b64_tr_b16 a[44:45], v18 offset:8192
    ds_read_b64_tr_b16 a[46:47], v19 offset:8192
    buffer_load_dwordx4 v29, s[36:39], s62 offen offset:1024 lds
    s_waitcnt vmcnt(15) lgkmcnt(8)
    v_mfma_f32_32x32x16_bf16 v[40:55], a[16:19], a[84:87], v[40:55]
    ds_read_b64_tr_b16 a[48:49], v12 offset:12288
    ds_read_b64_tr_b16 a[50:51], v13 offset:12288
    v_mfma_f32_32x32x16_bf16 v[56:71], a[20:23], a[84:87], v[56:71]
    ds_read_b64_tr_b16 a[52:53], v14 offset:12288
    ds_read_b64_tr_b16 a[54:55], v15 offset:12288
    buffer_load_dwordx4 v30, s[36:39], s62 offen offset:2048 lds
    v_mfma_f32_32x32x16_bf16 v[72:87], a[24:27], a[84:87], v[72:87]
    ds_read_b64_tr_b16 a[56:57], v16 offset:12288
    ds_read_b64_tr_b16 a[58:59], v17 offset:12288
    v_mfma_f32_32x32x16_bf16 v[88:103], a[28:31], a[84:87], v[88:103]
    ds_read_b64_tr_b16 a[60:61], v18 offset:12288
    ds_read_b64_tr_b16 a[62:63], v19 offset:12288
    buffer_load_dwordx4 v31, s[36:39], s62 offen offset:3072 lds
    s_waitcnt vmcnt(16) lgkmcnt(8)
    v_mfma_f32_32x32x16_bf16 v[40:55], a[32:35], a[88:91], v[40:55]
    ds_read_b64_tr_b16 a[0:1], v12 offset:16384
    ds_read_b64_tr_b16 a[2:3], v13 offset:16384
    s_add_u32 m0, s49, 81920
    s_add_u32 s62, s56, 286720
    v_mfma_f32_32x32x16_bf16 v[56:71], a[36:39], a[88:91], v[56:71]
    ds_read_b64_tr_b16 a[4:5], v14 offset:16384
    ds_read_b64_tr_b16 a[6:7], v15 offset:16384
    buffer_load_dwordx4 v28, s[36:39], s62 offen offset:0 lds
    v_mfma_f32_32x32x16_bf16 v[72:87], a[40:43], a[88:91], v[72:87]
    ds_read_b64_tr_b16 a[8:9], v16 offset:16384
    ds_read_b64_tr_b16 a[10:11], v17 offset:16384
    buffer_load_dword v39, v38, s[8:11], s48 offen offset:3072 sc1
    v_mfma_f32_32x32x16_bf16 v[88:103], a[44:47], a[88:91], v[88:103]
    ds_read_b64_tr_b16 a[12:13], v18 offset:16384
    ds_read_b64_tr_b16 a[14:15], v19 offset:16384
    buffer_load_dwordx4 v29, s[36:39], s62 offen offset:1024 lds
    s_waitcnt vmcnt(18) lgkmcnt(8)
    v_mfma_f32_32x32x16_bf16 v[40:55], a[48:51], a[92:95], v[40:55]
    ds_read_b64_tr_b16 a[16:17], v12 offset:20480
    ds_read_b64_tr_b16 a[18:19], v13 offset:20480
    v_mfma_f32_32x32x16_bf16 v[56:71], a[52:55], a[92:95], v[56:71]
    ds_read_b64_tr_b16 a[20:21], v14 offset:20480
    ds_read_b64_tr_b16 a[22:23], v15 offset:20480
    buffer_load_dwordx4 v30, s[36:39], s62 offen offset:2048 lds
    v_mfma_f32_32x32x16_bf16 v[72:87], a[56:59], a[92:95], v[72:87]
    ds_read_b64_tr_b16 a[24:25], v16 offset:20480
    ds_read_b64_tr_b16 a[26:27], v17 offset:20480
    v_mfma_f32_32x32x16_bf16 v[88:103], a[60:63], a[92:95], v[88:103]
    ds_read_b64_tr_b16 a[28:29], v18 offset:20480
    ds_read_b64_tr_b16 a[30:31], v19 offset:20480
    buffer_load_dwordx4 v31, s[36:39], s62 offen offset:3072 lds
    s_waitcnt vmcnt(19) lgkmcnt(8)
    v_mfma_f32_32x32x16_bf16 v[40:55], a[0:3], a[96:99], v[40:55]
    s_barrier
    ds_read_b64_tr_b16 a[32:33], v12 offset:24576
    ds_read_b64_tr_b16 a[34:35], v13 offset:24576
    s_add_u32 m0, s49, 98304
    s_add_u32 s62, s56, 450560
    v_mfma_f32_32x32x16_bf16 v[56:71], a[4:7], a[96:99], v[56:71]
    ds_read_b64_tr_b16 a[36:37], v14 offset:24576
    ds_read_b64_tr_b16 a[38:39], v15 offset:24576
    buffer_load_dwordx4 v28, s[36:39], s62 offen offset:0 lds
    v_mfma_f32_32x32x16_bf16 v[72:87], a[8:11], a[96:99], v[72:87]
    ds_read_b64_tr_b16 a[40:41], v16 offset:24576
    ds_read_b64_tr_b16 a[42:43], v17 offset:24576
    v_mfma_f32_32x32x16_bf16 v[88:103], a[12:15], a[96:99], v[88:103]
    ds_read_b64_tr_b16 a[44:45], v18 offset:24576
    ds_read_b64_tr_b16 a[46:47], v19 offset:24576
    buffer_load_dwordx4 v29, s[36:39], s62 offen offset:1024 lds
    s_waitcnt vmcnt(19) lgkmcnt(8)
    v_mfma_f32_32x32x16_bf16 v[40:55], a[16:19], a[100:103], v[40:55]
    ds_read_b64_tr_b16 a[48:49], v12 offset:28672
    ds_read_b64_tr_b16 a[50:51], v13 offset:28672
    v_mfma_f32_32x32x16_bf16 v[56:71], a[20:23], a[100:103], v[56:71]
    ds_read_b64_tr_b16 a[52:53], v14 offset:28672
    ds_read_b64_tr_b16 a[54:55], v15 offset:28672
    buffer_load_dwordx4 v30, s[36:39], s62 offen offset:2048 lds
    v_mfma_f32_32x32x16_bf16 v[72:87], a[24:27], a[100:103], v[72:87]
    ds_read_b64_tr_b16 a[56:57], v16 offset:28672
    ds_read_b64_tr_b16 a[58:59], v17 offset:28672
    s_waitcnt vmcnt(6)
    v_cmp_ne_u32 vcc, s97, v39
    v_mfma_f32_32x32x16_bf16 v[88:103], a[28:31], a[100:103], v[88:103]
    ds_read_b64_tr_b16 a[60:61], v18 offset:28672
    ds_read_b64_tr_b16 a[62:63], v19 offset:28672
    buffer_load_dwordx4 v31, s[36:39], s62 offen offset:3072 lds
    s_waitcnt lgkmcnt(8)
    s_cmp_eq_u64 vcc, 0
    s_cbranch_scc0 LD3_spin
LD3_back:
    v_mfma_f32_32x32x16_bf16 v[40:55], a[32:35], a[104:107], v[40:55]
    ds_read_b64_tr_b16 a[0:1], v12 offset:32768
    ds_read_b64_tr_b16 a[2:3], v13 offset:32768
    s_add_u32 s60, s52, 0
    v_mfma_f32_32x32x16_bf16 v[56:71], a[36:39], a[104:107], v[56:71]
    ds_read_b64_tr_b16 a[4:5], v14 offset:32768
    ds_read_b64_tr_b16 a[6:7], v15 offset:32768
    buffer_load_dwordx4 a[136:139], v2, s[8:11], s60 offen offset:2048 sc1
    v_mfma_f32_32x32x16_bf16 v[72:87], a[40:43], a[104:107], v[72:87]
    ds_read_b64_tr_b16 a[8:9], v16 offset:32768
    ds_read_b64_tr_b16 a[10:11], v17 offset:32768
    buffer_load_dwordx4 a[140:143], v2, s[8:11], s60 offen offset:3072 sc1
    s_add_u32 m0, s49, 114688
    s_add_u32 s62, s56, 614400
    v_mfma_f32_32x32x16_bf16 v[88:103], a[44:47], a[104:107], v[88:103]
    ds_read_b64_tr_b16 a[12:13], v18 offset:32768
    ds_read_b64_tr_b16 a[14:15], v19 offset:32768
    buffer_load_dwordx4 v28, s[36:39], s62 offen offset:0 lds
    s_waitcnt lgkmcnt(8)
    v_mfma_f32_32x32x16_bf16 v[40:55], a[48:51], a[108:111], v[40:55]
    ds_read_b64_tr_b16 a[16:17], v12 offset:36864
    ds_read_b64_tr_b16 a[18:19], v13 offset:36864
    s_add_u32 s60, s52, 4096
    v_mfma_f32_32x32x16_bf16 v[56:71], a[52:55], a[108:111], v[56:71]
    ds_read_b64_tr_b16 a[20:21], v14 offset:36864
    ds_read_b64_tr_b16 a[22:23], v15 offset:36864
    buffer_load_dwordx4 a[144:147], v2, s[8:11], s60 offen offset:2048 sc1
    v_mfma_f32_32x32x16_bf16 v[72:87], a[56:59], a[108:111], v[72:87]
    ds_read_b64_tr_b16 a[24:25], v16 offset:36864
    ds_read_b64_tr_b16 a[26:27], v17 offset:36864
    buffer_load_dwordx4 a[148:151], v2, s[8:11], s60 offen offset:3072 sc1
    v_mfma_f32_32x32x16_bf16 v[88:103], a[60:63], a[108:111], v[88:103]
    ds_read_b64_tr_b16 a[28:29], v18 offset:36864
    ds_read_b64_tr_b16 a[30:31], v19 offset:36864
    buffer_load_dwordx4 v29, s[36:39], s62 offen offset:1024 lds
    s_waitcnt lgkmcnt(8)
    v_mfma_f32_32x32x16_bf16 v[40:55], a[0:3], a[112:115], v[40:55]
    ds_read_b64_tr_b16 a[32:33], v12 offset:40960
    ds_read_b64_tr_b16 a[34:35], v13 offset:40960
    s_add_u32 s60, s52, 8192
    v_mfma_f32_32x32x16_bf16 v[56:71], a[4:7], a[112:115], v[56:71]
    ds_read_b64_tr_b16 a[36:37], v14 offset:40960
    ds_read_b64_tr_b16 a[38:39], v15 offset:40960
    buffer_load_dwordx4 a[152:155], v2, s[8:11], s60 offen offset:2048 sc1
    v_mfma_f32_32x32x16_bf16 v[72:87], a[8:11], a[112:115], v[72:87]
    ds_read_b64_tr_b16 a[40:41], v16 offset:40960
    ds_read_b64_tr_b16 a[42:43], v17 offset:40960
    buffer_load_dwordx4 a[156:159], v2, s[8:11], s60 offen offset:3072 sc1
    v_mfma_f32_32x32x16_bf16 v[88:103], a[12:15], a[112:115], v[88:103]
    ds_read_b64_tr_b16 a[44:45], v18 offset:40960
    ds_read_b64_tr_b16 a[46:47], v19 offset:40960
    buffer_load_dwordx4 v30, s[36:39], s62 offen offset:2048 lds
    s_waitcnt lgkmcnt(8)
    v_mfma_f32_32x32x16_bf16 v[40:55], a[16:19], a[116:119], v[40:55]
    ds_read_b64_tr_b16 a[48:49], v12 offset:45056
    ds_read_b64_tr_b16 a[50:51], v13 offset:45056
    s_add_u32 s60, s52, 12288
    v_mfma_f32_32x32x16_bf16 v[56:71], a[20:23], a[116:119], v[56:71]
    ds_read_b64_tr_b16 a[52:53], v14 offset:45056
    ds_read_b64_tr_b16 a[54:55], v15 offset:45056
    buffer_load_dwordx4 a[160:163], v2, s[8:11], s60 offen offset:2048 sc1
    v_mfma_f32_32x32x16_bf16 v[72:87], a[24:27], a[116:119], v[72:87]
    ds_read_b64_tr_b16 a[56:57], v16 offset:45056
    ds_read_b64_tr_b16 a[58:59], v17 offset:45056
    buffer_load_dwordx4 a[164:167], v2, s[8:11], s60 offen offset:3072 sc1
    v_mfma_f32_32x32x16_bf16 v[88:103], a[28:31], a[116:119], v[88:103]
    ds_read_b64_tr_b16 a[60:61], v18 offset:45056
    ds_read_b64_tr_b16 a[62:63], v19 offset:45056
    buffer_load_dwordx4 v31, s[36:39], s62 offen offset:3072 lds
    s_waitcnt lgkmcnt(8)
    v_mfma_f32_32x32x16_bf16 v[40:55], a[32:35], a[120:123], v[40:55]
    ds_read_b64_tr_b16 a[0:1], v12 offset:49152
    ds_read_b64_tr_b16 a[2:3], v13 offset:49152
    s_add_u32 s60, s52, 16384
    v_mfma_f32_32x32x16_bf16 v[56:71], a[36:39], a[120:123], v[56:71]
    ds_read_b64_tr_b16 a[4:5], v14 offset:49152
    ds_read_b64_tr_b16 a[6:7], v15 offset:49152
    buffer_load_dwordx4 a[168:171], v2, s[8:11], s60 offen offset:2048 sc1
    v_mfma_f32_32x32x16_bf16 v[72:87], a[40:43], a[120:123], v[72:87]
    ds_read_b64_tr_b16 a[8:9], v16 offset:49152
    ds_read_b64_tr_b16 a[10:11], v17 offset:49152
    v_mfma_f32_32x32x16_bf16 v[88:103], a[44:47], a[120:123], v[88:103]
    ds_read_b64_tr_b16 a[12:13], v18 offset:49152
    ds_read_b64_tr_b16 a[14:15], v19 offset:49152
    buffer_load_dwordx4 a[172:175], v2, s[8:11], s60 offen offset:3072 sc1
    s_waitcnt lgkmcnt(8)
    v_mfma_f32_32x32x16_bf16 v[40:55], a[48:51], a[124:127], v[40:55]
    ds_read_b64_tr_b16 a[16:17], v12 offset:53248
    ds_read_b64_tr_b16 a[18:19], v13 offset:53248
    s_add_u32 s60, s52, 20480
    v_mfma_f32_32x32x16_bf16 v[56:71], a[52:55], a[124:127], v[56:71]
    ds_read_b64_tr_b16 a[20:21], v14 offset:53248
    ds_read_b64_tr_b16 a[22:23], v15 offset:53248
    buffer_load_dwordx4 a[176:179], v2, s[8:11], s60 offen offset:2048 sc1
    v_mfma_f32_32x32x16_bf16 v[72:87], a[56:59], a[124:127], v[72:87]
    ds_read_b64_tr_b16 a[24:25], v16 offset:53248
    ds_read_b64_tr_b16 a[26:27], v17 offset:53248
    v_mfma_f32_32x32x16_bf16 v[88:103], a[60:63], a[124:127], v[88:103]
    ds_read_b64_tr_b16 a[28:29], v18 offset:53248
    ds_read_b64_tr_b16 a[30:31], v19 offset:53248
    buffer_load_dwordx4 a[180:183], v2, s[8:11], s60 offen offset:3072 sc1
    s_waitcnt lgkmcnt(8)
    v_mfma_f32_32x32x16_bf16 v[40:55], a[0:3], a[128:131], v[40:55]
    ds_read_b64_tr_b16 a[32:33], v12 offset:57344
    ds_read_b64_tr_b16 a[34:35], v13 offset:57344
    s_add_u32 s60, s52, 24576
    v_mfma_f32_32x32x16_bf16 v[56:71], a[4:7], a[128:131], v[56:71]
    ds_read_b64_tr_b16 a[36:37], v14 offset:57344
    ds_read_b64_tr_b16 a[38:39], v15 offset:57344
    buffer_load_dwordx4 a[184:187], v2, s[8:11], s60 offen offset:2048 sc1
    v_mfma_f32_32x32x16_bf16 v[72:87], a[8:11], a[128:131], v[72:87]
    ds_read_b64_tr_b16 a[40:41], v16 offset:57344
    ds_read_b64_tr_b16 a[42:43], v17 offset:57344
    v_mfma_f32_32x32x16_bf16 v[88:103], a[12:15], a[128:131], v[88:103]
    ds_read_b64_tr_b16 a[44:45], v18 offset:57344
    ds_read_b64_tr_b16 a[46:47], v19 offset:57344
    buffer_load_dwordx4 a[188:191], v2, s[8:11], s60 offen offset:3072 sc1
    s_waitcnt lgkmcnt(8)
    v_mfma_f32_32x32x16_bf16 v[40:55], a[16:19], a[132:135], v[40:55]
    ds_read_b64_tr_b16 a[48:49], v12 offset:61440
    ds_read_b64_tr_b16 a[50:51], v13 offset:61440
    s_add_u32 s60, s52, 28672
    v_mfma_f32_32x32x16_bf16 v[56:71], a[20:23], a[132:135], v[56:71]
    ds_read_b64_tr_b16 a[52:53], v14 offset:61440
    ds_read_b64_tr_b16 a[54:55], v15 offset:61440
    buffer_load_dwordx4 a[192:195], v2, s[8:11], s60 offen offset:2048 sc1
    v_mfma_f32_32x32x16_bf16 v[72:87], a[24:27], a[132:135], v[72:87]
    ds_read_b64_tr_b16 a[56:57], v16 offset:61440
    ds_read_b64_tr_b16 a[58:59], v17 offset:61440
    v_mfma_f32_32x32x16_bf16 v[88:103], a[28:31], a[132:135], v[88:103]
    ds_read_b64_tr_b16 a[60:61], v18 offset:61440
    ds_read_b64_tr_b16 a[62:63], v19 offset:61440
    buffer_load_dwordx4 a[196:199], v2, s[8:11], s60 offen offset:3072 sc1
    s_waitcnt vmcnt(19) lgkmcnt(8)
    v_mfma_f32_32x32x16_bf16 v[40:55], a[32:35], a[136:139], v[40:55]
    s_barrier
    ds_read_b64_tr_b16 a[0:1], v20 offset:0
    ds_read_b64_tr_b16 a[2:3], v21 offset:0
    s_add_u32 s60, s52, 32768
    v_mfma_f32_32x32x16_bf16 v[56:71], a[36:39], a[136:139], v[56:71]
    ds_read_b64_tr_b16 a[4:5], v22 offset:0
    ds_read_b64_tr_b16 a[6:7], v23 offset:0
    buffer_load_dwordx4 a[200:203], v2, s[8:11], s60 offen offset:2048 sc1
    v_mfma_f32_32x32x16_bf16 v[72:87], a[40:43], a[136:139], v[72:87]
    ds_read_b64_tr_b16 a[8:9], v24 offset:0
    ds_read_b64_tr_b16 a[10:11], v25 offset:0
    v_mfma_f32_32x32x16_bf16 v[88:103], a[44:47], a[136:139], v[88:103]
    ds_read_b64_tr_b16 a[12:13], v26 offset:0
    ds_read_b64_tr_b16 a[14:15], v27 offset:0
    buffer_load_dwordx4 a[204:207], v2, s[8:11], s60 offen offset:3072 sc1
    s_waitcnt vmcnt(20) lgkmcnt(8)
    v_mfma_f32_32x32x16_bf16 v[40:55], a[48:51], a[140:143], v[40:55]
    ds_read_b64_tr_b16 a[16:17], v20 offset:4096
    ds_read_b64_tr_b16 a[18:19], v21 offset:4096
    v_mfma_f32_32x32x16_bf16 v[56:71], a[52:55], a[140:143], v[56:71]
    ds_read_b64_tr_b16 a[20:21], v22 offset:4096
    ds_read_b64_tr_b16 a[22:23], v23 offset:4096
    v_mfma_f32_32x32x16_bf16 v[72:87], a[56:59], a[140:143], v[72:87]
    ds_read_b64_tr_b16 a[24:25], v24 offset:4096
    ds_read_b64_tr_b16 a[26:27], v25 offset:4096
    v_mfma_f32_32x32x16_bf16 v[88:103], a[60:63], a[140:143], v[88:103]
    ds_read_b64_tr_b16 a[28:29], v26 offset:4096
    ds_read_b64_tr_b16 a[30:31], v27 offset:4096
    s_waitcnt vmcnt(18) lgkmcnt(8)
    v_mfma_f32_32x32x16_bf16 v[40:55], a[0:3], a[144:147], v[40:55]
    ds_read_b64_tr_b16 a[32:33], v20 offset:8192
    ds_read_b64_tr_b16 a[34:35], v21 offset:8192
    v_mfma_f32_32x32x16_bf16 v[56:71], a[4:7], a[144:147], v[56:71]
    ds_read_b64_tr_b16 a[36:37], v22 offset:8192
    ds_read_b64_tr_b16 a[38:39], v23 offset:8192
    buffer_load_dword v251, v252, s[8:11], s51 offen
    v_mfma_f32_32x32x16_bf16 v[72:87], a[8:11], a[144:147], v[72:87]
    ds_read_b64_tr_b16 a[40:41], v24 offset:8192
    ds_read_b64_tr_b16 a[42:43], v25 offset:8192
    v_mfma_f32_32x32x16_bf16 v[88:103], a[12:15], a[144:147], v[88:103]
    ds_read_b64_tr_b16 a[44:45], v26 offset:8192
    ds_read_b64_tr_b16 a[46:47], v27 offset:8192
    s_waitcnt vmcnt(18) lgkmcnt(8)
    v_mfma_f32_32x32x16_bf16 v[40:55], a[16:19], a[148:151], v[40:55]
    ds_read_b64_tr_b16 a[48:49], v20 offset:12288
    ds_read_b64_tr_b16 a[50:51], v21 offset:12288
    v_mfma_f32_32x32x16_bf16 v[56:71], a[20:23], a[148:151], v[56:71]
    ds_read_b64_tr_b16 a[52:53], v22 offset:12288
    ds_read_b64_tr_b16 a[54:55], v23 offset:12288
    v_mfma_f32_32x32x16_bf16 v[72:87], a[24:27], a[148:151], v[72:87]
    ds_read_b64_tr_b16 a[56:57], v24 offset:12288
    ds_read_b64_tr_b16 a[58:59], v25 offset:12288
    v_mfma_f32_32x32x16_bf16 v[88:103], a[28:31], a[148:151], v[88:103]
    ds_read_b64_tr_b16 a[60:61], v26 offset:12288
    ds_read_b64_tr_b16 a[62:63], v27 offset:12288
    s_waitcnt vmcnt(16) lgkmcnt(8)
    v_mfma_f32_32x32x16_bf16 v[40:55], a[32:35], a[152:155], v[40:55]
    ds_read_b64_tr_b16 a[0:1], v20 offset:16384
    ds_read_b64_tr_b16 a[2:3], v21 offset:16384
    v_mfma_f32_32x32x16_bf16 v[56:71], a[36:39], a[152:155], v[56:71]
    ds_read_b64_tr_b16 a[4:5], v22 offset:16384
    ds_read_b64_tr_b16 a[6:7], v23 offset:16384
    v_mfma_f32_32x32x16_bf16 v[72:87], a[40:43], a[152:155], v[72:87]
    ds_read_b64_tr_b16 a[8:9], v24 offset:16384
    ds_read_b64_tr_b16 a[10:11], v25 offset:16384
    v_mfma_f32_32x32x16_bf16 v[88:103], a[44:47], a[152:155], v[88:103]
    ds_read_b64_tr_b16 a[12:13], v26 offset:16384
    ds_read_b64_tr_b16 a[14:15], v27 offset:16384
    s_waitcnt vmcnt(15) lgkmcnt(8)
    v_mfma_f32_32x32x16_bf16 v[40:55], a[48:51], a[156:159], v[40:55]
    ds_read_b64_tr_b16 a[16:17], v20 offset:20480
    ds_read_b64_tr_b16 a[18:19], v21 offset:20480
    v_mfma_f32_32x32x16_bf16 v[56:71], a[52:55], a[156:159], v[56:71]
    ds_read_b64_tr_b16 a[20:21], v22 offset:20480
    ds_read_b64_tr_b16 a[22:23], v23 offset:20480
    v_mfma_f32_32x32x16_bf16 v[72:87], a[56:59], a[156:159], v[72:87]
    ds_read_b64_tr_b16 a[24:25], v24 offset:20480
    ds_read_b64_tr_b16 a[26:27], v25 offset:20480
    v_mfma_f32_32x32x16_bf16 v[88:103], a[60:63], a[156:159], v[88:103]
    ds_read_b64_tr_b16 a[28:29], v26 offset:20480
    ds_read_b64_tr_b16 a[30:31], v27 offset:20480
    s_waitcnt vmcnt(13) lgkmcnt(8)
    v_mfma_f32_32x32x16_bf16 v[40:55], a[0:3], a[160:163], v[40:55]
    ds_read_b64_tr_b16 a[32:33], v20 offset:24576
    ds_read_b64_tr_b16 a[34:35], v21 offset:24576
    v_mfma_f32_32x32x16_bf16 v[56:71], a[4:7], a[160:163], v[56:71]
    ds_read_b64_tr_b16 a[36:37], v22 offset:24576
    ds_read_b64_tr_b16 a[38:39], v23 offset:24576
    v_mfma_f32_32x32x16_bf16 v[72:87], a[8:11], a[160:163], v[72:87]
    ds_read_b64_tr_b16 a[40:41], v24 offset:24576
    ds_read_b64_tr_b16 a[42:43], v25 offset:24576
    v_mfma_f32_32x32x16_bf16 v[88:103], a[12:15], a[160:163], v[88:103]
    ds_read_b64_tr_b16 a[44:45], v26 offset:24576
    ds_read_b64_tr_b16 a[46:47], v27 offset:24576
    s_waitcnt vmcnt(12) lgkmcnt(8)
    v_mfma_f32_32x32x16_bf16 v[40:55], a[16:19], a[164:167], v[40:55]
    ds_read_b64_tr_b16 a[48:49], v20 offset:28672
    ds_read_b64_tr_b16 a[50:51], v21 offset:28672
    v_mfma_f32_32x32x16_bf16 v[56:71], a[20:23], a[164:167], v[56:71]
    ds_read_b64_tr_b16 a[52:53], v22 offset:28672
    ds_read_b64_tr_b16 a[54:55], v23 offset:28672
    v_mfma_f32_32x32x16_bf16 v[72:87], a[24:27], a[164:167], v[72:87]
    ds_read_b64_tr_b16 a[56:57], v24 offset:28672
    ds_read_b64_tr_b16 a[58:59], v25 offset:28672
    v_mfma_f32_32x32x16_bf16 v[88:103], a[28:31], a[164:167], v[88:103]
    ds_read_b64_tr_b16 a[60:61], v26 offset:28672
    ds_read_b64_tr_b16 a[62:63], v27 offset:28672
    s_waitcnt vmcnt(10) lgkmcnt(8)
    v_mfma_f32_32x32x16_bf16 v[40:55], a[32:35], a[168:171], v[40:55]
    s_barrier
    ds_read_b64_tr_b16 a[0:1], v20 offset:32768
    ds_read_b64_tr_b16 a[2:3], v21 offset:32768
    v_mfma_f32_32x32x16_bf16 v[56:71], a[36:39], a[168:171], v[56:71]
    ds_read_b64_tr_b16 a[4:5], v20 offset:36864
    ds_read_b64_tr_b16 a[6:7], v21 offset:36864
    v_mfma_f32_32x32x16_bf16 v[72:87], a[40:43], a[168:171], v[72:87]
    ds_read_b64_tr_b16 a[8:9], v20 offset:40960
    ds_read_b64_tr_b16 a[10:11], v21 offset:40960
    v_mfma_f32_32x32x16_bf16 v[88:103], a[44:47], a[168:171], v[88:103]
    ds_read_b64_tr_b16 a[12:13], v20 offset:45056
    ds_read_b64_tr_b16 a[14:15], v21 offset:45056
    s_waitcnt vmcnt(9) lgkmcnt(8)
    v_mfma_f32_32x32x16_bf16 v[40:55], a[48:51], a[172:175], v[40:55]
    ds_read_b64_tr_b16 a[16:17], v20 offset:49152
    ds_read_b64_tr_b16 a[18:19], v21 offset:49152
    v_mfma_f32_32x32x16_bf16 v[56:71], a[52:55], a[172:175], v[56:71]
    ds_read_b64_tr_b16 a[20:21], v20 offset:53248
    ds_read_b64_tr_b16 a[22:23], v21 offset:53248
    v_mfma_f32_32x32x16_bf16 v[72:87], a[56:59], a[172:175], v[72:87]
    ds_read_b64_tr_b16 a[24:25], v20 offset:57344
    ds_read_b64_tr_b16 a[26:27], v21 offset:57344
    v_mfma_f32_32x32x16_bf16 v[88:103], a[60:63], a[172:175], v[88:103]
    ds_read_b64_tr_b16 a[28:29], v20 offset:61440
    ds_read_b64_tr_b16 a[30:31], v21 offset:61440
    s_waitcnt vmcnt(5) lgkmcnt(8)
    v_mfma_f32_32x32x16_bf16 v[40:55], a[0:3], a[176:179], v[40:55]
    ds_read_b64_tr_b16 a[32:33], v22 offset:32768
    ds_read_b64_tr_b16 a[34:35], v23 offset:32768
    v_mfma_f32_32x32x16_bf16 v[40:55], a[4:7], a[180:183], v[40:55]
    ds_read_b64_tr_b16 a[36:37], v22 offset:36864
    ds_read_b64_tr_b16 a[38:39], v23 offset:36864
    v_mfma_f32_32x32x16_bf16 v[40:55], a[8:11], a[184:187], v[40:55]
    ds_read_b64_tr_b16 a[40:41], v22 offset:40960
    ds_read_b64_tr_b16 a[42:43], v23 offset:40960
    v_mfma_f32_32x32x16_bf16 v[40:55], a[12:15], a[188:191], v[40:55]
    ds_read_b64_tr_b16 a[44:45], v22 offset:45056
    ds_read_b64_tr_b16 a[46:47], v23 offset:45056
    s_waitcnt vmcnt(1) lgkmcnt(8)
    v_mfma_f32_32x32x16_bf16 v[40:55], a[16:19], a[192:195], v[40:55]
    ds_read_b64_tr_b16 a[48:49], v22 offset:49152
    ds_read_b64_tr_b16 a[50:51], v23 offset:49152
    v_mfma_f32_32x32x16_bf16 v[40:55], a[20:23], a[196:199], v[40:55]
    ds_read_b64_tr_b16 a[52:53], v22 offset:53248
    ds_read_b64_tr_b16 a[54:55], v23 offset:53248
    v_mfma_f32_32x32x16_bf16 v[40:55], a[24:27], a[200:203], v[40:55]
    ds_read_b64_tr_b16 a[56:57], v22 offset:57344
    ds_read_b64_tr_b16 a[58:59], v23 offset:57344
    v_mfma_f32_32x32x16_bf16 v[40:55], a[28:31], a[204:207], v[40:55]
    ds_read_b64_tr_b16 a[60:61], v22 offset:61440
    ds_read_b64_tr_b16 a[62:63], v23 offset:61440
    s_waitcnt lgkmcnt(8)
    v_mfma_f32_32x32x16_bf16 v[56:71], a[32:35], a[176:179], v[56:71]
    ds_read_b64_tr_b16 a[0:1], v24 offset:32768
    ds_read_b64_tr_b16 a[2:3], v25 offset:32768
    v_mfma_f32_32x32x16_bf16 v[56:71], a[36:39], a[180:183], v[56:71]
    ds_read_b64_tr_b16 a[4:5], v24 offset:36864
    ds_read_b64_tr_b16 a[6:7], v25 offset:36864
    v_mfma_f32_32x32x16_bf16 v[56:71], a[40:43], a[184:187], v[56:71]
    ds_read_b64_tr_b16 a[8:9], v24 offset:40960
    ds_read_b64_tr_b16 a[10:11], v25 offset:40960
    v_cvt_pk_bf16_f32 v104, v40, v41
    v_cvt_pk_bf16_f32 v105, v42, v43
    v_cvt_pk_bf16_f32 v106, v44, v45
    v_cvt_pk_bf16_f32 v107, v46, v47
    v_mfma_f32_32x32x16_bf16 v[56:71], a[44:47], a[188:191], v[56:71]
    ds_read_b64_tr_b16 a[12:13], v24 offset:45056
    ds_read_b64_tr_b16 a[14:15], v25 offset:45056
    buffer_store_dwordx4 v[104:107], v120, s[8:11], s51 offen offset:0
    v_cvt_pk_bf16_f32 v108, v48, v49
    v_cvt_pk_bf16_f32 v109, v50, v51
    v_cvt_pk_bf16_f32 v110, v52, v53
    v_cvt_pk_bf16_f32 v111, v54, v55
    s_waitcnt lgkmcnt(8)
    v_mfma_f32_32x32x16_bf16 v[56:71], a[48:51], a[192:195], v[56:71]
    ds_read_b64_tr_b16 a[16:17], v24 offset:49152
    ds_read_b64_tr_b16 a[18:19], v25 offset:49152
    buffer_store_dwordx4 v[108:111], v120, s[8:11], s51 offen offset:256
    v_mfma_f32_32x32x16_bf16 v[56:71], a[52:55], a[196:199], v[56:71]
    ds_read_b64_tr_b16 a[20:21], v24 offset:53248
    ds_read_b64_tr_b16 a[22:23], v25 offset:53248
    v_mfma_f32_32x32x16_bf16 v[56:71], a[56:59], a[200:203], v[56:71]
    ds_read_b64_tr_b16 a[24:25], v24 offset:57344
    ds_read_b64_tr_b16 a[26:27], v25 offset:57344
    v_mfma_f32_32x32x16_bf16 v[56:71], a[60:63], a[204:207], v[56:71]
    ds_read_b64_tr_b16 a[28:29], v24 offset:61440
    ds_read_b64_tr_b16 a[30:31], v25 offset:61440
    s_waitcnt lgkmcnt(8)
    v_mfma_f32_32x32x16_bf16 v[72:87], a[0:3], a[176:179], v[72:87]
    ds_read_b64_tr_b16 a[32:33], v26 offset:32768
    ds_read_b64_tr_b16 a[34:35], v27 offset:32768
    v_mfma_f32_32x32x16_bf16 v[72:87], a[4:7], a[180:183], v[72:87]
    ds_read_b64_tr_b16 a[36:37], v26 offset:36864
    ds_read_b64_tr_b16 a[38:39], v27 offset:36864
    v_mfma_f32_32x32x16_bf16 v[72:87], a[8:11], a[184:187], v[72:87]
    ds_read_b64_tr_b16 a[40:41], v26 offset:40960
    ds_read_b64_tr_b16 a[42:43], v27 offset:40960
    v_cvt_pk_bf16_f32 v112, v56, v57
    v_cvt_pk_bf16_f32 v113, v58, v59
    v_cvt_pk_bf16_f32 v114, v60, v61
    v_cvt_pk_bf16_f32 v115, v62, v63
    v_mfma_f32_32x32x16_bf16 v[72:87], a[12:15], a[188:191], v[72:87]
    ds_read_b64_tr_b16 a[44:45], v26 offset:45056
    ds_read_b64_tr_b16 a[46:47], v27 offset:45056
    buffer_store_dwordx4 v[112:115], v120, s[8:11], s51 offen offset:512
    v_cvt_pk_bf16_f32 v116, v64, v65
    v_cvt_pk_bf16_f32 v117, v66, v67
    v_cvt_pk_bf16_f32 v118, v68, v69
    v_cvt_pk_bf16_f32 v119, v70, v71
    s_waitcnt lgkmcnt(8)
    v_mfma_f32_32x32x16_bf16 v[72:87], a[16:19], a[192:195], v[72:87]
    ds_read_b64_tr_b16 a[48:49], v26 offset:49152
    ds_read_b64_tr_b16 a[50:51], v27 offset:49152
    buffer_store_dwordx4 v[116:119], v120, s[8:11], s51 offen offset:768
    v_mfma_f32_32x32x16_bf16 v[72:87], a[20:23], a[196:199], v[72:87]
    ds_read_b64_tr_b16 a[52:53], v26 offset:53248
    ds_read_b64_tr_b16 a[54:55], v27 offset:53248
    v_mfma_f32_32x32x16_bf16 v[72:87], a[24:27], a[200:203], v[72:87]
    ds_read_b64_tr_b16 a[56:57], v26 offset:57344
    ds_read_b64_tr_b16 a[58:59], v27 offset:57344
    v_mfma_f32_32x32x16_bf16 v[72:87], a[28:31], a[204:207], v[72:87]
    ds_read_b64_tr_b16 a[60:61], v26 offset:61440
    ds_read_b64_tr_b16 a[62:63], v27 offset:61440
    s_waitcnt lgkmcnt(8)
    v_mfma_f32_32x32x16_bf16 v[88:103], a[32:35], a[176:179], v[88:103]
    v_mfma_f32_32x32x16_bf16 v[88:103], a[36:39], a[180:183], v[88:103]
    v_mfma_f32_32x32x16_bf16 v[88:103], a[40:43], a[184:187], v[88:103]
    s_nop 5
    v_cvt_pk_bf16_f32 v104, v72, v73
    v_cvt_pk_bf16_f32 v105, v74, v75
    v_cvt_pk_bf16_f32 v106, v76, v77
    v_cvt_pk_bf16_f32 v107, v78, v79
    v_mfma_f32_32x32x16_bf16 v[88:103], a[44:47], a[188:191], v[88:103]
    buffer_store_dwordx4 v[104:107], v120, s[8:11], s51 offen offset:1024
    v_cvt_pk_bf16_f32 v108, v80, v81
    v_cvt_pk_bf16_f32 v109, v82, v83
    v_cvt_pk_bf16_f32 v110, v84, v85
    v_cvt_pk_bf16_f32 v111, v86, v87
    s_waitcnt lgkmcnt(0)
    v_mfma_f32_32x32x16_bf16 v[88:103], a[48:51], a[192:195], v[88:103]
    buffer_store_dwordx4 v[108:111], v120, s[8:11], s51 offen offset:1280
    v_mfma_f32_32x32x16_bf16 v[88:103], a[52:55], a[196:199], v[88:103]
    v_mfma_f32_32x32x16_bf16 v[88:103], a[56:59], a[200:203], v[88:103]
    v_mfma_f32_32x32x16_bf16 v[88:103], a[60:63], a[204:207], v[88:103]
    s_nop 11
    v_cvt_pk_bf16_f32 v112, v88, v89
    v_cvt_pk_bf16_f32 v113, v90, v91
    v_cvt_pk_bf16_f32 v114, v92, v93
    v_cvt_pk_bf16_f32 v115, v94, v95
    buffer_store_dwordx4 v[112:115], v120, s[8:11], s51 offen offset:1536
    v_cvt_pk_bf16_f32 v116, v96, v97
    v_cvt_pk_bf16_f32 v117, v98, v99
    v_cvt_pk_bf16_f32 v118, v100, v101
    v_cvt_pk_bf16_f32 v119, v102, v103
    buffer_store_dwordx4 v[116:119], v120, s[8:11], s51 offen offset:1792
    s_mov_b32 s64, s99
    v_mov_b32 v39, s97
    s_cmp_eq_u32 s6, 0
    s_waitcnt vmcnt(0)
    s_cbranch_scc1 LD_sf
    buffer_wbl2 sc1
    s_waitcnt vmcnt(0)
    buffer_store_dword v39, off, s[8:11], s64 offset:2048 sc0 sc1
    s_branch LD_sd
LD_sf:
    buffer_store_dword v39, off, s[8:11], s64 offset:2048
LD_sd:
LD_skip:
    v_lshlrev_b32 v40, 4, v0
    v_lshrrev_b32 v4, 4, v0
    v_lshlrev_b32 v41, 7, v4
    v_and_b32 v5, 7, v0
    v_lshl_add_u32 v41, v5, 4, v41
    v_and_b32 v6, 8, v0
    v_add_u32 v41, v41, v6
    v_mul_u32_u24 v43, 1280, v5
    v_and_b32 v7, 0xf8, v0
    v_lshl_add_u32 v42, v7, 1, v43
    v_add_u32 v43, v43, v7
    v_lshlrev_b32 v44, 2, v7
    v_add_u32 v44, 147456, v44
    v_lshlrev_b32 v45, 1, v7
    v_add_u32 v45, 147456, v45
    s_mul_i32 s68, s59, 10240
    ds_read_b128 v[132:135], v44 offset:12800
    ds_read_b128 v[136:139], v44 offset:12816
    ds_read_b128 v[140:143], v44 offset:13824
    ds_read_b128 v[144:147], v44 offset:13840
    ds_read_b128 v[148:151], v45 offset:14848
    v_min_u32 v4, 14, v1
    s_lshr_b32 s64, s5, 4
    s_lshl_b32 s64, s64, 4
    s_and_b32 s65, s5, 12
    s_add_u32 s64, s64, s65
    v_lshl_add_u32 v38, v4, 5, s64
    s_mul_i32 s69, s4, 4194304
    s_mul_i32 s70, s5, 10240
    s_add_u32 s69, s69, s70
    s_add_u32 s69, s69, 5636096
    v_lshlrev_b32 v192, 16, v240
    v_and_b32 v193, 0xffff0000, v240
    v_lshlrev_b32 v194, 16, v241
    v_and_b32 v195, 0xffff0000, v241
    v_lshlrev_b32 v196, 16, v242
    v_and_b32 v197, 0xffff0000, v242
    v_lshlrev_b32 v198, 16, v243
    v_and_b32 v199, 0xffff0000, v243
    v_lshlrev_b32 v200, 16, v244
    v_and_b32 v201, 0xffff0000, v244
    v_lshlrev_b32 v202, 16, v245
    v_and_b32 v203, 0xffff0000, v245
    v_lshlrev_b32 v204, 16, v246
    v_and_b32 v205, 0xffff0000, v246
    v_lshlrev_b32 v206, 16, v247
    v_and_b32 v207, 0xffff0000, v247
    v_lshlrev_b32 v208, 16, v248
    v_and_b32 v209, 0xffff0000, v248
    v_lshlrev_b32 v210, 16, v249
    v_and_b32 v211, 0xffff0000, v249
    s_mov_b32 s64, 0
LE_p:
    buffer_load_dword v39, v38, s[8:11], s48 offen offset:2048 sc1
    s_add_u32 s64, s64, 1
    s_waitcnt vmcnt(0)
    v_cmp_ne_u32 vcc, s97, v39
    s_nop 0
    s_cmp_eq_u64 vcc, 0
    s_cbranch_scc1 LE_pd
    s_cmp_lt_u32 s64, 200000
    s_cbranch_scc1 LE_p
LE_pd:
    s_cmp_eq_u32 s6, 0
    s_cbranch_scc1 LE_pf
    buffer_inv sc1
    s_waitcnt vmcnt(0)
LE_pf:
    s_add_u32 s70, s69, 0
    s_add_u32 s71, s69, 4096
    s_add_u32 s72, s69, 8192
    buffer_load_dwordx4 v[48:51], v40, s[8:11], s70 offen sc1
    buffer_load_dwordx4 v[52:55], v40, s[8:11], s71 offen sc1
    buffer_load_dwordx2 v[56:57], v41, s[8:11], s72 offen sc1
    s_add_u32 s70, s69, 327680
    s_add_u32 s71, s69, 331776
    s_add_u32 s72, s69, 335872
    buffer_load_dwordx4 v[58:61], v40, s[8:11], s70 offen sc1
    buffer_load_dwordx4 v[62:65], v40, s[8:11], s71 offen sc1
    buffer_load_dwordx2 v[66:67], v41, s[8:11], s72 offen sc1
    s_add_u32 s70, s69, 655360
    s_add_u32 s71, s69, 659456
    s_add_u32 s72, s69, 663552
    buffer_load_dwordx4 v[68:71], v40, s[8:11], s70 offen sc1
    buffer_load_dwordx4 v[72:75], v40, s[8:11], s71 offen sc1
    buffer_load_dwordx2 v[76:77], v41, s[8:11], s72 offen sc1
    s_waitcnt vmcnt(8)
    v_lshlrev_b32 v92, 16, v48
    v_and_b32 v93, 0xffff0000, v48
    v_lshlrev_b32 v94, 16, v49
    v_and_b32 v95, 0xffff0000, v49
    v_lshlrev_b32 v96, 16, v50
    v_and_b32 v97, 0xffff0000, v50
    v_lshlrev_b32 v98, 16, v51
    v_and_b32 v99, 0xffff0000, v51
    s_waitcnt vmcnt(7)
    v_lshlrev_b32 v100, 16, v52
    v_and_b32 v101, 0xffff0000, v52
    v_lshlrev_b32 v102, 16, v53
    v_and_b32 v103, 0xffff0000, v53
    v_lshlrev_b32 v104, 16, v54
    v_and_b32 v105, 0xffff0000, v54
    v_lshlrev_b32 v106, 16, v55
    v_and_b32 v107, 0xffff0000, v55
    s_waitcnt vmcnt(6)
    v_lshlrev_b32 v108, 16, v56
    v_and_b32 v109, 0xffff0000, v56
    v_lshlrev_b32 v110, 16, v57
    v_and_b32 v111, 0xffff0000, v57
    s_waitcnt vmcnt(5)
    v_lshlrev_b32 v112, 16, v58
    v_and_b32 v113, 0xffff0000, v58
    v_lshlrev_b32 v114, 16, v59
    v_and_b32 v115, 0xffff0000, v59
    v_lshlrev_b32 v116, 16, v60
    v_and_b32 v117, 0xffff0000, v60
    v_lshlrev_b32 v118, 16, v61
    v_and_b32 v119, 0xffff0000, v61
    s_waitcnt vmcnt(4)
    v_lshlrev_b32 v120, 16, v62
    v_and_b32 v121, 0xffff0000, v62
    v_lshlrev_b32 v122, 16, v63
    v_and_b32 v123, 0xffff0000, v63
    v_lshlrev_b32 v124, 16, v64
    v_and_b32 v125, 0xffff0000, v64
    v_lshlrev_b32 v126, 16, v65
    v_and_b32 v127, 0xffff0000, v65
    s_waitcnt vmcnt(3)
    v_lshlrev_b32 v128, 16, v66
    v_and_b32 v129, 0xffff0000, v66
    v_lshlrev_b32 v130, 16, v67
    v_and_b32 v131, 0xffff0000, v67
    v_pk_add_f32 v[92:93], v[92:93], v[112:113]
    v_pk_add_f32 v[94:95], v[94:95], v[114:115]
    v_pk_add_f32 v[96:97], v[96:97], v[116:117]
    v_pk_add_f32 v[98:99], v[98:99], v[118:119]
    v_pk_add_f32 v[100:101], v[100:101], v[120:121]
    v_pk_add_f32 v[102:103], v[102:103], v[122:123]
    v_pk_add_f32 v[104:105], v[104:105], v[124:125]
    v_pk_add_f32 v[106:107], v[106:107], v[126:127]
    v_pk_add_f32 v[108:109], v[108:109], v[128:129]
    v_pk_add_f32 v[110:111], v[110:111], v[130:131]
    s_waitcnt vmcnt(2)
    v_lshlrev_b32 v112, 16, v68
    v_and_b32 v113, 0xffff0000, v68
    v_lshlrev_b32 v114, 16, v69
    v_and_b32 v115, 0xffff0000, v69
    v_lshlrev_b32 v116, 16, v70
    v_and_b32 v117, 0xffff0000, v70
    v_lshlrev_b32 v118, 16, v71
    v_and_b32 v119, 0xffff0000, v71
    s_waitcnt vmcnt(1)
    v_lshlrev_b32 v120, 16, v72
    v_and_b32 v121, 0xffff0000, v72
    v_lshlrev_b32 v122, 16, v73
    v_and_b32 v123, 0xffff0000, v73
    v_lshlrev_b32 v124, 16, v74
    v_and_b32 v125, 0xffff0000, v74
    v_lshlrev_b32 v126, 16, v75
    v_and_b32 v127, 0xffff0000, v75
    s_waitcnt vmcnt(0)
    v_lshlrev_b32 v128, 16, v76
    v_and_b32 v129, 0xffff0000, v76
    v_lshlrev_b32 v130, 16, v77
    v_and_b32 v131, 0xffff0000, v77
    v_pk_add_f32 v[92:93], v[92:93], v[112:113]
    v_pk_add_f32 v[94:95], v[94:95], v[114:115]
    v_pk_add_f32 v[96:97], v[96:97], v[116:117]
    v_pk_add_f32 v[98:99], v[98:99], v[118:119]
    v_pk_add_f32 v[100:101], v[100:101], v[120:121]
    v_pk_add_f32 v[102:103], v[102:103], v[122:123]
    v_pk_add_f32 v[104:105], v[104:105], v[124:125]
    v_pk_add_f32 v[106:107], v[106:107], v[126:127]
    v_pk_add_f32 v[108:109], v[108:109], v[128:129]
    v_pk_add_f32 v[110:111], v[110:111], v[130:131]
    s_waitcnt lgkmcnt(4)
    v_pk_fma_f32 v[92:93], v[92:93], v[132:133], v[192:193]
    v_pk_fma_f32 v[94:95], v[94:95], v[134:135], v[194:195]
    s_waitcnt lgkmcnt(3)
    v_pk_fma_f32 v[96:97], v[96:97], v[136:137], v[196:197]
    v_pk_fma_f32 v[98:99], v[98:99], v[138:139], v[198:199]
    s_waitcnt lgkmcnt(2)
    v_pk_fma_f32 v[100:101], v[100:101], v[140:141], v[200:201]
    v_pk_fma_f32 v[102:103], v[102:103], v[142:143], v[202:203]
    s_waitcnt lgkmcnt(1)
    v_pk_fma_f32 v[104:105], v[104:105], v[144:145], v[204:205]
    v_pk_fma_f32 v[106:107], v[106:107], v[146:147], v[206:207]
    s_waitcnt lgkmcnt(0)
    v_pk_fma_f32 v[108:109], v[108:109], v[148:149], v[208:209]
    v_pk_fma_f32 v[110:111], v[110:111], v[150:151], v[210:211]
    v_cvt_pk_bf16_f32 v240, v92, v93
    v_cvt_pk_bf16_f32 v241, v94, v95
    v_cvt_pk_bf16_f32 v242, v96, v97
    v_cvt_pk_bf16_f32 v243, v98, v99
    v_cvt_pk_bf16_f32 v244, v100, v101
    v_cvt_pk_bf16_f32 v245, v102, v103
    v_cvt_pk_bf16_f32 v246, v104, v105
    v_cvt_pk_bf16_f32 v247, v106, v107
    v_cvt_pk_bf16_f32 v248, v108, v109
    v_cvt_pk_bf16_f32 v249, v110, v111
    buffer_store_dwordx4 v[240:243], v42, s[44:47], s68 offen
    buffer_store_dwordx4 v[244:247], v42, s[44:47], s68 offen offset:512
    buffer_store_dwordx2 v[248:249], v43, s[44:47], s68 offen offset:1024
    s_cmp_lg_u32 s63, 0
    s_cbranch_scc1 L_noep
    v_mov_b32 v4, s97
    s_mov_b32 s64, 49152
    buffer_store_dword v4, off, s[8:11], s64
L_noep:
L_end:
    s_endpgm
LB3_spin:
    s_mov_b32 s64, 0
LB3_p:
    buffer_load_dword v39, v38, s[8:11], s48 offen offset:2560 sc1
    s_add_u32 s64, s64, 1
    s_waitcnt vmcnt(0)
    v_cmp_ne_u32 vcc, s97, v39
    s_nop 1
    s_cmp_eq_u64 vcc, 0
    s_cbranch_scc1 LB3_back
    s_cmp_lt_u32 s64, 200000
    s_cbranch_scc1 LB3_p
    s_branch LB3_back
LD3_spin:
    s_mov_b32 s64, 0
LD3_p:
    buffer_load_dword v39, v38, s[8:11], s48 offen offset:3072 sc1
    s_add_u32 s64, s64, 1
    s_waitcnt vmcnt(0)
    v_cmp_ne_u32 vcc, s97, v39
    s_nop 1
    s_cmp_eq_u64 vcc, 0
    s_cbranch_scc1 LD3_back
    s_cmp_lt_u32 s64, 200000
    s_cbranch_scc1 LD3_p
    s_branch LD3_back
LA_fallback:
    s_mov_b32 s7, 1
    s_mov_b32 s72, 0
    s_waitcnt vmcnt(0)
LA_fb_loop:
    s_barrier
    s_add_u32 m0, s49, 32768
    s_add_u32 s62, s50, s72
    buffer_load_dwordx4 v32, s[16:19], s62 offen offset:0 lds
    buffer_load_dwordx4 v33, s[16:19], s62 offen offset:1024 lds
    buffer_load_dwordx4 v34, s[16:19], s62 offen offset:2048 lds
    buffer_load_dwordx4 v35, s[16:19], s62 offen offset:3072 lds
    s_waitcnt vmcnt(0)
    s_barrier
    ds_read_b128 a[160:163], v40 offset:32768
    ds_read_b128 a[164:167], v41 offset:32768
    ds_read_b128 a[168:171], v42 offset:32768
    ds_read_b128 a[172:175], v43 offset:32768
    ds_read_b128 a[176:179], v44 offset:32768
    ds_read_b128 a[180:183], v45 offset:32768
    ds_read_b128 a[184:187], v46 offset:32768
    ds_read_b128 a[188:191], v47 offset:32768
    s_waitcnt lgkmcnt(7)
    v_mfma_f32_32x32x16_bf16 v[124:139], a[160:163], v[92:95], 0
    s_waitcnt lgkmcnt(6)
    v_mfma_f32_32x32x16_bf16 v[124:139], a[164:167], v[96:99], v[124:139]
    s_waitcnt lgkmcnt(5)
    v_mfma_f32_32x32x16_bf16 v[124:139], a[168:171], v[100:103], v[124:139]
    s_waitcnt lgkmcnt(4)
    v_mfma_f32_32x32x16_bf16 v[124:139], a[172:175], v[104:107], v[124:139]
    s_waitcnt lgkmcnt(3)
    v_mfma_f32_32x32x16_bf16 v[124:139], a[176:179], v[108:111], v[124:139]
    s_waitcnt lgkmcnt(2)
    v_mfma_f32_32x32x16_bf16 v[124:139], a[180:183], v[112:115], v[124:139]
    s_waitcnt lgkmcnt(1)
    v_mfma_f32_32x32x16_bf16 v[124:139], a[184:187], v[116:119], v[124:139]
    s_waitcnt lgkmcnt(0)
    v_mfma_f32_32x32x16_bf16 v[124:139], a[188:191], v[120:123], v[124:139]
    v_mfma_f32_32x32x16_bf16 v[140:155], a[160:163], v[60:63], 0
    v_mfma_f32_32x32x16_bf16 v[140:155], a[164:167], v[64:67], v[140:155]
    v_mfma_f32_32x32x16_bf16 v[140:155], a[168:171], v[68:71], v[140:155]
    v_mfma_f32_32x32x16_bf16 v[140:155], a[172:175], v[72:75], v[140:155]
    v_mfma_f32_32x32x16_bf16 v[140:155], a[176:179], v[76:79], v[140:155]
    v_mfma_f32_32x32x16_bf16 v[140:155], a[180:183], v[80:83], v[140:155]
    v_mfma_f32_32x32x16_bf16 v[140:155], a[184:187], v[84:87], v[140:155]
    v_mfma_f32_32x32x16_bf16 v[140:155], a[188:191], v[88:91], v[140:155]
    s_nop 3
    v_max3_f32 v224, v224, v124, v125
    v_max3_f32 v224, v224, v126, v127
    v_max3_f32 v224, v224, v128, v129
    v_max3_f32 v224, v224, v130, v131
    v_max3_f32 v224, v224, v132, v133
    v_max3_f32 v224, v224, v134, v135
    v_max3_f32 v224, v224, v136, v137
    v_max3_f32 v224, v224, v138, v139
    v_max3_f32 v225, v225, v140, v141
    v_max3_f32 v225, v225, v142, v143
    v_max3_f32 v225, v225, v144, v145
    v_max3_f32 v225, v225, v146, v147
    v_max3_f32 v225, v225, v148, v149
    v_max3_f32 v225, v225, v150, v151
    v_max3_f32 v225, v225, v152, v153
    v_max3_f32 v225, v225, v154, v155
    ds_read_b128 a[128:131], v40 offset:40960
    ds_read_b128 a[132:135], v41 offset:40960
    ds_read_b128 a[136:139], v42 offset:40960
    ds_read_b128 a[140:143], v43 offset:40960
    ds_read_b128 a[144:147], v44 offset:40960
    ds_read_b128 a[148:151], v45 offset:40960
    ds_read_b128 a[152:155], v46 offset:40960
    ds_read_b128 a[156:159], v47 offset:40960
    s_waitcnt lgkmcnt(7)
    v_mfma_f32_32x32x16_bf16 v[124:139], a[128:131], v[92:95], 0
    s_waitcnt lgkmcnt(6)
    v_mfma_f32_32x32x16_bf16 v[124:139], a[132:135], v[96:99], v[124:139]
    s_waitcnt lgkmcnt(5)
    v_mfma_f32_32x32x16_bf16 v[124:139], a[136:139], v[100:103], v[124:139]
    s_waitcnt lgkmcnt(4)
    v_mfma_f32_32x32x16_bf16 v[124:139], a[140:143], v[104:107], v[124:139]
    s_waitcnt lgkmcnt(3)
    v_mfma_f32_32x32x16_bf16 v[124:139], a[144:147], v[108:111], v[124:139]
    s_waitcnt lgkmcnt(2)
    v_mfma_f32_32x32x16_bf16 v[124:139], a[148:151], v[112:115], v[124:139]
    s_waitcnt lgkmcnt(1)
    v_mfma_f32_32x32x16_bf16 v[124:139], a[152:155], v[116:119], v[124:139]
    s_waitcnt lgkmcnt(0)
    v_mfma_f32_32x32x16_bf16 v[124:139], a[156:159], v[120:123], v[124:139]
    v_mfma_f32_32x32x16_bf16 v[140:155], a[128:131], v[60:63], 0
    v_mfma_f32_32x32x16_bf16 v[140:155], a[132:135], v[64:67], v[140:155]
    v_mfma_f32_32x32x16_bf16 v[140:155], a[136:139], v[68:71], v[140:155]
    v_mfma_f32_32x32x16_bf16 v[140:155], a[140:143], v[72:75], v[140:155]
    v_mfma_f32_32x32x16_bf16 v[140:155], a[144:147], v[76:79], v[140:155]
    v_mfma_f32_32x32x16_bf16 v[140:155], a[148:151], v[80:83], v[140:155]
    v_mfma_f32_32x32x16_bf16 v[140:155], a[152:155], v[84:87], v[140:155]
    v_mfma_f32_32x32x16_bf16 v[140:155], a[156:159], v[88:91], v[140:155]
    s_nop 3
    v_max3_f32 v224, v224, v124, v125
    v_max3_f32 v224, v224, v126, v127
    v_max3_f32 v224, v224, v128, v129
    v_max3_f32 v224, v224, v130, v131
    v_max3_f32 v224, v224, v132, v133
    v_max3_f32 v224, v224, v134, v135
    v_max3_f32 v224, v224, v136, v137
    v_max3_f32 v224, v224, v138, v139
    v_max3_f32 v225, v225, v140, v141
    v_max3_f32 v225, v225, v142, v143
    v_max3_f32 v225, v225, v144, v145
    v_max3_f32 v225, v225, v146, v147
    v_max3_f32 v225, v225, v148, v149
    v_max3_f32 v225, v225, v150, v151
    v_max3_f32 v225, v225, v152, v153
    v_max3_f32 v225, v225, v154, v155
    s_add_u32 s72, s72, 16384
    s_cmp_lt_u32 s72, 131072
    s_cbranch_scc1 LA_fb_loop
    s_barrier
    s_add_u32 m0, s49, 32768
    s_add_u32 s62, s50, 0
    buffer_load_dwordx4 v32, s[16:19], s62 offen offset:0 lds
    buffer_load_dwordx4 v33, s[16:19], s62 offen offset:1024 lds
    buffer_load_dwordx4 v34, s[16:19], s62 offen offset:2048 lds
    buffer_load_dwordx4 v35, s[16:19], s62 offen offset:3072 lds
    s_add_u32 m0, s49, 49152
    s_add_u32 s62, s50, 0
    buffer_load_dwordx4 v32, s[20:23], s62 offen offset:0 lds
    buffer_load_dwordx4 v33, s[20:23], s62 offen offset:1024 lds
    buffer_load_dwordx4 v34, s[20:23], s62 offen offset:2048 lds
    buffer_load_dwordx4 v35, s[20:23], s62 offen offset:3072 lds
    s_add_u32 m0, s49, 65536
    s_add_u32 s62, s50, 16384
    buffer_load_dwordx4 v32, s[16:19], s62 offen offset:0 lds
    buffer_load_dwordx4 v33, s[16:19], s62 offen offset:1024 lds
    buffer_load_dwordx4 v34, s[16:19], s62 offen offset:2048 lds
    buffer_load_dwordx4 v35, s[16:19], s62 offen offset:3072 lds
    s_add_u32 m0, s49, 81920
    s_add_u32 s62, s50, 16384
    buffer_load_dwordx4 v32, s[20:23], s62 offen offset:0 lds
    buffer_load_dwordx4 v33, s[20:23], s62 offen offset:1024 lds
    buffer_load_dwordx4 v34, s[20:23], s62 offen offset:2048 lds
    buffer_load_dwordx4 v35, s[20:23], s62 offen offset:3072 lds
    s_waitcnt vmcnt(8)
    s_barrier
    ds_read_b128 a[160:163], v40 offset:32768
    ds_read_b128 a[164:167], v41 offset:32768
    ds_read_b128 a[168:171], v42 offset:32768
    ds_read_b128 a[172:175], v43 offset:32768
    ds_read_b128 a[176:179], v44 offset:32768
    ds_read_b128 a[180:183], v45 offset:32768
    ds_read_b128 a[184:187], v46 offset:32768
    ds_read_b128 a[188:191], v47 offset:32768
    ds_read_b64_tr_b16 a[192:193], v12 offset:49152
    ds_read_b64_tr_b16 a[194:195], v13 offset:49152
    ds_read_b64_tr_b16 a[196:197], v14 offset:49152
    ds_read_b64_tr_b16 a[198:199], v15 offset:49152
    ds_read_b64_tr_b16 a[200:201], v16 offset:49152
    ds_read_b64_tr_b16 a[202:203], v17 offset:49152
    ds_read_b64_tr_b16 a[204:205], v18 offset:49152
    ds_read_b64_tr_b16 a[206:207], v19 offset:49152
    ds_read_b64_tr_b16 a[208:209], v12 offset:53248
    ds_read_b64_tr_b16 a[210:211], v13 offset:53248
    ds_read_b64_tr_b16 a[212:213], v14 offset:53248
    ds_read_b64_tr_b16 a[214:215], v15 offset:53248
    ds_read_b64_tr_b16 a[216:217], v16 offset:53248
    ds_read_b64_tr_b16 a[218:219], v17 offset:53248
    ds_read_b64_tr_b16 a[220:221], v18 offset:53248
    ds_read_b64_tr_b16 a[222:223], v19 offset:53248
    s_waitcnt lgkmcnt(15)
    v_mfma_f32_32x32x16_bf16 v[124:139], a[160:163], v[92:95], 0
    v_mfma_f32_32x32x16_bf16 v[124:139], a[164:167], v[96:99], v[124:139]
    v_mfma_f32_32x32x16_bf16 v[124:139], a[168:171], v[100:103], v[124:139]
    v_mfma_f32_32x32x16_bf16 v[124:139], a[172:175], v[104:107], v[124:139]
    v_mfma_f32_32x32x16_bf16 v[124:139], a[176:179], v[108:111], v[124:139]
    v_mfma_f32_32x32x16_bf16 v[124:139], a[180:183], v[112:115], v[124:139]
    v_mfma_f32_32x32x16_bf16 v[124:139], a[184:187], v[116:119], v[124:139]
    v_mfma_f32_32x32x16_bf16 v[124:139], a[188:191], v[120:123], v[124:139]
    s_nop 15
    s_branch LA_att
L_code_end:
.section .rodata,"a"
.p2align 6
.amdhsa_kernel adaLN_cond__sliding_block_cached__glu_gated_bilinear__prompt_kernel
  .amdhsa_next_free_vgpr 512
  .amdhsa_next_free_sgpr 102
  .amdhsa_accum_offset 256
  .amdhsa_group_segment_fixed_size 0
  .amdhsa_kernarg_size 112
  .amdhsa_user_sgpr_count 2
  .amdhsa_user_sgpr_kernarg_segment_ptr 1
  .amdhsa_system_sgpr_workgroup_id_x 1
  .amdhsa_float_denorm_mode_32 3
  .amdhsa_float_denorm_mode_16_64 3
.end_amdhsa_kernel
```
